```python
import torch

def _softmax(x, axis=-1):
    return torch.softmax(x, dim=axis)
def _gelu(x):
    return torch.nn.functional.gelu(x, approximate="tanh")
def _silu(x):
    return torch.nn.functional.silu(x)
def _sigmoid(x):
    return torch.sigmoid(x)
def _layernorm(x, axis=-1, eps=1e-5):
    m = x.mean(dim=axis, keepdim=True)
    v = x.var(dim=axis, keepdim=True, unbiased=False)
    return (x - m) / torch.sqrt(v + eps)
def _scatter_add(tgt, idx, src, axis=0):
    return tgt.clone().index_add_(axis, idx, src)
def _segment_sum(src, seg, n):
    out = torch.zeros((n,) + src.shape[1:], dtype=src.dtype)
    return out.index_add_(0, seg, src)
def _pad(x, pw):
    flat = tuple(v for pair in reversed(pw) for v in pair)
    return torch.nn.functional.pad(x, flat)

kernel_name = 'sequential_preLN__compressed_kv_cla__swiglu_ffn__prompt'

def setup_inputs():

    _w = (lambda a: (lambda t: t.to(torch.bfloat16) if t.is_floating_point() else t)(torch.as_tensor(a)))
    def _A_setup():
        B, H, Sq, Sk, D, M = 1, 32, 2048, 2048, 128, 576
        Dc = 4 * D
        return {
            "x": _w((lambda *s: torch.randn(*s, dtype=torch.bfloat16) * 0.05)(B, Sq, M)),
            "c_kv": _w((lambda *s: torch.randn(*s, dtype=torch.bfloat16) * 0.4)(B, Sk, Dc)),
            "w_q": _w((lambda *s: torch.randn(*s, dtype=torch.bfloat16) * 1.6)(M, H, D) * (M ** -0.5)),
            "w_uk": _w((lambda *s: torch.randn(*s, dtype=torch.bfloat16) * 1.6)(Dc, H, D) * (Dc ** -0.5)),
            "w_uv": _w((lambda *s: torch.randn(*s, dtype=torch.bfloat16) * 0.4)(Dc, H, D) * (Dc ** -0.5)),
            "w_o": _w((lambda *s: torch.randn(*s, dtype=torch.bfloat16) * 0.4)(H, D, M) * ((H * D) ** -0.5)),
        }
    _A_in = _A_setup()

    def _B_setup():
        B, S, D, F = 1, 2048, 576, 4608
        return {
            "x": _w((lambda *s: torch.randn(*s, dtype=torch.bfloat16) * 0.05)(B, S, D)),
            "w_gate": _w((lambda *s: torch.randn(*s, dtype=torch.bfloat16) * 0.05)(D, F)),
            "w_up": _w((lambda *s: torch.randn(*s, dtype=torch.bfloat16) * 0.05)(D, F)),
            "w_down": _w((lambda *s: torch.randn(*s, dtype=torch.bfloat16) * 0.05)(F, D)),
        }
    _B_in = _B_setup()

    return {
        "A_x": _A_in["x"],
        "A_c_kv": _A_in["c_kv"],
        "A_w_q": _A_in["w_q"],
        "A_w_uk": _A_in["w_uk"],
        "A_w_uv": _A_in["w_uv"],
        "A_w_o": _A_in["w_o"],
        "B_x": _B_in["x"],
        "B_w_gate": _B_in["w_gate"],
        "B_w_up": _B_in["w_up"],
        "B_w_down": _B_in["w_down"],
    }

def reference(A_x, A_c_kv, A_w_q, A_w_uk, A_w_uv, A_w_o, B_x, B_w_gate, B_w_up, B_w_down):
    def _A_ref(x, c_kv, w_q, w_uk, w_uv, w_o):
        B, Sq, M = x.shape[0], x.shape[1], x.shape[2]
        Sk = c_kv.shape[1]
        H, D = w_q.shape[1], w_q.shape[2]
        q = torch.einsum("bqm,mhd->bhqd", x, w_q)
        k = torch.einsum("bkc,chd->bhkd", c_kv, w_uk)
        v = torch.einsum("bkc,chd->bhkd", c_kv, w_uv)
        scores = torch.einsum("bhqd,bhkd->bhqk", q, k) * (D ** -0.5)
        off = Sk - Sq
        qi = torch.arange(Sq)[:, None]
        kj = torch.arange(Sk)[None, :]
        cmask = kj <= (qi + off)
        scores = torch.where(cmask[None, None], scores, -1e9)
        p = _softmax(scores, axis=-1)
        ctx = torch.einsum("bhqk,bhkd->bhqd", p, v)
        return torch.einsum("bhqd,hdm->bqm", ctx, w_o)

    def _B_ref(x, w_gate, w_up, w_down):
        g = _silu(x @ w_gate)
        u = x @ w_up
        return (g * u) @ w_down

    x = A_x
    h = x + _A_ref(_layernorm(x, axis=-1), A_c_kv, A_w_q, A_w_uk, A_w_uv, A_w_o)
    h2 = h + _B_ref(_layernorm(h, axis=-1), B_w_gate, B_w_up, B_w_down)
    return h2
```

```asm
; @launch kernel=k1_kv_kernel grid=(256,1,1) block=(512,1,1) lds=163840
; @launch kernel=k2_attn_kernel grid=(256,1,1) block=(512,1,1) lds=163840
; @launch kernel=k3_outproj_kernel grid=(256,1,1) block=(256,1,1) lds=88064
; @launch kernel=k4_up_kernel grid=(256,1,1) block=(512,1,1) lds=139264
; @launch kernel=k5_down_kernel grid=(256,1,1) block=(256,1,1) lds=88064
.amdgcn_target "amdgcn-amd-amdhsa--gfx950"
.text
.globl k1_kv_kernel
.p2align 8
.type k1_kv_kernel,@function
k1_kv_kernel:
    s_cmp_ge_u32 s2, 256
    s_cbranch_scc1 L_k1_kv_kernel_done_1
    s_load_dwordx2 s[32:33], s[0:1], 96
    s_load_dwordx2 s[34:35], s[0:1], 8
    s_load_dwordx2 s[36:37], s[0:1], 24
    s_load_dwordx2 s[38:39], s[0:1], 32
    s_load_dwordx2 s[40:41], s[0:1], 0
    s_load_dwordx2 s[84:85], s[0:1], 16
    s_load_dwordx2 s[86:87], s[0:1], 40
    s_load_dwordx4 s[88:91], s[0:1], 56
    s_load_dwordx2 s[92:93], s[0:1], 72
    v_lshrrev_b32 v8, 6, v0
    v_and_b32 v1, 63, v0
    v_readfirstlane_b32 s44, v8
    s_and_b32 s42, s2, 1
    s_lshl_b32 s42, s42, 2
    s_lshr_b32 s47, s2, 3
    s_and_b32 s48, s47, 3
    s_add_u32 s42, s42, s48
    s_bfe_u32 s43, s2, 0x20001
    s_lshl_b32 s43, s43, 3
    s_lshr_b32 s47, s47, 2
    s_add_u32 s43, s43, s47
    s_and_b32 s45, s44, 1
    s_lshr_b32 s46, s44, 1
    v_lshrrev_b32 v8, 3, v1
    v_and_b32 v9, 7, v1
    v_xor_b32 v9, v9, v8
    v_lshlrev_b32 v8, 10, v8
    v_lshl_add_u32 v2, v9, 4, v8
    v_add_u32 v3, 7168, v2
    s_lshl_b32 s49, s42, 18
    s_lshl_b32 s47, s44, 14
    s_add_u32 s49, s49, s47
    s_lshl_b32 s51, s44, 11
    v_lshrrev_b32 v8, 4, v1
    s_and_b32 s47, s44, 1
    s_lshl_b32 s47, s47, 2
    v_or_b32 v9, s47, v8
    v_bfe_u32 v10, v1, 1, 3
    v_xor_b32 v9, v9, v10
    v_lshlrev_b32 v8, 13, v8
    v_lshl_add_u32 v8, v9, 5, v8
    v_and_b32 v9, 1, v1
    v_lshl_add_u32 v4, v9, 4, v8
    v_add_u32 v5, 31744, v4
    s_and_b32 s50, s44, 3
    s_lshl_b32 s50, s50, 16
    s_lshl_b32 s47, s43, 8
    s_add_u32 s50, s50, s47
    s_add_u32 s52, s51, 98304
    s_waitcnt lgkmcnt(0)
    s_mov_b32 s8, s34
    s_mov_b32 s9, s35
    s_mov_b32 s10, 2097152
    s_mov_b32 s11, 0x00020000
    s_cmp_ge_u32 s44, 4
    s_cselect_b32 s24, s38, s36
    s_cselect_b32 s25, s39, s37
    s_mov_b32 s26, 4194304
    s_mov_b32 s27, 0x00020000
    s_add_u32 m0, s51, 0
    s_add_u32 s47, s49, 0
    buffer_load_dwordx4 v2, s[8:11], s47 offen lds
    buffer_load_dwordx4 v3, s[8:11], s47 offen offset:1024 lds
    s_add_u32 m0, s51, 16384
    s_add_u32 s47, s49, 131072
    buffer_load_dwordx4 v2, s[8:11], s47 offen lds
    buffer_load_dwordx4 v3, s[8:11], s47 offen offset:1024 lds
    s_add_u32 m0, s52, 0
    s_nop 0
    buffer_load_dwordx4 v4, s[24:27], s50 offen lds
    buffer_load_dwordx4 v5, s[24:27], s50 offen offset:1024 lds
    s_add_u32 s50, s50, 262144
    s_add_u32 s20, s32, 16777216
    s_addc_u32 s21, s33, 0
    s_mov_b32 s22, 33554432
    s_mov_b32 s23, 0x00020000
    v_and_b32 v8, 15, v1
    v_lshrrev_b32 v9, 4, v1
    v_and_b32 v10, 7, v1
    v_xor_b32 v9, v9, v10
    v_lshlrev_b32 v8, 7, v8
    v_lshl_add_u32 v6, v9, 4, v8
    s_lshl_b32 s47, s45, 14
    v_add_u32 v6, s47, v6
    v_xor_b32 v7, 64, v6
    v_add_u32 v14, 65536, v6
    v_add_u32 v15, 65536, v7
    v_lshrrev_b32 v8, 4, v1
    v_bfe_u32 v9, v1, 2, 2
    v_lshl_add_u32 v10, v8, 3, v9
    v_and_b32 v8, 1, v8
    v_lshl_or_b32 v8, v8, 2, v9
    s_and_b32 s47, s46, 1
    s_lshl_b32 s47, s47, 2
    v_xor_b32 v8, s47, v8
    v_lshlrev_b32 v10, 8, v10
    v_and_b32 v9, 3, v1
    v_lshl_add_u32 v10, v9, 3, v10
    s_lshr_b32 s47, s46, 1
    s_lshl_b32 s47, s47, 13
    s_add_u32 s47, s47, 98304
    v_add_u32 v10, s47, v10
    v_xor_b32 v9, 0, v8
    v_lshl_add_u32 v16, v9, 5, v10
    v_xor_b32 v9, 1, v8
    v_lshl_add_u32 v17, v9, 5, v10
    v_xor_b32 v9, 2, v8
    v_lshl_add_u32 v18, v9, 5, v10
    v_xor_b32 v9, 3, v8
    v_lshl_add_u32 v19, v9, 5, v10
    s_waitcnt vmcnt(0)
    s_barrier
    s_cmp_ge_u32 s44, 4
    s_cbranch_scc1 L_k1_kv_kernel_vwave_2
    ds_read_b64_tr_b16 v[20:21], v16 offset:0
    ds_read_b64_tr_b16 v[22:23], v16 offset:1024
    ds_read_b64_tr_b16 v[24:25], v17 offset:0
    ds_read_b64_tr_b16 v[26:27], v17 offset:1024
    ds_read_b64_tr_b16 v[28:29], v18 offset:0
    ds_read_b64_tr_b16 v[30:31], v18 offset:1024
    ds_read_b64_tr_b16 v[32:33], v19 offset:0
    ds_read_b64_tr_b16 v[34:35], v19 offset:1024
    ds_read_b128 v[52:55], v6 offset:0
    ds_read_b128 v[56:59], v6 offset:2048
    ds_read_b128 v[60:63], v6 offset:4096
    s_waitcnt lgkmcnt(2)
    v_mfma_f32_16x16x32_bf16 v[68:71], v[20:23], v[52:55], 0
    ds_read_b128 v[64:67], v6 offset:6144
    v_mfma_f32_16x16x32_bf16 v[72:75], v[24:27], v[52:55], 0
    v_mfma_f32_16x16x32_bf16 v[76:79], v[28:31], v[52:55], 0
    v_mfma_f32_16x16x32_bf16 v[80:83], v[32:35], v[52:55], 0
    s_add_u32 m0, s52, 16384
    s_nop 0
    buffer_load_dwordx4 v4, s[24:27], s50 offen lds
    buffer_load_dwordx4 v5, s[24:27], s50 offen offset:1024 lds
    s_add_u32 s50, s50, 262144
    s_waitcnt lgkmcnt(2)
    v_mfma_f32_16x16x32_bf16 v[84:87], v[20:23], v[56:59], 0
    ds_read_b128 v[52:55], v6 offset:8192
    v_mfma_f32_16x16x32_bf16 v[88:91], v[24:27], v[56:59], 0
    v_mfma_f32_16x16x32_bf16 v[92:95], v[28:31], v[56:59], 0
    v_mfma_f32_16x16x32_bf16 v[96:99], v[32:35], v[56:59], 0
    s_add_u32 m0, s51, 32768
    s_add_u32 s47, s49, 128
    buffer_load_dwordx4 v2, s[8:11], s47 offen lds
    buffer_load_dwordx4 v3, s[8:11], s47 offen offset:1024 lds
    s_waitcnt lgkmcnt(2)
    v_mfma_f32_16x16x32_bf16 v[100:103], v[20:23], v[60:63], 0
    ds_read_b128 v[56:59], v6 offset:10240
    v_mfma_f32_16x16x32_bf16 v[104:107], v[24:27], v[60:63], 0
    s_add_u32 m0, s51, 49152
    s_add_u32 s47, s49, 131200
    buffer_load_dwordx4 v2, s[8:11], s47 offen lds
    buffer_load_dwordx4 v3, s[8:11], s47 offen offset:1024 lds
    v_mfma_f32_16x16x32_bf16 v[108:111], v[28:31], v[60:63], 0
    v_mfma_f32_16x16x32_bf16 v[112:115], v[32:35], v[60:63], 0
    s_add_u32 m0, s52, 32768
    s_nop 0
    buffer_load_dwordx4 v4, s[24:27], s50 offen lds
    buffer_load_dwordx4 v5, s[24:27], s50 offen offset:1024 lds
    s_add_u32 s50, s50, 262144
    s_add_u32 m0, s52, 49152
    s_nop 0
    buffer_load_dwordx4 v4, s[24:27], s50 offen lds
    buffer_load_dwordx4 v5, s[24:27], s50 offen offset:1024 lds
    s_add_u32 s50, s50, 262144
    s_waitcnt vmcnt(8)
    s_barrier
    s_add_u32 m0, s52, 0
    s_nop 0
    buffer_load_dwordx4 v4, s[24:27], s50 offen lds
    buffer_load_dwordx4 v5, s[24:27], s50 offen offset:1024 lds
    s_add_u32 s50, s50, 262144
    s_add_u32 m0, s51, 65536
    s_add_u32 s47, s49, 256
    buffer_load_dwordx4 v2, s[8:11], s47 offen lds
    buffer_load_dwordx4 v3, s[8:11], s47 offen offset:1024 lds
    s_waitcnt lgkmcnt(2)
    v_mfma_f32_16x16x32_bf16 v[116:119], v[20:23], v[64:67], 0
    ds_read_b128 v[60:63], v6 offset:12288
    v_mfma_f32_16x16x32_bf16 v[120:123], v[24:27], v[64:67], 0
    v_mfma_f32_16x16x32_bf16 v[124:127], v[28:31], v[64:67], 0
    v_mfma_f32_16x16x32_bf16 v[128:131], v[32:35], v[64:67], 0
    s_waitcnt lgkmcnt(2)
    v_mfma_f32_16x16x32_bf16 v[132:135], v[20:23], v[52:55], 0
    ds_read_b128 v[64:67], v6 offset:14336
    v_mfma_f32_16x16x32_bf16 v[136:139], v[24:27], v[52:55], 0
    v_mfma_f32_16x16x32_bf16 v[140:143], v[28:31], v[52:55], 0
    ds_read_b64_tr_b16 v[36:37], v16 offset:16384
    ds_read_b64_tr_b16 v[38:39], v16 offset:17408
    v_mfma_f32_16x16x32_bf16 v[144:147], v[32:35], v[52:55], 0
    s_waitcnt lgkmcnt(4)
    v_mfma_f32_16x16x32_bf16 v[148:151], v[20:23], v[56:59], 0
    ds_read_b128 v[52:55], v7 offset:0
    v_mfma_f32_16x16x32_bf16 v[152:155], v[24:27], v[56:59], 0
    v_mfma_f32_16x16x32_bf16 v[156:159], v[28:31], v[56:59], 0
    ds_read_b64_tr_b16 v[40:41], v17 offset:16384
    ds_read_b64_tr_b16 v[42:43], v17 offset:17408
    v_mfma_f32_16x16x32_bf16 v[160:163], v[32:35], v[56:59], 0
    s_waitcnt lgkmcnt(6)
    v_mfma_f32_16x16x32_bf16 v[164:167], v[20:23], v[60:63], 0
    ds_read_b128 v[56:59], v7 offset:2048
    v_mfma_f32_16x16x32_bf16 v[168:171], v[24:27], v[60:63], 0
    v_mfma_f32_16x16x32_bf16 v[172:175], v[28:31], v[60:63], 0
    ds_read_b64_tr_b16 v[44:45], v18 offset:16384
    ds_read_b64_tr_b16 v[46:47], v18 offset:17408
    v_mfma_f32_16x16x32_bf16 v[176:179], v[32:35], v[60:63], 0
    s_waitcnt lgkmcnt(8)
    v_mfma_f32_16x16x32_bf16 v[180:183], v[20:23], v[64:67], 0
    ds_read_b128 v[60:63], v7 offset:4096
    v_mfma_f32_16x16x32_bf16 v[184:187], v[24:27], v[64:67], 0
    v_mfma_f32_16x16x32_bf16 v[188:191], v[28:31], v[64:67], 0
    ds_read_b64_tr_b16 v[48:49], v19 offset:16384
    ds_read_b64_tr_b16 v[50:51], v19 offset:17408
    v_mfma_f32_16x16x32_bf16 v[192:195], v[32:35], v[64:67], 0
    s_waitcnt lgkmcnt(8)
    v_mfma_f32_16x16x32_bf16 v[68:71], v[36:39], v[52:55], v[68:71]
    ds_read_b128 v[64:67], v7 offset:6144
    s_waitcnt lgkmcnt(7)
    v_mfma_f32_16x16x32_bf16 v[72:75], v[40:43], v[52:55], v[72:75]
    s_waitcnt lgkmcnt(4)
    v_mfma_f32_16x16x32_bf16 v[76:79], v[44:47], v[52:55], v[76:79]
    s_waitcnt lgkmcnt(1)
    v_mfma_f32_16x16x32_bf16 v[80:83], v[48:51], v[52:55], v[80:83]
    v_mfma_f32_16x16x32_bf16 v[84:87], v[36:39], v[56:59], v[84:87]
    ds_read_b128 v[52:55], v7 offset:8192
    v_mfma_f32_16x16x32_bf16 v[88:91], v[40:43], v[56:59], v[88:91]
    v_mfma_f32_16x16x32_bf16 v[92:95], v[44:47], v[56:59], v[92:95]
    v_mfma_f32_16x16x32_bf16 v[96:99], v[48:51], v[56:59], v[96:99]
    v_mfma_f32_16x16x32_bf16 v[100:103], v[36:39], v[60:63], v[100:103]
    ds_read_b128 v[56:59], v7 offset:10240
    v_mfma_f32_16x16x32_bf16 v[104:107], v[40:43], v[60:63], v[104:107]
    v_mfma_f32_16x16x32_bf16 v[108:111], v[44:47], v[60:63], v[108:111]
    v_mfma_f32_16x16x32_bf16 v[112:115], v[48:51], v[60:63], v[112:115]
    s_waitcnt vmcnt(6)
    s_barrier
    s_add_u32 m0, s52, 16384
    s_nop 0
    buffer_load_dwordx4 v4, s[24:27], s50 offen lds
    buffer_load_dwordx4 v5, s[24:27], s50 offen offset:1024 lds
    s_add_u32 s50, s50, 262144
    s_add_u32 m0, s51, 81920
    s_add_u32 s47, s49, 131328
    buffer_load_dwordx4 v2, s[8:11], s47 offen lds
    buffer_load_dwordx4 v3, s[8:11], s47 offen offset:1024 lds
    s_waitcnt lgkmcnt(2)
    v_mfma_f32_16x16x32_bf16 v[116:119], v[36:39], v[64:67], v[116:119]
    ds_read_b128 v[60:63], v7 offset:12288
    v_mfma_f32_16x16x32_bf16 v[120:123], v[40:43], v[64:67], v[120:123]
    v_mfma_f32_16x16x32_bf16 v[124:127], v[44:47], v[64:67], v[124:127]
    v_mfma_f32_16x16x32_bf16 v[128:131], v[48:51], v[64:67], v[128:131]
    s_waitcnt lgkmcnt(2)
    v_mfma_f32_16x16x32_bf16 v[132:135], v[36:39], v[52:55], v[132:135]
    ds_read_b128 v[64:67], v7 offset:14336
    v_mfma_f32_16x16x32_bf16 v[136:139], v[40:43], v[52:55], v[136:139]
    v_mfma_f32_16x16x32_bf16 v[140:143], v[44:47], v[52:55], v[140:143]
    ds_read_b64_tr_b16 v[20:21], v16 offset:32768
    ds_read_b64_tr_b16 v[22:23], v16 offset:33792
    v_mfma_f32_16x16x32_bf16 v[144:147], v[48:51], v[52:55], v[144:147]
    s_waitcnt lgkmcnt(4)
    v_mfma_f32_16x16x32_bf16 v[148:151], v[36:39], v[56:59], v[148:151]
    ds_read_b128 v[52:55], v6 offset:32768
    v_mfma_f32_16x16x32_bf16 v[152:155], v[40:43], v[56:59], v[152:155]
    v_mfma_f32_16x16x32_bf16 v[156:159], v[44:47], v[56:59], v[156:159]
    ds_read_b64_tr_b16 v[24:25], v17 offset:32768
    ds_read_b64_tr_b16 v[26:27], v17 offset:33792
    v_mfma_f32_16x16x32_bf16 v[160:163], v[48:51], v[56:59], v[160:163]
    s_waitcnt lgkmcnt(6)
    v_mfma_f32_16x16x32_bf16 v[164:167], v[36:39], v[60:63], v[164:167]
    ds_read_b128 v[56:59], v6 offset:34816
    v_mfma_f32_16x16x32_bf16 v[168:171], v[40:43], v[60:63], v[168:171]
    v_mfma_f32_16x16x32_bf16 v[172:175], v[44:47], v[60:63], v[172:175]
    ds_read_b64_tr_b16 v[28:29], v18 offset:32768
    ds_read_b64_tr_b16 v[30:31], v18 offset:33792
    v_mfma_f32_16x16x32_bf16 v[176:179], v[48:51], v[60:63], v[176:179]
    s_waitcnt lgkmcnt(8)
    v_mfma_f32_16x16x32_bf16 v[180:183], v[36:39], v[64:67], v[180:183]
    ds_read_b128 v[60:63], v6 offset:36864
    v_mfma_f32_16x16x32_bf16 v[184:187], v[40:43], v[64:67], v[184:187]
    v_mfma_f32_16x16x32_bf16 v[188:191], v[44:47], v[64:67], v[188:191]
    ds_read_b64_tr_b16 v[32:33], v19 offset:32768
    ds_read_b64_tr_b16 v[34:35], v19 offset:33792
    v_mfma_f32_16x16x32_bf16 v[192:195], v[48:51], v[64:67], v[192:195]
    s_waitcnt lgkmcnt(8)
    v_mfma_f32_16x16x32_bf16 v[68:71], v[20:23], v[52:55], v[68:71]
    ds_read_b128 v[64:67], v6 offset:38912
    s_waitcnt lgkmcnt(7)
    v_mfma_f32_16x16x32_bf16 v[72:75], v[24:27], v[52:55], v[72:75]
    s_waitcnt lgkmcnt(4)
    v_mfma_f32_16x16x32_bf16 v[76:79], v[28:31], v[52:55], v[76:79]
    s_waitcnt lgkmcnt(1)
    v_mfma_f32_16x16x32_bf16 v[80:83], v[32:35], v[52:55], v[80:83]
    v_mfma_f32_16x16x32_bf16 v[84:87], v[20:23], v[56:59], v[84:87]
    ds_read_b128 v[52:55], v6 offset:40960
    v_mfma_f32_16x16x32_bf16 v[88:91], v[24:27], v[56:59], v[88:91]
    v_mfma_f32_16x16x32_bf16 v[92:95], v[28:31], v[56:59], v[92:95]
    v_mfma_f32_16x16x32_bf16 v[96:99], v[32:35], v[56:59], v[96:99]
    v_mfma_f32_16x16x32_bf16 v[100:103], v[20:23], v[60:63], v[100:103]
    ds_read_b128 v[56:59], v6 offset:43008
    v_mfma_f32_16x16x32_bf16 v[104:107], v[24:27], v[60:63], v[104:107]
    v_mfma_f32_16x16x32_bf16 v[108:111], v[28:31], v[60:63], v[108:111]
    v_mfma_f32_16x16x32_bf16 v[112:115], v[32:35], v[60:63], v[112:115]
    s_waitcnt vmcnt(8)
    s_barrier
    s_add_u32 m0, s52, 32768
    s_nop 0
    buffer_load_dwordx4 v4, s[24:27], s50 offen lds
    buffer_load_dwordx4 v5, s[24:27], s50 offen offset:1024 lds
    s_add_u32 s50, s50, 262144
    s_add_u32 m0, s51, 0
    s_add_u32 s47, s49, 384
    buffer_load_dwordx4 v2, s[8:11], s47 offen lds
    buffer_load_dwordx4 v3, s[8:11], s47 offen offset:1024 lds
    s_waitcnt lgkmcnt(2)
    v_mfma_f32_16x16x32_bf16 v[116:119], v[20:23], v[64:67], v[116:119]
    ds_read_b128 v[60:63], v6 offset:45056
    v_mfma_f32_16x16x32_bf16 v[120:123], v[24:27], v[64:67], v[120:123]
    v_mfma_f32_16x16x32_bf16 v[124:127], v[28:31], v[64:67], v[124:127]
    v_mfma_f32_16x16x32_bf16 v[128:131], v[32:35], v[64:67], v[128:131]
    s_waitcnt lgkmcnt(2)
    v_mfma_f32_16x16x32_bf16 v[132:135], v[20:23], v[52:55], v[132:135]
    ds_read_b128 v[64:67], v6 offset:47104
    v_mfma_f32_16x16x32_bf16 v[136:139], v[24:27], v[52:55], v[136:139]
    v_mfma_f32_16x16x32_bf16 v[140:143], v[28:31], v[52:55], v[140:143]
    ds_read_b64_tr_b16 v[36:37], v16 offset:49152
    ds_read_b64_tr_b16 v[38:39], v16 offset:50176
    v_mfma_f32_16x16x32_bf16 v[144:147], v[32:35], v[52:55], v[144:147]
    s_waitcnt lgkmcnt(4)
    v_mfma_f32_16x16x32_bf16 v[148:151], v[20:23], v[56:59], v[148:151]
    ds_read_b128 v[52:55], v7 offset:32768
    v_mfma_f32_16x16x32_bf16 v[152:155], v[24:27], v[56:59], v[152:155]
    v_mfma_f32_16x16x32_bf16 v[156:159], v[28:31], v[56:59], v[156:159]
    ds_read_b64_tr_b16 v[40:41], v17 offset:49152
    ds_read_b64_tr_b16 v[42:43], v17 offset:50176
    v_mfma_f32_16x16x32_bf16 v[160:163], v[32:35], v[56:59], v[160:163]
    s_waitcnt lgkmcnt(6)
    v_mfma_f32_16x16x32_bf16 v[164:167], v[20:23], v[60:63], v[164:167]
    ds_read_b128 v[56:59], v7 offset:34816
    v_mfma_f32_16x16x32_bf16 v[168:171], v[24:27], v[60:63], v[168:171]
    v_mfma_f32_16x16x32_bf16 v[172:175], v[28:31], v[60:63], v[172:175]
    ds_read_b64_tr_b16 v[44:45], v18 offset:49152
    ds_read_b64_tr_b16 v[46:47], v18 offset:50176
    v_mfma_f32_16x16x32_bf16 v[176:179], v[32:35], v[60:63], v[176:179]
    s_waitcnt lgkmcnt(8)
    v_mfma_f32_16x16x32_bf16 v[180:183], v[20:23], v[64:67], v[180:183]
    ds_read_b128 v[60:63], v7 offset:36864
    v_mfma_f32_16x16x32_bf16 v[184:187], v[24:27], v[64:67], v[184:187]
    v_mfma_f32_16x16x32_bf16 v[188:191], v[28:31], v[64:67], v[188:191]
    ds_read_b64_tr_b16 v[48:49], v19 offset:49152
    ds_read_b64_tr_b16 v[50:51], v19 offset:50176
    v_mfma_f32_16x16x32_bf16 v[192:195], v[32:35], v[64:67], v[192:195]
    s_waitcnt lgkmcnt(8)
    v_mfma_f32_16x16x32_bf16 v[68:71], v[36:39], v[52:55], v[68:71]
    ds_read_b128 v[64:67], v7 offset:38912
    s_waitcnt lgkmcnt(7)
    v_mfma_f32_16x16x32_bf16 v[72:75], v[40:43], v[52:55], v[72:75]
    s_waitcnt lgkmcnt(4)
    v_mfma_f32_16x16x32_bf16 v[76:79], v[44:47], v[52:55], v[76:79]
    s_waitcnt lgkmcnt(1)
    v_mfma_f32_16x16x32_bf16 v[80:83], v[48:51], v[52:55], v[80:83]
    v_mfma_f32_16x16x32_bf16 v[84:87], v[36:39], v[56:59], v[84:87]
    ds_read_b128 v[52:55], v7 offset:40960
    v_mfma_f32_16x16x32_bf16 v[88:91], v[40:43], v[56:59], v[88:91]
    v_mfma_f32_16x16x32_bf16 v[92:95], v[44:47], v[56:59], v[92:95]
    v_mfma_f32_16x16x32_bf16 v[96:99], v[48:51], v[56:59], v[96:99]
    v_mfma_f32_16x16x32_bf16 v[100:103], v[36:39], v[60:63], v[100:103]
    ds_read_b128 v[56:59], v7 offset:43008
    v_mfma_f32_16x16x32_bf16 v[104:107], v[40:43], v[60:63], v[104:107]
    v_mfma_f32_16x16x32_bf16 v[108:111], v[44:47], v[60:63], v[108:111]
    v_mfma_f32_16x16x32_bf16 v[112:115], v[48:51], v[60:63], v[112:115]
    s_waitcnt vmcnt(4)
    s_barrier
    s_add_u32 m0, s52, 49152
    s_nop 0
    buffer_load_dwordx4 v4, s[24:27], s50 offen lds
    buffer_load_dwordx4 v5, s[24:27], s50 offen offset:1024 lds
    s_add_u32 s50, s50, 262144
    s_add_u32 m0, s51, 16384
    s_add_u32 s47, s49, 131456
    buffer_load_dwordx4 v2, s[8:11], s47 offen lds
    buffer_load_dwordx4 v3, s[8:11], s47 offen offset:1024 lds
    s_waitcnt lgkmcnt(2)
    v_mfma_f32_16x16x32_bf16 v[116:119], v[36:39], v[64:67], v[116:119]
    ds_read_b128 v[60:63], v7 offset:45056
    v_mfma_f32_16x16x32_bf16 v[120:123], v[40:43], v[64:67], v[120:123]
    v_mfma_f32_16x16x32_bf16 v[124:127], v[44:47], v[64:67], v[124:127]
    v_mfma_f32_16x16x32_bf16 v[128:131], v[48:51], v[64:67], v[128:131]
    s_waitcnt lgkmcnt(2)
    v_mfma_f32_16x16x32_bf16 v[132:135], v[36:39], v[52:55], v[132:135]
    ds_read_b128 v[64:67], v7 offset:47104
    v_mfma_f32_16x16x32_bf16 v[136:139], v[40:43], v[52:55], v[136:139]
    v_mfma_f32_16x16x32_bf16 v[140:143], v[44:47], v[52:55], v[140:143]
    ds_read_b64_tr_b16 v[20:21], v16 offset:0
    ds_read_b64_tr_b16 v[22:23], v16 offset:1024
    v_mfma_f32_16x16x32_bf16 v[144:147], v[48:51], v[52:55], v[144:147]
    s_waitcnt lgkmcnt(4)
    v_mfma_f32_16x16x32_bf16 v[148:151], v[36:39], v[56:59], v[148:151]
    ds_read_b128 v[52:55], v14 offset:0
    v_mfma_f32_16x16x32_bf16 v[152:155], v[40:43], v[56:59], v[152:155]
    v_mfma_f32_16x16x32_bf16 v[156:159], v[44:47], v[56:59], v[156:159]
    ds_read_b64_tr_b16 v[24:25], v17 offset:0
    ds_read_b64_tr_b16 v[26:27], v17 offset:1024
    v_mfma_f32_16x16x32_bf16 v[160:163], v[48:51], v[56:59], v[160:163]
    s_waitcnt lgkmcnt(6)
    v_mfma_f32_16x16x32_bf16 v[164:167], v[36:39], v[60:63], v[164:167]
    ds_read_b128 v[56:59], v14 offset:2048
    v_mfma_f32_16x16x32_bf16 v[168:171], v[40:43], v[60:63], v[168:171]
    v_mfma_f32_16x16x32_bf16 v[172:175], v[44:47], v[60:63], v[172:175]
    ds_read_b64_tr_b16 v[28:29], v18 offset:0
    ds_read_b64_tr_b16 v[30:31], v18 offset:1024
    v_mfma_f32_16x16x32_bf16 v[176:179], v[48:51], v[60:63], v[176:179]
    s_mov_b32 s28, s40
    s_mov_b32 s29, s41
    s_mov_b32 s30, 2359296
    s_mov_b32 s31, 0x00020000
    s_lshl_b32 s47, s2, 3
    s_add_u32 s47, s47, s44
    s_mul_i32 s47, s47, 1152
    v_lshlrev_b32 v204, 4, v1
    v_add_u32 v205, 1024, v204
    v_cmp_gt_u32 vcc, 8, v1
    v_mov_b32 v206, 0x7f000000
    s_nop 0
    v_cndmask_b32 v205, v206, v205, vcc
    buffer_load_dwordx4 v[196:199], v204, s[28:31], s47 offen
    buffer_load_dwordx4 v[200:203], v205, s[28:31], s47 offen
    s_waitcnt lgkmcnt(8)
    v_mfma_f32_16x16x32_bf16 v[180:183], v[36:39], v[64:67], v[180:183]
    ds_read_b128 v[60:63], v14 offset:4096
    v_mfma_f32_16x16x32_bf16 v[184:187], v[40:43], v[64:67], v[184:187]
    v_mfma_f32_16x16x32_bf16 v[188:191], v[44:47], v[64:67], v[188:191]
    ds_read_b64_tr_b16 v[32:33], v19 offset:0
    ds_read_b64_tr_b16 v[34:35], v19 offset:1024
    v_mfma_f32_16x16x32_bf16 v[192:195], v[48:51], v[64:67], v[192:195]
    s_waitcnt lgkmcnt(8)
    v_mfma_f32_16x16x32_bf16 v[68:71], v[20:23], v[52:55], v[68:71]
    ds_read_b128 v[64:67], v14 offset:6144
    s_waitcnt lgkmcnt(7)
    v_mfma_f32_16x16x32_bf16 v[72:75], v[24:27], v[52:55], v[72:75]
    s_waitcnt lgkmcnt(4)
    v_mfma_f32_16x16x32_bf16 v[76:79], v[28:31], v[52:55], v[76:79]
    s_waitcnt lgkmcnt(1)
    v_mfma_f32_16x16x32_bf16 v[80:83], v[32:35], v[52:55], v[80:83]
    v_mfma_f32_16x16x32_bf16 v[84:87], v[20:23], v[56:59], v[84:87]
    ds_read_b128 v[52:55], v14 offset:8192
    v_mfma_f32_16x16x32_bf16 v[88:91], v[24:27], v[56:59], v[88:91]
    v_mfma_f32_16x16x32_bf16 v[92:95], v[28:31], v[56:59], v[92:95]
    v_mfma_f32_16x16x32_bf16 v[96:99], v[32:35], v[56:59], v[96:99]
    v_mfma_f32_16x16x32_bf16 v[100:103], v[20:23], v[60:63], v[100:103]
    ds_read_b128 v[56:59], v14 offset:10240
    v_mfma_f32_16x16x32_bf16 v[104:107], v[24:27], v[60:63], v[104:107]
    v_mfma_f32_16x16x32_bf16 v[108:111], v[28:31], v[60:63], v[108:111]
    v_mfma_f32_16x16x32_bf16 v[112:115], v[32:35], v[60:63], v[112:115]
    s_barrier
    s_add_u32 m0, s52, 0
    s_nop 0
    buffer_load_dwordx4 v4, s[24:27], s50 offen lds
    buffer_load_dwordx4 v5, s[24:27], s50 offen offset:1024 lds
    s_add_u32 s50, s50, 262144
    s_add_u32 m0, s51, 32768
    s_add_u32 s47, s49, 512
    buffer_load_dwordx4 v2, s[8:11], s47 offen lds
    buffer_load_dwordx4 v3, s[8:11], s47 offen offset:1024 lds
    s_waitcnt lgkmcnt(2)
    v_mfma_f32_16x16x32_bf16 v[116:119], v[20:23], v[64:67], v[116:119]
    ds_read_b128 v[60:63], v14 offset:12288
    v_mfma_f32_16x16x32_bf16 v[120:123], v[24:27], v[64:67], v[120:123]
    v_mfma_f32_16x16x32_bf16 v[124:127], v[28:31], v[64:67], v[124:127]
    v_mfma_f32_16x16x32_bf16 v[128:131], v[32:35], v[64:67], v[128:131]
    s_waitcnt lgkmcnt(2)
    v_mfma_f32_16x16x32_bf16 v[132:135], v[20:23], v[52:55], v[132:135]
    ds_read_b128 v[64:67], v14 offset:14336
    v_mfma_f32_16x16x32_bf16 v[136:139], v[24:27], v[52:55], v[136:139]
    v_mfma_f32_16x16x32_bf16 v[140:143], v[28:31], v[52:55], v[140:143]
    ds_read_b64_tr_b16 v[36:37], v16 offset:16384
    ds_read_b64_tr_b16 v[38:39], v16 offset:17408
    v_mfma_f32_16x16x32_bf16 v[144:147], v[32:35], v[52:55], v[144:147]
    s_waitcnt lgkmcnt(4)
    v_mfma_f32_16x16x32_bf16 v[148:151], v[20:23], v[56:59], v[148:151]
    ds_read_b128 v[52:55], v15 offset:0
    v_mfma_f32_16x16x32_bf16 v[152:155], v[24:27], v[56:59], v[152:155]
    v_mfma_f32_16x16x32_bf16 v[156:159], v[28:31], v[56:59], v[156:159]
    ds_read_b64_tr_b16 v[40:41], v17 offset:16384
    ds_read_b64_tr_b16 v[42:43], v17 offset:17408
    v_mfma_f32_16x16x32_bf16 v[160:163], v[32:35], v[56:59], v[160:163]
    s_waitcnt lgkmcnt(6)
    v_mfma_f32_16x16x32_bf16 v[164:167], v[20:23], v[60:63], v[164:167]
    ds_read_b128 v[56:59], v15 offset:2048
    v_mfma_f32_16x16x32_bf16 v[168:171], v[24:27], v[60:63], v[168:171]
    v_mfma_f32_16x16x32_bf16 v[172:175], v[28:31], v[60:63], v[172:175]
    ds_read_b64_tr_b16 v[44:45], v18 offset:16384
    ds_read_b64_tr_b16 v[46:47], v18 offset:17408
    v_mfma_f32_16x16x32_bf16 v[176:179], v[32:35], v[60:63], v[176:179]
    s_waitcnt lgkmcnt(8)
    v_mfma_f32_16x16x32_bf16 v[180:183], v[20:23], v[64:67], v[180:183]
    ds_read_b128 v[60:63], v15 offset:4096
    v_mfma_f32_16x16x32_bf16 v[184:187], v[24:27], v[64:67], v[184:187]
    v_mfma_f32_16x16x32_bf16 v[188:191], v[28:31], v[64:67], v[188:191]
    ds_read_b64_tr_b16 v[48:49], v19 offset:16384
    ds_read_b64_tr_b16 v[50:51], v19 offset:17408
    v_mfma_f32_16x16x32_bf16 v[192:195], v[32:35], v[64:67], v[192:195]
    s_waitcnt lgkmcnt(8)
    v_mfma_f32_16x16x32_bf16 v[68:71], v[36:39], v[52:55], v[68:71]
    ds_read_b128 v[64:67], v15 offset:6144
    s_waitcnt lgkmcnt(7)
    v_mfma_f32_16x16x32_bf16 v[72:75], v[40:43], v[52:55], v[72:75]
    s_waitcnt lgkmcnt(4)
    v_mfma_f32_16x16x32_bf16 v[76:79], v[44:47], v[52:55], v[76:79]
    s_waitcnt lgkmcnt(1)
    v_mfma_f32_16x16x32_bf16 v[80:83], v[48:51], v[52:55], v[80:83]
    v_mfma_f32_16x16x32_bf16 v[84:87], v[36:39], v[56:59], v[84:87]
    ds_read_b128 v[52:55], v15 offset:8192
    v_mfma_f32_16x16x32_bf16 v[88:91], v[40:43], v[56:59], v[88:91]
    v_mfma_f32_16x16x32_bf16 v[92:95], v[44:47], v[56:59], v[92:95]
    v_mfma_f32_16x16x32_bf16 v[96:99], v[48:51], v[56:59], v[96:99]
    v_mfma_f32_16x16x32_bf16 v[100:103], v[36:39], v[60:63], v[100:103]
    ds_read_b128 v[56:59], v15 offset:10240
    v_mfma_f32_16x16x32_bf16 v[104:107], v[40:43], v[60:63], v[104:107]
    v_mfma_f32_16x16x32_bf16 v[108:111], v[44:47], v[60:63], v[108:111]
    v_mfma_f32_16x16x32_bf16 v[112:115], v[48:51], v[60:63], v[112:115]
    s_waitcnt vmcnt(6)
    s_barrier
    s_add_u32 m0, s52, 16384
    s_nop 0
    buffer_load_dwordx4 v4, s[24:27], s50 offen lds
    buffer_load_dwordx4 v5, s[24:27], s50 offen offset:1024 lds
    s_add_u32 s50, s50, 262144
    s_add_u32 m0, s51, 49152
    s_add_u32 s47, s49, 131584
    buffer_load_dwordx4 v2, s[8:11], s47 offen lds
    buffer_load_dwordx4 v3, s[8:11], s47 offen offset:1024 lds
    s_waitcnt lgkmcnt(2)
    v_mfma_f32_16x16x32_bf16 v[116:119], v[36:39], v[64:67], v[116:119]
    ds_read_b128 v[60:63], v15 offset:12288
    v_mfma_f32_16x16x32_bf16 v[120:123], v[40:43], v[64:67], v[120:123]
    v_mfma_f32_16x16x32_bf16 v[124:127], v[44:47], v[64:67], v[124:127]
    v_mfma_f32_16x16x32_bf16 v[128:131], v[48:51], v[64:67], v[128:131]
    s_waitcnt lgkmcnt(2)
    v_mfma_f32_16x16x32_bf16 v[132:135], v[36:39], v[52:55], v[132:135]
    ds_read_b128 v[64:67], v15 offset:14336
    v_mfma_f32_16x16x32_bf16 v[136:139], v[40:43], v[52:55], v[136:139]
    v_mfma_f32_16x16x32_bf16 v[140:143], v[44:47], v[52:55], v[140:143]
    ds_read_b64_tr_b16 v[20:21], v16 offset:32768
    ds_read_b64_tr_b16 v[22:23], v16 offset:33792
    v_mfma_f32_16x16x32_bf16 v[144:147], v[48:51], v[52:55], v[144:147]
    s_waitcnt lgkmcnt(4)
    v_mfma_f32_16x16x32_bf16 v[148:151], v[36:39], v[56:59], v[148:151]
    ds_read_b128 v[52:55], v6 offset:0
    v_mfma_f32_16x16x32_bf16 v[152:155], v[40:43], v[56:59], v[152:155]
    v_mfma_f32_16x16x32_bf16 v[156:159], v[44:47], v[56:59], v[156:159]
    ds_read_b64_tr_b16 v[24:25], v17 offset:32768
    ds_read_b64_tr_b16 v[26:27], v17 offset:33792
    v_mfma_f32_16x16x32_bf16 v[160:163], v[48:51], v[56:59], v[160:163]
    s_waitcnt lgkmcnt(6)
    v_mfma_f32_16x16x32_bf16 v[164:167], v[36:39], v[60:63], v[164:167]
    ds_read_b128 v[56:59], v6 offset:2048
    v_mfma_f32_16x16x32_bf16 v[168:171], v[40:43], v[60:63], v[168:171]
    v_mfma_f32_16x16x32_bf16 v[172:175], v[44:47], v[60:63], v[172:175]
    ds_read_b64_tr_b16 v[28:29], v18 offset:32768
    ds_read_b64_tr_b16 v[30:31], v18 offset:33792
    v_mfma_f32_16x16x32_bf16 v[176:179], v[48:51], v[60:63], v[176:179]
    s_waitcnt lgkmcnt(8)
    v_mfma_f32_16x16x32_bf16 v[180:183], v[36:39], v[64:67], v[180:183]
    ds_read_b128 v[60:63], v6 offset:4096
    v_mfma_f32_16x16x32_bf16 v[184:187], v[40:43], v[64:67], v[184:187]
    v_mfma_f32_16x16x32_bf16 v[188:191], v[44:47], v[64:67], v[188:191]
    ds_read_b64_tr_b16 v[32:33], v19 offset:32768
    ds_read_b64_tr_b16 v[34:35], v19 offset:33792
    v_mfma_f32_16x16x32_bf16 v[192:195], v[48:51], v[64:67], v[192:195]
    s_waitcnt vmcnt(8)
    s_waitcnt lgkmcnt(8)
    v_mfma_f32_16x16x32_bf16 v[68:71], v[20:23], v[52:55], v[68:71]
    ds_read_b128 v[64:67], v6 offset:6144
    s_waitcnt lgkmcnt(7)
    v_mfma_f32_16x16x32_bf16 v[72:75], v[24:27], v[52:55], v[72:75]
    v_lshlrev_b32 v208, 16, v196
    v_and_b32 v209, 0xffff0000, v196
    s_waitcnt lgkmcnt(4)
    v_mfma_f32_16x16x32_bf16 v[76:79], v[28:31], v[52:55], v[76:79]
    s_waitcnt lgkmcnt(1)
    v_mfma_f32_16x16x32_bf16 v[80:83], v[32:35], v[52:55], v[80:83]
    v_lshlrev_b32 v210, 16, v197
    v_and_b32 v211, 0xffff0000, v197
    v_mfma_f32_16x16x32_bf16 v[84:87], v[20:23], v[56:59], v[84:87]
    ds_read_b128 v[52:55], v6 offset:8192
    v_mfma_f32_16x16x32_bf16 v[88:91], v[24:27], v[56:59], v[88:91]
    v_lshlrev_b32 v212, 16, v198
    v_and_b32 v213, 0xffff0000, v198
    v_mfma_f32_16x16x32_bf16 v[92:95], v[28:31], v[56:59], v[92:95]
    v_mfma_f32_16x16x32_bf16 v[96:99], v[32:35], v[56:59], v[96:99]
    v_lshlrev_b32 v214, 16, v199
    v_and_b32 v215, 0xffff0000, v199
    v_mfma_f32_16x16x32_bf16 v[100:103], v[20:23], v[60:63], v[100:103]
    ds_read_b128 v[56:59], v6 offset:10240
    v_mfma_f32_16x16x32_bf16 v[104:107], v[24:27], v[60:63], v[104:107]
    v_lshlrev_b32 v216, 16, v200
    v_and_b32 v217, 0xffff0000, v200
    v_mfma_f32_16x16x32_bf16 v[108:111], v[28:31], v[60:63], v[108:111]
    v_mfma_f32_16x16x32_bf16 v[112:115], v[32:35], v[60:63], v[112:115]
    v_lshlrev_b32 v218, 16, v201
    v_and_b32 v219, 0xffff0000, v201
    s_barrier
    s_add_u32 m0, s52, 32768
    s_nop 0
    buffer_load_dwordx4 v4, s[24:27], s50 offen lds
    buffer_load_dwordx4 v5, s[24:27], s50 offen offset:1024 lds
    s_add_u32 s50, s50, 262144
    s_add_u32 m0, s51, 65536
    s_add_u32 s47, s49, 640
    buffer_load_dwordx4 v2, s[8:11], s47 offen lds
    buffer_load_dwordx4 v3, s[8:11], s47 offen offset:1024 lds
    s_waitcnt lgkmcnt(2)
    v_mfma_f32_16x16x32_bf16 v[116:119], v[20:23], v[64:67], v[116:119]
    ds_read_b128 v[60:63], v6 offset:12288
    v_mfma_f32_16x16x32_bf16 v[120:123], v[24:27], v[64:67], v[120:123]
    v_lshlrev_b32 v220, 16, v202
    v_and_b32 v221, 0xffff0000, v202
    v_mfma_f32_16x16x32_bf16 v[124:127], v[28:31], v[64:67], v[124:127]
    v_mfma_f32_16x16x32_bf16 v[128:131], v[32:35], v[64:67], v[128:131]
    v_lshlrev_b32 v222, 16, v203
    v_and_b32 v223, 0xffff0000, v203
    s_waitcnt lgkmcnt(2)
    v_mfma_f32_16x16x32_bf16 v[132:135], v[20:23], v[52:55], v[132:135]
    ds_read_b128 v[64:67], v6 offset:14336
    v_mfma_f32_16x16x32_bf16 v[136:139], v[24:27], v[52:55], v[136:139]
    v_add_f32 v224, v208, v209
    v_add_f32 v224, v224, v210
    v_mfma_f32_16x16x32_bf16 v[140:143], v[28:31], v[52:55], v[140:143]
    ds_read_b64_tr_b16 v[36:37], v16 offset:49152
    ds_read_b64_tr_b16 v[38:39], v16 offset:50176
    v_mfma_f32_16x16x32_bf16 v[144:147], v[32:35], v[52:55], v[144:147]
    v_add_f32 v224, v224, v211
    v_add_f32 v224, v224, v212
    s_waitcnt lgkmcnt(4)
    v_mfma_f32_16x16x32_bf16 v[148:151], v[20:23], v[56:59], v[148:151]
    ds_read_b128 v[52:55], v7 offset:0
    v_mfma_f32_16x16x32_bf16 v[152:155], v[24:27], v[56:59], v[152:155]
    v_add_f32 v224, v224, v213
    v_add_f32 v224, v224, v214
    v_mfma_f32_16x16x32_bf16 v[156:159], v[28:31], v[56:59], v[156:159]
    ds_read_b64_tr_b16 v[40:41], v17 offset:49152
    ds_read_b64_tr_b16 v[42:43], v17 offset:50176
    v_mfma_f32_16x16x32_bf16 v[160:163], v[32:35], v[56:59], v[160:163]
    v_add_f32 v224, v224, v215
    v_add_f32 v224, v224, v216
    s_waitcnt lgkmcnt(6)
    v_mfma_f32_16x16x32_bf16 v[164:167], v[20:23], v[60:63], v[164:167]
    ds_read_b128 v[56:59], v7 offset:2048
    v_mfma_f32_16x16x32_bf16 v[168:171], v[24:27], v[60:63], v[168:171]
    v_add_f32 v224, v224, v217
    v_add_f32 v224, v224, v218
    v_mfma_f32_16x16x32_bf16 v[172:175], v[28:31], v[60:63], v[172:175]
    ds_read_b64_tr_b16 v[44:45], v18 offset:49152
    ds_read_b64_tr_b16 v[46:47], v18 offset:50176
    v_mfma_f32_16x16x32_bf16 v[176:179], v[32:35], v[60:63], v[176:179]
    v_add_f32 v224, v224, v219
    v_add_f32 v224, v224, v220
    s_waitcnt lgkmcnt(8)
    v_mfma_f32_16x16x32_bf16 v[180:183], v[20:23], v[64:67], v[180:183]
    ds_read_b128 v[60:63], v7 offset:4096
    v_mfma_f32_16x16x32_bf16 v[184:187], v[24:27], v[64:67], v[184:187]
    v_add_f32 v224, v224, v221
    v_add_f32 v224, v224, v222
    v_mfma_f32_16x16x32_bf16 v[188:191], v[28:31], v[64:67], v[188:191]
    ds_read_b64_tr_b16 v[48:49], v19 offset:49152
    ds_read_b64_tr_b16 v[50:51], v19 offset:50176
    v_mfma_f32_16x16x32_bf16 v[192:195], v[32:35], v[64:67], v[192:195]
    v_add_f32 v224, v224, v223
    s_nop 1
    v_add_f32_dpp v224, v224, v224 quad_perm:[1,0,3,2] row_mask:0xf bank_mask:0xf
    s_waitcnt lgkmcnt(8)
    v_mfma_f32_16x16x32_bf16 v[68:71], v[36:39], v[52:55], v[68:71]
    ds_read_b128 v[64:67], v7 offset:6144
    s_waitcnt lgkmcnt(7)
    v_mfma_f32_16x16x32_bf16 v[72:75], v[40:43], v[52:55], v[72:75]
    v_add_f32_dpp v224, v224, v224 quad_perm:[2,3,0,1] row_mask:0xf bank_mask:0xf
    s_nop 1
    v_add_f32_dpp v224, v224, v224 row_ror:4 row_mask:0xf bank_mask:0xf
    s_waitcnt lgkmcnt(4)
    v_mfma_f32_16x16x32_bf16 v[76:79], v[44:47], v[52:55], v[76:79]
    s_waitcnt lgkmcnt(1)
    v_mfma_f32_16x16x32_bf16 v[80:83], v[48:51], v[52:55], v[80:83]
    v_add_f32_dpp v224, v224, v224 row_ror:8 row_mask:0xf bank_mask:0xf
    v_mov_b32 v225, v224
    v_mfma_f32_16x16x32_bf16 v[84:87], v[36:39], v[56:59], v[84:87]
    ds_read_b128 v[52:55], v7 offset:8192
    v_mfma_f32_16x16x32_bf16 v[88:91], v[40:43], v[56:59], v[88:91]
    v_permlane16_swap_b32 v224, v225
    v_add_f32 v224, v224, v225
    v_mfma_f32_16x16x32_bf16 v[92:95], v[44:47], v[56:59], v[92:95]
    v_mfma_f32_16x16x32_bf16 v[96:99], v[48:51], v[56:59], v[96:99]
    v_mov_b32 v225, v224
    s_nop 1
    v_permlane32_swap_b32 v224, v225
    v_mfma_f32_16x16x32_bf16 v[100:103], v[36:39], v[60:63], v[100:103]
    ds_read_b128 v[56:59], v7 offset:10240
    v_mfma_f32_16x16x32_bf16 v[104:107], v[40:43], v[60:63], v[104:107]
    v_add_f32 v224, v224, v225
    v_mul_f32 v224, 0x3ae38e39, v224
    v_mfma_f32_16x16x32_bf16 v[108:111], v[44:47], v[60:63], v[108:111]
    v_mfma_f32_16x16x32_bf16 v[112:115], v[48:51], v[60:63], v[112:115]
    v_cmp_gt_u32 vcc, 8, v1
    s_nop 1
    v_cndmask_b32 v226, 0, v224, vcc
    s_waitcnt vmcnt(4)
    s_barrier
    s_add_u32 m0, s52, 49152
    s_nop 0
    buffer_load_dwordx4 v4, s[24:27], s50 offen lds
    buffer_load_dwordx4 v5, s[24:27], s50 offen offset:1024 lds
    s_add_u32 s50, s50, 262144
    s_add_u32 m0, s51, 81920
    s_add_u32 s47, s49, 131712
    buffer_load_dwordx4 v2, s[8:11], s47 offen lds
    buffer_load_dwordx4 v3, s[8:11], s47 offen offset:1024 lds
    s_waitcnt lgkmcnt(2)
    v_mfma_f32_16x16x32_bf16 v[116:119], v[36:39], v[64:67], v[116:119]
    ds_read_b128 v[60:63], v7 offset:12288
    v_mfma_f32_16x16x32_bf16 v[120:123], v[40:43], v[64:67], v[120:123]
    v_sub_f32 v208, v208, v224
    v_sub_f32 v216, v216, v226
    v_mfma_f32_16x16x32_bf16 v[124:127], v[44:47], v[64:67], v[124:127]
    v_mfma_f32_16x16x32_bf16 v[128:131], v[48:51], v[64:67], v[128:131]
    v_sub_f32 v209, v209, v224
    v_sub_f32 v217, v217, v226
    s_waitcnt lgkmcnt(2)
    v_mfma_f32_16x16x32_bf16 v[132:135], v[36:39], v[52:55], v[132:135]
    ds_read_b128 v[64:67], v7 offset:14336
    v_mfma_f32_16x16x32_bf16 v[136:139], v[40:43], v[52:55], v[136:139]
    v_sub_f32 v210, v210, v224
    v_sub_f32 v218, v218, v226
    v_mfma_f32_16x16x32_bf16 v[140:143], v[44:47], v[52:55], v[140:143]
    ds_read_b64_tr_b16 v[20:21], v16 offset:0
    ds_read_b64_tr_b16 v[22:23], v16 offset:1024
    v_mfma_f32_16x16x32_bf16 v[144:147], v[48:51], v[52:55], v[144:147]
    v_sub_f32 v211, v211, v224
    v_sub_f32 v219, v219, v226
    s_waitcnt lgkmcnt(4)
    v_mfma_f32_16x16x32_bf16 v[148:151], v[36:39], v[56:59], v[148:151]
    ds_read_b128 v[52:55], v6 offset:32768
    v_mfma_f32_16x16x32_bf16 v[152:155], v[40:43], v[56:59], v[152:155]
    v_sub_f32 v212, v212, v224
    v_sub_f32 v220, v220, v226
    v_mfma_f32_16x16x32_bf16 v[156:159], v[44:47], v[56:59], v[156:159]
    ds_read_b64_tr_b16 v[24:25], v17 offset:0
    ds_read_b64_tr_b16 v[26:27], v17 offset:1024
    v_mfma_f32_16x16x32_bf16 v[160:163], v[48:51], v[56:59], v[160:163]
    v_sub_f32 v213, v213, v224
    v_sub_f32 v221, v221, v226
    s_waitcnt lgkmcnt(6)
    v_mfma_f32_16x16x32_bf16 v[164:167], v[36:39], v[60:63], v[164:167]
    ds_read_b128 v[56:59], v6 offset:34816
    v_mfma_f32_16x16x32_bf16 v[168:171], v[40:43], v[60:63], v[168:171]
    v_sub_f32 v214, v214, v224
    v_sub_f32 v222, v222, v226
    v_mfma_f32_16x16x32_bf16 v[172:175], v[44:47], v[60:63], v[172:175]
    ds_read_b64_tr_b16 v[28:29], v18 offset:0
    ds_read_b64_tr_b16 v[30:31], v18 offset:1024
    v_mfma_f32_16x16x32_bf16 v[176:179], v[48:51], v[60:63], v[176:179]
    v_sub_f32 v215, v215, v224
    v_sub_f32 v223, v223, v226
    s_waitcnt lgkmcnt(8)
    v_mfma_f32_16x16x32_bf16 v[180:183], v[36:39], v[64:67], v[180:183]
    ds_read_b128 v[60:63], v6 offset:36864
    v_mfma_f32_16x16x32_bf16 v[184:187], v[40:43], v[64:67], v[184:187]
    v_mul_f32 v224, v208, v208
    v_fmac_f32 v224, v209, v209
    v_mfma_f32_16x16x32_bf16 v[188:191], v[44:47], v[64:67], v[188:191]
    ds_read_b64_tr_b16 v[32:33], v19 offset:0
    ds_read_b64_tr_b16 v[34:35], v19 offset:1024
    v_mfma_f32_16x16x32_bf16 v[192:195], v[48:51], v[64:67], v[192:195]
    v_fmac_f32 v224, v210, v210
    v_fmac_f32 v224, v211, v211
    s_waitcnt lgkmcnt(8)
    v_mfma_f32_16x16x32_bf16 v[68:71], v[20:23], v[52:55], v[68:71]
    ds_read_b128 v[64:67], v6 offset:38912
    s_waitcnt lgkmcnt(7)
    v_mfma_f32_16x16x32_bf16 v[72:75], v[24:27], v[52:55], v[72:75]
    v_fmac_f32 v224, v212, v212
    v_fmac_f32 v224, v213, v213
    s_waitcnt lgkmcnt(4)
    v_mfma_f32_16x16x32_bf16 v[76:79], v[28:31], v[52:55], v[76:79]
    s_waitcnt lgkmcnt(1)
    v_mfma_f32_16x16x32_bf16 v[80:83], v[32:35], v[52:55], v[80:83]
    v_fmac_f32 v224, v214, v214
    v_fmac_f32 v224, v215, v215
    v_mfma_f32_16x16x32_bf16 v[84:87], v[20:23], v[56:59], v[84:87]
    ds_read_b128 v[52:55], v6 offset:40960
    v_mfma_f32_16x16x32_bf16 v[88:91], v[24:27], v[56:59], v[88:91]
    v_fmac_f32 v224, v216, v216
    v_fmac_f32 v224, v217, v217
    v_mfma_f32_16x16x32_bf16 v[92:95], v[28:31], v[56:59], v[92:95]
    v_mfma_f32_16x16x32_bf16 v[96:99], v[32:35], v[56:59], v[96:99]
    v_fmac_f32 v224, v218, v218
    v_fmac_f32 v224, v219, v219
    v_mfma_f32_16x16x32_bf16 v[100:103], v[20:23], v[60:63], v[100:103]
    ds_read_b128 v[56:59], v6 offset:43008
    v_mfma_f32_16x16x32_bf16 v[104:107], v[24:27], v[60:63], v[104:107]
    v_fmac_f32 v224, v220, v220
    v_fmac_f32 v224, v221, v221
    v_mfma_f32_16x16x32_bf16 v[108:111], v[28:31], v[60:63], v[108:111]
    v_mfma_f32_16x16x32_bf16 v[112:115], v[32:35], v[60:63], v[112:115]
    v_fmac_f32 v224, v222, v222
    v_fmac_f32 v224, v223, v223
    s_barrier
    s_add_u32 m0, s52, 0
    s_nop 0
    buffer_load_dwordx4 v4, s[24:27], s50 offen lds
    buffer_load_dwordx4 v5, s[24:27], s50 offen offset:1024 lds
    s_add_u32 s50, s50, 262144
    s_add_u32 m0, s51, 0
    s_add_u32 s47, s49, 768
    buffer_load_dwordx4 v2, s[8:11], s47 offen lds
    buffer_load_dwordx4 v3, s[8:11], s47 offen offset:1024 lds
    s_waitcnt lgkmcnt(2)
    v_mfma_f32_16x16x32_bf16 v[116:119], v[20:23], v[64:67], v[116:119]
    ds_read_b128 v[60:63], v6 offset:45056
    v_mfma_f32_16x16x32_bf16 v[120:123], v[24:27], v[64:67], v[120:123]
    v_add_f32_dpp v224, v224, v224 quad_perm:[1,0,3,2] row_mask:0xf bank_mask:0xf
    s_nop 1
    v_add_f32_dpp v224, v224, v224 quad_perm:[2,3,0,1] row_mask:0xf bank_mask:0xf
    v_mfma_f32_16x16x32_bf16 v[124:127], v[28:31], v[64:67], v[124:127]
    v_mfma_f32_16x16x32_bf16 v[128:131], v[32:35], v[64:67], v[128:131]
    v_add_f32_dpp v224, v224, v224 row_ror:4 row_mask:0xf bank_mask:0xf
    s_nop 1
    v_add_f32_dpp v224, v224, v224 row_ror:8 row_mask:0xf bank_mask:0xf
    s_waitcnt lgkmcnt(2)
    v_mfma_f32_16x16x32_bf16 v[132:135], v[20:23], v[52:55], v[132:135]
    ds_read_b128 v[64:67], v6 offset:47104
    v_mfma_f32_16x16x32_bf16 v[136:139], v[24:27], v[52:55], v[136:139]
    v_mov_b32 v225, v224
    s_nop 1
    v_permlane16_swap_b32 v224, v225
    v_mfma_f32_16x16x32_bf16 v[140:143], v[28:31], v[52:55], v[140:143]
    ds_read_b64_tr_b16 v[36:37], v16 offset:16384
    ds_read_b64_tr_b16 v[38:39], v16 offset:17408
    v_mfma_f32_16x16x32_bf16 v[144:147], v[32:35], v[52:55], v[144:147]
    v_add_f32 v224, v224, v225
    v_mov_b32 v225, v224
    s_waitcnt lgkmcnt(4)
    v_mfma_f32_16x16x32_bf16 v[148:151], v[20:23], v[56:59], v[148:151]
    ds_read_b128 v[52:55], v7 offset:32768
    v_mfma_f32_16x16x32_bf16 v[152:155], v[24:27], v[56:59], v[152:155]
    v_permlane32_swap_b32 v224, v225
    v_add_f32 v224, v224, v225
    v_mfma_f32_16x16x32_bf16 v[156:159], v[28:31], v[56:59], v[156:159]
    ds_read_b64_tr_b16 v[40:41], v17 offset:16384
    ds_read_b64_tr_b16 v[42:43], v17 offset:17408
    v_mfma_f32_16x16x32_bf16 v[160:163], v[32:35], v[56:59], v[160:163]
    v_mov_b32 v225, 0x3727c5ac
    v_fmac_f32 v225, 0x3ae38e39, v224
    s_waitcnt lgkmcnt(6)
    v_mfma_f32_16x16x32_bf16 v[164:167], v[20:23], v[60:63], v[164:167]
    ds_read_b128 v[56:59], v7 offset:34816
    v_mfma_f32_16x16x32_bf16 v[168:171], v[24:27], v[60:63], v[168:171]
    v_rsq_f32 v224, v225
    s_nop 0
    v_mul_f32 v208, v208, v224
    v_mfma_f32_16x16x32_bf16 v[172:175], v[28:31], v[60:63], v[172:175]
    ds_read_b64_tr_b16 v[44:45], v18 offset:16384
    ds_read_b64_tr_b16 v[46:47], v18 offset:17408
    v_mfma_f32_16x16x32_bf16 v[176:179], v[32:35], v[60:63], v[176:179]
    v_mul_f32 v209, v209, v224
    v_mul_f32 v210, v210, v224
    s_waitcnt lgkmcnt(8)
    v_mfma_f32_16x16x32_bf16 v[180:183], v[20:23], v[64:67], v[180:183]
    ds_read_b128 v[60:63], v7 offset:36864
    v_mfma_f32_16x16x32_bf16 v[184:187], v[24:27], v[64:67], v[184:187]
    v_mul_f32 v211, v211, v224
    v_mul_f32 v212, v212, v224
    v_mfma_f32_16x16x32_bf16 v[188:191], v[28:31], v[64:67], v[188:191]
    ds_read_b64_tr_b16 v[48:49], v19 offset:16384
    ds_read_b64_tr_b16 v[50:51], v19 offset:17408
    v_mfma_f32_16x16x32_bf16 v[192:195], v[32:35], v[64:67], v[192:195]
    v_mul_f32 v213, v213, v224
    v_mul_f32 v214, v214, v224
    s_waitcnt lgkmcnt(8)
    v_mfma_f32_16x16x32_bf16 v[68:71], v[36:39], v[52:55], v[68:71]
    ds_read_b128 v[64:67], v7 offset:38912
    s_waitcnt lgkmcnt(7)
    v_mfma_f32_16x16x32_bf16 v[72:75], v[40:43], v[52:55], v[72:75]
    v_mul_f32 v215, v215, v224
    v_mul_f32 v216, v216, v224
    s_waitcnt lgkmcnt(4)
    v_mfma_f32_16x16x32_bf16 v[76:79], v[44:47], v[52:55], v[76:79]
    s_waitcnt lgkmcnt(1)
    v_mfma_f32_16x16x32_bf16 v[80:83], v[48:51], v[52:55], v[80:83]
    v_mul_f32 v217, v217, v224
    v_mul_f32 v218, v218, v224
    v_mfma_f32_16x16x32_bf16 v[84:87], v[36:39], v[56:59], v[84:87]
    ds_read_b128 v[52:55], v7 offset:40960
    v_mfma_f32_16x16x32_bf16 v[88:91], v[40:43], v[56:59], v[88:91]
    v_mul_f32 v219, v219, v224
    v_mul_f32 v220, v220, v224
    v_mfma_f32_16x16x32_bf16 v[92:95], v[44:47], v[56:59], v[92:95]
    v_mfma_f32_16x16x32_bf16 v[96:99], v[48:51], v[56:59], v[96:99]
    v_mul_f32 v221, v221, v224
    v_mul_f32 v222, v222, v224
    v_mfma_f32_16x16x32_bf16 v[100:103], v[36:39], v[60:63], v[100:103]
    ds_read_b128 v[56:59], v7 offset:43008
    v_mfma_f32_16x16x32_bf16 v[104:107], v[40:43], v[60:63], v[104:107]
    v_mul_f32 v223, v223, v224
    v_cvt_pk_bf16_f32 v196, v208, v209
    v_mfma_f32_16x16x32_bf16 v[108:111], v[44:47], v[60:63], v[108:111]
    v_mfma_f32_16x16x32_bf16 v[112:115], v[48:51], v[60:63], v[112:115]
    v_cvt_pk_bf16_f32 v197, v210, v211
    v_cvt_pk_bf16_f32 v198, v212, v213
    s_waitcnt vmcnt(4)
    s_barrier
    s_add_u32 m0, s52, 16384
    s_nop 0
    buffer_load_dwordx4 v4, s[24:27], s50 offen lds
    buffer_load_dwordx4 v5, s[24:27], s50 offen offset:1024 lds
    s_add_u32 s50, s50, 262144
    s_add_u32 m0, s51, 16384
    s_add_u32 s47, s49, 131840
    buffer_load_dwordx4 v2, s[8:11], s47 offen lds
    buffer_load_dwordx4 v3, s[8:11], s47 offen offset:1024 lds
    s_waitcnt lgkmcnt(2)
    v_mfma_f32_16x16x32_bf16 v[116:119], v[36:39], v[64:67], v[116:119]
    ds_read_b128 v[60:63], v7 offset:45056
    v_mfma_f32_16x16x32_bf16 v[120:123], v[40:43], v[64:67], v[120:123]
    v_cvt_pk_bf16_f32 v199, v214, v215
    v_cvt_pk_bf16_f32 v200, v216, v217
    v_mfma_f32_16x16x32_bf16 v[124:127], v[44:47], v[64:67], v[124:127]
    v_mfma_f32_16x16x32_bf16 v[128:131], v[48:51], v[64:67], v[128:131]
    v_cvt_pk_bf16_f32 v201, v218, v219
    v_cvt_pk_bf16_f32 v202, v220, v221
    s_waitcnt lgkmcnt(2)
    v_mfma_f32_16x16x32_bf16 v[132:135], v[36:39], v[52:55], v[132:135]
    ds_read_b128 v[64:67], v7 offset:47104
    v_mfma_f32_16x16x32_bf16 v[136:139], v[40:43], v[52:55], v[136:139]
    v_cvt_pk_bf16_f32 v203, v222, v223
    v_lshlrev_b32 v224, 8, v1
    v_mfma_f32_16x16x32_bf16 v[140:143], v[44:47], v[52:55], v[140:143]
    ds_read_b64_tr_b16 v[20:21], v16 offset:32768
    ds_read_b64_tr_b16 v[22:23], v16 offset:33792
    v_mfma_f32_16x16x32_bf16 v[144:147], v[48:51], v[52:55], v[144:147]
    v_add_u32 v225, 16384, v224
    v_mov_b32 v226, 0x7f000000
    s_waitcnt lgkmcnt(4)
    v_mfma_f32_16x16x32_bf16 v[148:151], v[36:39], v[56:59], v[148:151]
    ds_read_b128 v[52:55], v14 offset:0
    v_mfma_f32_16x16x32_bf16 v[152:155], v[40:43], v[56:59], v[152:155]
    v_cndmask_b32 v225, v226, v225, vcc
    s_lshr_b32 s54, s2, 1
    v_mfma_f32_16x16x32_bf16 v[156:159], v[44:47], v[56:59], v[156:159]
    ds_read_b64_tr_b16 v[24:25], v17 offset:32768
    ds_read_b64_tr_b16 v[26:27], v17 offset:33792
    v_mfma_f32_16x16x32_bf16 v[160:163], v[48:51], v[56:59], v[160:163]
    s_mul_i32 s54, s54, 18432
    s_and_b32 s48, s2, 1
    s_waitcnt lgkmcnt(6)
    v_mfma_f32_16x16x32_bf16 v[164:167], v[36:39], v[60:63], v[164:167]
    ds_read_b128 v[56:59], v14 offset:2048
    v_mfma_f32_16x16x32_bf16 v[168:171], v[40:43], v[60:63], v[168:171]
    s_lshl_b32 s48, s48, 3
    s_add_u32 s48, s48, s44
    v_mfma_f32_16x16x32_bf16 v[172:175], v[44:47], v[60:63], v[172:175]
    ds_read_b64_tr_b16 v[28:29], v18 offset:32768
    ds_read_b64_tr_b16 v[30:31], v18 offset:33792
    v_mfma_f32_16x16x32_bf16 v[176:179], v[48:51], v[60:63], v[176:179]
    s_lshl_b32 s48, s48, 4
    s_add_u32 s54, s54, s48
    s_waitcnt lgkmcnt(8)
    v_mfma_f32_16x16x32_bf16 v[180:183], v[36:39], v[64:67], v[180:183]
    ds_read_b128 v[60:63], v14 offset:4096
    v_mfma_f32_16x16x32_bf16 v[184:187], v[40:43], v[64:67], v[184:187]
    s_add_u32 s28, s32, 0
    s_addc_u32 s29, s33, 0
    v_mfma_f32_16x16x32_bf16 v[188:191], v[44:47], v[64:67], v[188:191]
    ds_read_b64_tr_b16 v[32:33], v19 offset:32768
    ds_read_b64_tr_b16 v[34:35], v19 offset:33792
    v_mfma_f32_16x16x32_bf16 v[192:195], v[48:51], v[64:67], v[192:195]
    buffer_store_dwordx4 v[196:199], v224, s[28:31], s54 offen
    buffer_store_dwordx4 v[200:203], v225, s[28:31], s54 offen
    s_waitcnt lgkmcnt(8)
    v_mfma_f32_16x16x32_bf16 v[68:71], v[20:23], v[52:55], v[68:71]
    ds_read_b128 v[64:67], v14 offset:6144
    s_waitcnt lgkmcnt(7)
    v_mfma_f32_16x16x32_bf16 v[72:75], v[24:27], v[52:55], v[72:75]
    s_waitcnt lgkmcnt(4)
    v_mfma_f32_16x16x32_bf16 v[76:79], v[28:31], v[52:55], v[76:79]
    s_waitcnt lgkmcnt(1)
    v_mfma_f32_16x16x32_bf16 v[80:83], v[32:35], v[52:55], v[80:83]
    v_mfma_f32_16x16x32_bf16 v[84:87], v[20:23], v[56:59], v[84:87]
    ds_read_b128 v[52:55], v14 offset:8192
    v_mfma_f32_16x16x32_bf16 v[88:91], v[24:27], v[56:59], v[88:91]
    v_mfma_f32_16x16x32_bf16 v[92:95], v[28:31], v[56:59], v[92:95]
    v_mfma_f32_16x16x32_bf16 v[96:99], v[32:35], v[56:59], v[96:99]
    v_mfma_f32_16x16x32_bf16 v[100:103], v[20:23], v[60:63], v[100:103]
    ds_read_b128 v[56:59], v14 offset:10240
    v_mfma_f32_16x16x32_bf16 v[104:107], v[24:27], v[60:63], v[104:107]
    v_mfma_f32_16x16x32_bf16 v[108:111], v[28:31], v[60:63], v[108:111]
    v_mfma_f32_16x16x32_bf16 v[112:115], v[32:35], v[60:63], v[112:115]
    s_barrier
    s_add_u32 m0, s52, 32768
    s_nop 0
    buffer_load_dwordx4 v4, s[24:27], s50 offen lds
    buffer_load_dwordx4 v5, s[24:27], s50 offen offset:1024 lds
    s_add_u32 s50, s50, 262144
    s_add_u32 m0, s51, 32768
    s_add_u32 s47, s49, 896
    buffer_load_dwordx4 v2, s[8:11], s47 offen lds
    buffer_load_dwordx4 v3, s[8:11], s47 offen offset:1024 lds
    s_waitcnt lgkmcnt(2)
    v_mfma_f32_16x16x32_bf16 v[116:119], v[20:23], v[64:67], v[116:119]
    ds_read_b128 v[60:63], v14 offset:12288
    v_mfma_f32_16x16x32_bf16 v[120:123], v[24:27], v[64:67], v[120:123]
    v_mfma_f32_16x16x32_bf16 v[124:127], v[28:31], v[64:67], v[124:127]
    v_mfma_f32_16x16x32_bf16 v[128:131], v[32:35], v[64:67], v[128:131]
    s_waitcnt lgkmcnt(2)
    v_mfma_f32_16x16x32_bf16 v[132:135], v[20:23], v[52:55], v[132:135]
    ds_read_b128 v[64:67], v14 offset:14336
    v_mfma_f32_16x16x32_bf16 v[136:139], v[24:27], v[52:55], v[136:139]
    v_mfma_f32_16x16x32_bf16 v[140:143], v[28:31], v[52:55], v[140:143]
    ds_read_b64_tr_b16 v[36:37], v16 offset:49152
    ds_read_b64_tr_b16 v[38:39], v16 offset:50176
    v_mfma_f32_16x16x32_bf16 v[144:147], v[32:35], v[52:55], v[144:147]
    s_waitcnt lgkmcnt(4)
    v_mfma_f32_16x16x32_bf16 v[148:151], v[20:23], v[56:59], v[148:151]
    ds_read_b128 v[52:55], v15 offset:0
    v_mfma_f32_16x16x32_bf16 v[152:155], v[24:27], v[56:59], v[152:155]
    v_mfma_f32_16x16x32_bf16 v[156:159], v[28:31], v[56:59], v[156:159]
    ds_read_b64_tr_b16 v[40:41], v17 offset:49152
    ds_read_b64_tr_b16 v[42:43], v17 offset:50176
    v_mfma_f32_16x16x32_bf16 v[160:163], v[32:35], v[56:59], v[160:163]
    s_waitcnt lgkmcnt(6)
    v_mfma_f32_16x16x32_bf16 v[164:167], v[20:23], v[60:63], v[164:167]
    ds_read_b128 v[56:59], v15 offset:2048
    v_mfma_f32_16x16x32_bf16 v[168:171], v[24:27], v[60:63], v[168:171]
    v_mfma_f32_16x16x32_bf16 v[172:175], v[28:31], v[60:63], v[172:175]
    ds_read_b64_tr_b16 v[44:45], v18 offset:49152
    ds_read_b64_tr_b16 v[46:47], v18 offset:50176
    v_mfma_f32_16x16x32_bf16 v[176:179], v[32:35], v[60:63], v[176:179]
    s_waitcnt lgkmcnt(8)
    v_mfma_f32_16x16x32_bf16 v[180:183], v[20:23], v[64:67], v[180:183]
    ds_read_b128 v[60:63], v15 offset:4096
    v_mfma_f32_16x16x32_bf16 v[184:187], v[24:27], v[64:67], v[184:187]
    v_mfma_f32_16x16x32_bf16 v[188:191], v[28:31], v[64:67], v[188:191]
    ds_read_b64_tr_b16 v[48:49], v19 offset:49152
    ds_read_b64_tr_b16 v[50:51], v19 offset:50176
    v_mfma_f32_16x16x32_bf16 v[192:195], v[32:35], v[64:67], v[192:195]
    s_waitcnt lgkmcnt(8)
    v_mfma_f32_16x16x32_bf16 v[68:71], v[36:39], v[52:55], v[68:71]
    ds_read_b128 v[64:67], v15 offset:6144
    s_waitcnt lgkmcnt(7)
    v_mfma_f32_16x16x32_bf16 v[72:75], v[40:43], v[52:55], v[72:75]
    s_waitcnt lgkmcnt(4)
    v_mfma_f32_16x16x32_bf16 v[76:79], v[44:47], v[52:55], v[76:79]
    s_waitcnt lgkmcnt(1)
    v_mfma_f32_16x16x32_bf16 v[80:83], v[48:51], v[52:55], v[80:83]
    v_mfma_f32_16x16x32_bf16 v[84:87], v[36:39], v[56:59], v[84:87]
    ds_read_b128 v[52:55], v15 offset:8192
    v_mfma_f32_16x16x32_bf16 v[88:91], v[40:43], v[56:59], v[88:91]
    v_mfma_f32_16x16x32_bf16 v[92:95], v[44:47], v[56:59], v[92:95]
    v_mfma_f32_16x16x32_bf16 v[96:99], v[48:51], v[56:59], v[96:99]
    v_mfma_f32_16x16x32_bf16 v[100:103], v[36:39], v[60:63], v[100:103]
    ds_read_b128 v[56:59], v15 offset:10240
    v_mfma_f32_16x16x32_bf16 v[104:107], v[40:43], v[60:63], v[104:107]
    v_mfma_f32_16x16x32_bf16 v[108:111], v[44:47], v[60:63], v[108:111]
    v_mfma_f32_16x16x32_bf16 v[112:115], v[48:51], v[60:63], v[112:115]
    s_waitcnt vmcnt(6)
    s_barrier
    s_add_u32 m0, s52, 49152
    s_nop 0
    buffer_load_dwordx4 v4, s[24:27], s50 offen lds
    buffer_load_dwordx4 v5, s[24:27], s50 offen offset:1024 lds
    s_add_u32 s50, s50, 262144
    s_add_u32 m0, s51, 49152
    s_add_u32 s47, s49, 131968
    buffer_load_dwordx4 v2, s[8:11], s47 offen lds
    buffer_load_dwordx4 v3, s[8:11], s47 offen offset:1024 lds
    s_waitcnt lgkmcnt(2)
    v_mfma_f32_16x16x32_bf16 v[116:119], v[36:39], v[64:67], v[116:119]
    ds_read_b128 v[60:63], v15 offset:12288
    v_mfma_f32_16x16x32_bf16 v[120:123], v[40:43], v[64:67], v[120:123]
    v_mfma_f32_16x16x32_bf16 v[124:127], v[44:47], v[64:67], v[124:127]
    v_mfma_f32_16x16x32_bf16 v[128:131], v[48:51], v[64:67], v[128:131]
    s_waitcnt lgkmcnt(2)
    v_mfma_f32_16x16x32_bf16 v[132:135], v[36:39], v[52:55], v[132:135]
    ds_read_b128 v[64:67], v15 offset:14336
    v_mfma_f32_16x16x32_bf16 v[136:139], v[40:43], v[52:55], v[136:139]
    v_mfma_f32_16x16x32_bf16 v[140:143], v[44:47], v[52:55], v[140:143]
    ds_read_b64_tr_b16 v[20:21], v16 offset:0
    ds_read_b64_tr_b16 v[22:23], v16 offset:1024
    v_mfma_f32_16x16x32_bf16 v[144:147], v[48:51], v[52:55], v[144:147]
    s_waitcnt lgkmcnt(4)
    v_mfma_f32_16x16x32_bf16 v[148:151], v[36:39], v[56:59], v[148:151]
    ds_read_b128 v[52:55], v6 offset:0
    v_mfma_f32_16x16x32_bf16 v[152:155], v[40:43], v[56:59], v[152:155]
    v_mfma_f32_16x16x32_bf16 v[156:159], v[44:47], v[56:59], v[156:159]
    ds_read_b64_tr_b16 v[24:25], v17 offset:0
    ds_read_b64_tr_b16 v[26:27], v17 offset:1024
    v_mfma_f32_16x16x32_bf16 v[160:163], v[48:51], v[56:59], v[160:163]
    s_waitcnt lgkmcnt(6)
    v_mfma_f32_16x16x32_bf16 v[164:167], v[36:39], v[60:63], v[164:167]
    ds_read_b128 v[56:59], v6 offset:2048
    v_mfma_f32_16x16x32_bf16 v[168:171], v[40:43], v[60:63], v[168:171]
    v_mfma_f32_16x16x32_bf16 v[172:175], v[44:47], v[60:63], v[172:175]
    ds_read_b64_tr_b16 v[28:29], v18 offset:0
    ds_read_b64_tr_b16 v[30:31], v18 offset:1024
    v_mfma_f32_16x16x32_bf16 v[176:179], v[48:51], v[60:63], v[176:179]
    s_waitcnt lgkmcnt(8)
    v_mfma_f32_16x16x32_bf16 v[180:183], v[36:39], v[64:67], v[180:183]
    ds_read_b128 v[60:63], v7 offset:0
    v_mfma_f32_16x16x32_bf16 v[184:187], v[40:43], v[64:67], v[184:187]
    v_mfma_f32_16x16x32_bf16 v[188:191], v[44:47], v[64:67], v[188:191]
    ds_read_b64_tr_b16 v[32:33], v19 offset:0
    ds_read_b64_tr_b16 v[34:35], v19 offset:1024
    v_mfma_f32_16x16x32_bf16 v[192:195], v[48:51], v[64:67], v[192:195]
    s_waitcnt lgkmcnt(8)
    v_mfma_f32_16x16x32_bf16 v[68:71], v[20:23], v[52:55], v[68:71]
    ds_read_b128 v[64:67], v7 offset:2048
    s_waitcnt lgkmcnt(7)
    v_mfma_f32_16x16x32_bf16 v[72:75], v[24:27], v[52:55], v[72:75]
    v_lshlrev_b32 v244, 4, v1
    s_lshl_b32 s53, s43, 19
    s_lshl_b32 s48, s42, 16
    s_waitcnt lgkmcnt(4)
    v_mfma_f32_16x16x32_bf16 v[76:79], v[28:31], v[52:55], v[76:79]
    ds_read_b64_tr_b16 v[36:37], v16 offset:16384
    ds_read_b64_tr_b16 v[38:39], v16 offset:17408
    s_waitcnt lgkmcnt(3)
    v_mfma_f32_16x16x32_bf16 v[80:83], v[32:35], v[52:55], v[80:83]
    ds_read_b64_tr_b16 v[40:41], v17 offset:16384
    ds_read_b64_tr_b16 v[42:43], v17 offset:17408
    s_add_u32 s53, s53, s48
    s_lshl_b32 s48, s45, 15
    s_add_u32 s53, s53, s48
    v_mfma_f32_16x16x32_bf16 v[84:87], v[20:23], v[56:59], v[84:87]
    ds_read_b128 v[52:55], v6 offset:4096
    v_mfma_f32_16x16x32_bf16 v[88:91], v[24:27], v[56:59], v[88:91]
    s_and_b32 s48, s46, 1
    s_lshl_b32 s48, s48, 11
    s_add_u32 s53, s53, s48
    v_mfma_f32_16x16x32_bf16 v[92:95], v[28:31], v[56:59], v[92:95]
    ds_read_b64_tr_b16 v[44:45], v18 offset:16384
    ds_read_b64_tr_b16 v[46:47], v18 offset:17408
    v_mfma_f32_16x16x32_bf16 v[96:99], v[32:35], v[56:59], v[96:99]
    ds_read_b64_tr_b16 v[48:49], v19 offset:16384
    ds_read_b64_tr_b16 v[50:51], v19 offset:17408
    s_waitcnt lgkmcnt(7)
    v_mfma_f32_16x16x32_bf16 v[68:71], v[36:39], v[60:63], v[68:71]
    ds_read_b128 v[56:59], v6 offset:6144
    s_waitcnt lgkmcnt(6)
    v_mfma_f32_16x16x32_bf16 v[72:75], v[40:43], v[60:63], v[72:75]
    s_waitcnt lgkmcnt(3)
    v_mfma_f32_16x16x32_bf16 v[76:79], v[44:47], v[60:63], v[76:79]
    s_waitcnt lgkmcnt(1)
    v_mfma_f32_16x16x32_bf16 v[80:83], v[48:51], v[60:63], v[80:83]
    v_mfma_f32_16x16x32_bf16 v[84:87], v[36:39], v[64:67], v[84:87]
    ds_read_b128 v[60:63], v7 offset:4096
    v_mfma_f32_16x16x32_bf16 v[88:91], v[40:43], v[64:67], v[88:91]
    v_mfma_f32_16x16x32_bf16 v[92:95], v[44:47], v[64:67], v[92:95]
    v_mfma_f32_16x16x32_bf16 v[96:99], v[48:51], v[64:67], v[96:99]
    v_mfma_f32_16x16x32_bf16 v[100:103], v[20:23], v[52:55], v[100:103]
    ds_read_b128 v[64:67], v7 offset:6144
    v_mfma_f32_16x16x32_bf16 v[104:107], v[24:27], v[52:55], v[104:107]
    v_mfma_f32_16x16x32_bf16 v[108:111], v[28:31], v[52:55], v[108:111]
    v_mfma_f32_16x16x32_bf16 v[112:115], v[32:35], v[52:55], v[112:115]
    s_waitcnt vmcnt(0)
    s_barrier
    s_waitcnt lgkmcnt(2)
    v_mfma_f32_16x16x32_bf16 v[116:119], v[20:23], v[56:59], v[116:119]
    ds_read_b128 v[52:55], v6 offset:32768
    v_mfma_f32_16x16x32_bf16 v[120:123], v[24:27], v[56:59], v[120:123]
    v_mfma_f32_16x16x32_bf16 v[124:127], v[28:31], v[56:59], v[124:127]
    ds_read_b64_tr_b16 v[196:197], v16 offset:32768
    ds_read_b64_tr_b16 v[198:199], v16 offset:33792
    v_mfma_f32_16x16x32_bf16 v[128:131], v[32:35], v[56:59], v[128:131]
    ds_read_b64_tr_b16 v[200:201], v17 offset:32768
    ds_read_b64_tr_b16 v[202:203], v17 offset:33792
    s_waitcnt lgkmcnt(6)
    v_mfma_f32_16x16x32_bf16 v[100:103], v[36:39], v[60:63], v[100:103]
    ds_read_b128 v[56:59], v6 offset:34816
    v_mfma_f32_16x16x32_bf16 v[104:107], v[40:43], v[60:63], v[104:107]
    v_mfma_f32_16x16x32_bf16 v[108:111], v[44:47], v[60:63], v[108:111]
    ds_read_b64_tr_b16 v[204:205], v18 offset:32768
    ds_read_b64_tr_b16 v[206:207], v18 offset:33792
    v_mfma_f32_16x16x32_bf16 v[112:115], v[48:51], v[60:63], v[112:115]
    ds_read_b64_tr_b16 v[208:209], v19 offset:32768
    ds_read_b64_tr_b16 v[210:211], v19 offset:33792
    s_waitcnt lgkmcnt(10)
    v_mfma_f32_16x16x32_bf16 v[116:119], v[36:39], v[64:67], v[116:119]
    ds_read_b128 v[60:63], v7 offset:32768
    v_mfma_f32_16x16x32_bf16 v[120:123], v[40:43], v[64:67], v[120:123]
    v_mfma_f32_16x16x32_bf16 v[124:127], v[44:47], v[64:67], v[124:127]
    ds_read_b64_tr_b16 v[212:213], v16 offset:49152
    ds_read_b64_tr_b16 v[214:215], v16 offset:50176
    v_mfma_f32_16x16x32_bf16 v[128:131], v[48:51], v[64:67], v[128:131]
    ds_read_b64_tr_b16 v[216:217], v17 offset:49152
    ds_read_b64_tr_b16 v[218:219], v17 offset:50176
    s_waitcnt lgkmcnt(14)
    s_waitcnt lgkmcnt(12)
    v_mfma_f32_16x16x32_bf16 v[68:71], v[196:199], v[52:55], v[68:71]
    ds_read_b128 v[64:67], v7 offset:34816
    s_waitcnt lgkmcnt(11)
    v_mfma_f32_16x16x32_bf16 v[72:75], v[200:203], v[52:55], v[72:75]
    s_waitcnt lgkmcnt(8)
    v_mfma_f32_16x16x32_bf16 v[76:79], v[204:207], v[52:55], v[76:79]
    ds_read_b64_tr_b16 v[220:221], v18 offset:49152
    ds_read_b64_tr_b16 v[222:223], v18 offset:50176
    s_waitcnt lgkmcnt(8)
    v_mfma_f32_16x16x32_bf16 v[80:83], v[208:211], v[52:55], v[80:83]
    ds_read_b64_tr_b16 v[224:225], v19 offset:49152
    ds_read_b64_tr_b16 v[226:227], v19 offset:50176
    v_mfma_f32_16x16x32_bf16 v[84:87], v[196:199], v[56:59], v[84:87]
    ds_read_b128 v[52:55], v6 offset:36864
    v_mfma_f32_16x16x32_bf16 v[88:91], v[200:203], v[56:59], v[88:91]
    v_mfma_f32_16x16x32_bf16 v[92:95], v[204:207], v[56:59], v[92:95]
    v_mfma_f32_16x16x32_bf16 v[96:99], v[208:211], v[56:59], v[96:99]
    s_waitcnt lgkmcnt(10)
    s_waitcnt lgkmcnt(8)
    v_mfma_f32_16x16x32_bf16 v[68:71], v[212:215], v[60:63], v[68:71]
    ds_read_b128 v[56:59], v6 offset:38912
    s_waitcnt lgkmcnt(7)
    v_mfma_f32_16x16x32_bf16 v[72:75], v[216:219], v[60:63], v[72:75]
    s_waitcnt lgkmcnt(4)
    v_mfma_f32_16x16x32_bf16 v[76:79], v[220:223], v[60:63], v[76:79]
    s_waitcnt lgkmcnt(2)
    v_mfma_f32_16x16x32_bf16 v[80:83], v[224:227], v[60:63], v[80:83]
    v_mfma_f32_16x16x32_bf16 v[84:87], v[212:215], v[64:67], v[84:87]
    ds_read_b128 v[60:63], v7 offset:36864
    v_mfma_f32_16x16x32_bf16 v[88:91], v[216:219], v[64:67], v[88:91]
    v_mfma_f32_16x16x32_bf16 v[92:95], v[220:223], v[64:67], v[92:95]
    v_mfma_f32_16x16x32_bf16 v[96:99], v[224:227], v[64:67], v[96:99]
    s_waitcnt lgkmcnt(2)
    v_mfma_f32_16x16x32_bf16 v[100:103], v[196:199], v[52:55], v[100:103]
    ds_read_b128 v[64:67], v7 offset:38912
    v_mfma_f32_16x16x32_bf16 v[104:107], v[200:203], v[52:55], v[104:107]
    v_mfma_f32_16x16x32_bf16 v[108:111], v[204:207], v[52:55], v[108:111]
    v_mfma_f32_16x16x32_bf16 v[112:115], v[208:211], v[52:55], v[112:115]
    s_waitcnt lgkmcnt(2)
    v_mfma_f32_16x16x32_bf16 v[116:119], v[196:199], v[56:59], v[116:119]
    ds_read_b128 v[52:55], v6 offset:8192
    v_mfma_f32_16x16x32_bf16 v[120:123], v[200:203], v[56:59], v[120:123]
    v_cvt_pk_bf16_f32 v228, v68, v69
    v_cvt_pk_bf16_f32 v229, v70, v71
    v_cvt_pk_bf16_f32 v230, v72, v73
    v_mfma_f32_16x16x32_bf16 v[124:127], v[204:207], v[56:59], v[124:127]
    v_mfma_f32_16x16x32_bf16 v[128:131], v[208:211], v[56:59], v[128:131]
    v_cvt_pk_bf16_f32 v231, v74, v75
    buffer_store_dwordx4 v[228:231], v244, s[20:23], s53 offen offset:0 sc1
    v_cvt_pk_bf16_f32 v232, v76, v77
    s_waitcnt lgkmcnt(2)
    v_mfma_f32_16x16x32_bf16 v[100:103], v[212:215], v[60:63], v[100:103]
    ds_read_b128 v[56:59], v6 offset:10240
    v_mfma_f32_16x16x32_bf16 v[104:107], v[216:219], v[60:63], v[104:107]
    v_cvt_pk_bf16_f32 v233, v78, v79
    v_cvt_pk_bf16_f32 v234, v80, v81
    v_cvt_pk_bf16_f32 v235, v82, v83
    v_mfma_f32_16x16x32_bf16 v[108:111], v[220:223], v[60:63], v[108:111]
    v_mfma_f32_16x16x32_bf16 v[112:115], v[224:227], v[60:63], v[112:115]
    buffer_store_dwordx4 v[232:235], v244, s[20:23], s53 offen offset:1024 sc1
    s_add_u32 s53, s53, 4096
    v_cvt_pk_bf16_f32 v236, v84, v85
    s_waitcnt lgkmcnt(2)
    v_mfma_f32_16x16x32_bf16 v[116:119], v[212:215], v[64:67], v[116:119]
    ds_read_b128 v[60:63], v7 offset:8192
    v_mfma_f32_16x16x32_bf16 v[120:123], v[216:219], v[64:67], v[120:123]
    v_cvt_pk_bf16_f32 v237, v86, v87
    v_cvt_pk_bf16_f32 v238, v88, v89
    v_cvt_pk_bf16_f32 v239, v90, v91
    v_mfma_f32_16x16x32_bf16 v[124:127], v[220:223], v[64:67], v[124:127]
    v_mfma_f32_16x16x32_bf16 v[128:131], v[224:227], v[64:67], v[128:131]
    buffer_store_dwordx4 v[236:239], v244, s[20:23], s53 offen offset:0 sc1
    v_cvt_pk_bf16_f32 v240, v92, v93
    v_cvt_pk_bf16_f32 v241, v94, v95
    s_waitcnt lgkmcnt(2)
    v_mfma_f32_16x16x32_bf16 v[132:135], v[20:23], v[52:55], v[132:135]
    ds_read_b128 v[64:67], v7 offset:10240
    v_mfma_f32_16x16x32_bf16 v[136:139], v[24:27], v[52:55], v[136:139]
    v_cvt_pk_bf16_f32 v242, v96, v97
    v_cvt_pk_bf16_f32 v243, v98, v99
    buffer_store_dwordx4 v[240:243], v244, s[20:23], s53 offen offset:1024 sc1
    v_mfma_f32_16x16x32_bf16 v[140:143], v[28:31], v[52:55], v[140:143]
    v_mfma_f32_16x16x32_bf16 v[144:147], v[32:35], v[52:55], v[144:147]
    s_add_u32 s53, s53, 4096
    s_waitcnt lgkmcnt(2)
    v_mfma_f32_16x16x32_bf16 v[148:151], v[20:23], v[56:59], v[148:151]
    ds_read_b128 v[52:55], v6 offset:40960
    v_mfma_f32_16x16x32_bf16 v[152:155], v[24:27], v[56:59], v[152:155]
    v_cvt_pk_bf16_f32 v228, v100, v101
    v_cvt_pk_bf16_f32 v229, v102, v103
    v_cvt_pk_bf16_f32 v230, v104, v105
    v_mfma_f32_16x16x32_bf16 v[156:159], v[28:31], v[56:59], v[156:159]
    v_mfma_f32_16x16x32_bf16 v[160:163], v[32:35], v[56:59], v[160:163]
    v_cvt_pk_bf16_f32 v231, v106, v107
    buffer_store_dwordx4 v[228:231], v244, s[20:23], s53 offen offset:0 sc1
    v_cvt_pk_bf16_f32 v232, v108, v109
    s_waitcnt lgkmcnt(2)
    v_mfma_f32_16x16x32_bf16 v[132:135], v[36:39], v[60:63], v[132:135]
    ds_read_b128 v[56:59], v6 offset:43008
    v_mfma_f32_16x16x32_bf16 v[136:139], v[40:43], v[60:63], v[136:139]
    v_cvt_pk_bf16_f32 v233, v110, v111
    v_cvt_pk_bf16_f32 v234, v112, v113
    v_cvt_pk_bf16_f32 v235, v114, v115
    v_mfma_f32_16x16x32_bf16 v[140:143], v[44:47], v[60:63], v[140:143]
    v_mfma_f32_16x16x32_bf16 v[144:147], v[48:51], v[60:63], v[144:147]
    buffer_store_dwordx4 v[232:235], v244, s[20:23], s53 offen offset:1024 sc1
    s_add_u32 s53, s53, 4096
    v_cvt_pk_bf16_f32 v236, v116, v117
    s_waitcnt lgkmcnt(2)
    v_mfma_f32_16x16x32_bf16 v[148:151], v[36:39], v[64:67], v[148:151]
    ds_read_b128 v[60:63], v7 offset:40960
    v_mfma_f32_16x16x32_bf16 v[152:155], v[40:43], v[64:67], v[152:155]
    v_cvt_pk_bf16_f32 v237, v118, v119
    v_cvt_pk_bf16_f32 v238, v120, v121
    v_cvt_pk_bf16_f32 v239, v122, v123
    v_mfma_f32_16x16x32_bf16 v[156:159], v[44:47], v[64:67], v[156:159]
    v_mfma_f32_16x16x32_bf16 v[160:163], v[48:51], v[64:67], v[160:163]
    buffer_store_dwordx4 v[236:239], v244, s[20:23], s53 offen offset:0 sc1
    v_cvt_pk_bf16_f32 v240, v124, v125
    v_cvt_pk_bf16_f32 v241, v126, v127
    s_waitcnt lgkmcnt(2)
    v_mfma_f32_16x16x32_bf16 v[132:135], v[196:199], v[52:55], v[132:135]
    ds_read_b128 v[64:67], v7 offset:43008
    v_mfma_f32_16x16x32_bf16 v[136:139], v[200:203], v[52:55], v[136:139]
    v_cvt_pk_bf16_f32 v242, v128, v129
    v_cvt_pk_bf16_f32 v243, v130, v131
    buffer_store_dwordx4 v[240:243], v244, s[20:23], s53 offen offset:1024 sc1
    v_mfma_f32_16x16x32_bf16 v[140:143], v[204:207], v[52:55], v[140:143]
    v_mfma_f32_16x16x32_bf16 v[144:147], v[208:211], v[52:55], v[144:147]
    s_add_u32 s53, s53, 4096
    s_waitcnt lgkmcnt(2)
    v_mfma_f32_16x16x32_bf16 v[148:151], v[196:199], v[56:59], v[148:151]
    ds_read_b128 v[52:55], v6 offset:12288
    v_mfma_f32_16x16x32_bf16 v[152:155], v[200:203], v[56:59], v[152:155]
    v_mfma_f32_16x16x32_bf16 v[156:159], v[204:207], v[56:59], v[156:159]
    v_mfma_f32_16x16x32_bf16 v[160:163], v[208:211], v[56:59], v[160:163]
    s_waitcnt lgkmcnt(2)
    v_mfma_f32_16x16x32_bf16 v[132:135], v[212:215], v[60:63], v[132:135]
    ds_read_b128 v[56:59], v6 offset:14336
    v_mfma_f32_16x16x32_bf16 v[136:139], v[216:219], v[60:63], v[136:139]
    v_mfma_f32_16x16x32_bf16 v[140:143], v[220:223], v[60:63], v[140:143]
    v_mfma_f32_16x16x32_bf16 v[144:147], v[224:227], v[60:63], v[144:147]
    s_waitcnt lgkmcnt(2)
    v_mfma_f32_16x16x32_bf16 v[148:151], v[212:215], v[64:67], v[148:151]
    ds_read_b128 v[60:63], v7 offset:12288
    v_mfma_f32_16x16x32_bf16 v[152:155], v[216:219], v[64:67], v[152:155]
    v_mfma_f32_16x16x32_bf16 v[156:159], v[220:223], v[64:67], v[156:159]
    v_mfma_f32_16x16x32_bf16 v[160:163], v[224:227], v[64:67], v[160:163]
    s_waitcnt lgkmcnt(2)
    v_mfma_f32_16x16x32_bf16 v[164:167], v[20:23], v[52:55], v[164:167]
    ds_read_b128 v[64:67], v7 offset:14336
    v_mfma_f32_16x16x32_bf16 v[168:171], v[24:27], v[52:55], v[168:171]
    v_mfma_f32_16x16x32_bf16 v[172:175], v[28:31], v[52:55], v[172:175]
    v_mfma_f32_16x16x32_bf16 v[176:179], v[32:35], v[52:55], v[176:179]
    s_waitcnt lgkmcnt(2)
    v_mfma_f32_16x16x32_bf16 v[180:183], v[20:23], v[56:59], v[180:183]
    ds_read_b128 v[52:55], v6 offset:45056
    v_mfma_f32_16x16x32_bf16 v[184:187], v[24:27], v[56:59], v[184:187]
    v_cvt_pk_bf16_f32 v228, v132, v133
    v_cvt_pk_bf16_f32 v229, v134, v135
    v_cvt_pk_bf16_f32 v230, v136, v137
    v_mfma_f32_16x16x32_bf16 v[188:191], v[28:31], v[56:59], v[188:191]
    v_mfma_f32_16x16x32_bf16 v[192:195], v[32:35], v[56:59], v[192:195]
    v_cvt_pk_bf16_f32 v231, v138, v139
    buffer_store_dwordx4 v[228:231], v244, s[20:23], s53 offen offset:0 sc1
    v_cvt_pk_bf16_f32 v232, v140, v141
    s_waitcnt lgkmcnt(2)
    v_mfma_f32_16x16x32_bf16 v[164:167], v[36:39], v[60:63], v[164:167]
    ds_read_b128 v[56:59], v6 offset:47104
    v_mfma_f32_16x16x32_bf16 v[168:171], v[40:43], v[60:63], v[168:171]
    v_cvt_pk_bf16_f32 v233, v142, v143
    v_cvt_pk_bf16_f32 v234, v144, v145
    v_cvt_pk_bf16_f32 v235, v146, v147
    v_mfma_f32_16x16x32_bf16 v[172:175], v[44:47], v[60:63], v[172:175]
    v_mfma_f32_16x16x32_bf16 v[176:179], v[48:51], v[60:63], v[176:179]
    buffer_store_dwordx4 v[232:235], v244, s[20:23], s53 offen offset:1024 sc1
    s_add_u32 s53, s53, 4096
    v_cvt_pk_bf16_f32 v236, v148, v149
    s_waitcnt lgkmcnt(2)
    v_mfma_f32_16x16x32_bf16 v[180:183], v[36:39], v[64:67], v[180:183]
    ds_read_b128 v[60:63], v7 offset:45056
    v_mfma_f32_16x16x32_bf16 v[184:187], v[40:43], v[64:67], v[184:187]
    v_cvt_pk_bf16_f32 v237, v150, v151
    v_cvt_pk_bf16_f32 v238, v152, v153
    v_cvt_pk_bf16_f32 v239, v154, v155
    v_mfma_f32_16x16x32_bf16 v[188:191], v[44:47], v[64:67], v[188:191]
    v_mfma_f32_16x16x32_bf16 v[192:195], v[48:51], v[64:67], v[192:195]
    buffer_store_dwordx4 v[236:239], v244, s[20:23], s53 offen offset:0 sc1
    v_cvt_pk_bf16_f32 v240, v156, v157
    v_cvt_pk_bf16_f32 v241, v158, v159
    s_waitcnt lgkmcnt(2)
    v_mfma_f32_16x16x32_bf16 v[164:167], v[196:199], v[52:55], v[164:167]
    ds_read_b128 v[64:67], v7 offset:47104
    v_mfma_f32_16x16x32_bf16 v[168:171], v[200:203], v[52:55], v[168:171]
    v_cvt_pk_bf16_f32 v242, v160, v161
    v_cvt_pk_bf16_f32 v243, v162, v163
    buffer_store_dwordx4 v[240:243], v244, s[20:23], s53 offen offset:1024 sc1
    v_mfma_f32_16x16x32_bf16 v[172:175], v[204:207], v[52:55], v[172:175]
    v_mfma_f32_16x16x32_bf16 v[176:179], v[208:211], v[52:55], v[176:179]
    s_add_u32 s53, s53, 4096
    s_waitcnt lgkmcnt(2)
    v_mfma_f32_16x16x32_bf16 v[180:183], v[196:199], v[56:59], v[180:183]
    v_mfma_f32_16x16x32_bf16 v[184:187], v[200:203], v[56:59], v[184:187]
    v_mfma_f32_16x16x32_bf16 v[188:191], v[204:207], v[56:59], v[188:191]
    v_mfma_f32_16x16x32_bf16 v[192:195], v[208:211], v[56:59], v[192:195]
    s_waitcnt lgkmcnt(1)
    v_mfma_f32_16x16x32_bf16 v[164:167], v[212:215], v[60:63], v[164:167]
    v_mfma_f32_16x16x32_bf16 v[168:171], v[216:219], v[60:63], v[168:171]
    v_mfma_f32_16x16x32_bf16 v[172:175], v[220:223], v[60:63], v[172:175]
    v_mfma_f32_16x16x32_bf16 v[176:179], v[224:227], v[60:63], v[176:179]
    s_waitcnt lgkmcnt(0)
    v_mfma_f32_16x16x32_bf16 v[180:183], v[212:215], v[64:67], v[180:183]
    v_mfma_f32_16x16x32_bf16 v[184:187], v[216:219], v[64:67], v[184:187]
    v_mfma_f32_16x16x32_bf16 v[188:191], v[220:223], v[64:67], v[188:191]
    v_mfma_f32_16x16x32_bf16 v[192:195], v[224:227], v[64:67], v[192:195]
    v_cvt_pk_bf16_f32 v228, v164, v165
    v_cvt_pk_bf16_f32 v229, v166, v167
    v_cvt_pk_bf16_f32 v230, v168, v169
    v_cvt_pk_bf16_f32 v231, v170, v171
    buffer_store_dwordx4 v[228:231], v244, s[20:23], s53 offen offset:0 sc1
    v_cvt_pk_bf16_f32 v232, v172, v173
    v_cvt_pk_bf16_f32 v233, v174, v175
    v_cvt_pk_bf16_f32 v234, v176, v177
    v_cvt_pk_bf16_f32 v235, v178, v179
    buffer_store_dwordx4 v[232:235], v244, s[20:23], s53 offen offset:1024 sc1
    s_add_u32 s53, s53, 4096
    v_cvt_pk_bf16_f32 v236, v180, v181
    v_cvt_pk_bf16_f32 v237, v182, v183
    v_cvt_pk_bf16_f32 v238, v184, v185
    v_cvt_pk_bf16_f32 v239, v186, v187
    buffer_store_dwordx4 v[236:239], v244, s[20:23], s53 offen offset:0 sc1
    v_cvt_pk_bf16_f32 v240, v188, v189
    v_cvt_pk_bf16_f32 v241, v190, v191
    v_cvt_pk_bf16_f32 v242, v192, v193
    v_cvt_pk_bf16_f32 v243, v194, v195
    buffer_store_dwordx4 v[240:243], v244, s[20:23], s53 offen offset:1024 sc1
    s_add_u32 s53, s53, 4096
    s_branch L_k1_kv_kernel_after_3
L_k1_kv_kernel_vwave_2:
    ds_read_b64_tr_b16 v[20:21], v16 offset:0
    ds_read_b64_tr_b16 v[22:23], v16 offset:1024
    ds_read_b64_tr_b16 v[24:25], v17 offset:0
    ds_read_b64_tr_b16 v[26:27], v17 offset:1024
    ds_read_b64_tr_b16 v[28:29], v18 offset:0
    ds_read_b64_tr_b16 v[30:31], v18 offset:1024
    ds_read_b64_tr_b16 v[32:33], v19 offset:0
    ds_read_b64_tr_b16 v[34:35], v19 offset:1024
    ds_read_b128 v[52:55], v6 offset:0
    ds_read_b128 v[56:59], v6 offset:2048
    ds_read_b128 v[60:63], v6 offset:4096
    s_waitcnt lgkmcnt(2)
    v_mfma_f32_16x16x32_bf16 v[68:71], v[52:55], v[20:23], 0
    ds_read_b128 v[64:67], v6 offset:6144
    v_mfma_f32_16x16x32_bf16 v[72:75], v[52:55], v[24:27], 0
    v_mfma_f32_16x16x32_bf16 v[76:79], v[52:55], v[28:31], 0
    v_mfma_f32_16x16x32_bf16 v[80:83], v[52:55], v[32:35], 0
    s_add_u32 m0, s52, 16384
    s_nop 0
    buffer_load_dwordx4 v4, s[24:27], s50 offen lds
    buffer_load_dwordx4 v5, s[24:27], s50 offen offset:1024 lds
    s_add_u32 s50, s50, 262144
    s_waitcnt lgkmcnt(2)
    v_mfma_f32_16x16x32_bf16 v[84:87], v[56:59], v[20:23], 0
    ds_read_b128 v[52:55], v6 offset:8192
    v_mfma_f32_16x16x32_bf16 v[88:91], v[56:59], v[24:27], 0
    v_mfma_f32_16x16x32_bf16 v[92:95], v[56:59], v[28:31], 0
    v_mfma_f32_16x16x32_bf16 v[96:99], v[56:59], v[32:35], 0
    s_add_u32 m0, s51, 32768
    s_add_u32 s47, s49, 128
    buffer_load_dwordx4 v2, s[8:11], s47 offen lds
    buffer_load_dwordx4 v3, s[8:11], s47 offen offset:1024 lds
    s_waitcnt lgkmcnt(2)
    v_mfma_f32_16x16x32_bf16 v[100:103], v[60:63], v[20:23], 0
    ds_read_b128 v[56:59], v6 offset:10240
    v_mfma_f32_16x16x32_bf16 v[104:107], v[60:63], v[24:27], 0
    s_add_u32 m0, s51, 49152
    s_add_u32 s47, s49, 131200
    buffer_load_dwordx4 v2, s[8:11], s47 offen lds
    buffer_load_dwordx4 v3, s[8:11], s47 offen offset:1024 lds
    v_mfma_f32_16x16x32_bf16 v[108:111], v[60:63], v[28:31], 0
    v_mfma_f32_16x16x32_bf16 v[112:115], v[60:63], v[32:35], 0
    s_add_u32 m0, s52, 32768
    s_nop 0
    buffer_load_dwordx4 v4, s[24:27], s50 offen lds
    buffer_load_dwordx4 v5, s[24:27], s50 offen offset:1024 lds
    s_add_u32 s50, s50, 262144
    s_add_u32 m0, s52, 49152
    s_nop 0
    buffer_load_dwordx4 v4, s[24:27], s50 offen lds
    buffer_load_dwordx4 v5, s[24:27], s50 offen offset:1024 lds
    s_add_u32 s50, s50, 262144
    s_waitcnt vmcnt(8)
    s_barrier
    s_add_u32 m0, s52, 0
    s_nop 0
    buffer_load_dwordx4 v4, s[24:27], s50 offen lds
    buffer_load_dwordx4 v5, s[24:27], s50 offen offset:1024 lds
    s_add_u32 s50, s50, 262144
    s_add_u32 m0, s51, 65536
    s_add_u32 s47, s49, 256
    buffer_load_dwordx4 v2, s[8:11], s47 offen lds
    buffer_load_dwordx4 v3, s[8:11], s47 offen offset:1024 lds
    s_waitcnt lgkmcnt(2)
    v_mfma_f32_16x16x32_bf16 v[116:119], v[64:67], v[20:23], 0
    ds_read_b128 v[60:63], v6 offset:12288
    v_mfma_f32_16x16x32_bf16 v[120:123], v[64:67], v[24:27], 0
    v_mfma_f32_16x16x32_bf16 v[124:127], v[64:67], v[28:31], 0
    v_mfma_f32_16x16x32_bf16 v[128:131], v[64:67], v[32:35], 0
    s_waitcnt lgkmcnt(2)
    v_mfma_f32_16x16x32_bf16 v[132:135], v[52:55], v[20:23], 0
    ds_read_b128 v[64:67], v6 offset:14336
    v_mfma_f32_16x16x32_bf16 v[136:139], v[52:55], v[24:27], 0
    v_mfma_f32_16x16x32_bf16 v[140:143], v[52:55], v[28:31], 0
    ds_read_b64_tr_b16 v[36:37], v16 offset:16384
    ds_read_b64_tr_b16 v[38:39], v16 offset:17408
    v_mfma_f32_16x16x32_bf16 v[144:147], v[52:55], v[32:35], 0
    s_waitcnt lgkmcnt(4)
    v_mfma_f32_16x16x32_bf16 v[148:151], v[56:59], v[20:23], 0
    ds_read_b128 v[52:55], v7 offset:0
    v_mfma_f32_16x16x32_bf16 v[152:155], v[56:59], v[24:27], 0
    v_mfma_f32_16x16x32_bf16 v[156:159], v[56:59], v[28:31], 0
    ds_read_b64_tr_b16 v[40:41], v17 offset:16384
    ds_read_b64_tr_b16 v[42:43], v17 offset:17408
    v_mfma_f32_16x16x32_bf16 v[160:163], v[56:59], v[32:35], 0
    s_waitcnt lgkmcnt(6)
    v_mfma_f32_16x16x32_bf16 v[164:167], v[60:63], v[20:23], 0
    ds_read_b128 v[56:59], v7 offset:2048
    v_mfma_f32_16x16x32_bf16 v[168:171], v[60:63], v[24:27], 0
    v_mfma_f32_16x16x32_bf16 v[172:175], v[60:63], v[28:31], 0
    ds_read_b64_tr_b16 v[44:45], v18 offset:16384
    ds_read_b64_tr_b16 v[46:47], v18 offset:17408
    v_mfma_f32_16x16x32_bf16 v[176:179], v[60:63], v[32:35], 0
    s_waitcnt lgkmcnt(8)
    v_mfma_f32_16x16x32_bf16 v[180:183], v[64:67], v[20:23], 0
    ds_read_b128 v[60:63], v7 offset:4096
    v_mfma_f32_16x16x32_bf16 v[184:187], v[64:67], v[24:27], 0
    v_mfma_f32_16x16x32_bf16 v[188:191], v[64:67], v[28:31], 0
    ds_read_b64_tr_b16 v[48:49], v19 offset:16384
    ds_read_b64_tr_b16 v[50:51], v19 offset:17408
    v_mfma_f32_16x16x32_bf16 v[192:195], v[64:67], v[32:35], 0
    s_waitcnt lgkmcnt(8)
    v_mfma_f32_16x16x32_bf16 v[68:71], v[52:55], v[36:39], v[68:71]
    ds_read_b128 v[64:67], v7 offset:6144
    s_waitcnt lgkmcnt(7)
    v_mfma_f32_16x16x32_bf16 v[72:75], v[52:55], v[40:43], v[72:75]
    s_waitcnt lgkmcnt(4)
    v_mfma_f32_16x16x32_bf16 v[76:79], v[52:55], v[44:47], v[76:79]
    s_waitcnt lgkmcnt(1)
    v_mfma_f32_16x16x32_bf16 v[80:83], v[52:55], v[48:51], v[80:83]
    v_mfma_f32_16x16x32_bf16 v[84:87], v[56:59], v[36:39], v[84:87]
    ds_read_b128 v[52:55], v7 offset:8192
    v_mfma_f32_16x16x32_bf16 v[88:91], v[56:59], v[40:43], v[88:91]
    v_mfma_f32_16x16x32_bf16 v[92:95], v[56:59], v[44:47], v[92:95]
    v_mfma_f32_16x16x32_bf16 v[96:99], v[56:59], v[48:51], v[96:99]
    v_mfma_f32_16x16x32_bf16 v[100:103], v[60:63], v[36:39], v[100:103]
    ds_read_b128 v[56:59], v7 offset:10240
    v_mfma_f32_16x16x32_bf16 v[104:107], v[60:63], v[40:43], v[104:107]
    v_mfma_f32_16x16x32_bf16 v[108:111], v[60:63], v[44:47], v[108:111]
    v_mfma_f32_16x16x32_bf16 v[112:115], v[60:63], v[48:51], v[112:115]
    s_waitcnt vmcnt(6)
    s_barrier
    s_add_u32 m0, s52, 16384
    s_nop 0
    buffer_load_dwordx4 v4, s[24:27], s50 offen lds
    buffer_load_dwordx4 v5, s[24:27], s50 offen offset:1024 lds
    s_add_u32 s50, s50, 262144
    s_add_u32 m0, s51, 81920
    s_add_u32 s47, s49, 131328
    buffer_load_dwordx4 v2, s[8:11], s47 offen lds
    buffer_load_dwordx4 v3, s[8:11], s47 offen offset:1024 lds
    s_waitcnt lgkmcnt(2)
    v_mfma_f32_16x16x32_bf16 v[116:119], v[64:67], v[36:39], v[116:119]
    ds_read_b128 v[60:63], v7 offset:12288
    v_mfma_f32_16x16x32_bf16 v[120:123], v[64:67], v[40:43], v[120:123]
    v_mfma_f32_16x16x32_bf16 v[124:127], v[64:67], v[44:47], v[124:127]
    v_mfma_f32_16x16x32_bf16 v[128:131], v[64:67], v[48:51], v[128:131]
    s_waitcnt lgkmcnt(2)
    v_mfma_f32_16x16x32_bf16 v[132:135], v[52:55], v[36:39], v[132:135]
    ds_read_b128 v[64:67], v7 offset:14336
    v_mfma_f32_16x16x32_bf16 v[136:139], v[52:55], v[40:43], v[136:139]
    v_mfma_f32_16x16x32_bf16 v[140:143], v[52:55], v[44:47], v[140:143]
    ds_read_b64_tr_b16 v[20:21], v16 offset:32768
    ds_read_b64_tr_b16 v[22:23], v16 offset:33792
    v_mfma_f32_16x16x32_bf16 v[144:147], v[52:55], v[48:51], v[144:147]
    s_waitcnt lgkmcnt(4)
    v_mfma_f32_16x16x32_bf16 v[148:151], v[56:59], v[36:39], v[148:151]
    ds_read_b128 v[52:55], v6 offset:32768
    v_mfma_f32_16x16x32_bf16 v[152:155], v[56:59], v[40:43], v[152:155]
    v_mfma_f32_16x16x32_bf16 v[156:159], v[56:59], v[44:47], v[156:159]
    ds_read_b64_tr_b16 v[24:25], v17 offset:32768
    ds_read_b64_tr_b16 v[26:27], v17 offset:33792
    v_mfma_f32_16x16x32_bf16 v[160:163], v[56:59], v[48:51], v[160:163]
    s_waitcnt lgkmcnt(6)
    v_mfma_f32_16x16x32_bf16 v[164:167], v[60:63], v[36:39], v[164:167]
    ds_read_b128 v[56:59], v6 offset:34816
    v_mfma_f32_16x16x32_bf16 v[168:171], v[60:63], v[40:43], v[168:171]
    v_mfma_f32_16x16x32_bf16 v[172:175], v[60:63], v[44:47], v[172:175]
    ds_read_b64_tr_b16 v[28:29], v18 offset:32768
    ds_read_b64_tr_b16 v[30:31], v18 offset:33792
    v_mfma_f32_16x16x32_bf16 v[176:179], v[60:63], v[48:51], v[176:179]
    s_waitcnt lgkmcnt(8)
    v_mfma_f32_16x16x32_bf16 v[180:183], v[64:67], v[36:39], v[180:183]
    ds_read_b128 v[60:63], v6 offset:36864
    v_mfma_f32_16x16x32_bf16 v[184:187], v[64:67], v[40:43], v[184:187]
    v_mfma_f32_16x16x32_bf16 v[188:191], v[64:67], v[44:47], v[188:191]
    ds_read_b64_tr_b16 v[32:33], v19 offset:32768
    ds_read_b64_tr_b16 v[34:35], v19 offset:33792
    v_mfma_f32_16x16x32_bf16 v[192:195], v[64:67], v[48:51], v[192:195]
    s_waitcnt lgkmcnt(8)
    v_mfma_f32_16x16x32_bf16 v[68:71], v[52:55], v[20:23], v[68:71]
    ds_read_b128 v[64:67], v6 offset:38912
    s_waitcnt lgkmcnt(7)
    v_mfma_f32_16x16x32_bf16 v[72:75], v[52:55], v[24:27], v[72:75]
    s_waitcnt lgkmcnt(4)
    v_mfma_f32_16x16x32_bf16 v[76:79], v[52:55], v[28:31], v[76:79]
    s_waitcnt lgkmcnt(1)
    v_mfma_f32_16x16x32_bf16 v[80:83], v[52:55], v[32:35], v[80:83]
    v_mfma_f32_16x16x32_bf16 v[84:87], v[56:59], v[20:23], v[84:87]
    ds_read_b128 v[52:55], v6 offset:40960
    v_mfma_f32_16x16x32_bf16 v[88:91], v[56:59], v[24:27], v[88:91]
    v_mfma_f32_16x16x32_bf16 v[92:95], v[56:59], v[28:31], v[92:95]
    v_mfma_f32_16x16x32_bf16 v[96:99], v[56:59], v[32:35], v[96:99]
    v_mfma_f32_16x16x32_bf16 v[100:103], v[60:63], v[20:23], v[100:103]
    ds_read_b128 v[56:59], v6 offset:43008
    v_mfma_f32_16x16x32_bf16 v[104:107], v[60:63], v[24:27], v[104:107]
    v_mfma_f32_16x16x32_bf16 v[108:111], v[60:63], v[28:31], v[108:111]
    v_mfma_f32_16x16x32_bf16 v[112:115], v[60:63], v[32:35], v[112:115]
    s_waitcnt vmcnt(8)
    s_barrier
    s_add_u32 m0, s52, 32768
    s_nop 0
    buffer_load_dwordx4 v4, s[24:27], s50 offen lds
    buffer_load_dwordx4 v5, s[24:27], s50 offen offset:1024 lds
    s_add_u32 s50, s50, 262144
    s_add_u32 m0, s51, 0
    s_add_u32 s47, s49, 384
    buffer_load_dwordx4 v2, s[8:11], s47 offen lds
    buffer_load_dwordx4 v3, s[8:11], s47 offen offset:1024 lds
    s_waitcnt lgkmcnt(2)
    v_mfma_f32_16x16x32_bf16 v[116:119], v[64:67], v[20:23], v[116:119]
    ds_read_b128 v[60:63], v6 offset:45056
    v_mfma_f32_16x16x32_bf16 v[120:123], v[64:67], v[24:27], v[120:123]
    v_mfma_f32_16x16x32_bf16 v[124:127], v[64:67], v[28:31], v[124:127]
    v_mfma_f32_16x16x32_bf16 v[128:131], v[64:67], v[32:35], v[128:131]
    s_waitcnt lgkmcnt(2)
    v_mfma_f32_16x16x32_bf16 v[132:135], v[52:55], v[20:23], v[132:135]
    ds_read_b128 v[64:67], v6 offset:47104
    v_mfma_f32_16x16x32_bf16 v[136:139], v[52:55], v[24:27], v[136:139]
    v_mfma_f32_16x16x32_bf16 v[140:143], v[52:55], v[28:31], v[140:143]
    ds_read_b64_tr_b16 v[36:37], v16 offset:49152
    ds_read_b64_tr_b16 v[38:39], v16 offset:50176
    v_mfma_f32_16x16x32_bf16 v[144:147], v[52:55], v[32:35], v[144:147]
    s_waitcnt lgkmcnt(4)
    v_mfma_f32_16x16x32_bf16 v[148:151], v[56:59], v[20:23], v[148:151]
    ds_read_b128 v[52:55], v7 offset:32768
    v_mfma_f32_16x16x32_bf16 v[152:155], v[56:59], v[24:27], v[152:155]
    v_mfma_f32_16x16x32_bf16 v[156:159], v[56:59], v[28:31], v[156:159]
    ds_read_b64_tr_b16 v[40:41], v17 offset:49152
    ds_read_b64_tr_b16 v[42:43], v17 offset:50176
    v_mfma_f32_16x16x32_bf16 v[160:163], v[56:59], v[32:35], v[160:163]
    s_waitcnt lgkmcnt(6)
    v_mfma_f32_16x16x32_bf16 v[164:167], v[60:63], v[20:23], v[164:167]
    ds_read_b128 v[56:59], v7 offset:34816
    v_mfma_f32_16x16x32_bf16 v[168:171], v[60:63], v[24:27], v[168:171]
    v_mfma_f32_16x16x32_bf16 v[172:175], v[60:63], v[28:31], v[172:175]
    ds_read_b64_tr_b16 v[44:45], v18 offset:49152
    ds_read_b64_tr_b16 v[46:47], v18 offset:50176
    v_mfma_f32_16x16x32_bf16 v[176:179], v[60:63], v[32:35], v[176:179]
    s_waitcnt lgkmcnt(8)
    v_mfma_f32_16x16x32_bf16 v[180:183], v[64:67], v[20:23], v[180:183]
    ds_read_b128 v[60:63], v7 offset:36864
    v_mfma_f32_16x16x32_bf16 v[184:187], v[64:67], v[24:27], v[184:187]
    v_mfma_f32_16x16x32_bf16 v[188:191], v[64:67], v[28:31], v[188:191]
    ds_read_b64_tr_b16 v[48:49], v19 offset:49152
    ds_read_b64_tr_b16 v[50:51], v19 offset:50176
    v_mfma_f32_16x16x32_bf16 v[192:195], v[64:67], v[32:35], v[192:195]
    s_waitcnt lgkmcnt(8)
    v_mfma_f32_16x16x32_bf16 v[68:71], v[52:55], v[36:39], v[68:71]
    ds_read_b128 v[64:67], v7 offset:38912
    s_waitcnt lgkmcnt(7)
    v_mfma_f32_16x16x32_bf16 v[72:75], v[52:55], v[40:43], v[72:75]
    s_waitcnt lgkmcnt(4)
    v_mfma_f32_16x16x32_bf16 v[76:79], v[52:55], v[44:47], v[76:79]
    s_waitcnt lgkmcnt(1)
    v_mfma_f32_16x16x32_bf16 v[80:83], v[52:55], v[48:51], v[80:83]
    v_mfma_f32_16x16x32_bf16 v[84:87], v[56:59], v[36:39], v[84:87]
    ds_read_b128 v[52:55], v7 offset:40960
    v_mfma_f32_16x16x32_bf16 v[88:91], v[56:59], v[40:43], v[88:91]
    v_mfma_f32_16x16x32_bf16 v[92:95], v[56:59], v[44:47], v[92:95]
    v_mfma_f32_16x16x32_bf16 v[96:99], v[56:59], v[48:51], v[96:99]
    v_mfma_f32_16x16x32_bf16 v[100:103], v[60:63], v[36:39], v[100:103]
    ds_read_b128 v[56:59], v7 offset:43008
    v_mfma_f32_16x16x32_bf16 v[104:107], v[60:63], v[40:43], v[104:107]
    v_mfma_f32_16x16x32_bf16 v[108:111], v[60:63], v[44:47], v[108:111]
    v_mfma_f32_16x16x32_bf16 v[112:115], v[60:63], v[48:51], v[112:115]
    s_waitcnt vmcnt(4)
    s_barrier
    s_add_u32 m0, s52, 49152
    s_nop 0
    buffer_load_dwordx4 v4, s[24:27], s50 offen lds
    buffer_load_dwordx4 v5, s[24:27], s50 offen offset:1024 lds
    s_add_u32 s50, s50, 262144
    s_add_u32 m0, s51, 16384
    s_add_u32 s47, s49, 131456
    buffer_load_dwordx4 v2, s[8:11], s47 offen lds
    buffer_load_dwordx4 v3, s[8:11], s47 offen offset:1024 lds
    s_waitcnt lgkmcnt(2)
    v_mfma_f32_16x16x32_bf16 v[116:119], v[64:67], v[36:39], v[116:119]
    ds_read_b128 v[60:63], v7 offset:45056
    v_mfma_f32_16x16x32_bf16 v[120:123], v[64:67], v[40:43], v[120:123]
    v_mfma_f32_16x16x32_bf16 v[124:127], v[64:67], v[44:47], v[124:127]
    v_mfma_f32_16x16x32_bf16 v[128:131], v[64:67], v[48:51], v[128:131]
    s_waitcnt lgkmcnt(2)
    v_mfma_f32_16x16x32_bf16 v[132:135], v[52:55], v[36:39], v[132:135]
    ds_read_b128 v[64:67], v7 offset:47104
    v_mfma_f32_16x16x32_bf16 v[136:139], v[52:55], v[40:43], v[136:139]
    v_mfma_f32_16x16x32_bf16 v[140:143], v[52:55], v[44:47], v[140:143]
    ds_read_b64_tr_b16 v[20:21], v16 offset:0
    ds_read_b64_tr_b16 v[22:23], v16 offset:1024
    v_mfma_f32_16x16x32_bf16 v[144:147], v[52:55], v[48:51], v[144:147]
    s_waitcnt lgkmcnt(4)
    v_mfma_f32_16x16x32_bf16 v[148:151], v[56:59], v[36:39], v[148:151]
    ds_read_b128 v[52:55], v14 offset:0
    v_mfma_f32_16x16x32_bf16 v[152:155], v[56:59], v[40:43], v[152:155]
    v_mfma_f32_16x16x32_bf16 v[156:159], v[56:59], v[44:47], v[156:159]
    ds_read_b64_tr_b16 v[24:25], v17 offset:0
    ds_read_b64_tr_b16 v[26:27], v17 offset:1024
    v_mfma_f32_16x16x32_bf16 v[160:163], v[56:59], v[48:51], v[160:163]
    s_waitcnt lgkmcnt(6)
    v_mfma_f32_16x16x32_bf16 v[164:167], v[60:63], v[36:39], v[164:167]
    ds_read_b128 v[56:59], v14 offset:2048
    v_mfma_f32_16x16x32_bf16 v[168:171], v[60:63], v[40:43], v[168:171]
    v_mfma_f32_16x16x32_bf16 v[172:175], v[60:63], v[44:47], v[172:175]
    ds_read_b64_tr_b16 v[28:29], v18 offset:0
    ds_read_b64_tr_b16 v[30:31], v18 offset:1024
    v_mfma_f32_16x16x32_bf16 v[176:179], v[60:63], v[48:51], v[176:179]
    s_mov_b32 s28, s40
    s_mov_b32 s29, s41
    s_mov_b32 s30, 2359296
    s_mov_b32 s31, 0x00020000
    s_lshl_b32 s47, s2, 3
    s_add_u32 s47, s47, s44
    s_mul_i32 s47, s47, 1152
    v_lshlrev_b32 v204, 4, v1
    v_add_u32 v205, 1024, v204
    v_cmp_gt_u32 vcc, 8, v1
    v_mov_b32 v206, 0x7f000000
    s_nop 0
    v_cndmask_b32 v205, v206, v205, vcc
    buffer_load_dwordx4 v[196:199], v204, s[28:31], s47 offen
    buffer_load_dwordx4 v[200:203], v205, s[28:31], s47 offen
    s_waitcnt lgkmcnt(8)
    v_mfma_f32_16x16x32_bf16 v[180:183], v[64:67], v[36:39], v[180:183]
    ds_read_b128 v[60:63], v14 offset:4096
    v_mfma_f32_16x16x32_bf16 v[184:187], v[64:67], v[40:43], v[184:187]
    v_mfma_f32_16x16x32_bf16 v[188:191], v[64:67], v[44:47], v[188:191]
    ds_read_b64_tr_b16 v[32:33], v19 offset:0
    ds_read_b64_tr_b16 v[34:35], v19 offset:1024
    v_mfma_f32_16x16x32_bf16 v[192:195], v[64:67], v[48:51], v[192:195]
    s_waitcnt lgkmcnt(8)
    v_mfma_f32_16x16x32_bf16 v[68:71], v[52:55], v[20:23], v[68:71]
    ds_read_b128 v[64:67], v14 offset:6144
    s_waitcnt lgkmcnt(7)
    v_mfma_f32_16x16x32_bf16 v[72:75], v[52:55], v[24:27], v[72:75]
    s_waitcnt lgkmcnt(4)
    v_mfma_f32_16x16x32_bf16 v[76:79], v[52:55], v[28:31], v[76:79]
    s_waitcnt lgkmcnt(1)
    v_mfma_f32_16x16x32_bf16 v[80:83], v[52:55], v[32:35], v[80:83]
    v_mfma_f32_16x16x32_bf16 v[84:87], v[56:59], v[20:23], v[84:87]
    ds_read_b128 v[52:55], v14 offset:8192
    v_mfma_f32_16x16x32_bf16 v[88:91], v[56:59], v[24:27], v[88:91]
    v_mfma_f32_16x16x32_bf16 v[92:95], v[56:59], v[28:31], v[92:95]
    v_mfma_f32_16x16x32_bf16 v[96:99], v[56:59], v[32:35], v[96:99]
    v_mfma_f32_16x16x32_bf16 v[100:103], v[60:63], v[20:23], v[100:103]
    ds_read_b128 v[56:59], v14 offset:10240
    v_mfma_f32_16x16x32_bf16 v[104:107], v[60:63], v[24:27], v[104:107]
    v_mfma_f32_16x16x32_bf16 v[108:111], v[60:63], v[28:31], v[108:111]
    v_mfma_f32_16x16x32_bf16 v[112:115], v[60:63], v[32:35], v[112:115]
    s_barrier
    s_add_u32 m0, s52, 0
    s_nop 0
    buffer_load_dwordx4 v4, s[24:27], s50 offen lds
    buffer_load_dwordx4 v5, s[24:27], s50 offen offset:1024 lds
    s_add_u32 s50, s50, 262144
    s_add_u32 m0, s51, 32768
    s_add_u32 s47, s49, 512
    buffer_load_dwordx4 v2, s[8:11], s47 offen lds
    buffer_load_dwordx4 v3, s[8:11], s47 offen offset:1024 lds
    s_waitcnt lgkmcnt(2)
    v_mfma_f32_16x16x32_bf16 v[116:119], v[64:67], v[20:23], v[116:119]
    ds_read_b128 v[60:63], v14 offset:12288
    v_mfma_f32_16x16x32_bf16 v[120:123], v[64:67], v[24:27], v[120:123]
    v_mfma_f32_16x16x32_bf16 v[124:127], v[64:67], v[28:31], v[124:127]
    v_mfma_f32_16x16x32_bf16 v[128:131], v[64:67], v[32:35], v[128:131]
    s_waitcnt lgkmcnt(2)
    v_mfma_f32_16x16x32_bf16 v[132:135], v[52:55], v[20:23], v[132:135]
    ds_read_b128 v[64:67], v14 offset:14336
    v_mfma_f32_16x16x32_bf16 v[136:139], v[52:55], v[24:27], v[136:139]
    v_mfma_f32_16x16x32_bf16 v[140:143], v[52:55], v[28:31], v[140:143]
    ds_read_b64_tr_b16 v[36:37], v16 offset:16384
    ds_read_b64_tr_b16 v[38:39], v16 offset:17408
    v_mfma_f32_16x16x32_bf16 v[144:147], v[52:55], v[32:35], v[144:147]
    s_waitcnt lgkmcnt(4)
    v_mfma_f32_16x16x32_bf16 v[148:151], v[56:59], v[20:23], v[148:151]
    ds_read_b128 v[52:55], v15 offset:0
    v_mfma_f32_16x16x32_bf16 v[152:155], v[56:59], v[24:27], v[152:155]
    v_mfma_f32_16x16x32_bf16 v[156:159], v[56:59], v[28:31], v[156:159]
    ds_read_b64_tr_b16 v[40:41], v17 offset:16384
    ds_read_b64_tr_b16 v[42:43], v17 offset:17408
    v_mfma_f32_16x16x32_bf16 v[160:163], v[56:59], v[32:35], v[160:163]
    s_waitcnt lgkmcnt(6)
    v_mfma_f32_16x16x32_bf16 v[164:167], v[60:63], v[20:23], v[164:167]
    ds_read_b128 v[56:59], v15 offset:2048
    v_mfma_f32_16x16x32_bf16 v[168:171], v[60:63], v[24:27], v[168:171]
    v_mfma_f32_16x16x32_bf16 v[172:175], v[60:63], v[28:31], v[172:175]
    ds_read_b64_tr_b16 v[44:45], v18 offset:16384
    ds_read_b64_tr_b16 v[46:47], v18 offset:17408
    v_mfma_f32_16x16x32_bf16 v[176:179], v[60:63], v[32:35], v[176:179]
    s_waitcnt lgkmcnt(8)
    v_mfma_f32_16x16x32_bf16 v[180:183], v[64:67], v[20:23], v[180:183]
    ds_read_b128 v[60:63], v15 offset:4096
    v_mfma_f32_16x16x32_bf16 v[184:187], v[64:67], v[24:27], v[184:187]
    v_mfma_f32_16x16x32_bf16 v[188:191], v[64:67], v[28:31], v[188:191]
    ds_read_b64_tr_b16 v[48:49], v19 offset:16384
    ds_read_b64_tr_b16 v[50:51], v19 offset:17408
    v_mfma_f32_16x16x32_bf16 v[192:195], v[64:67], v[32:35], v[192:195]
    s_waitcnt lgkmcnt(8)
    v_mfma_f32_16x16x32_bf16 v[68:71], v[52:55], v[36:39], v[68:71]
    ds_read_b128 v[64:67], v15 offset:6144
    s_waitcnt lgkmcnt(7)
    v_mfma_f32_16x16x32_bf16 v[72:75], v[52:55], v[40:43], v[72:75]
    s_waitcnt lgkmcnt(4)
    v_mfma_f32_16x16x32_bf16 v[76:79], v[52:55], v[44:47], v[76:79]
    s_waitcnt lgkmcnt(1)
    v_mfma_f32_16x16x32_bf16 v[80:83], v[52:55], v[48:51], v[80:83]
    v_mfma_f32_16x16x32_bf16 v[84:87], v[56:59], v[36:39], v[84:87]
    ds_read_b128 v[52:55], v15 offset:8192
    v_mfma_f32_16x16x32_bf16 v[88:91], v[56:59], v[40:43], v[88:91]
    v_mfma_f32_16x16x32_bf16 v[92:95], v[56:59], v[44:47], v[92:95]
    v_mfma_f32_16x16x32_bf16 v[96:99], v[56:59], v[48:51], v[96:99]
    v_mfma_f32_16x16x32_bf16 v[100:103], v[60:63], v[36:39], v[100:103]
    ds_read_b128 v[56:59], v15 offset:10240
    v_mfma_f32_16x16x32_bf16 v[104:107], v[60:63], v[40:43], v[104:107]
    v_mfma_f32_16x16x32_bf16 v[108:111], v[60:63], v[44:47], v[108:111]
    v_mfma_f32_16x16x32_bf16 v[112:115], v[60:63], v[48:51], v[112:115]
    s_waitcnt vmcnt(6)
    s_barrier
    s_add_u32 m0, s52, 16384
    s_nop 0
    buffer_load_dwordx4 v4, s[24:27], s50 offen lds
    buffer_load_dwordx4 v5, s[24:27], s50 offen offset:1024 lds
    s_add_u32 s50, s50, 262144
    s_add_u32 m0, s51, 49152
    s_add_u32 s47, s49, 131584
    buffer_load_dwordx4 v2, s[8:11], s47 offen lds
    buffer_load_dwordx4 v3, s[8:11], s47 offen offset:1024 lds
    s_waitcnt lgkmcnt(2)
    v_mfma_f32_16x16x32_bf16 v[116:119], v[64:67], v[36:39], v[116:119]
    ds_read_b128 v[60:63], v15 offset:12288
    v_mfma_f32_16x16x32_bf16 v[120:123], v[64:67], v[40:43], v[120:123]
    v_mfma_f32_16x16x32_bf16 v[124:127], v[64:67], v[44:47], v[124:127]
    v_mfma_f32_16x16x32_bf16 v[128:131], v[64:67], v[48:51], v[128:131]
    s_waitcnt lgkmcnt(2)
    v_mfma_f32_16x16x32_bf16 v[132:135], v[52:55], v[36:39], v[132:135]
    ds_read_b128 v[64:67], v15 offset:14336
    v_mfma_f32_16x16x32_bf16 v[136:139], v[52:55], v[40:43], v[136:139]
    v_mfma_f32_16x16x32_bf16 v[140:143], v[52:55], v[44:47], v[140:143]
    ds_read_b64_tr_b16 v[20:21], v16 offset:32768
    ds_read_b64_tr_b16 v[22:23], v16 offset:33792
    v_mfma_f32_16x16x32_bf16 v[144:147], v[52:55], v[48:51], v[144:147]
    s_waitcnt lgkmcnt(4)
    v_mfma_f32_16x16x32_bf16 v[148:151], v[56:59], v[36:39], v[148:151]
    ds_read_b128 v[52:55], v6 offset:0
    v_mfma_f32_16x16x32_bf16 v[152:155], v[56:59], v[40:43], v[152:155]
    v_mfma_f32_16x16x32_bf16 v[156:159], v[56:59], v[44:47], v[156:159]
    ds_read_b64_tr_b16 v[24:25], v17 offset:32768
    ds_read_b64_tr_b16 v[26:27], v17 offset:33792
    v_mfma_f32_16x16x32_bf16 v[160:163], v[56:59], v[48:51], v[160:163]
    s_waitcnt lgkmcnt(6)
    v_mfma_f32_16x16x32_bf16 v[164:167], v[60:63], v[36:39], v[164:167]
    ds_read_b128 v[56:59], v6 offset:2048
    v_mfma_f32_16x16x32_bf16 v[168:171], v[60:63], v[40:43], v[168:171]
    v_mfma_f32_16x16x32_bf16 v[172:175], v[60:63], v[44:47], v[172:175]
    ds_read_b64_tr_b16 v[28:29], v18 offset:32768
    ds_read_b64_tr_b16 v[30:31], v18 offset:33792
    v_mfma_f32_16x16x32_bf16 v[176:179], v[60:63], v[48:51], v[176:179]
    s_waitcnt lgkmcnt(8)
    v_mfma_f32_16x16x32_bf16 v[180:183], v[64:67], v[36:39], v[180:183]
    ds_read_b128 v[60:63], v6 offset:4096
    v_mfma_f32_16x16x32_bf16 v[184:187], v[64:67], v[40:43], v[184:187]
    v_mfma_f32_16x16x32_bf16 v[188:191], v[64:67], v[44:47], v[188:191]
    ds_read_b64_tr_b16 v[32:33], v19 offset:32768
    ds_read_b64_tr_b16 v[34:35], v19 offset:33792
    v_mfma_f32_16x16x32_bf16 v[192:195], v[64:67], v[48:51], v[192:195]
    s_waitcnt vmcnt(8)
    s_waitcnt lgkmcnt(8)
    v_mfma_f32_16x16x32_bf16 v[68:71], v[52:55], v[20:23], v[68:71]
    ds_read_b128 v[64:67], v6 offset:6144
    s_waitcnt lgkmcnt(7)
    v_mfma_f32_16x16x32_bf16 v[72:75], v[52:55], v[24:27], v[72:75]
    v_lshlrev_b32 v208, 16, v196
    v_and_b32 v209, 0xffff0000, v196
    s_waitcnt lgkmcnt(4)
    v_mfma_f32_16x16x32_bf16 v[76:79], v[52:55], v[28:31], v[76:79]
    s_waitcnt lgkmcnt(1)
    v_mfma_f32_16x16x32_bf16 v[80:83], v[52:55], v[32:35], v[80:83]
    v_lshlrev_b32 v210, 16, v197
    v_and_b32 v211, 0xffff0000, v197
    v_mfma_f32_16x16x32_bf16 v[84:87], v[56:59], v[20:23], v[84:87]
    ds_read_b128 v[52:55], v6 offset:8192
    v_mfma_f32_16x16x32_bf16 v[88:91], v[56:59], v[24:27], v[88:91]
    v_lshlrev_b32 v212, 16, v198
    v_and_b32 v213, 0xffff0000, v198
    v_mfma_f32_16x16x32_bf16 v[92:95], v[56:59], v[28:31], v[92:95]
    v_mfma_f32_16x16x32_bf16 v[96:99], v[56:59], v[32:35], v[96:99]
    v_lshlrev_b32 v214, 16, v199
    v_and_b32 v215, 0xffff0000, v199
    v_mfma_f32_16x16x32_bf16 v[100:103], v[60:63], v[20:23], v[100:103]
    ds_read_b128 v[56:59], v6 offset:10240
    v_mfma_f32_16x16x32_bf16 v[104:107], v[60:63], v[24:27], v[104:107]
    v_lshlrev_b32 v216, 16, v200
    v_and_b32 v217, 0xffff0000, v200
    v_mfma_f32_16x16x32_bf16 v[108:111], v[60:63], v[28:31], v[108:111]
    v_mfma_f32_16x16x32_bf16 v[112:115], v[60:63], v[32:35], v[112:115]
    v_lshlrev_b32 v218, 16, v201
    v_and_b32 v219, 0xffff0000, v201
    s_barrier
    s_add_u32 m0, s52, 32768
    s_nop 0
    buffer_load_dwordx4 v4, s[24:27], s50 offen lds
    buffer_load_dwordx4 v5, s[24:27], s50 offen offset:1024 lds
    s_add_u32 s50, s50, 262144
    s_add_u32 m0, s51, 65536
    s_add_u32 s47, s49, 640
    buffer_load_dwordx4 v2, s[8:11], s47 offen lds
    buffer_load_dwordx4 v3, s[8:11], s47 offen offset:1024 lds
    s_waitcnt lgkmcnt(2)
    v_mfma_f32_16x16x32_bf16 v[116:119], v[64:67], v[20:23], v[116:119]
    ds_read_b128 v[60:63], v6 offset:12288
    v_mfma_f32_16x16x32_bf16 v[120:123], v[64:67], v[24:27], v[120:123]
    v_lshlrev_b32 v220, 16, v202
    v_and_b32 v221, 0xffff0000, v202
    v_mfma_f32_16x16x32_bf16 v[124:127], v[64:67], v[28:31], v[124:127]
    v_mfma_f32_16x16x32_bf16 v[128:131], v[64:67], v[32:35], v[128:131]
    v_lshlrev_b32 v222, 16, v203
    v_and_b32 v223, 0xffff0000, v203
    s_waitcnt lgkmcnt(2)
    v_mfma_f32_16x16x32_bf16 v[132:135], v[52:55], v[20:23], v[132:135]
    ds_read_b128 v[64:67], v6 offset:14336
    v_mfma_f32_16x16x32_bf16 v[136:139], v[52:55], v[24:27], v[136:139]
    v_add_f32 v224, v208, v209
    v_add_f32 v224, v224, v210
    v_mfma_f32_16x16x32_bf16 v[140:143], v[52:55], v[28:31], v[140:143]
    ds_read_b64_tr_b16 v[36:37], v16 offset:49152
    ds_read_b64_tr_b16 v[38:39], v16 offset:50176
    v_mfma_f32_16x16x32_bf16 v[144:147], v[52:55], v[32:35], v[144:147]
    v_add_f32 v224, v224, v211
    v_add_f32 v224, v224, v212
    s_waitcnt lgkmcnt(4)
    v_mfma_f32_16x16x32_bf16 v[148:151], v[56:59], v[20:23], v[148:151]
    ds_read_b128 v[52:55], v7 offset:0
    v_mfma_f32_16x16x32_bf16 v[152:155], v[56:59], v[24:27], v[152:155]
    v_add_f32 v224, v224, v213
    v_add_f32 v224, v224, v214
    v_mfma_f32_16x16x32_bf16 v[156:159], v[56:59], v[28:31], v[156:159]
    ds_read_b64_tr_b16 v[40:41], v17 offset:49152
    ds_read_b64_tr_b16 v[42:43], v17 offset:50176
    v_mfma_f32_16x16x32_bf16 v[160:163], v[56:59], v[32:35], v[160:163]
    v_add_f32 v224, v224, v215
    v_add_f32 v224, v224, v216
    s_waitcnt lgkmcnt(6)
    v_mfma_f32_16x16x32_bf16 v[164:167], v[60:63], v[20:23], v[164:167]
    ds_read_b128 v[56:59], v7 offset:2048
    v_mfma_f32_16x16x32_bf16 v[168:171], v[60:63], v[24:27], v[168:171]
    v_add_f32 v224, v224, v217
    v_add_f32 v224, v224, v218
    v_mfma_f32_16x16x32_bf16 v[172:175], v[60:63], v[28:31], v[172:175]
    ds_read_b64_tr_b16 v[44:45], v18 offset:49152
    ds_read_b64_tr_b16 v[46:47], v18 offset:50176
    v_mfma_f32_16x16x32_bf16 v[176:179], v[60:63], v[32:35], v[176:179]
    v_add_f32 v224, v224, v219
    v_add_f32 v224, v224, v220
    s_waitcnt lgkmcnt(8)
    v_mfma_f32_16x16x32_bf16 v[180:183], v[64:67], v[20:23], v[180:183]
    ds_read_b128 v[60:63], v7 offset:4096
    v_mfma_f32_16x16x32_bf16 v[184:187], v[64:67], v[24:27], v[184:187]
    v_add_f32 v224, v224, v221
    v_add_f32 v224, v224, v222
    v_mfma_f32_16x16x32_bf16 v[188:191], v[64:67], v[28:31], v[188:191]
    ds_read_b64_tr_b16 v[48:49], v19 offset:49152
    ds_read_b64_tr_b16 v[50:51], v19 offset:50176
    v_mfma_f32_16x16x32_bf16 v[192:195], v[64:67], v[32:35], v[192:195]
    v_add_f32 v224, v224, v223
    s_nop 1
    v_add_f32_dpp v224, v224, v224 quad_perm:[1,0,3,2] row_mask:0xf bank_mask:0xf
    s_waitcnt lgkmcnt(8)
    v_mfma_f32_16x16x32_bf16 v[68:71], v[52:55], v[36:39], v[68:71]
    ds_read_b128 v[64:67], v7 offset:6144
    s_waitcnt lgkmcnt(7)
    v_mfma_f32_16x16x32_bf16 v[72:75], v[52:55], v[40:43], v[72:75]
    v_add_f32_dpp v224, v224, v224 quad_perm:[2,3,0,1] row_mask:0xf bank_mask:0xf
    s_nop 1
    v_add_f32_dpp v224, v224, v224 row_ror:4 row_mask:0xf bank_mask:0xf
    s_waitcnt lgkmcnt(4)
    v_mfma_f32_16x16x32_bf16 v[76:79], v[52:55], v[44:47], v[76:79]
    s_waitcnt lgkmcnt(1)
    v_mfma_f32_16x16x32_bf16 v[80:83], v[52:55], v[48:51], v[80:83]
    v_add_f32_dpp v224, v224, v224 row_ror:8 row_mask:0xf bank_mask:0xf
    v_mov_b32 v225, v224
    v_mfma_f32_16x16x32_bf16 v[84:87], v[56:59], v[36:39], v[84:87]
    ds_read_b128 v[52:55], v7 offset:8192
    v_mfma_f32_16x16x32_bf16 v[88:91], v[56:59], v[40:43], v[88:91]
    v_permlane16_swap_b32 v224, v225
    v_add_f32 v224, v224, v225
    v_mfma_f32_16x16x32_bf16 v[92:95], v[56:59], v[44:47], v[92:95]
    v_mfma_f32_16x16x32_bf16 v[96:99], v[56:59], v[48:51], v[96:99]
    v_mov_b32 v225, v224
    s_nop 1
    v_permlane32_swap_b32 v224, v225
    v_mfma_f32_16x16x32_bf16 v[100:103], v[60:63], v[36:39], v[100:103]
    ds_read_b128 v[56:59], v7 offset:10240
    v_mfma_f32_16x16x32_bf16 v[104:107], v[60:63], v[40:43], v[104:107]
    v_add_f32 v224, v224, v225
    v_mul_f32 v224, 0x3ae38e39, v224
    v_mfma_f32_16x16x32_bf16 v[108:111], v[60:63], v[44:47], v[108:111]
    v_mfma_f32_16x16x32_bf16 v[112:115], v[60:63], v[48:51], v[112:115]
    v_cmp_gt_u32 vcc, 8, v1
    s_nop 1
    v_cndmask_b32 v226, 0, v224, vcc
    s_waitcnt vmcnt(4)
    s_barrier
    s_add_u32 m0, s52, 49152
    s_nop 0
    buffer_load_dwordx4 v4, s[24:27], s50 offen lds
    buffer_load_dwordx4 v5, s[24:27], s50 offen offset:1024 lds
    s_add_u32 s50, s50, 262144
    s_add_u32 m0, s51, 81920
    s_add_u32 s47, s49, 131712
    buffer_load_dwordx4 v2, s[8:11], s47 offen lds
    buffer_load_dwordx4 v3, s[8:11], s47 offen offset:1024 lds
    s_waitcnt lgkmcnt(2)
    v_mfma_f32_16x16x32_bf16 v[116:119], v[64:67], v[36:39], v[116:119]
    ds_read_b128 v[60:63], v7 offset:12288
    v_mfma_f32_16x16x32_bf16 v[120:123], v[64:67], v[40:43], v[120:123]
    v_sub_f32 v208, v208, v224
    v_sub_f32 v216, v216, v226
    v_mfma_f32_16x16x32_bf16 v[124:127], v[64:67], v[44:47], v[124:127]
    v_mfma_f32_16x16x32_bf16 v[128:131], v[64:67], v[48:51], v[128:131]
    v_sub_f32 v209, v209, v224
    v_sub_f32 v217, v217, v226
    s_waitcnt lgkmcnt(2)
    v_mfma_f32_16x16x32_bf16 v[132:135], v[52:55], v[36:39], v[132:135]
    ds_read_b128 v[64:67], v7 offset:14336
    v_mfma_f32_16x16x32_bf16 v[136:139], v[52:55], v[40:43], v[136:139]
    v_sub_f32 v210, v210, v224
    v_sub_f32 v218, v218, v226
    v_mfma_f32_16x16x32_bf16 v[140:143], v[52:55], v[44:47], v[140:143]
    ds_read_b64_tr_b16 v[20:21], v16 offset:0
    ds_read_b64_tr_b16 v[22:23], v16 offset:1024
    v_mfma_f32_16x16x32_bf16 v[144:147], v[52:55], v[48:51], v[144:147]
    v_sub_f32 v211, v211, v224
    v_sub_f32 v219, v219, v226
    s_waitcnt lgkmcnt(4)
    v_mfma_f32_16x16x32_bf16 v[148:151], v[56:59], v[36:39], v[148:151]
    ds_read_b128 v[52:55], v6 offset:32768
    v_mfma_f32_16x16x32_bf16 v[152:155], v[56:59], v[40:43], v[152:155]
    v_sub_f32 v212, v212, v224
    v_sub_f32 v220, v220, v226
    v_mfma_f32_16x16x32_bf16 v[156:159], v[56:59], v[44:47], v[156:159]
    ds_read_b64_tr_b16 v[24:25], v17 offset:0
    ds_read_b64_tr_b16 v[26:27], v17 offset:1024
    v_mfma_f32_16x16x32_bf16 v[160:163], v[56:59], v[48:51], v[160:163]
    v_sub_f32 v213, v213, v224
    v_sub_f32 v221, v221, v226
    s_waitcnt lgkmcnt(6)
    v_mfma_f32_16x16x32_bf16 v[164:167], v[60:63], v[36:39], v[164:167]
    ds_read_b128 v[56:59], v6 offset:34816
    v_mfma_f32_16x16x32_bf16 v[168:171], v[60:63], v[40:43], v[168:171]
    v_sub_f32 v214, v214, v224
    v_sub_f32 v222, v222, v226
    v_mfma_f32_16x16x32_bf16 v[172:175], v[60:63], v[44:47], v[172:175]
    ds_read_b64_tr_b16 v[28:29], v18 offset:0
    ds_read_b64_tr_b16 v[30:31], v18 offset:1024
    v_mfma_f32_16x16x32_bf16 v[176:179], v[60:63], v[48:51], v[176:179]
    v_sub_f32 v215, v215, v224
    v_sub_f32 v223, v223, v226
    s_waitcnt lgkmcnt(8)
    v_mfma_f32_16x16x32_bf16 v[180:183], v[64:67], v[36:39], v[180:183]
    ds_read_b128 v[60:63], v6 offset:36864
    v_mfma_f32_16x16x32_bf16 v[184:187], v[64:67], v[40:43], v[184:187]
    v_mul_f32 v224, v208, v208
    v_fmac_f32 v224, v209, v209
    v_mfma_f32_16x16x32_bf16 v[188:191], v[64:67], v[44:47], v[188:191]
    ds_read_b64_tr_b16 v[32:33], v19 offset:0
    ds_read_b64_tr_b16 v[34:35], v19 offset:1024
    v_mfma_f32_16x16x32_bf16 v[192:195], v[64:67], v[48:51], v[192:195]
    v_fmac_f32 v224, v210, v210
    v_fmac_f32 v224, v211, v211
    s_waitcnt lgkmcnt(8)
    v_mfma_f32_16x16x32_bf16 v[68:71], v[52:55], v[20:23], v[68:71]
    ds_read_b128 v[64:67], v6 offset:38912
    s_waitcnt lgkmcnt(7)
    v_mfma_f32_16x16x32_bf16 v[72:75], v[52:55], v[24:27], v[72:75]
    v_fmac_f32 v224, v212, v212
    v_fmac_f32 v224, v213, v213
    s_waitcnt lgkmcnt(4)
    v_mfma_f32_16x16x32_bf16 v[76:79], v[52:55], v[28:31], v[76:79]
    s_waitcnt lgkmcnt(1)
    v_mfma_f32_16x16x32_bf16 v[80:83], v[52:55], v[32:35], v[80:83]
    v_fmac_f32 v224, v214, v214
    v_fmac_f32 v224, v215, v215
    v_mfma_f32_16x16x32_bf16 v[84:87], v[56:59], v[20:23], v[84:87]
    ds_read_b128 v[52:55], v6 offset:40960
    v_mfma_f32_16x16x32_bf16 v[88:91], v[56:59], v[24:27], v[88:91]
    v_fmac_f32 v224, v216, v216
    v_fmac_f32 v224, v217, v217
    v_mfma_f32_16x16x32_bf16 v[92:95], v[56:59], v[28:31], v[92:95]
    v_mfma_f32_16x16x32_bf16 v[96:99], v[56:59], v[32:35], v[96:99]
    v_fmac_f32 v224, v218, v218
    v_fmac_f32 v224, v219, v219
    v_mfma_f32_16x16x32_bf16 v[100:103], v[60:63], v[20:23], v[100:103]
    ds_read_b128 v[56:59], v6 offset:43008
    v_mfma_f32_16x16x32_bf16 v[104:107], v[60:63], v[24:27], v[104:107]
    v_fmac_f32 v224, v220, v220
    v_fmac_f32 v224, v221, v221
    v_mfma_f32_16x16x32_bf16 v[108:111], v[60:63], v[28:31], v[108:111]
    v_mfma_f32_16x16x32_bf16 v[112:115], v[60:63], v[32:35], v[112:115]
    v_fmac_f32 v224, v222, v222
    v_fmac_f32 v224, v223, v223
    s_barrier
    s_add_u32 m0, s52, 0
    s_nop 0
    buffer_load_dwordx4 v4, s[24:27], s50 offen lds
    buffer_load_dwordx4 v5, s[24:27], s50 offen offset:1024 lds
    s_add_u32 s50, s50, 262144
    s_add_u32 m0, s51, 0
    s_add_u32 s47, s49, 768
    buffer_load_dwordx4 v2, s[8:11], s47 offen lds
    buffer_load_dwordx4 v3, s[8:11], s47 offen offset:1024 lds
    s_waitcnt lgkmcnt(2)
    v_mfma_f32_16x16x32_bf16 v[116:119], v[64:67], v[20:23], v[116:119]
    ds_read_b128 v[60:63], v6 offset:45056
    v_mfma_f32_16x16x32_bf16 v[120:123], v[64:67], v[24:27], v[120:123]
    v_add_f32_dpp v224, v224, v224 quad_perm:[1,0,3,2] row_mask:0xf bank_mask:0xf
    s_nop 1
    v_add_f32_dpp v224, v224, v224 quad_perm:[2,3,0,1] row_mask:0xf bank_mask:0xf
    v_mfma_f32_16x16x32_bf16 v[124:127], v[64:67], v[28:31], v[124:127]
    v_mfma_f32_16x16x32_bf16 v[128:131], v[64:67], v[32:35], v[128:131]
    v_add_f32_dpp v224, v224, v224 row_ror:4 row_mask:0xf bank_mask:0xf
    s_nop 1
    v_add_f32_dpp v224, v224, v224 row_ror:8 row_mask:0xf bank_mask:0xf
    s_waitcnt lgkmcnt(2)
    v_mfma_f32_16x16x32_bf16 v[132:135], v[52:55], v[20:23], v[132:135]
    ds_read_b128 v[64:67], v6 offset:47104
    v_mfma_f32_16x16x32_bf16 v[136:139], v[52:55], v[24:27], v[136:139]
    v_mov_b32 v225, v224
    s_nop 1
    v_permlane16_swap_b32 v224, v225
    v_mfma_f32_16x16x32_bf16 v[140:143], v[52:55], v[28:31], v[140:143]
    ds_read_b64_tr_b16 v[36:37], v16 offset:16384
    ds_read_b64_tr_b16 v[38:39], v16 offset:17408
    v_mfma_f32_16x16x32_bf16 v[144:147], v[52:55], v[32:35], v[144:147]
    v_add_f32 v224, v224, v225
    v_mov_b32 v225, v224
    s_waitcnt lgkmcnt(4)
    v_mfma_f32_16x16x32_bf16 v[148:151], v[56:59], v[20:23], v[148:151]
    ds_read_b128 v[52:55], v7 offset:32768
    v_mfma_f32_16x16x32_bf16 v[152:155], v[56:59], v[24:27], v[152:155]
    v_permlane32_swap_b32 v224, v225
    v_add_f32 v224, v224, v225
    v_mfma_f32_16x16x32_bf16 v[156:159], v[56:59], v[28:31], v[156:159]
    ds_read_b64_tr_b16 v[40:41], v17 offset:16384
    ds_read_b64_tr_b16 v[42:43], v17 offset:17408
    v_mfma_f32_16x16x32_bf16 v[160:163], v[56:59], v[32:35], v[160:163]
    v_mov_b32 v225, 0x3727c5ac
    v_fmac_f32 v225, 0x3ae38e39, v224
    s_waitcnt lgkmcnt(6)
    v_mfma_f32_16x16x32_bf16 v[164:167], v[60:63], v[20:23], v[164:167]
    ds_read_b128 v[56:59], v7 offset:34816
    v_mfma_f32_16x16x32_bf16 v[168:171], v[60:63], v[24:27], v[168:171]
    v_rsq_f32 v224, v225
    s_nop 0
    v_mul_f32 v208, v208, v224
    v_mfma_f32_16x16x32_bf16 v[172:175], v[60:63], v[28:31], v[172:175]
    ds_read_b64_tr_b16 v[44:45], v18 offset:16384
    ds_read_b64_tr_b16 v[46:47], v18 offset:17408
    v_mfma_f32_16x16x32_bf16 v[176:179], v[60:63], v[32:35], v[176:179]
    v_mul_f32 v209, v209, v224
    v_mul_f32 v210, v210, v224
    s_waitcnt lgkmcnt(8)
    v_mfma_f32_16x16x32_bf16 v[180:183], v[64:67], v[20:23], v[180:183]
    ds_read_b128 v[60:63], v7 offset:36864
    v_mfma_f32_16x16x32_bf16 v[184:187], v[64:67], v[24:27], v[184:187]
    v_mul_f32 v211, v211, v224
    v_mul_f32 v212, v212, v224
    v_mfma_f32_16x16x32_bf16 v[188:191], v[64:67], v[28:31], v[188:191]
    ds_read_b64_tr_b16 v[48:49], v19 offset:16384
    ds_read_b64_tr_b16 v[50:51], v19 offset:17408
    v_mfma_f32_16x16x32_bf16 v[192:195], v[64:67], v[32:35], v[192:195]
    v_mul_f32 v213, v213, v224
    v_mul_f32 v214, v214, v224
    s_waitcnt lgkmcnt(8)
    v_mfma_f32_16x16x32_bf16 v[68:71], v[52:55], v[36:39], v[68:71]
    ds_read_b128 v[64:67], v7 offset:38912
    s_waitcnt lgkmcnt(7)
    v_mfma_f32_16x16x32_bf16 v[72:75], v[52:55], v[40:43], v[72:75]
    v_mul_f32 v215, v215, v224
    v_mul_f32 v216, v216, v224
    s_waitcnt lgkmcnt(4)
    v_mfma_f32_16x16x32_bf16 v[76:79], v[52:55], v[44:47], v[76:79]
    s_waitcnt lgkmcnt(1)
    v_mfma_f32_16x16x32_bf16 v[80:83], v[52:55], v[48:51], v[80:83]
    v_mul_f32 v217, v217, v224
    v_mul_f32 v218, v218, v224
    v_mfma_f32_16x16x32_bf16 v[84:87], v[56:59], v[36:39], v[84:87]
    ds_read_b128 v[52:55], v7 offset:40960
    v_mfma_f32_16x16x32_bf16 v[88:91], v[56:59], v[40:43], v[88:91]
    v_mul_f32 v219, v219, v224
    v_mul_f32 v220, v220, v224
    v_mfma_f32_16x16x32_bf16 v[92:95], v[56:59], v[44:47], v[92:95]
    v_mfma_f32_16x16x32_bf16 v[96:99], v[56:59], v[48:51], v[96:99]
    v_mul_f32 v221, v221, v224
    v_mul_f32 v222, v222, v224
    v_mfma_f32_16x16x32_bf16 v[100:103], v[60:63], v[36:39], v[100:103]
    ds_read_b128 v[56:59], v7 offset:43008
    v_mfma_f32_16x16x32_bf16 v[104:107], v[60:63], v[40:43], v[104:107]
    v_mul_f32 v223, v223, v224
    v_cvt_pk_bf16_f32 v196, v208, v209
    v_mfma_f32_16x16x32_bf16 v[108:111], v[60:63], v[44:47], v[108:111]
    v_mfma_f32_16x16x32_bf16 v[112:115], v[60:63], v[48:51], v[112:115]
    v_cvt_pk_bf16_f32 v197, v210, v211
    v_cvt_pk_bf16_f32 v198, v212, v213
    s_waitcnt vmcnt(4)
    s_barrier
    s_add_u32 m0, s52, 16384
    s_nop 0
    buffer_load_dwordx4 v4, s[24:27], s50 offen lds
    buffer_load_dwordx4 v5, s[24:27], s50 offen offset:1024 lds
    s_add_u32 s50, s50, 262144
    s_add_u32 m0, s51, 16384
    s_add_u32 s47, s49, 131840
    buffer_load_dwordx4 v2, s[8:11], s47 offen lds
    buffer_load_dwordx4 v3, s[8:11], s47 offen offset:1024 lds
    s_waitcnt lgkmcnt(2)
    v_mfma_f32_16x16x32_bf16 v[116:119], v[64:67], v[36:39], v[116:119]
    ds_read_b128 v[60:63], v7 offset:45056
    v_mfma_f32_16x16x32_bf16 v[120:123], v[64:67], v[40:43], v[120:123]
    v_cvt_pk_bf16_f32 v199, v214, v215
    v_cvt_pk_bf16_f32 v200, v216, v217
    v_mfma_f32_16x16x32_bf16 v[124:127], v[64:67], v[44:47], v[124:127]
    v_mfma_f32_16x16x32_bf16 v[128:131], v[64:67], v[48:51], v[128:131]
    v_cvt_pk_bf16_f32 v201, v218, v219
    v_cvt_pk_bf16_f32 v202, v220, v221
    s_waitcnt lgkmcnt(2)
    v_mfma_f32_16x16x32_bf16 v[132:135], v[52:55], v[36:39], v[132:135]
    ds_read_b128 v[64:67], v7 offset:47104
    v_mfma_f32_16x16x32_bf16 v[136:139], v[52:55], v[40:43], v[136:139]
    v_cvt_pk_bf16_f32 v203, v222, v223
    v_lshlrev_b32 v224, 8, v1
    v_mfma_f32_16x16x32_bf16 v[140:143], v[52:55], v[44:47], v[140:143]
    ds_read_b64_tr_b16 v[20:21], v16 offset:32768
    ds_read_b64_tr_b16 v[22:23], v16 offset:33792
    v_mfma_f32_16x16x32_bf16 v[144:147], v[52:55], v[48:51], v[144:147]
    v_add_u32 v225, 16384, v224
    v_mov_b32 v226, 0x7f000000
    s_waitcnt lgkmcnt(4)
    v_mfma_f32_16x16x32_bf16 v[148:151], v[56:59], v[36:39], v[148:151]
    ds_read_b128 v[52:55], v14 offset:0
    v_mfma_f32_16x16x32_bf16 v[152:155], v[56:59], v[40:43], v[152:155]
    v_cndmask_b32 v225, v226, v225, vcc
    s_lshr_b32 s54, s2, 1
    v_mfma_f32_16x16x32_bf16 v[156:159], v[56:59], v[44:47], v[156:159]
    ds_read_b64_tr_b16 v[24:25], v17 offset:32768
    ds_read_b64_tr_b16 v[26:27], v17 offset:33792
    v_mfma_f32_16x16x32_bf16 v[160:163], v[56:59], v[48:51], v[160:163]
    s_mul_i32 s54, s54, 18432
    s_and_b32 s48, s2, 1
    s_waitcnt lgkmcnt(6)
    v_mfma_f32_16x16x32_bf16 v[164:167], v[60:63], v[36:39], v[164:167]
    ds_read_b128 v[56:59], v14 offset:2048
    v_mfma_f32_16x16x32_bf16 v[168:171], v[60:63], v[40:43], v[168:171]
    s_lshl_b32 s48, s48, 3
    s_add_u32 s48, s48, s44
    v_mfma_f32_16x16x32_bf16 v[172:175], v[60:63], v[44:47], v[172:175]
    ds_read_b64_tr_b16 v[28:29], v18 offset:32768
    ds_read_b64_tr_b16 v[30:31], v18 offset:33792
    v_mfma_f32_16x16x32_bf16 v[176:179], v[60:63], v[48:51], v[176:179]
    s_lshl_b32 s48, s48, 4
    s_add_u32 s54, s54, s48
    s_waitcnt lgkmcnt(8)
    v_mfma_f32_16x16x32_bf16 v[180:183], v[64:67], v[36:39], v[180:183]
    ds_read_b128 v[60:63], v14 offset:4096
    v_mfma_f32_16x16x32_bf16 v[184:187], v[64:67], v[40:43], v[184:187]
    s_add_u32 s28, s32, 0
    s_addc_u32 s29, s33, 0
    v_mfma_f32_16x16x32_bf16 v[188:191], v[64:67], v[44:47], v[188:191]
    ds_read_b64_tr_b16 v[32:33], v19 offset:32768
    ds_read_b64_tr_b16 v[34:35], v19 offset:33792
    v_mfma_f32_16x16x32_bf16 v[192:195], v[64:67], v[48:51], v[192:195]
    buffer_store_dwordx4 v[196:199], v224, s[28:31], s54 offen
    buffer_store_dwordx4 v[200:203], v225, s[28:31], s54 offen
    s_waitcnt lgkmcnt(8)
    v_mfma_f32_16x16x32_bf16 v[68:71], v[52:55], v[20:23], v[68:71]
    ds_read_b128 v[64:67], v14 offset:6144
    s_waitcnt lgkmcnt(7)
    v_mfma_f32_16x16x32_bf16 v[72:75], v[52:55], v[24:27], v[72:75]
    s_waitcnt lgkmcnt(4)
    v_mfma_f32_16x16x32_bf16 v[76:79], v[52:55], v[28:31], v[76:79]
    s_waitcnt lgkmcnt(1)
    v_mfma_f32_16x16x32_bf16 v[80:83], v[52:55], v[32:35], v[80:83]
    v_mfma_f32_16x16x32_bf16 v[84:87], v[56:59], v[20:23], v[84:87]
    ds_read_b128 v[52:55], v14 offset:8192
    v_mfma_f32_16x16x32_bf16 v[88:91], v[56:59], v[24:27], v[88:91]
    v_mfma_f32_16x16x32_bf16 v[92:95], v[56:59], v[28:31], v[92:95]
    v_mfma_f32_16x16x32_bf16 v[96:99], v[56:59], v[32:35], v[96:99]
    v_mfma_f32_16x16x32_bf16 v[100:103], v[60:63], v[20:23], v[100:103]
    ds_read_b128 v[56:59], v14 offset:10240
    v_mfma_f32_16x16x32_bf16 v[104:107], v[60:63], v[24:27], v[104:107]
    v_mfma_f32_16x16x32_bf16 v[108:111], v[60:63], v[28:31], v[108:111]
    v_mfma_f32_16x16x32_bf16 v[112:115], v[60:63], v[32:35], v[112:115]
    s_barrier
    s_add_u32 m0, s52, 32768
    s_nop 0
    buffer_load_dwordx4 v4, s[24:27], s50 offen lds
    buffer_load_dwordx4 v5, s[24:27], s50 offen offset:1024 lds
    s_add_u32 s50, s50, 262144
    s_add_u32 m0, s51, 32768
    s_add_u32 s47, s49, 896
    buffer_load_dwordx4 v2, s[8:11], s47 offen lds
    buffer_load_dwordx4 v3, s[8:11], s47 offen offset:1024 lds
    s_waitcnt lgkmcnt(2)
    v_mfma_f32_16x16x32_bf16 v[116:119], v[64:67], v[20:23], v[116:119]
    ds_read_b128 v[60:63], v14 offset:12288
    v_mfma_f32_16x16x32_bf16 v[120:123], v[64:67], v[24:27], v[120:123]
    v_mfma_f32_16x16x32_bf16 v[124:127], v[64:67], v[28:31], v[124:127]
    v_mfma_f32_16x16x32_bf16 v[128:131], v[64:67], v[32:35], v[128:131]
    s_waitcnt lgkmcnt(2)
    v_mfma_f32_16x16x32_bf16 v[132:135], v[52:55], v[20:23], v[132:135]
    ds_read_b128 v[64:67], v14 offset:14336
    v_mfma_f32_16x16x32_bf16 v[136:139], v[52:55], v[24:27], v[136:139]
    v_mfma_f32_16x16x32_bf16 v[140:143], v[52:55], v[28:31], v[140:143]
    ds_read_b64_tr_b16 v[36:37], v16 offset:49152
    ds_read_b64_tr_b16 v[38:39], v16 offset:50176
    v_mfma_f32_16x16x32_bf16 v[144:147], v[52:55], v[32:35], v[144:147]
    s_waitcnt lgkmcnt(4)
    v_mfma_f32_16x16x32_bf16 v[148:151], v[56:59], v[20:23], v[148:151]
    ds_read_b128 v[52:55], v15 offset:0
    v_mfma_f32_16x16x32_bf16 v[152:155], v[56:59], v[24:27], v[152:155]
    v_mfma_f32_16x16x32_bf16 v[156:159], v[56:59], v[28:31], v[156:159]
    ds_read_b64_tr_b16 v[40:41], v17 offset:49152
    ds_read_b64_tr_b16 v[42:43], v17 offset:50176
    v_mfma_f32_16x16x32_bf16 v[160:163], v[56:59], v[32:35], v[160:163]
    s_waitcnt lgkmcnt(6)
    v_mfma_f32_16x16x32_bf16 v[164:167], v[60:63], v[20:23], v[164:167]
    ds_read_b128 v[56:59], v15 offset:2048
    v_mfma_f32_16x16x32_bf16 v[168:171], v[60:63], v[24:27], v[168:171]
    v_mfma_f32_16x16x32_bf16 v[172:175], v[60:63], v[28:31], v[172:175]
    ds_read_b64_tr_b16 v[44:45], v18 offset:49152
    ds_read_b64_tr_b16 v[46:47], v18 offset:50176
    v_mfma_f32_16x16x32_bf16 v[176:179], v[60:63], v[32:35], v[176:179]
    s_waitcnt lgkmcnt(8)
    v_mfma_f32_16x16x32_bf16 v[180:183], v[64:67], v[20:23], v[180:183]
    ds_read_b128 v[60:63], v15 offset:4096
    v_mfma_f32_16x16x32_bf16 v[184:187], v[64:67], v[24:27], v[184:187]
    v_mfma_f32_16x16x32_bf16 v[188:191], v[64:67], v[28:31], v[188:191]
    ds_read_b64_tr_b16 v[48:49], v19 offset:49152
    ds_read_b64_tr_b16 v[50:51], v19 offset:50176
    v_mfma_f32_16x16x32_bf16 v[192:195], v[64:67], v[32:35], v[192:195]
    s_waitcnt lgkmcnt(8)
    v_mfma_f32_16x16x32_bf16 v[68:71], v[52:55], v[36:39], v[68:71]
    ds_read_b128 v[64:67], v15 offset:6144
    s_waitcnt lgkmcnt(7)
    v_mfma_f32_16x16x32_bf16 v[72:75], v[52:55], v[40:43], v[72:75]
    s_waitcnt lgkmcnt(4)
    v_mfma_f32_16x16x32_bf16 v[76:79], v[52:55], v[44:47], v[76:79]
    s_waitcnt lgkmcnt(1)
    v_mfma_f32_16x16x32_bf16 v[80:83], v[52:55], v[48:51], v[80:83]
    v_mfma_f32_16x16x32_bf16 v[84:87], v[56:59], v[36:39], v[84:87]
    ds_read_b128 v[52:55], v15 offset:8192
    v_mfma_f32_16x16x32_bf16 v[88:91], v[56:59], v[40:43], v[88:91]
    v_mfma_f32_16x16x32_bf16 v[92:95], v[56:59], v[44:47], v[92:95]
    v_mfma_f32_16x16x32_bf16 v[96:99], v[56:59], v[48:51], v[96:99]
    v_mfma_f32_16x16x32_bf16 v[100:103], v[60:63], v[36:39], v[100:103]
    ds_read_b128 v[56:59], v15 offset:10240
    v_mfma_f32_16x16x32_bf16 v[104:107], v[60:63], v[40:43], v[104:107]
    v_mfma_f32_16x16x32_bf16 v[108:111], v[60:63], v[44:47], v[108:111]
    v_mfma_f32_16x16x32_bf16 v[112:115], v[60:63], v[48:51], v[112:115]
    s_waitcnt vmcnt(6)
    s_barrier
    s_add_u32 m0, s52, 49152
    s_nop 0
    buffer_load_dwordx4 v4, s[24:27], s50 offen lds
    buffer_load_dwordx4 v5, s[24:27], s50 offen offset:1024 lds
    s_add_u32 s50, s50, 262144
    s_add_u32 m0, s51, 49152
    s_add_u32 s47, s49, 131968
    buffer_load_dwordx4 v2, s[8:11], s47 offen lds
    buffer_load_dwordx4 v3, s[8:11], s47 offen offset:1024 lds
    s_waitcnt lgkmcnt(2)
    v_mfma_f32_16x16x32_bf16 v[116:119], v[64:67], v[36:39], v[116:119]
    ds_read_b128 v[60:63], v15 offset:12288
    v_mfma_f32_16x16x32_bf16 v[120:123], v[64:67], v[40:43], v[120:123]
    v_mfma_f32_16x16x32_bf16 v[124:127], v[64:67], v[44:47], v[124:127]
    v_mfma_f32_16x16x32_bf16 v[128:131], v[64:67], v[48:51], v[128:131]
    s_waitcnt lgkmcnt(2)
    v_mfma_f32_16x16x32_bf16 v[132:135], v[52:55], v[36:39], v[132:135]
    ds_read_b128 v[64:67], v15 offset:14336
    v_mfma_f32_16x16x32_bf16 v[136:139], v[52:55], v[40:43], v[136:139]
    v_mfma_f32_16x16x32_bf16 v[140:143], v[52:55], v[44:47], v[140:143]
    ds_read_b64_tr_b16 v[20:21], v16 offset:0
    ds_read_b64_tr_b16 v[22:23], v16 offset:1024
    v_mfma_f32_16x16x32_bf16 v[144:147], v[52:55], v[48:51], v[144:147]
    s_waitcnt lgkmcnt(4)
    v_mfma_f32_16x16x32_bf16 v[148:151], v[56:59], v[36:39], v[148:151]
    ds_read_b128 v[52:55], v6 offset:0
    v_mfma_f32_16x16x32_bf16 v[152:155], v[56:59], v[40:43], v[152:155]
    v_mfma_f32_16x16x32_bf16 v[156:159], v[56:59], v[44:47], v[156:159]
    ds_read_b64_tr_b16 v[24:25], v17 offset:0
    ds_read_b64_tr_b16 v[26:27], v17 offset:1024
    v_mfma_f32_16x16x32_bf16 v[160:163], v[56:59], v[48:51], v[160:163]
    s_waitcnt lgkmcnt(6)
    v_mfma_f32_16x16x32_bf16 v[164:167], v[60:63], v[36:39], v[164:167]
    ds_read_b128 v[56:59], v6 offset:2048
    v_mfma_f32_16x16x32_bf16 v[168:171], v[60:63], v[40:43], v[168:171]
    v_mfma_f32_16x16x32_bf16 v[172:175], v[60:63], v[44:47], v[172:175]
    ds_read_b64_tr_b16 v[28:29], v18 offset:0
    ds_read_b64_tr_b16 v[30:31], v18 offset:1024
    v_mfma_f32_16x16x32_bf16 v[176:179], v[60:63], v[48:51], v[176:179]
    s_waitcnt lgkmcnt(8)
    v_mfma_f32_16x16x32_bf16 v[180:183], v[64:67], v[36:39], v[180:183]
    ds_read_b128 v[60:63], v7 offset:0
    v_mfma_f32_16x16x32_bf16 v[184:187], v[64:67], v[40:43], v[184:187]
    v_mfma_f32_16x16x32_bf16 v[188:191], v[64:67], v[44:47], v[188:191]
    ds_read_b64_tr_b16 v[32:33], v19 offset:0
    ds_read_b64_tr_b16 v[34:35], v19 offset:1024
    v_mfma_f32_16x16x32_bf16 v[192:195], v[64:67], v[48:51], v[192:195]
    s_waitcnt lgkmcnt(8)
    v_mfma_f32_16x16x32_bf16 v[68:71], v[52:55], v[20:23], v[68:71]
    ds_read_b128 v[64:67], v7 offset:2048
    s_waitcnt lgkmcnt(7)
    v_mfma_f32_16x16x32_bf16 v[72:75], v[52:55], v[24:27], v[72:75]
    v_lshlrev_b32 v244, 4, v1
    s_lshl_b32 s53, s43, 19
    s_lshl_b32 s48, s42, 16
    s_waitcnt lgkmcnt(4)
    v_mfma_f32_16x16x32_bf16 v[76:79], v[52:55], v[28:31], v[76:79]
    ds_read_b64_tr_b16 v[36:37], v16 offset:16384
    ds_read_b64_tr_b16 v[38:39], v16 offset:17408
    s_waitcnt lgkmcnt(3)
    v_mfma_f32_16x16x32_bf16 v[80:83], v[52:55], v[32:35], v[80:83]
    ds_read_b64_tr_b16 v[40:41], v17 offset:16384
    ds_read_b64_tr_b16 v[42:43], v17 offset:17408
    s_add_u32 s53, s53, s48
    s_lshl_b32 s48, s45, 15
    s_add_u32 s53, s53, s48
    v_mfma_f32_16x16x32_bf16 v[84:87], v[56:59], v[20:23], v[84:87]
    ds_read_b128 v[52:55], v6 offset:4096
    v_mfma_f32_16x16x32_bf16 v[88:91], v[56:59], v[24:27], v[88:91]
    s_and_b32 s48, s46, 1
    s_lshl_b32 s48, s48, 13
    s_add_u32 s53, s53, s48
    v_mfma_f32_16x16x32_bf16 v[92:95], v[56:59], v[28:31], v[92:95]
    ds_read_b64_tr_b16 v[44:45], v18 offset:16384
    ds_read_b64_tr_b16 v[46:47], v18 offset:17408
    v_mfma_f32_16x16x32_bf16 v[96:99], v[56:59], v[32:35], v[96:99]
    ds_read_b64_tr_b16 v[48:49], v19 offset:16384
    ds_read_b64_tr_b16 v[50:51], v19 offset:17408
    s_add_u32 s53, s53, 16777216
    s_waitcnt lgkmcnt(7)
    v_mfma_f32_16x16x32_bf16 v[68:71], v[60:63], v[36:39], v[68:71]
    ds_read_b128 v[56:59], v6 offset:6144
    s_waitcnt lgkmcnt(6)
    v_mfma_f32_16x16x32_bf16 v[72:75], v[60:63], v[40:43], v[72:75]
    s_waitcnt lgkmcnt(3)
    v_mfma_f32_16x16x32_bf16 v[76:79], v[60:63], v[44:47], v[76:79]
    s_waitcnt lgkmcnt(1)
    v_mfma_f32_16x16x32_bf16 v[80:83], v[60:63], v[48:51], v[80:83]
    v_mfma_f32_16x16x32_bf16 v[84:87], v[64:67], v[36:39], v[84:87]
    ds_read_b128 v[60:63], v7 offset:4096
    v_mfma_f32_16x16x32_bf16 v[88:91], v[64:67], v[40:43], v[88:91]
    v_mfma_f32_16x16x32_bf16 v[92:95], v[64:67], v[44:47], v[92:95]
    v_mfma_f32_16x16x32_bf16 v[96:99], v[64:67], v[48:51], v[96:99]
    v_mfma_f32_16x16x32_bf16 v[100:103], v[52:55], v[20:23], v[100:103]
    ds_read_b128 v[64:67], v7 offset:6144
    v_mfma_f32_16x16x32_bf16 v[104:107], v[52:55], v[24:27], v[104:107]
    v_mfma_f32_16x16x32_bf16 v[108:111], v[52:55], v[28:31], v[108:111]
    v_mfma_f32_16x16x32_bf16 v[112:115], v[52:55], v[32:35], v[112:115]
    s_waitcnt vmcnt(0)
    s_barrier
    s_waitcnt lgkmcnt(2)
    v_mfma_f32_16x16x32_bf16 v[116:119], v[56:59], v[20:23], v[116:119]
    ds_read_b128 v[52:55], v6 offset:32768
    v_mfma_f32_16x16x32_bf16 v[120:123], v[56:59], v[24:27], v[120:123]
    v_mfma_f32_16x16x32_bf16 v[124:127], v[56:59], v[28:31], v[124:127]
    ds_read_b64_tr_b16 v[196:197], v16 offset:32768
    ds_read_b64_tr_b16 v[198:199], v16 offset:33792
    v_mfma_f32_16x16x32_bf16 v[128:131], v[56:59], v[32:35], v[128:131]
    ds_read_b64_tr_b16 v[200:201], v17 offset:32768
    ds_read_b64_tr_b16 v[202:203], v17 offset:33792
    s_waitcnt lgkmcnt(6)
    v_mfma_f32_16x16x32_bf16 v[100:103], v[60:63], v[36:39], v[100:103]
    ds_read_b128 v[56:59], v6 offset:34816
    v_mfma_f32_16x16x32_bf16 v[104:107], v[60:63], v[40:43], v[104:107]
    v_mfma_f32_16x16x32_bf16 v[108:111], v[60:63], v[44:47], v[108:111]
    ds_read_b64_tr_b16 v[204:205], v18 offset:32768
    ds_read_b64_tr_b16 v[206:207], v18 offset:33792
    v_mfma_f32_16x16x32_bf16 v[112:115], v[60:63], v[48:51], v[112:115]
    ds_read_b64_tr_b16 v[208:209], v19 offset:32768
    ds_read_b64_tr_b16 v[210:211], v19 offset:33792
    s_waitcnt lgkmcnt(10)
    v_mfma_f32_16x16x32_bf16 v[116:119], v[64:67], v[36:39], v[116:119]
    ds_read_b128 v[60:63], v7 offset:32768
    v_mfma_f32_16x16x32_bf16 v[120:123], v[64:67], v[40:43], v[120:123]
    v_mfma_f32_16x16x32_bf16 v[124:127], v[64:67], v[44:47], v[124:127]
    ds_read_b64_tr_b16 v[212:213], v16 offset:49152
    ds_read_b64_tr_b16 v[214:215], v16 offset:50176
    v_mfma_f32_16x16x32_bf16 v[128:131], v[64:67], v[48:51], v[128:131]
    ds_read_b64_tr_b16 v[216:217], v17 offset:49152
    ds_read_b64_tr_b16 v[218:219], v17 offset:50176
    s_waitcnt lgkmcnt(14)
    s_waitcnt lgkmcnt(12)
    v_mfma_f32_16x16x32_bf16 v[68:71], v[52:55], v[196:199], v[68:71]
    ds_read_b128 v[64:67], v7 offset:34816
    s_waitcnt lgkmcnt(11)
    v_mfma_f32_16x16x32_bf16 v[72:75], v[52:55], v[200:203], v[72:75]
    s_waitcnt lgkmcnt(8)
    v_mfma_f32_16x16x32_bf16 v[76:79], v[52:55], v[204:207], v[76:79]
    ds_read_b64_tr_b16 v[220:221], v18 offset:49152
    ds_read_b64_tr_b16 v[222:223], v18 offset:50176
    s_waitcnt lgkmcnt(8)
    v_mfma_f32_16x16x32_bf16 v[80:83], v[52:55], v[208:211], v[80:83]
    ds_read_b64_tr_b16 v[224:225], v19 offset:49152
    ds_read_b64_tr_b16 v[226:227], v19 offset:50176
    v_mfma_f32_16x16x32_bf16 v[84:87], v[56:59], v[196:199], v[84:87]
    ds_read_b128 v[52:55], v6 offset:36864
    v_mfma_f32_16x16x32_bf16 v[88:91], v[56:59], v[200:203], v[88:91]
    v_mfma_f32_16x16x32_bf16 v[92:95], v[56:59], v[204:207], v[92:95]
    v_mfma_f32_16x16x32_bf16 v[96:99], v[56:59], v[208:211], v[96:99]
    s_waitcnt lgkmcnt(10)
    s_waitcnt lgkmcnt(8)
    v_mfma_f32_16x16x32_bf16 v[68:71], v[60:63], v[212:215], v[68:71]
    ds_read_b128 v[56:59], v6 offset:38912
    s_waitcnt lgkmcnt(7)
    v_mfma_f32_16x16x32_bf16 v[72:75], v[60:63], v[216:219], v[72:75]
    s_waitcnt lgkmcnt(4)
    v_mfma_f32_16x16x32_bf16 v[76:79], v[60:63], v[220:223], v[76:79]
    s_waitcnt lgkmcnt(2)
    v_mfma_f32_16x16x32_bf16 v[80:83], v[60:63], v[224:227], v[80:83]
    v_mfma_f32_16x16x32_bf16 v[84:87], v[64:67], v[212:215], v[84:87]
    ds_read_b128 v[60:63], v7 offset:36864
    v_mfma_f32_16x16x32_bf16 v[88:91], v[64:67], v[216:219], v[88:91]
    v_mfma_f32_16x16x32_bf16 v[92:95], v[64:67], v[220:223], v[92:95]
    v_mfma_f32_16x16x32_bf16 v[96:99], v[64:67], v[224:227], v[96:99]
    s_waitcnt lgkmcnt(2)
    v_mfma_f32_16x16x32_bf16 v[100:103], v[52:55], v[196:199], v[100:103]
    ds_read_b128 v[64:67], v7 offset:38912
    v_mfma_f32_16x16x32_bf16 v[104:107], v[52:55], v[200:203], v[104:107]
    v_mfma_f32_16x16x32_bf16 v[108:111], v[52:55], v[204:207], v[108:111]
    v_mfma_f32_16x16x32_bf16 v[112:115], v[52:55], v[208:211], v[112:115]
    s_waitcnt lgkmcnt(2)
    v_mfma_f32_16x16x32_bf16 v[116:119], v[56:59], v[196:199], v[116:119]
    ds_read_b128 v[52:55], v6 offset:8192
    v_mfma_f32_16x16x32_bf16 v[120:123], v[56:59], v[200:203], v[120:123]
    s_add_u32 s48, s53, 4096
    v_cvt_pk_bf16_f32 v228, v68, v69
    v_cvt_pk_bf16_f32 v229, v70, v71
    v_mfma_f32_16x16x32_bf16 v[124:127], v[56:59], v[204:207], v[124:127]
    v_mfma_f32_16x16x32_bf16 v[128:131], v[56:59], v[208:211], v[128:131]
    v_cvt_pk_bf16_f32 v230, v84, v85
    v_cvt_pk_bf16_f32 v231, v86, v87
    buffer_store_dwordx4 v[228:231], v244, s[20:23], s53 offen offset:0 sc1
    s_waitcnt lgkmcnt(2)
    v_mfma_f32_16x16x32_bf16 v[100:103], v[60:63], v[212:215], v[100:103]
    ds_read_b128 v[56:59], v6 offset:10240
    v_mfma_f32_16x16x32_bf16 v[104:107], v[60:63], v[216:219], v[104:107]
    v_cvt_pk_bf16_f32 v232, v72, v73
    v_cvt_pk_bf16_f32 v233, v74, v75
    v_cvt_pk_bf16_f32 v234, v88, v89
    v_mfma_f32_16x16x32_bf16 v[108:111], v[60:63], v[220:223], v[108:111]
    v_mfma_f32_16x16x32_bf16 v[112:115], v[60:63], v[224:227], v[112:115]
    v_cvt_pk_bf16_f32 v235, v90, v91
    buffer_store_dwordx4 v[232:235], v244, s[20:23], s53 offen offset:2048 sc1
    v_cvt_pk_bf16_f32 v236, v76, v77
    s_waitcnt lgkmcnt(2)
    v_mfma_f32_16x16x32_bf16 v[116:119], v[64:67], v[212:215], v[116:119]
    ds_read_b128 v[60:63], v7 offset:8192
    v_mfma_f32_16x16x32_bf16 v[120:123], v[64:67], v[216:219], v[120:123]
    v_cvt_pk_bf16_f32 v237, v78, v79
    v_cvt_pk_bf16_f32 v238, v92, v93
    v_cvt_pk_bf16_f32 v239, v94, v95
    v_mfma_f32_16x16x32_bf16 v[124:127], v[64:67], v[220:223], v[124:127]
    v_mfma_f32_16x16x32_bf16 v[128:131], v[64:67], v[224:227], v[128:131]
    buffer_store_dwordx4 v[236:239], v244, s[20:23], s48 offen offset:0 sc1
    v_cvt_pk_bf16_f32 v240, v80, v81
    v_cvt_pk_bf16_f32 v241, v82, v83
    s_waitcnt lgkmcnt(2)
    v_mfma_f32_16x16x32_bf16 v[132:135], v[52:55], v[20:23], v[132:135]
    ds_read_b128 v[64:67], v7 offset:10240
    v_mfma_f32_16x16x32_bf16 v[136:139], v[52:55], v[24:27], v[136:139]
    v_cvt_pk_bf16_f32 v242, v96, v97
    v_cvt_pk_bf16_f32 v243, v98, v99
    buffer_store_dwordx4 v[240:243], v244, s[20:23], s48 offen offset:2048 sc1
    v_mfma_f32_16x16x32_bf16 v[140:143], v[52:55], v[28:31], v[140:143]
    v_mfma_f32_16x16x32_bf16 v[144:147], v[52:55], v[32:35], v[144:147]
    s_waitcnt lgkmcnt(2)
    v_mfma_f32_16x16x32_bf16 v[148:151], v[56:59], v[20:23], v[148:151]
    ds_read_b128 v[52:55], v6 offset:40960
    v_mfma_f32_16x16x32_bf16 v[152:155], v[56:59], v[24:27], v[152:155]
    s_add_u32 s48, s53, 4096
    v_cvt_pk_bf16_f32 v228, v100, v101
    v_cvt_pk_bf16_f32 v229, v102, v103
    v_mfma_f32_16x16x32_bf16 v[156:159], v[56:59], v[28:31], v[156:159]
    v_mfma_f32_16x16x32_bf16 v[160:163], v[56:59], v[32:35], v[160:163]
    v_cvt_pk_bf16_f32 v230, v116, v117
    v_cvt_pk_bf16_f32 v231, v118, v119
    buffer_store_dwordx4 v[228:231], v244, s[20:23], s53 offen offset:1024 sc1
    s_waitcnt lgkmcnt(2)
    v_mfma_f32_16x16x32_bf16 v[132:135], v[60:63], v[36:39], v[132:135]
    ds_read_b128 v[56:59], v6 offset:43008
    v_mfma_f32_16x16x32_bf16 v[136:139], v[60:63], v[40:43], v[136:139]
    v_cvt_pk_bf16_f32 v232, v104, v105
    v_cvt_pk_bf16_f32 v233, v106, v107
    v_cvt_pk_bf16_f32 v234, v120, v121
    v_mfma_f32_16x16x32_bf16 v[140:143], v[60:63], v[44:47], v[140:143]
    v_mfma_f32_16x16x32_bf16 v[144:147], v[60:63], v[48:51], v[144:147]
    v_cvt_pk_bf16_f32 v235, v122, v123
    buffer_store_dwordx4 v[232:235], v244, s[20:23], s53 offen offset:3072 sc1
    v_cvt_pk_bf16_f32 v236, v108, v109
    s_waitcnt lgkmcnt(2)
    v_mfma_f32_16x16x32_bf16 v[148:151], v[64:67], v[36:39], v[148:151]
    ds_read_b128 v[60:63], v7 offset:40960
    v_mfma_f32_16x16x32_bf16 v[152:155], v[64:67], v[40:43], v[152:155]
    v_cvt_pk_bf16_f32 v237, v110, v111
    v_cvt_pk_bf16_f32 v238, v124, v125
    v_cvt_pk_bf16_f32 v239, v126, v127
    v_mfma_f32_16x16x32_bf16 v[156:159], v[64:67], v[44:47], v[156:159]
    v_mfma_f32_16x16x32_bf16 v[160:163], v[64:67], v[48:51], v[160:163]
    buffer_store_dwordx4 v[236:239], v244, s[20:23], s48 offen offset:1024 sc1
    v_cvt_pk_bf16_f32 v240, v112, v113
    v_cvt_pk_bf16_f32 v241, v114, v115
    s_waitcnt lgkmcnt(2)
    v_mfma_f32_16x16x32_bf16 v[132:135], v[52:55], v[196:199], v[132:135]
    ds_read_b128 v[64:67], v7 offset:43008
    v_mfma_f32_16x16x32_bf16 v[136:139], v[52:55], v[200:203], v[136:139]
    v_cvt_pk_bf16_f32 v242, v128, v129
    v_cvt_pk_bf16_f32 v243, v130, v131
    buffer_store_dwordx4 v[240:243], v244, s[20:23], s48 offen offset:3072 sc1
    v_mfma_f32_16x16x32_bf16 v[140:143], v[52:55], v[204:207], v[140:143]
    v_mfma_f32_16x16x32_bf16 v[144:147], v[52:55], v[208:211], v[144:147]
    s_add_u32 s53, s53, 16384
    s_waitcnt lgkmcnt(2)
    v_mfma_f32_16x16x32_bf16 v[148:151], v[56:59], v[196:199], v[148:151]
    ds_read_b128 v[52:55], v6 offset:12288
    v_mfma_f32_16x16x32_bf16 v[152:155], v[56:59], v[200:203], v[152:155]
    v_mfma_f32_16x16x32_bf16 v[156:159], v[56:59], v[204:207], v[156:159]
    v_mfma_f32_16x16x32_bf16 v[160:163], v[56:59], v[208:211], v[160:163]
    s_waitcnt lgkmcnt(2)
    v_mfma_f32_16x16x32_bf16 v[132:135], v[60:63], v[212:215], v[132:135]
    ds_read_b128 v[56:59], v6 offset:14336
    v_mfma_f32_16x16x32_bf16 v[136:139], v[60:63], v[216:219], v[136:139]
    v_mfma_f32_16x16x32_bf16 v[140:143], v[60:63], v[220:223], v[140:143]
    v_mfma_f32_16x16x32_bf16 v[144:147], v[60:63], v[224:227], v[144:147]
    s_waitcnt lgkmcnt(2)
    v_mfma_f32_16x16x32_bf16 v[148:151], v[64:67], v[212:215], v[148:151]
    ds_read_b128 v[60:63], v7 offset:12288
    v_mfma_f32_16x16x32_bf16 v[152:155], v[64:67], v[216:219], v[152:155]
    v_mfma_f32_16x16x32_bf16 v[156:159], v[64:67], v[220:223], v[156:159]
    v_mfma_f32_16x16x32_bf16 v[160:163], v[64:67], v[224:227], v[160:163]
    s_waitcnt lgkmcnt(2)
    v_mfma_f32_16x16x32_bf16 v[164:167], v[52:55], v[20:23], v[164:167]
    ds_read_b128 v[64:67], v7 offset:14336
    v_mfma_f32_16x16x32_bf16 v[168:171], v[52:55], v[24:27], v[168:171]
    v_mfma_f32_16x16x32_bf16 v[172:175], v[52:55], v[28:31], v[172:175]
    v_mfma_f32_16x16x32_bf16 v[176:179], v[52:55], v[32:35], v[176:179]
    s_waitcnt lgkmcnt(2)
    v_mfma_f32_16x16x32_bf16 v[180:183], v[56:59], v[20:23], v[180:183]
    ds_read_b128 v[52:55], v6 offset:45056
    v_mfma_f32_16x16x32_bf16 v[184:187], v[56:59], v[24:27], v[184:187]
    s_add_u32 s48, s53, 4096
    v_cvt_pk_bf16_f32 v228, v132, v133
    v_cvt_pk_bf16_f32 v229, v134, v135
    v_mfma_f32_16x16x32_bf16 v[188:191], v[56:59], v[28:31], v[188:191]
    v_mfma_f32_16x16x32_bf16 v[192:195], v[56:59], v[32:35], v[192:195]
    v_cvt_pk_bf16_f32 v230, v148, v149
    v_cvt_pk_bf16_f32 v231, v150, v151
    buffer_store_dwordx4 v[228:231], v244, s[20:23], s53 offen offset:0 sc1
    s_waitcnt lgkmcnt(2)
    v_mfma_f32_16x16x32_bf16 v[164:167], v[60:63], v[36:39], v[164:167]
    ds_read_b128 v[56:59], v6 offset:47104
    v_mfma_f32_16x16x32_bf16 v[168:171], v[60:63], v[40:43], v[168:171]
    v_cvt_pk_bf16_f32 v232, v136, v137
    v_cvt_pk_bf16_f32 v233, v138, v139
    v_cvt_pk_bf16_f32 v234, v152, v153
    v_mfma_f32_16x16x32_bf16 v[172:175], v[60:63], v[44:47], v[172:175]
    v_mfma_f32_16x16x32_bf16 v[176:179], v[60:63], v[48:51], v[176:179]
    v_cvt_pk_bf16_f32 v235, v154, v155
    buffer_store_dwordx4 v[232:235], v244, s[20:23], s53 offen offset:2048 sc1
    v_cvt_pk_bf16_f32 v236, v140, v141
    s_waitcnt lgkmcnt(2)
    v_mfma_f32_16x16x32_bf16 v[180:183], v[64:67], v[36:39], v[180:183]
    ds_read_b128 v[60:63], v7 offset:45056
    v_mfma_f32_16x16x32_bf16 v[184:187], v[64:67], v[40:43], v[184:187]
    v_cvt_pk_bf16_f32 v237, v142, v143
    v_cvt_pk_bf16_f32 v238, v156, v157
    v_cvt_pk_bf16_f32 v239, v158, v159
    v_mfma_f32_16x16x32_bf16 v[188:191], v[64:67], v[44:47], v[188:191]
    v_mfma_f32_16x16x32_bf16 v[192:195], v[64:67], v[48:51], v[192:195]
    buffer_store_dwordx4 v[236:239], v244, s[20:23], s48 offen offset:0 sc1
    v_cvt_pk_bf16_f32 v240, v144, v145
    v_cvt_pk_bf16_f32 v241, v146, v147
    s_waitcnt lgkmcnt(2)
    v_mfma_f32_16x16x32_bf16 v[164:167], v[52:55], v[196:199], v[164:167]
    ds_read_b128 v[64:67], v7 offset:47104
    v_mfma_f32_16x16x32_bf16 v[168:171], v[52:55], v[200:203], v[168:171]
    v_cvt_pk_bf16_f32 v242, v160, v161
    v_cvt_pk_bf16_f32 v243, v162, v163
    buffer_store_dwordx4 v[240:243], v244, s[20:23], s48 offen offset:2048 sc1
    v_mfma_f32_16x16x32_bf16 v[172:175], v[52:55], v[204:207], v[172:175]
    v_mfma_f32_16x16x32_bf16 v[176:179], v[52:55], v[208:211], v[176:179]
    s_waitcnt lgkmcnt(2)
    v_mfma_f32_16x16x32_bf16 v[180:183], v[56:59], v[196:199], v[180:183]
    v_mfma_f32_16x16x32_bf16 v[184:187], v[56:59], v[200:203], v[184:187]
    v_mfma_f32_16x16x32_bf16 v[188:191], v[56:59], v[204:207], v[188:191]
    v_mfma_f32_16x16x32_bf16 v[192:195], v[56:59], v[208:211], v[192:195]
    s_waitcnt lgkmcnt(1)
    v_mfma_f32_16x16x32_bf16 v[164:167], v[60:63], v[212:215], v[164:167]
    v_mfma_f32_16x16x32_bf16 v[168:171], v[60:63], v[216:219], v[168:171]
    v_mfma_f32_16x16x32_bf16 v[172:175], v[60:63], v[220:223], v[172:175]
    v_mfma_f32_16x16x32_bf16 v[176:179], v[60:63], v[224:227], v[176:179]
    s_waitcnt lgkmcnt(0)
    v_mfma_f32_16x16x32_bf16 v[180:183], v[64:67], v[212:215], v[180:183]
    v_mfma_f32_16x16x32_bf16 v[184:187], v[64:67], v[216:219], v[184:187]
    v_mfma_f32_16x16x32_bf16 v[188:191], v[64:67], v[220:223], v[188:191]
    v_mfma_f32_16x16x32_bf16 v[192:195], v[64:67], v[224:227], v[192:195]
    s_add_u32 s48, s53, 4096
    v_cvt_pk_bf16_f32 v228, v164, v165
    v_cvt_pk_bf16_f32 v229, v166, v167
    s_nop 1
    v_cvt_pk_bf16_f32 v230, v180, v181
    v_cvt_pk_bf16_f32 v231, v182, v183
    buffer_store_dwordx4 v[228:231], v244, s[20:23], s53 offen offset:1024 sc1
    v_cvt_pk_bf16_f32 v232, v168, v169
    v_cvt_pk_bf16_f32 v233, v170, v171
    v_cvt_pk_bf16_f32 v234, v184, v185
    v_cvt_pk_bf16_f32 v235, v186, v187
    buffer_store_dwordx4 v[232:235], v244, s[20:23], s53 offen offset:3072 sc1
    v_cvt_pk_bf16_f32 v236, v172, v173
    v_cvt_pk_bf16_f32 v237, v174, v175
    v_cvt_pk_bf16_f32 v238, v188, v189
    v_cvt_pk_bf16_f32 v239, v190, v191
    buffer_store_dwordx4 v[236:239], v244, s[20:23], s48 offen offset:1024 sc1
    v_cvt_pk_bf16_f32 v240, v176, v177
    v_cvt_pk_bf16_f32 v241, v178, v179
    v_cvt_pk_bf16_f32 v242, v192, v193
    v_cvt_pk_bf16_f32 v243, v194, v195
    buffer_store_dwordx4 v[240:243], v244, s[20:23], s48 offen offset:3072 sc1
L_k1_kv_kernel_after_3:
L_k1_kv_kernel_done_1:
    s_endpgm

.section .rodata,"a"
.p2align 6
.amdhsa_kernel k1_kv_kernel
  .amdhsa_next_free_vgpr 248
  .amdhsa_next_free_sgpr 102
  .amdhsa_accum_offset 248
  .amdhsa_group_segment_fixed_size 0
  .amdhsa_kernarg_size 104
  .amdhsa_user_sgpr_count 2
  .amdhsa_user_sgpr_kernarg_segment_ptr 1
  .amdhsa_system_sgpr_workgroup_id_x 1
.end_amdhsa_kernel
.text
.globl k2_attn_kernel
.p2align 8
.type k2_attn_kernel,@function
k2_attn_kernel:
    s_cmp_ge_u32 s2, 256
    s_cbranch_scc1 L_k2_attn_kernel_done_1
    s_load_dwordx2 s[24:25], s[0:1], 96
    s_load_dwordx2 s[26:27], s[0:1], 16
    s_load_dwordx2 s[66:67], s[0:1], 40
    s_load_dwordx2 s[68:69], s[0:1], 72
    s_load_dwordx2 s[70:71], s[0:1], 56
    s_load_dwordx2 s[72:73], s[0:1], 64
    v_lshrrev_b32 v5, 6, v0
    v_and_b32 v1, 63, v0
    v_readfirstlane_b32 s36, v5
    s_and_b32 s34, s2, 7
    s_lshl_b32 s34, s34, 2
    s_lshr_b32 s39, s2, 3
    s_and_b32 s40, s39, 3
    s_add_u32 s34, s34, s40
    s_lshr_b32 s35, s39, 2
    s_and_b32 s37, s36, 3
    s_lshr_b32 s38, s36, 2
    v_lshlrev_b32 v2, 4, v1
    s_sub_u32 s49, 15, s35
    s_lshl_b32 s49, s49, 7
    s_lshl_b32 s39, s37, 5
    s_add_u32 s49, s49, s39
    s_lshl_b32 s42, s35, 7
    s_add_u32 s42, s42, s39
    s_lshl_b32 s46, s35, 1
    s_add_u32 s46, s46, 2
    s_cmp_eq_u32 s38, 0
    s_cselect_b32 s42, s49, s42
    s_cselect_b32 s53, 99, s46
    s_sub_u32 s54, 18, s46
    s_lshl_b32 s54, s54, 14
    s_lshl_b32 s48, s38, 16
    v_lshrrev_b32 v5, 4, v1
    s_and_b32 s39, s36, 1
    s_lshl_b32 s39, s39, 2
    v_or_b32 v6, s39, v5
    v_bfe_u32 v7, v1, 1, 3
    v_xor_b32 v6, v6, v7
    v_lshlrev_b32 v5, 13, v5
    v_lshl_add_u32 v5, v6, 5, v5
    v_and_b32 v6, 1, v1
    v_lshl_add_u32 v30, v6, 4, v5
    v_add_u32 v31, 31744, v30
    s_lshl_b32 s51, s36, 16
    s_lshl_b32 s39, s34, 8
    s_add_u32 s51, s51, s39
    s_lshr_b32 s52, s42, 4
    s_mul_i32 s52, s52, 18432
    v_add_u32 v4, 18432, v2
    s_lshl_b32 s47, s34, 19
    s_lshl_b32 s39, s37, 12
    s_add_u32 s47, s47, s39
    s_add_u32 s48, s48, s39
    s_lshl_b32 s50, s36, 11
    s_waitcnt lgkmcnt(0)
    s_mov_b32 s8, s26
    s_mov_b32 s9, s27
    s_mov_b32 s10, 4718592
    s_mov_b32 s11, 0x00020000
    s_mov_b32 s12, s24
    s_mov_b32 s13, s25
    s_mov_b32 s14, 2359296
    s_mov_b32 s15, 0x00020000
    s_add_u32 m0, s50, 16384
    s_nop 0
    buffer_load_dwordx4 v30, s[8:11], s51 offen lds
    buffer_load_dwordx4 v31, s[8:11], s51 offen offset:1024 lds
    s_add_u32 s51, s51, 524288
    buffer_load_dwordx4 v[32:35], v2, s[12:15], s52 offen offset:0
    buffer_load_dwordx4 v[36:39], v4, s[12:15], s52 offen offset:0
    buffer_load_dwordx4 v[40:43], v2, s[12:15], s52 offen offset:1024
    buffer_load_dwordx4 v[44:47], v4, s[12:15], s52 offen offset:1024
    s_add_u32 s52, s52, 2048
    s_add_u32 m0, s50, 32768
    s_nop 0
    buffer_load_dwordx4 v30, s[8:11], s51 offen lds
    buffer_load_dwordx4 v31, s[8:11], s51 offen offset:1024 lds
    s_add_u32 s51, s51, 524288
    buffer_load_dwordx4 v[48:51], v2, s[12:15], s52 offen offset:0
    buffer_load_dwordx4 v[52:55], v4, s[12:15], s52 offen offset:0
    buffer_load_dwordx4 v[56:59], v2, s[12:15], s52 offen offset:1024
    buffer_load_dwordx4 v[60:63], v4, s[12:15], s52 offen offset:1024
    s_add_u32 s52, s52, 2048
    s_add_u32 s16, s24, 16777216
    s_addc_u32 s17, s25, 0
    s_mov_b32 s18, 33554432
    s_mov_b32 s19, 0x00020000
    s_add_u32 s20, s24, 50331648
    s_addc_u32 s21, s25, 0
    s_mov_b32 s22, 16777216
    s_mov_b32 s23, 0x00020000
    v_lshrrev_b32 v5, 4, v1
    v_bfe_u32 v6, v1, 2, 2
    v_lshl_add_u32 v7, v5, 3, v6
    v_and_b32 v5, 1, v5
    v_lshl_or_b32 v5, v5, 2, v6
    v_lshlrev_b32 v7, 8, v7
    v_and_b32 v6, 3, v1
    v_lshl_add_u32 v7, v6, 3, v7
    v_add_u32 v7, 16384, v7
    v_xor_b32 v6, 0, v5
    v_lshl_add_u32 v22, v6, 5, v7
    v_xor_b32 v6, 1, v5
    v_lshl_add_u32 v23, v6, 5, v7
    v_xor_b32 v6, 2, v5
    v_lshl_add_u32 v24, v6, 5, v7
    v_xor_b32 v6, 3, v5
    v_lshl_add_u32 v25, v6, 5, v7
    v_xor_b32 v6, 4, v5
    v_lshl_add_u32 v26, v6, 5, v7
    v_xor_b32 v6, 5, v5
    v_lshl_add_u32 v27, v6, 5, v7
    v_xor_b32 v6, 6, v5
    v_lshl_add_u32 v28, v6, 5, v7
    v_xor_b32 v6, 7, v5
    v_lshl_add_u32 v29, v6, 5, v7
    v_and_b32 v5, 15, v1
    v_lshrrev_b32 v6, 4, v1
    s_lshl_b32 s39, s38, 16
    v_add_u32 v232, s39, v2
    v_lshlrev_b32 v6, 2, v6
    v_sub_u32 v3, v5, v6
    v_cmp_gt_i32 s[58:59], 0, v3
    v_cmp_gt_i32 s[60:61], 1, v3
    v_cmp_gt_i32 s[62:63], 2, v3
    v_cmp_gt_i32 s[64:65], 3, v3
    v_mov_b32 v14, 0
    v_mov_b32 v15, 0
    v_mov_b32 v18, 0
    v_mov_b32 v19, 0
    s_lshl_b32 s88, s36, 12
    s_add_u32 s88, s88, 131072
    s_lshl_b32 s89, s2, 15
    s_lshl_b32 s39, s37, 13
    s_add_u32 s89, s89, s39
    s_add_u32 s89, s89, 134217728
    s_mov_b32 s43, 1
    s_mov_b32 s44, 0
    s_mov_b32 s41, 0
    s_mov_b32 s57, 0
    s_mov_b64 s[30:31], -1
    s_mov_b32 s45, 0
    s_mov_b32 s87, 0
    s_mov_b32 s55, s47
    s_lshr_b32 s84, s2, 3
    s_mul_i32 s39, s84, 205
    s_lshr_b32 s39, s39, 11
    s_mul_i32 s39, s39, 10
    s_mov_b32 s75, -1
    s_sub_u32 s84, s84, s39
    s_add_u32 s84, s84, 1
    s_mov_b32 s85, 0
    s_lshl_b32 s86, s2, 3
    s_add_u32 s86, s86, s36
    s_waitcnt vmcnt(6)
    s_barrier
    ds_read_b64_tr_b16 v[128:129], v22 offset:0
    ds_read_b64_tr_b16 v[130:131], v22 offset:1024
    ds_read_b64_tr_b16 v[132:133], v23 offset:0
    ds_read_b64_tr_b16 v[134:135], v23 offset:1024
    ds_read_b64_tr_b16 v[136:137], v24 offset:0
    ds_read_b64_tr_b16 v[138:139], v24 offset:1024
    ds_read_b64_tr_b16 v[140:141], v25 offset:0
    ds_read_b64_tr_b16 v[142:143], v25 offset:1024
    ds_read_b64_tr_b16 v[144:145], v26 offset:0
    ds_read_b64_tr_b16 v[146:147], v26 offset:1024
    s_waitcnt lgkmcnt(8)
    v_mfma_f32_16x16x32_bf16 v[160:163], v[128:131], v[32:35], 0
    v_mfma_f32_16x16x32_bf16 v[164:167], v[128:131], v[36:39], 0
    ds_read_b64_tr_b16 v[148:149], v27 offset:0
    ds_read_b64_tr_b16 v[150:151], v27 offset:1024
    s_add_u32 m0, s50, 49152
    s_nop 0
    buffer_load_dwordx4 v30, s[8:11], s51 offen lds
    buffer_load_dwordx4 v31, s[8:11], s51 offen offset:1024 lds
    s_add_u32 s51, s51, 524288
    s_waitcnt lgkmcnt(8)
    v_mfma_f32_16x16x32_bf16 v[168:171], v[132:135], v[32:35], 0
    v_mfma_f32_16x16x32_bf16 v[172:175], v[132:135], v[36:39], 0
    ds_read_b64_tr_b16 v[152:153], v28 offset:0
    ds_read_b64_tr_b16 v[154:155], v28 offset:1024
    buffer_load_dwordx4 v[64:67], v2, s[12:15], s52 offen offset:0
    buffer_load_dwordx4 v[68:71], v4, s[12:15], s52 offen offset:0
    buffer_load_dwordx4 v[72:75], v2, s[12:15], s52 offen offset:1024
    buffer_load_dwordx4 v[76:79], v4, s[12:15], s52 offen offset:1024
    s_add_u32 s52, s52, 2048
    s_waitcnt lgkmcnt(8)
    v_mfma_f32_16x16x32_bf16 v[176:179], v[136:139], v[32:35], 0
    v_mfma_f32_16x16x32_bf16 v[180:183], v[136:139], v[36:39], 0
    ds_read_b64_tr_b16 v[156:157], v29 offset:0
    ds_read_b64_tr_b16 v[158:159], v29 offset:1024
    s_waitcnt lgkmcnt(8)
    v_mfma_f32_16x16x32_bf16 v[184:187], v[140:143], v[32:35], 0
    v_mfma_f32_16x16x32_bf16 v[188:191], v[140:143], v[36:39], 0
    ds_read_b64_tr_b16 v[128:129], v22 offset:8192
    ds_read_b64_tr_b16 v[130:131], v22 offset:9216
    v_add_u32 v22, 16384, v22
    s_waitcnt lgkmcnt(8)
    v_mfma_f32_16x16x32_bf16 v[192:195], v[144:147], v[32:35], 0
    v_mfma_f32_16x16x32_bf16 v[196:199], v[144:147], v[36:39], 0
    ds_read_b64_tr_b16 v[132:133], v23 offset:8192
    ds_read_b64_tr_b16 v[134:135], v23 offset:9216
    v_add_u32 v23, 16384, v23
    s_waitcnt lgkmcnt(8)
    v_mfma_f32_16x16x32_bf16 v[200:203], v[148:151], v[32:35], 0
    v_mfma_f32_16x16x32_bf16 v[204:207], v[148:151], v[36:39], 0
    ds_read_b64_tr_b16 v[136:137], v24 offset:8192
    ds_read_b64_tr_b16 v[138:139], v24 offset:9216
    v_add_u32 v24, 16384, v24
    s_waitcnt lgkmcnt(8)
    v_mfma_f32_16x16x32_bf16 v[208:211], v[152:155], v[32:35], 0
    v_mfma_f32_16x16x32_bf16 v[212:215], v[152:155], v[36:39], 0
    ds_read_b64_tr_b16 v[140:141], v25 offset:8192
    ds_read_b64_tr_b16 v[142:143], v25 offset:9216
    v_add_u32 v25, 16384, v25
    s_waitcnt lgkmcnt(8)
    v_mfma_f32_16x16x32_bf16 v[216:219], v[156:159], v[32:35], 0
    v_mfma_f32_16x16x32_bf16 v[220:223], v[156:159], v[36:39], 0
    ds_read_b64_tr_b16 v[144:145], v26 offset:8192
    ds_read_b64_tr_b16 v[146:147], v26 offset:9216
    v_add_u32 v26, 16384, v26
    s_waitcnt lgkmcnt(8)
    v_mfma_f32_16x16x32_bf16 v[160:163], v[128:131], v[40:43], v[160:163]
    v_mfma_f32_16x16x32_bf16 v[164:167], v[128:131], v[44:47], v[164:167]
    ds_read_b64_tr_b16 v[148:149], v27 offset:8192
    ds_read_b64_tr_b16 v[150:151], v27 offset:9216
    v_add_u32 v27, 16384, v27
    s_waitcnt lgkmcnt(8)
    v_mfma_f32_16x16x32_bf16 v[168:171], v[132:135], v[40:43], v[168:171]
    v_mfma_f32_16x16x32_bf16 v[172:175], v[132:135], v[44:47], v[172:175]
    ds_read_b64_tr_b16 v[152:153], v28 offset:8192
    ds_read_b64_tr_b16 v[154:155], v28 offset:9216
    v_add_u32 v28, 16384, v28
    s_waitcnt vmcnt(6)
    s_barrier
    s_waitcnt lgkmcnt(8)
    v_mfma_f32_16x16x32_bf16 v[176:179], v[136:139], v[40:43], v[176:179]
    v_mfma_f32_16x16x32_bf16 v[180:183], v[136:139], v[44:47], v[180:183]
    ds_read_b64_tr_b16 v[156:157], v29 offset:8192
    ds_read_b64_tr_b16 v[158:159], v29 offset:9216
    v_add_u32 v29, 16384, v29
    s_waitcnt lgkmcnt(8)
    v_mfma_f32_16x16x32_bf16 v[184:187], v[140:143], v[40:43], v[184:187]
    v_mfma_f32_16x16x32_bf16 v[188:191], v[140:143], v[44:47], v[188:191]
    ds_read_b64_tr_b16 v[128:129], v22 offset:0
    ds_read_b64_tr_b16 v[130:131], v22 offset:1024
    s_add_u32 m0, s50, 81920
    s_nop 0
    buffer_load_dwordx4 v30, s[8:11], s51 offen lds
    buffer_load_dwordx4 v31, s[8:11], s51 offen offset:1024 lds
    s_add_u32 s51, s51, 524288
    s_waitcnt lgkmcnt(8)
    v_mfma_f32_16x16x32_bf16 v[192:195], v[144:147], v[40:43], v[192:195]
    v_mfma_f32_16x16x32_bf16 v[196:199], v[144:147], v[44:47], v[196:199]
    ds_read_b64_tr_b16 v[132:133], v23 offset:0
    ds_read_b64_tr_b16 v[134:135], v23 offset:1024
    s_waitcnt lgkmcnt(8)
    v_mfma_f32_16x16x32_bf16 v[200:203], v[148:151], v[40:43], v[200:203]
    v_mfma_f32_16x16x32_bf16 v[204:207], v[148:151], v[44:47], v[204:207]
    ds_read_b64_tr_b16 v[136:137], v24 offset:0
    ds_read_b64_tr_b16 v[138:139], v24 offset:1024
    buffer_load_dwordx4 v[80:83], v2, s[12:15], s52 offen offset:0
    buffer_load_dwordx4 v[84:87], v4, s[12:15], s52 offen offset:0
    buffer_load_dwordx4 v[88:91], v2, s[12:15], s52 offen offset:1024
    buffer_load_dwordx4 v[92:95], v4, s[12:15], s52 offen offset:1024
    s_add_u32 s52, s52, 2048
    s_waitcnt lgkmcnt(8)
    v_mfma_f32_16x16x32_bf16 v[208:211], v[152:155], v[40:43], v[208:211]
    v_mfma_f32_16x16x32_bf16 v[212:215], v[152:155], v[44:47], v[212:215]
    ds_read_b64_tr_b16 v[140:141], v25 offset:0
    ds_read_b64_tr_b16 v[142:143], v25 offset:1024
    s_waitcnt lgkmcnt(8)
    v_mfma_f32_16x16x32_bf16 v[216:219], v[156:159], v[40:43], v[216:219]
    v_mfma_f32_16x16x32_bf16 v[220:223], v[156:159], v[44:47], v[220:223]
    ds_read_b64_tr_b16 v[144:145], v26 offset:0
    ds_read_b64_tr_b16 v[146:147], v26 offset:1024
    s_waitcnt lgkmcnt(8)
    v_mfma_f32_16x16x32_bf16 v[160:163], v[128:131], v[48:51], v[160:163]
    v_mfma_f32_16x16x32_bf16 v[164:167], v[128:131], v[52:55], v[164:167]
    ds_read_b64_tr_b16 v[148:149], v27 offset:0
    ds_read_b64_tr_b16 v[150:151], v27 offset:1024
    s_waitcnt lgkmcnt(8)
    v_mfma_f32_16x16x32_bf16 v[168:171], v[132:135], v[48:51], v[168:171]
    v_mfma_f32_16x16x32_bf16 v[172:175], v[132:135], v[52:55], v[172:175]
    ds_read_b64_tr_b16 v[152:153], v28 offset:0
    ds_read_b64_tr_b16 v[154:155], v28 offset:1024
    s_waitcnt lgkmcnt(8)
    v_mfma_f32_16x16x32_bf16 v[176:179], v[136:139], v[48:51], v[176:179]
    v_mfma_f32_16x16x32_bf16 v[180:183], v[136:139], v[52:55], v[180:183]
    ds_read_b64_tr_b16 v[156:157], v29 offset:0
    ds_read_b64_tr_b16 v[158:159], v29 offset:1024
    s_waitcnt lgkmcnt(8)
    v_mfma_f32_16x16x32_bf16 v[184:187], v[140:143], v[48:51], v[184:187]
    v_mfma_f32_16x16x32_bf16 v[188:191], v[140:143], v[52:55], v[188:191]
    ds_read_b64_tr_b16 v[128:129], v22 offset:8192
    ds_read_b64_tr_b16 v[130:131], v22 offset:9216
    v_add_u32 v22, 16384, v22
    s_waitcnt lgkmcnt(8)
    v_mfma_f32_16x16x32_bf16 v[192:195], v[144:147], v[48:51], v[192:195]
    v_mfma_f32_16x16x32_bf16 v[196:199], v[144:147], v[52:55], v[196:199]
    ds_read_b64_tr_b16 v[132:133], v23 offset:8192
    ds_read_b64_tr_b16 v[134:135], v23 offset:9216
    v_add_u32 v23, 16384, v23
    s_waitcnt lgkmcnt(8)
    v_mfma_f32_16x16x32_bf16 v[200:203], v[148:151], v[48:51], v[200:203]
    v_mfma_f32_16x16x32_bf16 v[204:207], v[148:151], v[52:55], v[204:207]
    ds_read_b64_tr_b16 v[136:137], v24 offset:8192
    ds_read_b64_tr_b16 v[138:139], v24 offset:9216
    v_add_u32 v24, 16384, v24
    s_waitcnt lgkmcnt(8)
    v_mfma_f32_16x16x32_bf16 v[208:211], v[152:155], v[48:51], v[208:211]
    v_mfma_f32_16x16x32_bf16 v[212:215], v[152:155], v[52:55], v[212:215]
    ds_read_b64_tr_b16 v[140:141], v25 offset:8192
    ds_read_b64_tr_b16 v[142:143], v25 offset:9216
    v_add_u32 v25, 16384, v25
    s_waitcnt lgkmcnt(8)
    v_mfma_f32_16x16x32_bf16 v[216:219], v[156:159], v[48:51], v[216:219]
    v_mfma_f32_16x16x32_bf16 v[220:223], v[156:159], v[52:55], v[220:223]
    ds_read_b64_tr_b16 v[144:145], v26 offset:8192
    ds_read_b64_tr_b16 v[146:147], v26 offset:9216
    v_add_u32 v26, 16384, v26
    s_waitcnt lgkmcnt(8)
    v_mfma_f32_16x16x32_bf16 v[160:163], v[128:131], v[56:59], v[160:163]
    v_mfma_f32_16x16x32_bf16 v[164:167], v[128:131], v[60:63], v[164:167]
    ds_read_b64_tr_b16 v[148:149], v27 offset:8192
    ds_read_b64_tr_b16 v[150:151], v27 offset:9216
    v_add_u32 v27, 16384, v27
    s_waitcnt lgkmcnt(8)
    v_mfma_f32_16x16x32_bf16 v[168:171], v[132:135], v[56:59], v[168:171]
    v_mfma_f32_16x16x32_bf16 v[172:175], v[132:135], v[60:63], v[172:175]
    ds_read_b64_tr_b16 v[152:153], v28 offset:8192
    ds_read_b64_tr_b16 v[154:155], v28 offset:9216
    v_add_u32 v28, 16384, v28
    s_waitcnt vmcnt(6)
    s_barrier
    s_waitcnt lgkmcnt(8)
    v_mfma_f32_16x16x32_bf16 v[176:179], v[136:139], v[56:59], v[176:179]
    v_mfma_f32_16x16x32_bf16 v[180:183], v[136:139], v[60:63], v[180:183]
    ds_read_b64_tr_b16 v[156:157], v29 offset:8192
    ds_read_b64_tr_b16 v[158:159], v29 offset:9216
    v_add_u32 v29, 16384, v29
    s_waitcnt lgkmcnt(8)
    v_mfma_f32_16x16x32_bf16 v[184:187], v[140:143], v[56:59], v[184:187]
    v_mfma_f32_16x16x32_bf16 v[188:191], v[140:143], v[60:63], v[188:191]
    ds_read_b64_tr_b16 v[128:129], v22 offset:0
    ds_read_b64_tr_b16 v[130:131], v22 offset:1024
    s_add_u32 m0, s50, 98304
    s_nop 0
    buffer_load_dwordx4 v30, s[8:11], s51 offen lds
    buffer_load_dwordx4 v31, s[8:11], s51 offen offset:1024 lds
    s_add_u32 s51, s51, 524288
    s_waitcnt lgkmcnt(8)
    v_mfma_f32_16x16x32_bf16 v[192:195], v[144:147], v[56:59], v[192:195]
    v_mfma_f32_16x16x32_bf16 v[196:199], v[144:147], v[60:63], v[196:199]
    ds_read_b64_tr_b16 v[132:133], v23 offset:0
    ds_read_b64_tr_b16 v[134:135], v23 offset:1024
    s_waitcnt lgkmcnt(8)
    v_mfma_f32_16x16x32_bf16 v[200:203], v[148:151], v[56:59], v[200:203]
    v_mfma_f32_16x16x32_bf16 v[204:207], v[148:151], v[60:63], v[204:207]
    ds_read_b64_tr_b16 v[136:137], v24 offset:0
    ds_read_b64_tr_b16 v[138:139], v24 offset:1024
    buffer_load_dwordx4 v[96:99], v2, s[12:15], s52 offen offset:0
    buffer_load_dwordx4 v[100:103], v4, s[12:15], s52 offen offset:0
    buffer_load_dwordx4 v[104:107], v2, s[12:15], s52 offen offset:1024
    buffer_load_dwordx4 v[108:111], v4, s[12:15], s52 offen offset:1024
    s_add_u32 s52, s52, 2048
    s_waitcnt lgkmcnt(8)
    v_mfma_f32_16x16x32_bf16 v[208:211], v[152:155], v[56:59], v[208:211]
    v_mfma_f32_16x16x32_bf16 v[212:215], v[152:155], v[60:63], v[212:215]
    ds_read_b64_tr_b16 v[140:141], v25 offset:0
    ds_read_b64_tr_b16 v[142:143], v25 offset:1024
    s_waitcnt lgkmcnt(8)
    v_mfma_f32_16x16x32_bf16 v[216:219], v[156:159], v[56:59], v[216:219]
    v_mfma_f32_16x16x32_bf16 v[220:223], v[156:159], v[60:63], v[220:223]
    ds_read_b64_tr_b16 v[144:145], v26 offset:0
    ds_read_b64_tr_b16 v[146:147], v26 offset:1024
    s_waitcnt lgkmcnt(8)
    v_mfma_f32_16x16x32_bf16 v[160:163], v[128:131], v[64:67], v[160:163]
    v_mfma_f32_16x16x32_bf16 v[164:167], v[128:131], v[68:71], v[164:167]
    ds_read_b64_tr_b16 v[148:149], v27 offset:0
    ds_read_b64_tr_b16 v[150:151], v27 offset:1024
    s_waitcnt lgkmcnt(8)
    v_mfma_f32_16x16x32_bf16 v[168:171], v[132:135], v[64:67], v[168:171]
    v_mfma_f32_16x16x32_bf16 v[172:175], v[132:135], v[68:71], v[172:175]
    ds_read_b64_tr_b16 v[152:153], v28 offset:0
    ds_read_b64_tr_b16 v[154:155], v28 offset:1024
    s_waitcnt lgkmcnt(8)
    v_mfma_f32_16x16x32_bf16 v[176:179], v[136:139], v[64:67], v[176:179]
    v_mfma_f32_16x16x32_bf16 v[180:183], v[136:139], v[68:71], v[180:183]
    ds_read_b64_tr_b16 v[156:157], v29 offset:0
    ds_read_b64_tr_b16 v[158:159], v29 offset:1024
    s_waitcnt lgkmcnt(8)
    v_mfma_f32_16x16x32_bf16 v[184:187], v[140:143], v[64:67], v[184:187]
    v_mfma_f32_16x16x32_bf16 v[188:191], v[140:143], v[68:71], v[188:191]
    ds_read_b64_tr_b16 v[128:129], v22 offset:8192
    ds_read_b64_tr_b16 v[130:131], v22 offset:9216
    v_add_u32 v22, 32768, v22
    s_waitcnt lgkmcnt(8)
    v_mfma_f32_16x16x32_bf16 v[192:195], v[144:147], v[64:67], v[192:195]
    v_mfma_f32_16x16x32_bf16 v[196:199], v[144:147], v[68:71], v[196:199]
    ds_read_b64_tr_b16 v[132:133], v23 offset:8192
    ds_read_b64_tr_b16 v[134:135], v23 offset:9216
    v_add_u32 v23, 32768, v23
    s_waitcnt lgkmcnt(8)
    v_mfma_f32_16x16x32_bf16 v[200:203], v[148:151], v[64:67], v[200:203]
    v_mfma_f32_16x16x32_bf16 v[204:207], v[148:151], v[68:71], v[204:207]
    ds_read_b64_tr_b16 v[136:137], v24 offset:8192
    ds_read_b64_tr_b16 v[138:139], v24 offset:9216
    v_add_u32 v24, 32768, v24
    s_waitcnt lgkmcnt(8)
    v_mfma_f32_16x16x32_bf16 v[208:211], v[152:155], v[64:67], v[208:211]
    v_mfma_f32_16x16x32_bf16 v[212:215], v[152:155], v[68:71], v[212:215]
    ds_read_b64_tr_b16 v[140:141], v25 offset:8192
    ds_read_b64_tr_b16 v[142:143], v25 offset:9216
    v_add_u32 v25, 32768, v25
    s_waitcnt lgkmcnt(8)
    v_mfma_f32_16x16x32_bf16 v[216:219], v[156:159], v[64:67], v[216:219]
    v_mfma_f32_16x16x32_bf16 v[220:223], v[156:159], v[68:71], v[220:223]
    ds_read_b64_tr_b16 v[144:145], v26 offset:8192
    ds_read_b64_tr_b16 v[146:147], v26 offset:9216
    v_add_u32 v26, 32768, v26
    s_waitcnt lgkmcnt(8)
    v_mfma_f32_16x16x32_bf16 v[160:163], v[128:131], v[72:75], v[160:163]
    v_mfma_f32_16x16x32_bf16 v[164:167], v[128:131], v[76:79], v[164:167]
    ds_read_b64_tr_b16 v[148:149], v27 offset:8192
    ds_read_b64_tr_b16 v[150:151], v27 offset:9216
    v_add_u32 v27, 32768, v27
    s_waitcnt lgkmcnt(8)
    v_mfma_f32_16x16x32_bf16 v[168:171], v[132:135], v[72:75], v[168:171]
    v_mfma_f32_16x16x32_bf16 v[172:175], v[132:135], v[76:79], v[172:175]
    ds_read_b64_tr_b16 v[152:153], v28 offset:8192
    ds_read_b64_tr_b16 v[154:155], v28 offset:9216
    v_add_u32 v28, 32768, v28
    s_waitcnt vmcnt(6)
    s_barrier
    s_waitcnt lgkmcnt(8)
    v_mfma_f32_16x16x32_bf16 v[176:179], v[136:139], v[72:75], v[176:179]
    v_mfma_f32_16x16x32_bf16 v[180:183], v[136:139], v[76:79], v[180:183]
    ds_read_b64_tr_b16 v[156:157], v29 offset:8192
    ds_read_b64_tr_b16 v[158:159], v29 offset:9216
    v_add_u32 v29, 32768, v29
    s_waitcnt lgkmcnt(8)
    v_mfma_f32_16x16x32_bf16 v[184:187], v[140:143], v[72:75], v[184:187]
    v_mfma_f32_16x16x32_bf16 v[188:191], v[140:143], v[76:79], v[188:191]
    ds_read_b64_tr_b16 v[128:129], v22 offset:0
    ds_read_b64_tr_b16 v[130:131], v22 offset:1024
    s_add_u32 m0, s50, 114688
    s_nop 0
    buffer_load_dwordx4 v30, s[8:11], s51 offen lds
    buffer_load_dwordx4 v31, s[8:11], s51 offen offset:1024 lds
    s_add_u32 s51, s51, 524288
    s_waitcnt lgkmcnt(8)
    v_mfma_f32_16x16x32_bf16 v[192:195], v[144:147], v[72:75], v[192:195]
    v_mfma_f32_16x16x32_bf16 v[196:199], v[144:147], v[76:79], v[196:199]
    ds_read_b64_tr_b16 v[132:133], v23 offset:0
    ds_read_b64_tr_b16 v[134:135], v23 offset:1024
    s_waitcnt lgkmcnt(8)
    v_mfma_f32_16x16x32_bf16 v[200:203], v[148:151], v[72:75], v[200:203]
    v_mfma_f32_16x16x32_bf16 v[204:207], v[148:151], v[76:79], v[204:207]
    ds_read_b64_tr_b16 v[136:137], v24 offset:0
    ds_read_b64_tr_b16 v[138:139], v24 offset:1024
    buffer_load_dwordx4 v[112:115], v2, s[12:15], s52 offen offset:0
    buffer_load_dwordx4 v[116:119], v4, s[12:15], s52 offen offset:0
    buffer_load_dwordx4 v[120:123], v2, s[12:15], s52 offen offset:1024
    buffer_load_dwordx4 v[124:127], v4, s[12:15], s52 offen offset:1024
    s_add_u32 s52, s52, 2048
    s_waitcnt lgkmcnt(8)
    v_mfma_f32_16x16x32_bf16 v[208:211], v[152:155], v[72:75], v[208:211]
    v_mfma_f32_16x16x32_bf16 v[212:215], v[152:155], v[76:79], v[212:215]
    ds_read_b64_tr_b16 v[140:141], v25 offset:0
    ds_read_b64_tr_b16 v[142:143], v25 offset:1024
    s_waitcnt lgkmcnt(8)
    v_mfma_f32_16x16x32_bf16 v[216:219], v[156:159], v[72:75], v[216:219]
    v_mfma_f32_16x16x32_bf16 v[220:223], v[156:159], v[76:79], v[220:223]
    ds_read_b64_tr_b16 v[144:145], v26 offset:0
    ds_read_b64_tr_b16 v[146:147], v26 offset:1024
    s_waitcnt lgkmcnt(8)
    v_mfma_f32_16x16x32_bf16 v[160:163], v[128:131], v[80:83], v[160:163]
    v_mfma_f32_16x16x32_bf16 v[164:167], v[128:131], v[84:87], v[164:167]
    ds_read_b64_tr_b16 v[148:149], v27 offset:0
    ds_read_b64_tr_b16 v[150:151], v27 offset:1024
    s_waitcnt lgkmcnt(8)
    v_mfma_f32_16x16x32_bf16 v[168:171], v[132:135], v[80:83], v[168:171]
    v_mfma_f32_16x16x32_bf16 v[172:175], v[132:135], v[84:87], v[172:175]
    ds_read_b64_tr_b16 v[152:153], v28 offset:0
    ds_read_b64_tr_b16 v[154:155], v28 offset:1024
    s_waitcnt lgkmcnt(8)
    v_mfma_f32_16x16x32_bf16 v[176:179], v[136:139], v[80:83], v[176:179]
    v_mfma_f32_16x16x32_bf16 v[180:183], v[136:139], v[84:87], v[180:183]
    ds_read_b64_tr_b16 v[156:157], v29 offset:0
    ds_read_b64_tr_b16 v[158:159], v29 offset:1024
    s_waitcnt lgkmcnt(8)
    v_mfma_f32_16x16x32_bf16 v[184:187], v[140:143], v[80:83], v[184:187]
    v_mfma_f32_16x16x32_bf16 v[188:191], v[140:143], v[84:87], v[188:191]
    ds_read_b64_tr_b16 v[128:129], v22 offset:8192
    ds_read_b64_tr_b16 v[130:131], v22 offset:9216
    v_add_u32 v22, 16384, v22
    s_waitcnt lgkmcnt(8)
    v_mfma_f32_16x16x32_bf16 v[192:195], v[144:147], v[80:83], v[192:195]
    v_mfma_f32_16x16x32_bf16 v[196:199], v[144:147], v[84:87], v[196:199]
    ds_read_b64_tr_b16 v[132:133], v23 offset:8192
    ds_read_b64_tr_b16 v[134:135], v23 offset:9216
    v_add_u32 v23, 16384, v23
    s_waitcnt lgkmcnt(8)
    v_mfma_f32_16x16x32_bf16 v[200:203], v[148:151], v[80:83], v[200:203]
    v_mfma_f32_16x16x32_bf16 v[204:207], v[148:151], v[84:87], v[204:207]
    ds_read_b64_tr_b16 v[136:137], v24 offset:8192
    ds_read_b64_tr_b16 v[138:139], v24 offset:9216
    v_add_u32 v24, 16384, v24
    s_waitcnt lgkmcnt(8)
    v_mfma_f32_16x16x32_bf16 v[208:211], v[152:155], v[80:83], v[208:211]
    v_mfma_f32_16x16x32_bf16 v[212:215], v[152:155], v[84:87], v[212:215]
    ds_read_b64_tr_b16 v[140:141], v25 offset:8192
    ds_read_b64_tr_b16 v[142:143], v25 offset:9216
    v_add_u32 v25, 16384, v25
    s_waitcnt lgkmcnt(8)
    v_mfma_f32_16x16x32_bf16 v[216:219], v[156:159], v[80:83], v[216:219]
    v_mfma_f32_16x16x32_bf16 v[220:223], v[156:159], v[84:87], v[220:223]
    ds_read_b64_tr_b16 v[144:145], v26 offset:8192
    ds_read_b64_tr_b16 v[146:147], v26 offset:9216
    v_add_u32 v26, 16384, v26
    s_waitcnt lgkmcnt(8)
    v_mfma_f32_16x16x32_bf16 v[160:163], v[128:131], v[88:91], v[160:163]
    v_mfma_f32_16x16x32_bf16 v[164:167], v[128:131], v[92:95], v[164:167]
    ds_read_b64_tr_b16 v[148:149], v27 offset:8192
    ds_read_b64_tr_b16 v[150:151], v27 offset:9216
    v_add_u32 v27, 16384, v27
    s_waitcnt lgkmcnt(8)
    v_mfma_f32_16x16x32_bf16 v[168:171], v[132:135], v[88:91], v[168:171]
    v_mfma_f32_16x16x32_bf16 v[172:175], v[132:135], v[92:95], v[172:175]
    ds_read_b64_tr_b16 v[152:153], v28 offset:8192
    ds_read_b64_tr_b16 v[154:155], v28 offset:9216
    v_add_u32 v28, 16384, v28
    s_waitcnt vmcnt(6)
    s_barrier
    s_waitcnt lgkmcnt(8)
    v_mfma_f32_16x16x32_bf16 v[176:179], v[136:139], v[88:91], v[176:179]
    v_mfma_f32_16x16x32_bf16 v[180:183], v[136:139], v[92:95], v[180:183]
    ds_read_b64_tr_b16 v[156:157], v29 offset:8192
    ds_read_b64_tr_b16 v[158:159], v29 offset:9216
    v_add_u32 v29, 16384, v29
    s_waitcnt lgkmcnt(8)
    v_mfma_f32_16x16x32_bf16 v[184:187], v[140:143], v[88:91], v[184:187]
    v_mfma_f32_16x16x32_bf16 v[188:191], v[140:143], v[92:95], v[188:191]
    ds_read_b64_tr_b16 v[128:129], v22 offset:0
    ds_read_b64_tr_b16 v[130:131], v22 offset:1024
    s_add_u32 m0, s50, 131072
    s_nop 0
    buffer_load_dwordx4 v30, s[8:11], s51 offen lds
    buffer_load_dwordx4 v31, s[8:11], s51 offen offset:1024 lds
    s_add_u32 s51, s51, 524288
    s_waitcnt lgkmcnt(8)
    v_mfma_f32_16x16x32_bf16 v[192:195], v[144:147], v[88:91], v[192:195]
    v_mfma_f32_16x16x32_bf16 v[196:199], v[144:147], v[92:95], v[196:199]
    ds_read_b64_tr_b16 v[132:133], v23 offset:0
    ds_read_b64_tr_b16 v[134:135], v23 offset:1024
    s_waitcnt lgkmcnt(8)
    v_mfma_f32_16x16x32_bf16 v[200:203], v[148:151], v[88:91], v[200:203]
    v_mfma_f32_16x16x32_bf16 v[204:207], v[148:151], v[92:95], v[204:207]
    ds_read_b64_tr_b16 v[136:137], v24 offset:0
    ds_read_b64_tr_b16 v[138:139], v24 offset:1024
    buffer_load_dwordx4 v[32:35], v2, s[12:15], s52 offen offset:0
    buffer_load_dwordx4 v[36:39], v4, s[12:15], s52 offen offset:0
    buffer_load_dwordx4 v[40:43], v2, s[12:15], s52 offen offset:1024
    buffer_load_dwordx4 v[44:47], v4, s[12:15], s52 offen offset:1024
    s_add_u32 s52, s52, 2048
    s_waitcnt lgkmcnt(8)
    v_mfma_f32_16x16x32_bf16 v[208:211], v[152:155], v[88:91], v[208:211]
    v_mfma_f32_16x16x32_bf16 v[212:215], v[152:155], v[92:95], v[212:215]
    ds_read_b64_tr_b16 v[140:141], v25 offset:0
    ds_read_b64_tr_b16 v[142:143], v25 offset:1024
    s_waitcnt lgkmcnt(8)
    v_mfma_f32_16x16x32_bf16 v[216:219], v[156:159], v[88:91], v[216:219]
    v_mfma_f32_16x16x32_bf16 v[220:223], v[156:159], v[92:95], v[220:223]
    ds_read_b64_tr_b16 v[144:145], v26 offset:0
    ds_read_b64_tr_b16 v[146:147], v26 offset:1024
    s_waitcnt lgkmcnt(8)
    v_mfma_f32_16x16x32_bf16 v[160:163], v[128:131], v[96:99], v[160:163]
    v_mfma_f32_16x16x32_bf16 v[164:167], v[128:131], v[100:103], v[164:167]
    ds_read_b64_tr_b16 v[148:149], v27 offset:0
    ds_read_b64_tr_b16 v[150:151], v27 offset:1024
    s_waitcnt lgkmcnt(8)
    v_mfma_f32_16x16x32_bf16 v[168:171], v[132:135], v[96:99], v[168:171]
    v_mfma_f32_16x16x32_bf16 v[172:175], v[132:135], v[100:103], v[172:175]
    ds_read_b64_tr_b16 v[152:153], v28 offset:0
    ds_read_b64_tr_b16 v[154:155], v28 offset:1024
    s_waitcnt lgkmcnt(8)
    v_mfma_f32_16x16x32_bf16 v[176:179], v[136:139], v[96:99], v[176:179]
    v_mfma_f32_16x16x32_bf16 v[180:183], v[136:139], v[100:103], v[180:183]
    ds_read_b64_tr_b16 v[156:157], v29 offset:0
    ds_read_b64_tr_b16 v[158:159], v29 offset:1024
    s_waitcnt lgkmcnt(8)
    v_mfma_f32_16x16x32_bf16 v[184:187], v[140:143], v[96:99], v[184:187]
    v_mfma_f32_16x16x32_bf16 v[188:191], v[140:143], v[100:103], v[188:191]
    ds_read_b64_tr_b16 v[128:129], v22 offset:8192
    ds_read_b64_tr_b16 v[130:131], v22 offset:9216
    v_add_u32 v22, 16384, v22
    s_waitcnt lgkmcnt(8)
    v_mfma_f32_16x16x32_bf16 v[192:195], v[144:147], v[96:99], v[192:195]
    v_mfma_f32_16x16x32_bf16 v[196:199], v[144:147], v[100:103], v[196:199]
    ds_read_b64_tr_b16 v[132:133], v23 offset:8192
    ds_read_b64_tr_b16 v[134:135], v23 offset:9216
    v_add_u32 v23, 16384, v23
    s_waitcnt lgkmcnt(8)
    v_mfma_f32_16x16x32_bf16 v[200:203], v[148:151], v[96:99], v[200:203]
    v_mfma_f32_16x16x32_bf16 v[204:207], v[148:151], v[100:103], v[204:207]
    ds_read_b64_tr_b16 v[136:137], v24 offset:8192
    ds_read_b64_tr_b16 v[138:139], v24 offset:9216
    v_add_u32 v24, 16384, v24
    s_waitcnt lgkmcnt(8)
    v_mfma_f32_16x16x32_bf16 v[208:211], v[152:155], v[96:99], v[208:211]
    v_mfma_f32_16x16x32_bf16 v[212:215], v[152:155], v[100:103], v[212:215]
    ds_read_b64_tr_b16 v[140:141], v25 offset:8192
    ds_read_b64_tr_b16 v[142:143], v25 offset:9216
    v_add_u32 v25, 16384, v25
    s_waitcnt lgkmcnt(8)
    v_mfma_f32_16x16x32_bf16 v[216:219], v[156:159], v[96:99], v[216:219]
    v_mfma_f32_16x16x32_bf16 v[220:223], v[156:159], v[100:103], v[220:223]
    ds_read_b64_tr_b16 v[144:145], v26 offset:8192
    ds_read_b64_tr_b16 v[146:147], v26 offset:9216
    v_add_u32 v26, 16384, v26
    s_waitcnt lgkmcnt(8)
    v_mfma_f32_16x16x32_bf16 v[160:163], v[128:131], v[104:107], v[160:163]
    v_mfma_f32_16x16x32_bf16 v[164:167], v[128:131], v[108:111], v[164:167]
    ds_read_b64_tr_b16 v[148:149], v27 offset:8192
    ds_read_b64_tr_b16 v[150:151], v27 offset:9216
    v_add_u32 v27, 16384, v27
    s_waitcnt lgkmcnt(8)
    v_mfma_f32_16x16x32_bf16 v[168:171], v[132:135], v[104:107], v[168:171]
    v_mfma_f32_16x16x32_bf16 v[172:175], v[132:135], v[108:111], v[172:175]
    ds_read_b64_tr_b16 v[152:153], v28 offset:8192
    ds_read_b64_tr_b16 v[154:155], v28 offset:9216
    v_add_u32 v28, 16384, v28
    s_waitcnt vmcnt(6)
    s_barrier
    s_waitcnt lgkmcnt(8)
    v_mfma_f32_16x16x32_bf16 v[176:179], v[136:139], v[104:107], v[176:179]
    v_mfma_f32_16x16x32_bf16 v[180:183], v[136:139], v[108:111], v[180:183]
    ds_read_b64_tr_b16 v[156:157], v29 offset:8192
    ds_read_b64_tr_b16 v[158:159], v29 offset:9216
    v_add_u32 v29, 16384, v29
    s_waitcnt lgkmcnt(8)
    v_mfma_f32_16x16x32_bf16 v[184:187], v[140:143], v[104:107], v[184:187]
    v_mfma_f32_16x16x32_bf16 v[188:191], v[140:143], v[108:111], v[188:191]
    ds_read_b64_tr_b16 v[128:129], v22 offset:0
    ds_read_b64_tr_b16 v[130:131], v22 offset:1024
    s_add_u32 m0, s50, 147456
    s_nop 0
    buffer_load_dwordx4 v30, s[8:11], s51 offen lds
    buffer_load_dwordx4 v31, s[8:11], s51 offen offset:1024 lds
    s_add_u32 s51, s51, 524288
    s_waitcnt lgkmcnt(8)
    v_mfma_f32_16x16x32_bf16 v[192:195], v[144:147], v[104:107], v[192:195]
    v_mfma_f32_16x16x32_bf16 v[196:199], v[144:147], v[108:111], v[196:199]
    ds_read_b64_tr_b16 v[132:133], v23 offset:0
    ds_read_b64_tr_b16 v[134:135], v23 offset:1024
    s_waitcnt lgkmcnt(8)
    v_mfma_f32_16x16x32_bf16 v[200:203], v[148:151], v[104:107], v[200:203]
    v_mfma_f32_16x16x32_bf16 v[204:207], v[148:151], v[108:111], v[204:207]
    ds_read_b64_tr_b16 v[136:137], v24 offset:0
    ds_read_b64_tr_b16 v[138:139], v24 offset:1024
    buffer_load_dwordx4 v[48:51], v2, s[12:15], s52 offen offset:0
    buffer_load_dwordx4 v[52:55], v4, s[12:15], s52 offen offset:0
    buffer_load_dwordx4 v[56:59], v2, s[12:15], s52 offen offset:1024
    buffer_load_dwordx4 v[60:63], v4, s[12:15], s52 offen offset:1024
    s_add_u32 s52, s52, 2048
    s_waitcnt lgkmcnt(8)
    v_mfma_f32_16x16x32_bf16 v[208:211], v[152:155], v[104:107], v[208:211]
    v_mfma_f32_16x16x32_bf16 v[212:215], v[152:155], v[108:111], v[212:215]
    ds_read_b64_tr_b16 v[140:141], v25 offset:0
    ds_read_b64_tr_b16 v[142:143], v25 offset:1024
    s_waitcnt lgkmcnt(8)
    v_mfma_f32_16x16x32_bf16 v[216:219], v[156:159], v[104:107], v[216:219]
    v_mfma_f32_16x16x32_bf16 v[220:223], v[156:159], v[108:111], v[220:223]
    ds_read_b64_tr_b16 v[144:145], v26 offset:0
    ds_read_b64_tr_b16 v[146:147], v26 offset:1024
    s_waitcnt lgkmcnt(8)
    v_mfma_f32_16x16x32_bf16 v[160:163], v[128:131], v[112:115], v[160:163]
    v_mfma_f32_16x16x32_bf16 v[164:167], v[128:131], v[116:119], v[164:167]
    ds_read_b64_tr_b16 v[148:149], v27 offset:0
    ds_read_b64_tr_b16 v[150:151], v27 offset:1024
    s_waitcnt lgkmcnt(8)
    v_mfma_f32_16x16x32_bf16 v[168:171], v[132:135], v[112:115], v[168:171]
    v_mfma_f32_16x16x32_bf16 v[172:175], v[132:135], v[116:119], v[172:175]
    ds_read_b64_tr_b16 v[152:153], v28 offset:0
    ds_read_b64_tr_b16 v[154:155], v28 offset:1024
    s_waitcnt lgkmcnt(8)
    v_mfma_f32_16x16x32_bf16 v[176:179], v[136:139], v[112:115], v[176:179]
    v_mfma_f32_16x16x32_bf16 v[180:183], v[136:139], v[116:119], v[180:183]
    ds_read_b64_tr_b16 v[156:157], v29 offset:0
    ds_read_b64_tr_b16 v[158:159], v29 offset:1024
    s_waitcnt lgkmcnt(8)
    v_mfma_f32_16x16x32_bf16 v[184:187], v[140:143], v[112:115], v[184:187]
    v_mfma_f32_16x16x32_bf16 v[188:191], v[140:143], v[116:119], v[188:191]
    ds_read_b64_tr_b16 v[128:129], v22 offset:8192
    ds_read_b64_tr_b16 v[130:131], v22 offset:9216
    v_add_u32 v22, 16384, v22
    s_waitcnt lgkmcnt(8)
    v_mfma_f32_16x16x32_bf16 v[192:195], v[144:147], v[112:115], v[192:195]
    v_mfma_f32_16x16x32_bf16 v[196:199], v[144:147], v[116:119], v[196:199]
    ds_read_b64_tr_b16 v[132:133], v23 offset:8192
    ds_read_b64_tr_b16 v[134:135], v23 offset:9216
    v_add_u32 v23, 16384, v23
    s_waitcnt lgkmcnt(8)
    v_mfma_f32_16x16x32_bf16 v[200:203], v[148:151], v[112:115], v[200:203]
    v_mfma_f32_16x16x32_bf16 v[204:207], v[148:151], v[116:119], v[204:207]
    ds_read_b64_tr_b16 v[136:137], v24 offset:8192
    ds_read_b64_tr_b16 v[138:139], v24 offset:9216
    v_add_u32 v24, 16384, v24
    s_waitcnt lgkmcnt(8)
    v_mfma_f32_16x16x32_bf16 v[208:211], v[152:155], v[112:115], v[208:211]
    v_mfma_f32_16x16x32_bf16 v[212:215], v[152:155], v[116:119], v[212:215]
    ds_read_b64_tr_b16 v[140:141], v25 offset:8192
    ds_read_b64_tr_b16 v[142:143], v25 offset:9216
    v_add_u32 v25, 16384, v25
    s_waitcnt lgkmcnt(8)
    v_mfma_f32_16x16x32_bf16 v[216:219], v[156:159], v[112:115], v[216:219]
    v_mfma_f32_16x16x32_bf16 v[220:223], v[156:159], v[116:119], v[220:223]
    ds_read_b64_tr_b16 v[144:145], v26 offset:8192
    ds_read_b64_tr_b16 v[146:147], v26 offset:9216
    v_add_u32 v26, 16384, v26
    s_waitcnt lgkmcnt(8)
    v_mfma_f32_16x16x32_bf16 v[160:163], v[128:131], v[120:123], v[160:163]
    v_mfma_f32_16x16x32_bf16 v[164:167], v[128:131], v[124:127], v[164:167]
    ds_read_b64_tr_b16 v[148:149], v27 offset:8192
    ds_read_b64_tr_b16 v[150:151], v27 offset:9216
    v_add_u32 v27, 16384, v27
    s_waitcnt lgkmcnt(8)
    v_mfma_f32_16x16x32_bf16 v[168:171], v[132:135], v[120:123], v[168:171]
    v_mfma_f32_16x16x32_bf16 v[172:175], v[132:135], v[124:127], v[172:175]
    ds_read_b64_tr_b16 v[152:153], v28 offset:8192
    ds_read_b64_tr_b16 v[154:155], v28 offset:9216
    v_add_u32 v28, 16384, v28
    s_waitcnt vmcnt(6)
    s_barrier
    s_waitcnt lgkmcnt(8)
    v_mfma_f32_16x16x32_bf16 v[176:179], v[136:139], v[120:123], v[176:179]
    v_mfma_f32_16x16x32_bf16 v[180:183], v[136:139], v[124:127], v[180:183]
    ds_read_b64_tr_b16 v[156:157], v29 offset:8192
    ds_read_b64_tr_b16 v[158:159], v29 offset:9216
    v_add_u32 v29, 16384, v29
    s_waitcnt lgkmcnt(8)
    v_mfma_f32_16x16x32_bf16 v[184:187], v[140:143], v[120:123], v[184:187]
    v_mfma_f32_16x16x32_bf16 v[188:191], v[140:143], v[124:127], v[188:191]
    ds_read_b64_tr_b16 v[128:129], v22 offset:0
    ds_read_b64_tr_b16 v[130:131], v22 offset:1024
    s_add_u32 m0, s50, 16384
    s_nop 0
    buffer_load_dwordx4 v30, s[8:11], s51 offen lds
    buffer_load_dwordx4 v31, s[8:11], s51 offen offset:1024 lds
    s_add_u32 s51, s51, 524288
    s_waitcnt lgkmcnt(8)
    v_mfma_f32_16x16x32_bf16 v[192:195], v[144:147], v[120:123], v[192:195]
    v_mfma_f32_16x16x32_bf16 v[196:199], v[144:147], v[124:127], v[196:199]
    ds_read_b64_tr_b16 v[132:133], v23 offset:0
    ds_read_b64_tr_b16 v[134:135], v23 offset:1024
    s_waitcnt lgkmcnt(8)
    v_mfma_f32_16x16x32_bf16 v[200:203], v[148:151], v[120:123], v[200:203]
    v_mfma_f32_16x16x32_bf16 v[204:207], v[148:151], v[124:127], v[204:207]
    ds_read_b64_tr_b16 v[136:137], v24 offset:0
    ds_read_b64_tr_b16 v[138:139], v24 offset:1024
    buffer_load_dwordx4 v[64:67], v2, s[12:15], s52 offen offset:0
    buffer_load_dwordx4 v[68:71], v4, s[12:15], s52 offen offset:0
    buffer_load_dwordx4 v[72:75], v2, s[12:15], s52 offen offset:1024
    buffer_load_dwordx4 v[76:79], v4, s[12:15], s52 offen offset:1024
    s_add_u32 s52, s52, 2048
    s_waitcnt lgkmcnt(8)
    v_mfma_f32_16x16x32_bf16 v[208:211], v[152:155], v[120:123], v[208:211]
    v_mfma_f32_16x16x32_bf16 v[212:215], v[152:155], v[124:127], v[212:215]
    ds_read_b64_tr_b16 v[140:141], v25 offset:0
    ds_read_b64_tr_b16 v[142:143], v25 offset:1024
    s_waitcnt lgkmcnt(8)
    v_mfma_f32_16x16x32_bf16 v[216:219], v[156:159], v[120:123], v[216:219]
    v_mfma_f32_16x16x32_bf16 v[220:223], v[156:159], v[124:127], v[220:223]
    ds_read_b64_tr_b16 v[144:145], v26 offset:0
    ds_read_b64_tr_b16 v[146:147], v26 offset:1024
    s_waitcnt lgkmcnt(8)
    v_mfma_f32_16x16x32_bf16 v[160:163], v[128:131], v[32:35], v[160:163]
    v_mfma_f32_16x16x32_bf16 v[164:167], v[128:131], v[36:39], v[164:167]
    ds_read_b64_tr_b16 v[148:149], v27 offset:0
    ds_read_b64_tr_b16 v[150:151], v27 offset:1024
    s_waitcnt lgkmcnt(8)
    v_mfma_f32_16x16x32_bf16 v[168:171], v[132:135], v[32:35], v[168:171]
    v_mfma_f32_16x16x32_bf16 v[172:175], v[132:135], v[36:39], v[172:175]
    ds_read_b64_tr_b16 v[152:153], v28 offset:0
    ds_read_b64_tr_b16 v[154:155], v28 offset:1024
    s_waitcnt lgkmcnt(8)
    v_mfma_f32_16x16x32_bf16 v[176:179], v[136:139], v[32:35], v[176:179]
    v_mfma_f32_16x16x32_bf16 v[180:183], v[136:139], v[36:39], v[180:183]
    ds_read_b64_tr_b16 v[156:157], v29 offset:0
    ds_read_b64_tr_b16 v[158:159], v29 offset:1024
    s_waitcnt lgkmcnt(8)
    v_mfma_f32_16x16x32_bf16 v[184:187], v[140:143], v[32:35], v[184:187]
    v_mfma_f32_16x16x32_bf16 v[188:191], v[140:143], v[36:39], v[188:191]
    ds_read_b64_tr_b16 v[128:129], v22 offset:8192
    ds_read_b64_tr_b16 v[130:131], v22 offset:9216
    v_add_u32 v22, 16384, v22
    s_waitcnt lgkmcnt(8)
    v_mfma_f32_16x16x32_bf16 v[192:195], v[144:147], v[32:35], v[192:195]
    v_mfma_f32_16x16x32_bf16 v[196:199], v[144:147], v[36:39], v[196:199]
    ds_read_b64_tr_b16 v[132:133], v23 offset:8192
    ds_read_b64_tr_b16 v[134:135], v23 offset:9216
    v_add_u32 v23, 16384, v23
    s_add_u32 m0, s48, 0
    s_nop 0
    buffer_load_dwordx4 v2, s[16:19], s55 offen offset:0 lds
    s_waitcnt lgkmcnt(8)
    v_mfma_f32_16x16x32_bf16 v[200:203], v[148:151], v[32:35], v[200:203]
    v_mfma_f32_16x16x32_bf16 v[204:207], v[148:151], v[36:39], v[204:207]
    ds_read_b64_tr_b16 v[136:137], v24 offset:8192
    ds_read_b64_tr_b16 v[138:139], v24 offset:9216
    v_add_u32 v24, 16384, v24
    s_waitcnt lgkmcnt(8)
    v_mfma_f32_16x16x32_bf16 v[208:211], v[152:155], v[32:35], v[208:211]
    v_mfma_f32_16x16x32_bf16 v[212:215], v[152:155], v[36:39], v[212:215]
    ds_read_b64_tr_b16 v[140:141], v25 offset:8192
    ds_read_b64_tr_b16 v[142:143], v25 offset:9216
    v_add_u32 v25, 16384, v25
    buffer_load_dwordx4 v2, s[16:19], s55 offen offset:1024 lds
    s_waitcnt lgkmcnt(8)
    v_mfma_f32_16x16x32_bf16 v[216:219], v[156:159], v[32:35], v[216:219]
    v_mfma_f32_16x16x32_bf16 v[220:223], v[156:159], v[36:39], v[220:223]
    ds_read_b64_tr_b16 v[144:145], v26 offset:8192
    ds_read_b64_tr_b16 v[146:147], v26 offset:9216
    v_add_u32 v26, 16384, v26
    s_waitcnt lgkmcnt(8)
    v_mfma_f32_16x16x32_bf16 v[160:163], v[128:131], v[40:43], v[160:163]
    v_mfma_f32_16x16x32_bf16 v[164:167], v[128:131], v[44:47], v[164:167]
    ds_read_b64_tr_b16 v[148:149], v27 offset:8192
    ds_read_b64_tr_b16 v[150:151], v27 offset:9216
    v_add_u32 v27, 16384, v27
    buffer_load_dwordx4 v2, s[16:19], s55 offen offset:2048 lds
    s_waitcnt lgkmcnt(8)
    v_mfma_f32_16x16x32_bf16 v[168:171], v[132:135], v[40:43], v[168:171]
    v_mfma_f32_16x16x32_bf16 v[172:175], v[132:135], v[44:47], v[172:175]
    ds_read_b64_tr_b16 v[152:153], v28 offset:8192
    ds_read_b64_tr_b16 v[154:155], v28 offset:9216
    v_add_u32 v28, 16384, v28
    s_waitcnt vmcnt(9)
    s_barrier
    s_waitcnt lgkmcnt(8)
    v_mfma_f32_16x16x32_bf16 v[176:179], v[136:139], v[40:43], v[176:179]
    v_mfma_f32_16x16x32_bf16 v[180:183], v[136:139], v[44:47], v[180:183]
    ds_read_b64_tr_b16 v[156:157], v29 offset:8192
    ds_read_b64_tr_b16 v[158:159], v29 offset:9216
    v_add_u32 v29, 16384, v29
    s_waitcnt lgkmcnt(8)
    v_mfma_f32_16x16x32_bf16 v[184:187], v[140:143], v[40:43], v[184:187]
    v_mfma_f32_16x16x32_bf16 v[188:191], v[140:143], v[44:47], v[188:191]
    ds_read_b64_tr_b16 v[128:129], v22 offset:0
    ds_read_b64_tr_b16 v[130:131], v22 offset:1024
    s_waitcnt lgkmcnt(8)
    v_mfma_f32_16x16x32_bf16 v[192:195], v[144:147], v[40:43], v[192:195]
    v_mfma_f32_16x16x32_bf16 v[196:199], v[144:147], v[44:47], v[196:199]
    ds_read_b64_tr_b16 v[132:133], v23 offset:0
    ds_read_b64_tr_b16 v[134:135], v23 offset:1024
    buffer_load_dwordx4 v2, s[16:19], s55 offen offset:3072 lds
    s_waitcnt lgkmcnt(8)
    v_mfma_f32_16x16x32_bf16 v[200:203], v[148:151], v[40:43], v[200:203]
    v_mfma_f32_16x16x32_bf16 v[204:207], v[148:151], v[44:47], v[204:207]
    ds_read_b64_tr_b16 v[136:137], v24 offset:0
    ds_read_b64_tr_b16 v[138:139], v24 offset:1024
    s_waitcnt lgkmcnt(8)
    v_mfma_f32_16x16x32_bf16 v[208:211], v[152:155], v[40:43], v[208:211]
    v_mfma_f32_16x16x32_bf16 v[212:215], v[152:155], v[44:47], v[212:215]
    ds_read_b64_tr_b16 v[140:141], v25 offset:0
    ds_read_b64_tr_b16 v[142:143], v25 offset:1024
    s_waitcnt lgkmcnt(8)
    v_mfma_f32_16x16x32_bf16 v[216:219], v[156:159], v[40:43], v[216:219]
    v_mfma_f32_16x16x32_bf16 v[220:223], v[156:159], v[44:47], v[220:223]
    ds_read_b64_tr_b16 v[144:145], v26 offset:0
    ds_read_b64_tr_b16 v[146:147], v26 offset:1024
    s_waitcnt lgkmcnt(8)
    v_mfma_f32_16x16x32_bf16 v[160:163], v[128:131], v[48:51], v[160:163]
    v_mfma_f32_16x16x32_bf16 v[164:167], v[128:131], v[52:55], v[164:167]
    ds_read_b64_tr_b16 v[148:149], v27 offset:0
    ds_read_b64_tr_b16 v[150:151], v27 offset:1024
    s_waitcnt lgkmcnt(8)
    v_mfma_f32_16x16x32_bf16 v[168:171], v[132:135], v[48:51], v[168:171]
    v_mfma_f32_16x16x32_bf16 v[172:175], v[132:135], v[52:55], v[172:175]
    ds_read_b64_tr_b16 v[152:153], v28 offset:0
    ds_read_b64_tr_b16 v[154:155], v28 offset:1024
    s_waitcnt lgkmcnt(8)
    v_mfma_f32_16x16x32_bf16 v[176:179], v[136:139], v[48:51], v[176:179]
    v_mfma_f32_16x16x32_bf16 v[180:183], v[136:139], v[52:55], v[180:183]
    ds_read_b64_tr_b16 v[156:157], v29 offset:0
    ds_read_b64_tr_b16 v[158:159], v29 offset:1024
    s_waitcnt lgkmcnt(8)
    v_mfma_f32_16x16x32_bf16 v[184:187], v[140:143], v[48:51], v[184:187]
    v_mfma_f32_16x16x32_bf16 v[188:191], v[140:143], v[52:55], v[188:191]
    ds_read_b64_tr_b16 v[128:129], v22 offset:8192
    ds_read_b64_tr_b16 v[130:131], v22 offset:9216
    v_add_u32 v22, 4294836224, v22
    s_waitcnt lgkmcnt(8)
    v_mfma_f32_16x16x32_bf16 v[192:195], v[144:147], v[48:51], v[192:195]
    v_mfma_f32_16x16x32_bf16 v[196:199], v[144:147], v[52:55], v[196:199]
    ds_read_b64_tr_b16 v[132:133], v23 offset:8192
    ds_read_b64_tr_b16 v[134:135], v23 offset:9216
    v_add_u32 v23, 4294836224, v23
    s_waitcnt lgkmcnt(8)
    v_mfma_f32_16x16x32_bf16 v[200:203], v[148:151], v[48:51], v[200:203]
    v_mfma_f32_16x16x32_bf16 v[204:207], v[148:151], v[52:55], v[204:207]
    ds_read_b64_tr_b16 v[136:137], v24 offset:8192
    ds_read_b64_tr_b16 v[138:139], v24 offset:9216
    v_add_u32 v24, 4294836224, v24
    s_waitcnt lgkmcnt(8)
    v_mfma_f32_16x16x32_bf16 v[208:211], v[152:155], v[48:51], v[208:211]
    v_mfma_f32_16x16x32_bf16 v[212:215], v[152:155], v[52:55], v[212:215]
    ds_read_b64_tr_b16 v[140:141], v25 offset:8192
    ds_read_b64_tr_b16 v[142:143], v25 offset:9216
    v_add_u32 v25, 4294836224, v25
    s_waitcnt lgkmcnt(8)
    v_mfma_f32_16x16x32_bf16 v[216:219], v[156:159], v[48:51], v[216:219]
    v_mfma_f32_16x16x32_bf16 v[220:223], v[156:159], v[52:55], v[220:223]
    ds_read_b64_tr_b16 v[144:145], v26 offset:8192
    ds_read_b64_tr_b16 v[146:147], v26 offset:9216
    v_add_u32 v26, 4294836224, v26
    s_waitcnt lgkmcnt(8)
    v_mfma_f32_16x16x32_bf16 v[160:163], v[128:131], v[56:59], v[160:163]
    v_mfma_f32_16x16x32_bf16 v[164:167], v[128:131], v[60:63], v[164:167]
    ds_read_b64_tr_b16 v[148:149], v27 offset:8192
    ds_read_b64_tr_b16 v[150:151], v27 offset:9216
    v_add_u32 v27, 4294836224, v27
    s_waitcnt lgkmcnt(8)
    v_mfma_f32_16x16x32_bf16 v[168:171], v[132:135], v[56:59], v[168:171]
    v_mfma_f32_16x16x32_bf16 v[172:175], v[132:135], v[60:63], v[172:175]
    ds_read_b64_tr_b16 v[152:153], v28 offset:8192
    ds_read_b64_tr_b16 v[154:155], v28 offset:9216
    v_add_u32 v28, 4294836224, v28
    s_waitcnt vmcnt(4)
    s_barrier
    s_waitcnt lgkmcnt(8)
    v_mfma_f32_16x16x32_bf16 v[176:179], v[136:139], v[56:59], v[176:179]
    v_mfma_f32_16x16x32_bf16 v[180:183], v[136:139], v[60:63], v[180:183]
    ds_read_b64_tr_b16 v[156:157], v29 offset:8192
    ds_read_b64_tr_b16 v[158:159], v29 offset:9216
    v_add_u32 v29, 4294836224, v29
    s_waitcnt lgkmcnt(8)
    v_mfma_f32_16x16x32_bf16 v[184:187], v[140:143], v[56:59], v[184:187]
    v_mfma_f32_16x16x32_bf16 v[188:191], v[140:143], v[60:63], v[188:191]
    ds_read_b64_tr_b16 v[128:129], v22 offset:0
    ds_read_b64_tr_b16 v[130:131], v22 offset:1024
    s_waitcnt lgkmcnt(8)
    v_mfma_f32_16x16x32_bf16 v[192:195], v[144:147], v[56:59], v[192:195]
    v_mfma_f32_16x16x32_bf16 v[196:199], v[144:147], v[60:63], v[196:199]
    ds_read_b64_tr_b16 v[132:133], v23 offset:0
    ds_read_b64_tr_b16 v[134:135], v23 offset:1024
    s_waitcnt lgkmcnt(8)
    v_mfma_f32_16x16x32_bf16 v[200:203], v[148:151], v[56:59], v[200:203]
    v_mfma_f32_16x16x32_bf16 v[204:207], v[148:151], v[60:63], v[204:207]
    ds_read_b64_tr_b16 v[136:137], v24 offset:0
    ds_read_b64_tr_b16 v[138:139], v24 offset:1024
    s_waitcnt lgkmcnt(8)
    v_mfma_f32_16x16x32_bf16 v[208:211], v[152:155], v[56:59], v[208:211]
    v_mfma_f32_16x16x32_bf16 v[212:215], v[152:155], v[60:63], v[212:215]
    ds_read_b64_tr_b16 v[140:141], v25 offset:0
    ds_read_b64_tr_b16 v[142:143], v25 offset:1024
    s_waitcnt lgkmcnt(8)
    v_mfma_f32_16x16x32_bf16 v[216:219], v[156:159], v[56:59], v[216:219]
    v_mfma_f32_16x16x32_bf16 v[220:223], v[156:159], v[60:63], v[220:223]
    ds_read_b64_tr_b16 v[144:145], v26 offset:0
    ds_read_b64_tr_b16 v[146:147], v26 offset:1024
    s_waitcnt lgkmcnt(8)
    v_mfma_f32_16x16x32_bf16 v[160:163], v[128:131], v[64:67], v[160:163]
    v_mfma_f32_16x16x32_bf16 v[164:167], v[128:131], v[68:71], v[164:167]
    ds_read_b64_tr_b16 v[148:149], v27 offset:0
    ds_read_b64_tr_b16 v[150:151], v27 offset:1024
    s_waitcnt lgkmcnt(8)
    v_mfma_f32_16x16x32_bf16 v[168:171], v[132:135], v[64:67], v[168:171]
    v_mfma_f32_16x16x32_bf16 v[172:175], v[132:135], v[68:71], v[172:175]
    ds_read_b64_tr_b16 v[152:153], v28 offset:0
    ds_read_b64_tr_b16 v[154:155], v28 offset:1024
    s_waitcnt lgkmcnt(8)
    v_mfma_f32_16x16x32_bf16 v[176:179], v[136:139], v[64:67], v[176:179]
    v_mfma_f32_16x16x32_bf16 v[180:183], v[136:139], v[68:71], v[180:183]
    ds_read_b64_tr_b16 v[156:157], v29 offset:0
    ds_read_b64_tr_b16 v[158:159], v29 offset:1024
    s_waitcnt lgkmcnt(8)
    v_mfma_f32_16x16x32_bf16 v[184:187], v[140:143], v[64:67], v[184:187]
    v_mfma_f32_16x16x32_bf16 v[188:191], v[140:143], v[68:71], v[188:191]
    ds_read_b64_tr_b16 v[128:129], v22 offset:8192
    ds_read_b64_tr_b16 v[130:131], v22 offset:9216
    s_waitcnt lgkmcnt(8)
    v_mfma_f32_16x16x32_bf16 v[192:195], v[144:147], v[64:67], v[192:195]
    v_mfma_f32_16x16x32_bf16 v[196:199], v[144:147], v[68:71], v[196:199]
    ds_read_b64_tr_b16 v[132:133], v23 offset:8192
    ds_read_b64_tr_b16 v[134:135], v23 offset:9216
    s_waitcnt lgkmcnt(8)
    v_mfma_f32_16x16x32_bf16 v[200:203], v[148:151], v[64:67], v[200:203]
    v_mfma_f32_16x16x32_bf16 v[204:207], v[148:151], v[68:71], v[204:207]
    ds_read_b64_tr_b16 v[136:137], v24 offset:8192
    ds_read_b64_tr_b16 v[138:139], v24 offset:9216
    s_waitcnt lgkmcnt(8)
    v_mfma_f32_16x16x32_bf16 v[208:211], v[152:155], v[64:67], v[208:211]
    v_mfma_f32_16x16x32_bf16 v[212:215], v[152:155], v[68:71], v[212:215]
    ds_read_b64_tr_b16 v[140:141], v25 offset:8192
    ds_read_b64_tr_b16 v[142:143], v25 offset:9216
    s_waitcnt lgkmcnt(8)
    v_mfma_f32_16x16x32_bf16 v[216:219], v[156:159], v[64:67], v[216:219]
    v_mfma_f32_16x16x32_bf16 v[220:223], v[156:159], v[68:71], v[220:223]
    ds_read_b64_tr_b16 v[144:145], v26 offset:8192
    ds_read_b64_tr_b16 v[146:147], v26 offset:9216
    s_waitcnt lgkmcnt(8)
    v_mfma_f32_16x16x32_bf16 v[160:163], v[128:131], v[72:75], v[160:163]
    v_mfma_f32_16x16x32_bf16 v[164:167], v[128:131], v[76:79], v[164:167]
    ds_read_b64_tr_b16 v[148:149], v27 offset:8192
    ds_read_b64_tr_b16 v[150:151], v27 offset:9216
    s_waitcnt lgkmcnt(8)
    v_mfma_f32_16x16x32_bf16 v[168:171], v[132:135], v[72:75], v[168:171]
    v_mfma_f32_16x16x32_bf16 v[172:175], v[132:135], v[76:79], v[172:175]
    ds_read_b64_tr_b16 v[152:153], v28 offset:8192
    ds_read_b64_tr_b16 v[154:155], v28 offset:9216
    s_waitcnt lgkmcnt(8)
    v_mfma_f32_16x16x32_bf16 v[176:179], v[136:139], v[72:75], v[176:179]
    v_mfma_f32_16x16x32_bf16 v[180:183], v[136:139], v[76:79], v[180:183]
    ds_read_b64_tr_b16 v[156:157], v29 offset:8192
    ds_read_b64_tr_b16 v[158:159], v29 offset:9216
    s_waitcnt lgkmcnt(8)
    v_mfma_f32_16x16x32_bf16 v[184:187], v[140:143], v[72:75], v[184:187]
    v_mfma_f32_16x16x32_bf16 v[188:191], v[140:143], v[76:79], v[188:191]
    s_waitcnt lgkmcnt(6)
    v_mfma_f32_16x16x32_bf16 v[192:195], v[144:147], v[72:75], v[192:195]
    v_mfma_f32_16x16x32_bf16 v[196:199], v[144:147], v[76:79], v[196:199]
    s_waitcnt lgkmcnt(4)
    v_mfma_f32_16x16x32_bf16 v[200:203], v[148:151], v[72:75], v[200:203]
    v_mfma_f32_16x16x32_bf16 v[204:207], v[148:151], v[76:79], v[204:207]
    s_waitcnt lgkmcnt(2)
    v_mfma_f32_16x16x32_bf16 v[208:211], v[152:155], v[72:75], v[208:211]
    v_mfma_f32_16x16x32_bf16 v[212:215], v[152:155], v[76:79], v[212:215]
    s_waitcnt lgkmcnt(0)
    v_mfma_f32_16x16x32_bf16 v[216:219], v[156:159], v[72:75], v[216:219]
    v_mfma_f32_16x16x32_bf16 v[220:223], v[156:159], v[76:79], v[220:223]
    s_add_u32 s56, s55, 16777216
    s_add_u32 s87, s87, 1
    s_cmp_eq_u32 s87, s53
    s_cselect_b32 s40, s54, 0x4000
    s_add_u32 s55, s55, s40
    s_cmp_gt_u32 s87, 16
    s_cselect_b32 s55, 0x70000000, s55
    s_mov_b32 s39, 0x3e0293ee
    s_waitcnt vmcnt(0)
    s_barrier
    ds_read_b128 v[128:131], v232 offset:0
    ds_read_b128 v[132:135], v232 offset:4096
    ds_read_b128 v[136:139], v232 offset:1024
    ds_read_b128 v[140:143], v232 offset:5120
    ds_read_b128 v[144:147], v232 offset:2048
    ds_read_b128 v[148:151], v232 offset:6144
    ds_read_b128 v[152:155], v232 offset:3072
    ds_read_b128 v[156:159], v232 offset:7168
    v_mul_f32 v160, s39, v160
    v_mul_f32 v161, s39, v161
    v_mul_f32 v162, s39, v162
    v_mul_f32 v163, s39, v163
    v_cvt_pk_bf16_f32 v32, v160, v161
    v_cvt_pk_bf16_f32 v33, v162, v163
    v_mul_f32 v168, s39, v168
    v_mul_f32 v169, s39, v169
    v_mul_f32 v170, s39, v170
    v_mul_f32 v171, s39, v171
    v_cvt_pk_bf16_f32 v34, v168, v169
    v_cvt_pk_bf16_f32 v35, v170, v171
    s_add_u32 m0, s48, 16384
    s_nop 0
    buffer_load_dwordx4 v2, s[16:19], s55 offen offset:0 lds
    v_mul_f32 v164, s39, v164
    v_mul_f32 v165, s39, v165
    v_mul_f32 v166, s39, v166
    v_mul_f32 v167, s39, v167
    v_cvt_pk_bf16_f32 v36, v164, v165
    v_cvt_pk_bf16_f32 v37, v166, v167
    v_mul_f32 v172, s39, v172
    v_mul_f32 v173, s39, v173
    v_mul_f32 v174, s39, v174
    v_mul_f32 v175, s39, v175
    v_cvt_pk_bf16_f32 v38, v172, v173
    v_cvt_pk_bf16_f32 v39, v174, v175
    buffer_load_dwordx4 v2, s[16:19], s55 offen offset:1024 lds
    v_mul_f32 v176, s39, v176
    v_mul_f32 v177, s39, v177
    v_mul_f32 v178, s39, v178
    v_mul_f32 v179, s39, v179
    v_cvt_pk_bf16_f32 v40, v176, v177
    v_cvt_pk_bf16_f32 v41, v178, v179
    v_mul_f32 v184, s39, v184
    v_mul_f32 v185, s39, v185
    v_mul_f32 v186, s39, v186
    v_mul_f32 v187, s39, v187
    v_cvt_pk_bf16_f32 v42, v184, v185
    v_cvt_pk_bf16_f32 v43, v186, v187
    buffer_load_dwordx4 v2, s[16:19], s55 offen offset:2048 lds
    v_mul_f32 v180, s39, v180
    v_mul_f32 v181, s39, v181
    v_mul_f32 v182, s39, v182
    v_mul_f32 v183, s39, v183
    v_cvt_pk_bf16_f32 v44, v180, v181
    v_cvt_pk_bf16_f32 v45, v182, v183
    v_mul_f32 v188, s39, v188
    v_mul_f32 v189, s39, v189
    v_mul_f32 v190, s39, v190
    v_mul_f32 v191, s39, v191
    v_cvt_pk_bf16_f32 v46, v188, v189
    v_cvt_pk_bf16_f32 v47, v190, v191
    buffer_load_dwordx4 v2, s[16:19], s55 offen offset:3072 lds
    v_mul_f32 v192, s39, v192
    v_mul_f32 v193, s39, v193
    v_mul_f32 v194, s39, v194
    v_mul_f32 v195, s39, v195
    v_cvt_pk_bf16_f32 v48, v192, v193
    v_cvt_pk_bf16_f32 v49, v194, v195
    v_mul_f32 v200, s39, v200
    v_mul_f32 v201, s39, v201
    v_mul_f32 v202, s39, v202
    v_mul_f32 v203, s39, v203
    v_cvt_pk_bf16_f32 v50, v200, v201
    v_cvt_pk_bf16_f32 v51, v202, v203
    s_add_u32 m0, s48, 32768
    s_nop 0
    buffer_load_dwordx4 v2, s[16:19], s56 offen offset:0 lds
    v_mul_f32 v196, s39, v196
    v_mul_f32 v197, s39, v197
    v_mul_f32 v198, s39, v198
    v_mul_f32 v199, s39, v199
    v_cvt_pk_bf16_f32 v52, v196, v197
    v_cvt_pk_bf16_f32 v53, v198, v199
    v_mul_f32 v204, s39, v204
    v_mul_f32 v205, s39, v205
    v_mul_f32 v206, s39, v206
    v_mul_f32 v207, s39, v207
    v_cvt_pk_bf16_f32 v54, v204, v205
    v_cvt_pk_bf16_f32 v55, v206, v207
    buffer_load_dwordx4 v2, s[16:19], s56 offen offset:1024 lds
    v_mul_f32 v208, s39, v208
    v_mul_f32 v209, s39, v209
    v_mul_f32 v210, s39, v210
    v_mul_f32 v211, s39, v211
    v_cvt_pk_bf16_f32 v56, v208, v209
    v_cvt_pk_bf16_f32 v57, v210, v211
    v_mul_f32 v216, s39, v216
    v_mul_f32 v217, s39, v217
    v_mul_f32 v218, s39, v218
    v_mul_f32 v219, s39, v219
    v_cvt_pk_bf16_f32 v58, v216, v217
    v_cvt_pk_bf16_f32 v59, v218, v219
    buffer_load_dwordx4 v2, s[16:19], s56 offen offset:2048 lds
    v_mul_f32 v212, s39, v212
    v_mul_f32 v213, s39, v213
    v_mul_f32 v214, s39, v214
    v_mul_f32 v215, s39, v215
    v_cvt_pk_bf16_f32 v60, v212, v213
    v_cvt_pk_bf16_f32 v61, v214, v215
    v_mul_f32 v220, s39, v220
    v_mul_f32 v221, s39, v221
    v_mul_f32 v222, s39, v222
    v_mul_f32 v223, s39, v223
    v_cvt_pk_bf16_f32 v62, v220, v221
    v_cvt_pk_bf16_f32 v63, v222, v223
    buffer_load_dwordx4 v2, s[16:19], s56 offen offset:3072 lds
    v_mov_b32 v112, 0
    v_mov_b32 v113, 0
    v_mov_b32 v114, 0
    v_mov_b32 v115, 0
    v_mov_b32 v116, 0
    v_mov_b32 v117, 0
    v_mov_b32 v118, 0
    v_mov_b32 v119, 0
    s_mov_b32 s12, s24
    s_mov_b32 s13, s25
    s_mov_b32 s14, 268435456
    s_mov_b32 s15, 0x00020000
    s_cmp_lg_u32 s38, 0
    s_cbranch_scc1 L_k2_attn_kernel_grp1_6
    s_add_u32 s39, s89, 4096
    buffer_store_dwordx4 v[32:35], v2, s[12:15], s89 offen offset:0 sc1
    buffer_store_dwordx4 v[36:39], v2, s[12:15], s89 offen offset:1024 sc1
    buffer_store_dwordx4 v[40:43], v2, s[12:15], s89 offen offset:2048 sc1
    buffer_store_dwordx4 v[44:47], v2, s[12:15], s89 offen offset:3072 sc1
    buffer_store_dwordx4 v[48:51], v2, s[12:15], s39 offen offset:0 sc1
    buffer_store_dwordx4 v[52:55], v2, s[12:15], s39 offen offset:1024 sc1
    buffer_store_dwordx4 v[56:59], v2, s[12:15], s39 offen offset:2048 sc1
    buffer_store_dwordx4 v[60:63], v2, s[12:15], s39 offen offset:3072 sc1
    s_waitcnt lgkmcnt(0)
    v_mfma_f32_16x16x32_bf16 v[64:67], v[128:131], v[32:35], v[112:115]
    v_mfma_f32_16x16x32_bf16 v[68:71], v[128:131], v[36:39], v[116:119]
    s_setprio 2
    v_mfma_f32_16x16x32_bf16 v[72:75], v[132:135], v[32:35], v[112:115]
    v_mfma_f32_16x16x32_bf16 v[76:79], v[132:135], v[36:39], v[116:119]
    v_mfma_f32_16x16x32_bf16 v[64:67], v[136:139], v[40:43], v[64:67]
    v_mfma_f32_16x16x32_bf16 v[68:71], v[136:139], v[44:47], v[68:71]
    v_mfma_f32_16x16x32_bf16 v[72:75], v[140:143], v[40:43], v[72:75]
    v_mfma_f32_16x16x32_bf16 v[76:79], v[140:143], v[44:47], v[76:79]
    v_mfma_f32_16x16x32_bf16 v[64:67], v[144:147], v[48:51], v[64:67]
    v_mfma_f32_16x16x32_bf16 v[68:71], v[144:147], v[52:55], v[68:71]
    v_mfma_f32_16x16x32_bf16 v[72:75], v[148:151], v[48:51], v[72:75]
    v_mfma_f32_16x16x32_bf16 v[76:79], v[148:151], v[52:55], v[76:79]
    v_mfma_f32_16x16x32_bf16 v[64:67], v[152:155], v[56:59], v[64:67]
    v_mfma_f32_16x16x32_bf16 v[68:71], v[152:155], v[60:63], v[68:71]
    v_mfma_f32_16x16x32_bf16 v[72:75], v[156:159], v[56:59], v[72:75]
    v_mfma_f32_16x16x32_bf16 v[76:79], v[156:159], v[60:63], v[76:79]
    s_setprio 0
    v_mov_b32 v160, 0
    v_mov_b32 v161, 0
    v_mov_b32 v162, 0
    v_mov_b32 v163, 0
    v_mov_b32 v164, 0
    v_mov_b32 v165, 0
    v_mov_b32 v166, 0
    v_mov_b32 v167, 0
    v_mov_b32 v168, 0
    v_mov_b32 v169, 0
    v_mov_b32 v170, 0
    v_mov_b32 v171, 0
    v_mov_b32 v172, 0
    v_mov_b32 v173, 0
    v_mov_b32 v174, 0
    v_mov_b32 v175, 0
    v_mov_b32 v176, 0
    v_mov_b32 v177, 0
    v_mov_b32 v178, 0
    v_mov_b32 v179, 0
    v_mov_b32 v180, 0
    v_mov_b32 v181, 0
    v_mov_b32 v182, 0
    v_mov_b32 v183, 0
    v_mov_b32 v184, 0
    v_mov_b32 v185, 0
    v_mov_b32 v186, 0
    v_mov_b32 v187, 0
    v_mov_b32 v188, 0
    v_mov_b32 v189, 0
    v_mov_b32 v190, 0
    v_mov_b32 v191, 0
    v_mov_b32 v192, 0
    v_mov_b32 v193, 0
    v_mov_b32 v194, 0
    v_mov_b32 v195, 0
    v_mov_b32 v196, 0
    v_mov_b32 v197, 0
    v_mov_b32 v198, 0
    v_mov_b32 v199, 0
    v_mov_b32 v200, 0
    v_mov_b32 v201, 0
    v_mov_b32 v202, 0
    v_mov_b32 v203, 0
    v_mov_b32 v204, 0
    v_mov_b32 v205, 0
    v_mov_b32 v206, 0
    v_mov_b32 v207, 0
    v_mov_b32 v208, 0
    v_mov_b32 v209, 0
    v_mov_b32 v210, 0
    v_mov_b32 v211, 0
    v_mov_b32 v212, 0
    v_mov_b32 v213, 0
    v_mov_b32 v214, 0
    v_mov_b32 v215, 0
    v_mov_b32 v216, 0
    v_mov_b32 v217, 0
    v_mov_b32 v218, 0
    v_mov_b32 v219, 0
    v_mov_b32 v220, 0
    v_mov_b32 v221, 0
    v_mov_b32 v222, 0
    v_mov_b32 v223, 0
    v_mov_b32 v224, 0
    v_mov_b32 v225, 0
    v_mov_b32 v226, 0
    v_mov_b32 v227, 0
    v_mov_b32 v228, 0
    v_mov_b32 v229, 0
    v_mov_b32 v230, 0
    v_mov_b32 v231, 0
    v_mov_b32 v120, 0x3f803f80
    v_mov_b32 v121, 0x3f803f80
    v_mov_b32 v122, 0x3f803f80
    v_mov_b32 v123, 0x3f803f80
    ds_read_b128 v[128:131], v232 offset:8192
    s_cmp_eq_u32 s41, s42
    s_cselect_b64 s[28:29], -1, s[30:31]
    ds_read_b128 v[132:135], v232 offset:12288
    s_add_u32 s41, s41, 32
    ds_read_b128 v[136:139], v232 offset:9216
    ds_read_b128 v[140:143], v232 offset:13312
    ds_read_b128 v[144:147], v232 offset:10240
    ds_read_b128 v[148:151], v232 offset:14336
    ds_read_b128 v[152:155], v232 offset:11264
    ds_read_b128 v[156:159], v232 offset:15360
    v_max3_f32 v4, v64, v65, v66
    v_max3_f32 v5, v67, v68, v69
    v_max3_f32 v4, v4, v70, v71
    v_max3_f32 v5, v5, v72, v73
    v_max3_f32 v4, v4, v74, v75
    v_max3_f32 v5, v5, v76, v77
    v_max3_f32 v4, v4, v78, v79
    v_max_f32 v4, v4, v5
    v_cmp_lt_f32 vcc, 0x41000000, v4
    s_or_b64 s[32:33], vcc, s[28:29]
    s_cbranch_scc1 L_k2_attn_kernel_slow_8
L_k2_attn_kernel_slowret_9:
    s_waitcnt lgkmcnt(0)
    v_mfma_f32_16x16x32_bf16 v[80:83], v[128:131], v[32:35], v[112:115]
    v_mfma_f32_16x16x32_bf16 v[84:87], v[128:131], v[36:39], v[116:119]
    s_setprio 2
    v_mfma_f32_16x16x32_bf16 v[88:91], v[132:135], v[32:35], v[112:115]
    v_mfma_f32_16x16x32_bf16 v[92:95], v[132:135], v[36:39], v[116:119]
    s_add_u32 s56, s55, 16777216
    s_add_u32 s87, s87, 1
    s_cmp_eq_u32 s87, s53
    s_cselect_b32 s40, s54, 0x4000
    v_mfma_f32_16x16x32_bf16 v[80:83], v[136:139], v[40:43], v[80:83]
    v_mfma_f32_16x16x32_bf16 v[84:87], v[136:139], v[44:47], v[84:87]
    v_mfma_f32_16x16x32_bf16 v[88:91], v[140:143], v[40:43], v[88:91]
    v_mfma_f32_16x16x32_bf16 v[92:95], v[140:143], v[44:47], v[92:95]
    s_add_u32 s55, s55, s40
    s_cmp_gt_u32 s87, 16
    s_cselect_b32 s55, 0x70000000, s55
    v_mfma_f32_16x16x32_bf16 v[80:83], v[144:147], v[48:51], v[80:83]
    v_mfma_f32_16x16x32_bf16 v[84:87], v[144:147], v[52:55], v[84:87]
    v_mfma_f32_16x16x32_bf16 v[88:91], v[148:151], v[48:51], v[88:91]
    v_mfma_f32_16x16x32_bf16 v[92:95], v[148:151], v[52:55], v[92:95]
    v_mfma_f32_16x16x32_bf16 v[80:83], v[152:155], v[56:59], v[80:83]
    v_mfma_f32_16x16x32_bf16 v[84:87], v[152:155], v[60:63], v[84:87]
    v_mfma_f32_16x16x32_bf16 v[88:91], v[156:159], v[56:59], v[88:91]
    v_mfma_f32_16x16x32_bf16 v[92:95], v[156:159], v[60:63], v[92:95]
    s_setprio 0
    v_exp_f32 v64, v64
    v_exp_f32 v65, v65
    v_exp_f32 v66, v66
    v_exp_f32 v67, v67
    v_cvt_pk_bf16_f32 v96, v64, v65
    v_exp_f32 v72, v72
    v_exp_f32 v73, v73
    v_cvt_pk_bf16_f32 v97, v66, v67
    v_exp_f32 v74, v74
    v_exp_f32 v75, v75
    v_cvt_pk_bf16_f32 v98, v72, v73
    v_exp_f32 v68, v68
    v_exp_f32 v69, v69
    v_cvt_pk_bf16_f32 v99, v74, v75
    v_exp_f32 v70, v70
    s_cmp_eq_u32 s41, s42
    s_cselect_b64 s[28:29], -1, s[30:31]
    s_add_u32 s45, s45, 1
    s_add_u32 s41, s41, 32
    s_cmp_lg_u32 s85, 0
    s_cbranch_scc1 L_k2_attn_kernel_vwalt_10
    s_waitcnt vmcnt(0)
L_k2_attn_kernel_vwret_11:
    s_barrier
    ds_read_b128 v[128:131], v232 offset:16384
    ds_read_b128 v[132:135], v232 offset:20480
    ds_read_b128 v[136:139], v232 offset:17408
    ds_read_b128 v[140:143], v232 offset:21504
    ds_read_b128 v[144:147], v232 offset:18432
    ds_read_b128 v[148:151], v232 offset:22528
    ds_read_b128 v[152:155], v232 offset:19456
    ds_read_b128 v[156:159], v232 offset:23552
    v_exp_f32 v71, v71
    v_cvt_pk_bf16_f32 v100, v68, v69
    v_exp_f32 v76, v76
    v_exp_f32 v77, v77
    v_cvt_pk_bf16_f32 v101, v70, v71
    v_exp_f32 v78, v78
    v_exp_f32 v79, v79
    v_cvt_pk_bf16_f32 v102, v76, v77
    v_cvt_pk_bf16_f32 v103, v78, v79
    v_max3_f32 v4, v80, v81, v82
    v_max3_f32 v5, v83, v84, v85
    v_max3_f32 v4, v4, v86, v87
    v_max3_f32 v5, v5, v88, v89
    v_max3_f32 v4, v4, v90, v91
    v_max3_f32 v5, v5, v92, v93
    v_max3_f32 v4, v4, v94, v95
    v_max_f32 v4, v4, v5
    v_cmp_lt_f32 vcc, 0x41000000, v4
    s_or_b64 s[32:33], vcc, s[28:29]
    s_cbranch_scc1 L_k2_attn_kernel_slow_12
L_k2_attn_kernel_slowret_13:
L_k2_attn_kernel_loop_14:
    s_waitcnt lgkmcnt(0)
    v_mfma_f32_16x16x32_bf16 v[64:67], v[128:131], v[32:35], v[112:115]
    v_mfma_f32_16x16x32_bf16 v[68:71], v[128:131], v[36:39], v[116:119]
    s_setprio 2
    ds_read_b128 v[128:131], v232 offset:32768
    v_mfma_f32_16x16x32_bf16 v[72:75], v[132:135], v[32:35], v[112:115]
    v_mfma_f32_16x16x32_bf16 v[76:79], v[132:135], v[36:39], v[116:119]
    ds_read_b128 v[132:135], v232 offset:34816
    s_add_u32 m0, s48, 0
    s_nop 0
    buffer_load_dwordx4 v2, s[16:19], s55 offen offset:0 lds
    v_mfma_f32_16x16x32_bf16 v[64:67], v[136:139], v[40:43], v[64:67]
    v_mfma_f32_16x16x32_bf16 v[68:71], v[136:139], v[44:47], v[68:71]
    ds_read_b128 v[136:139], v232 offset:36864
    v_mfma_f32_16x16x32_bf16 v[72:75], v[140:143], v[40:43], v[72:75]
    v_mfma_f32_16x16x32_bf16 v[76:79], v[140:143], v[44:47], v[76:79]
    ds_read_b128 v[140:143], v232 offset:38912
    buffer_load_dwordx4 v2, s[16:19], s55 offen offset:1024 lds
    v_mfma_f32_16x16x32_bf16 v[64:67], v[144:147], v[48:51], v[64:67]
    v_mfma_f32_16x16x32_bf16 v[68:71], v[144:147], v[52:55], v[68:71]
    ds_read_b128 v[144:147], v232 offset:40960
    v_mfma_f32_16x16x32_bf16 v[72:75], v[148:151], v[48:51], v[72:75]
    v_mfma_f32_16x16x32_bf16 v[76:79], v[148:151], v[52:55], v[76:79]
    ds_read_b128 v[148:151], v232 offset:43008
    buffer_load_dwordx4 v2, s[16:19], s55 offen offset:2048 lds
    v_mfma_f32_16x16x32_bf16 v[64:67], v[152:155], v[56:59], v[64:67]
    v_mfma_f32_16x16x32_bf16 v[68:71], v[152:155], v[60:63], v[68:71]
    ds_read_b128 v[152:155], v232 offset:45056
    v_mfma_f32_16x16x32_bf16 v[72:75], v[156:159], v[56:59], v[72:75]
    v_mfma_f32_16x16x32_bf16 v[76:79], v[156:159], v[60:63], v[76:79]
    s_setprio 0
    ds_read_b128 v[156:159], v232 offset:47104
    buffer_load_dwordx4 v2, s[16:19], s55 offen offset:3072 lds
    v_exp_f32 v80, v80
    v_exp_f32 v81, v81
    v_exp_f32 v82, v82
    v_exp_f32 v83, v83
    v_cvt_pk_bf16_f32 v104, v80, v81
    v_exp_f32 v88, v88
    v_exp_f32 v89, v89
    v_cvt_pk_bf16_f32 v105, v82, v83
    v_exp_f32 v90, v90
    v_exp_f32 v91, v91
    v_cvt_pk_bf16_f32 v106, v88, v89
    v_exp_f32 v84, v84
    v_exp_f32 v85, v85
    v_cvt_pk_bf16_f32 v107, v90, v91
    v_exp_f32 v86, v86
    s_waitcnt lgkmcnt(0)
    v_mfma_f32_16x16x32_bf16 v[224:227], v[120:123], v[96:99], v[224:227]
    v_mfma_f32_16x16x32_bf16 v[228:231], v[120:123], v[100:103], v[228:231]
    s_setprio 2
    v_mfma_f32_16x16x32_bf16 v[160:163], v[128:131], v[96:99], v[160:163]
    v_mfma_f32_16x16x32_bf16 v[164:167], v[128:131], v[100:103], v[164:167]
    ds_read_b128 v[128:131], v232 offset:24576
    s_add_u32 m0, s48, 49152
    s_nop 0
    buffer_load_dwordx4 v2, s[16:19], s56 offen offset:0 lds
    v_mfma_f32_16x16x32_bf16 v[168:171], v[132:135], v[96:99], v[168:171]
    v_mfma_f32_16x16x32_bf16 v[172:175], v[132:135], v[100:103], v[172:175]
    ds_read_b128 v[132:135], v232 offset:28672
    buffer_load_dwordx4 v2, s[16:19], s56 offen offset:1024 lds
    v_mfma_f32_16x16x32_bf16 v[176:179], v[136:139], v[96:99], v[176:179]
    v_mfma_f32_16x16x32_bf16 v[180:183], v[136:139], v[100:103], v[180:183]
    ds_read_b128 v[136:139], v232 offset:25600
    buffer_load_dwordx4 v2, s[16:19], s56 offen offset:2048 lds
    v_mfma_f32_16x16x32_bf16 v[184:187], v[140:143], v[96:99], v[184:187]
    v_mfma_f32_16x16x32_bf16 v[188:191], v[140:143], v[100:103], v[188:191]
    ds_read_b128 v[140:143], v232 offset:29696
    buffer_load_dwordx4 v2, s[16:19], s56 offen offset:3072 lds
    v_mfma_f32_16x16x32_bf16 v[192:195], v[144:147], v[96:99], v[192:195]
    v_mfma_f32_16x16x32_bf16 v[196:199], v[144:147], v[100:103], v[196:199]
    ds_read_b128 v[144:147], v232 offset:26624
    s_cmp_eq_u32 s41, s42
    s_cselect_b64 s[28:29], -1, s[30:31]
    v_mfma_f32_16x16x32_bf16 v[200:203], v[148:151], v[96:99], v[200:203]
    v_mfma_f32_16x16x32_bf16 v[204:207], v[148:151], v[100:103], v[204:207]
    ds_read_b128 v[148:151], v232 offset:30720
    s_add_u32 s41, s41, 32
    v_mfma_f32_16x16x32_bf16 v[208:211], v[152:155], v[96:99], v[208:211]
    v_mfma_f32_16x16x32_bf16 v[212:215], v[152:155], v[100:103], v[212:215]
    ds_read_b128 v[152:155], v232 offset:27648
    v_mfma_f32_16x16x32_bf16 v[216:219], v[156:159], v[96:99], v[216:219]
    v_mfma_f32_16x16x32_bf16 v[220:223], v[156:159], v[100:103], v[220:223]
    s_setprio 0
    ds_read_b128 v[156:159], v232 offset:31744
    v_exp_f32 v87, v87
    v_cvt_pk_bf16_f32 v108, v84, v85
    v_exp_f32 v92, v92
    v_exp_f32 v93, v93
    v_cvt_pk_bf16_f32 v109, v86, v87
    v_exp_f32 v94, v94
    v_exp_f32 v95, v95
    v_cvt_pk_bf16_f32 v110, v92, v93
    v_cvt_pk_bf16_f32 v111, v94, v95
    v_max3_f32 v4, v64, v65, v66
    v_max3_f32 v5, v67, v68, v69
    v_max3_f32 v4, v4, v70, v71
    v_max3_f32 v5, v5, v72, v73
    v_max3_f32 v4, v4, v74, v75
    v_max3_f32 v5, v5, v76, v77
    v_max3_f32 v4, v4, v78, v79
    v_max_f32 v4, v4, v5
    v_cmp_lt_f32 vcc, 0x41000000, v4
    s_or_b64 s[32:33], vcc, s[28:29]
    s_cbranch_scc1 L_k2_attn_kernel_slow_15
L_k2_attn_kernel_slowret_16:
    s_cmp_eq_u32 s45, s84
    s_cbranch_scc1 L_k2_attn_kernel_rps_17
L_k2_attn_kernel_rpret_18:
    s_waitcnt lgkmcnt(0)
    v_mfma_f32_16x16x32_bf16 v[80:83], v[128:131], v[32:35], v[112:115]
    v_mfma_f32_16x16x32_bf16 v[84:87], v[128:131], v[36:39], v[116:119]
    s_setprio 2
    ds_read_b128 v[128:131], v232 offset:33792
    v_mfma_f32_16x16x32_bf16 v[88:91], v[132:135], v[32:35], v[112:115]
    v_mfma_f32_16x16x32_bf16 v[92:95], v[132:135], v[36:39], v[116:119]
    ds_read_b128 v[132:135], v232 offset:35840
    s_add_u32 s56, s55, 16777216
    s_add_u32 s87, s87, 1
    s_cmp_eq_u32 s87, s53
    s_cselect_b32 s40, s54, 0x4000
    v_mfma_f32_16x16x32_bf16 v[80:83], v[136:139], v[40:43], v[80:83]
    v_mfma_f32_16x16x32_bf16 v[84:87], v[136:139], v[44:47], v[84:87]
    ds_read_b128 v[136:139], v232 offset:37888
    v_mfma_f32_16x16x32_bf16 v[88:91], v[140:143], v[40:43], v[88:91]
    v_mfma_f32_16x16x32_bf16 v[92:95], v[140:143], v[44:47], v[92:95]
    ds_read_b128 v[140:143], v232 offset:39936
    s_add_u32 s55, s55, s40
    s_cmp_gt_u32 s87, 16
    s_cselect_b32 s55, 0x70000000, s55
    v_mfma_f32_16x16x32_bf16 v[80:83], v[144:147], v[48:51], v[80:83]
    v_mfma_f32_16x16x32_bf16 v[84:87], v[144:147], v[52:55], v[84:87]
    ds_read_b128 v[144:147], v232 offset:41984
    v_mfma_f32_16x16x32_bf16 v[88:91], v[148:151], v[48:51], v[88:91]
    v_mfma_f32_16x16x32_bf16 v[92:95], v[148:151], v[52:55], v[92:95]
    ds_read_b128 v[148:151], v232 offset:44032
    v_mfma_f32_16x16x32_bf16 v[80:83], v[152:155], v[56:59], v[80:83]
    v_mfma_f32_16x16x32_bf16 v[84:87], v[152:155], v[60:63], v[84:87]
    ds_read_b128 v[152:155], v232 offset:46080
    v_mfma_f32_16x16x32_bf16 v[88:91], v[156:159], v[56:59], v[88:91]
    v_mfma_f32_16x16x32_bf16 v[92:95], v[156:159], v[60:63], v[92:95]
    s_setprio 0
    ds_read_b128 v[156:159], v232 offset:48128
    v_exp_f32 v64, v64
    v_exp_f32 v65, v65
    v_exp_f32 v66, v66
    v_exp_f32 v67, v67
    v_cvt_pk_bf16_f32 v96, v64, v65
    v_exp_f32 v72, v72
    v_exp_f32 v73, v73
    v_cvt_pk_bf16_f32 v97, v66, v67
    v_exp_f32 v74, v74
    v_exp_f32 v75, v75
    v_cvt_pk_bf16_f32 v98, v72, v73
    v_exp_f32 v68, v68
    v_exp_f32 v69, v69
    v_cvt_pk_bf16_f32 v99, v74, v75
    v_exp_f32 v70, v70
    s_waitcnt lgkmcnt(0)
    v_mfma_f32_16x16x32_bf16 v[224:227], v[120:123], v[104:107], v[224:227]
    v_mfma_f32_16x16x32_bf16 v[228:231], v[120:123], v[108:111], v[228:231]
    s_setprio 2
    v_mfma_f32_16x16x32_bf16 v[160:163], v[128:131], v[104:107], v[160:163]
    v_mfma_f32_16x16x32_bf16 v[164:167], v[128:131], v[108:111], v[164:167]
    s_cmp_eq_u32 s41, s42
    s_cselect_b64 s[28:29], -1, s[30:31]
    v_mfma_f32_16x16x32_bf16 v[168:171], v[132:135], v[104:107], v[168:171]
    v_mfma_f32_16x16x32_bf16 v[172:175], v[132:135], v[108:111], v[172:175]
    s_add_u32 s45, s45, 1
    s_add_u32 s41, s41, 32
    v_mfma_f32_16x16x32_bf16 v[176:179], v[136:139], v[104:107], v[176:179]
    v_mfma_f32_16x16x32_bf16 v[180:183], v[136:139], v[108:111], v[180:183]
    v_mfma_f32_16x16x32_bf16 v[184:187], v[140:143], v[104:107], v[184:187]
    v_mfma_f32_16x16x32_bf16 v[188:191], v[140:143], v[108:111], v[188:191]
    v_mfma_f32_16x16x32_bf16 v[192:195], v[144:147], v[104:107], v[192:195]
    v_mfma_f32_16x16x32_bf16 v[196:199], v[144:147], v[108:111], v[196:199]
    v_mfma_f32_16x16x32_bf16 v[200:203], v[148:151], v[104:107], v[200:203]
    v_mfma_f32_16x16x32_bf16 v[204:207], v[148:151], v[108:111], v[204:207]
    v_mfma_f32_16x16x32_bf16 v[208:211], v[152:155], v[104:107], v[208:211]
    v_mfma_f32_16x16x32_bf16 v[212:215], v[152:155], v[108:111], v[212:215]
    v_mfma_f32_16x16x32_bf16 v[216:219], v[156:159], v[104:107], v[216:219]
    v_mfma_f32_16x16x32_bf16 v[220:223], v[156:159], v[108:111], v[220:223]
    s_setprio 0
    s_cmp_lg_u32 s85, 0
    s_cbranch_scc1 L_k2_attn_kernel_vwalt_19
    s_waitcnt vmcnt(0)
L_k2_attn_kernel_vwret_20:
    s_barrier
    ds_read_b128 v[128:131], v232 offset:0
    ds_read_b128 v[132:135], v232 offset:4096
    ds_read_b128 v[136:139], v232 offset:1024
    ds_read_b128 v[140:143], v232 offset:5120
    ds_read_b128 v[144:147], v232 offset:2048
    ds_read_b128 v[148:151], v232 offset:6144
    ds_read_b128 v[152:155], v232 offset:3072
    ds_read_b128 v[156:159], v232 offset:7168
    v_exp_f32 v71, v71
    v_cvt_pk_bf16_f32 v100, v68, v69
    v_exp_f32 v76, v76
    v_exp_f32 v77, v77
    v_cvt_pk_bf16_f32 v101, v70, v71
    v_exp_f32 v78, v78
    v_exp_f32 v79, v79
    v_cvt_pk_bf16_f32 v102, v76, v77
    v_cvt_pk_bf16_f32 v103, v78, v79
    v_max3_f32 v4, v80, v81, v82
    v_max3_f32 v5, v83, v84, v85
    v_max3_f32 v4, v4, v86, v87
    v_max3_f32 v5, v5, v88, v89
    v_max3_f32 v4, v4, v90, v91
    v_max3_f32 v5, v5, v92, v93
    v_max3_f32 v4, v4, v94, v95
    v_max_f32 v4, v4, v5
    v_cmp_lt_f32 vcc, 0x41000000, v4
    s_or_b64 s[32:33], vcc, s[28:29]
    s_cbranch_scc1 L_k2_attn_kernel_slow_21
L_k2_attn_kernel_slowret_22:
    s_waitcnt lgkmcnt(0)
    v_mfma_f32_16x16x32_bf16 v[64:67], v[128:131], v[32:35], v[112:115]
    v_mfma_f32_16x16x32_bf16 v[68:71], v[128:131], v[36:39], v[116:119]
    s_setprio 2
    ds_read_b128 v[128:131], v232 offset:49152
    v_mfma_f32_16x16x32_bf16 v[72:75], v[132:135], v[32:35], v[112:115]
    v_mfma_f32_16x16x32_bf16 v[76:79], v[132:135], v[36:39], v[116:119]
    ds_read_b128 v[132:135], v232 offset:51200
    s_add_u32 m0, s48, 16384
    s_nop 0
    buffer_load_dwordx4 v2, s[16:19], s55 offen offset:0 lds
    v_mfma_f32_16x16x32_bf16 v[64:67], v[136:139], v[40:43], v[64:67]
    v_mfma_f32_16x16x32_bf16 v[68:71], v[136:139], v[44:47], v[68:71]
    ds_read_b128 v[136:139], v232 offset:53248
    v_mfma_f32_16x16x32_bf16 v[72:75], v[140:143], v[40:43], v[72:75]
    v_mfma_f32_16x16x32_bf16 v[76:79], v[140:143], v[44:47], v[76:79]
    ds_read_b128 v[140:143], v232 offset:55296
    buffer_load_dwordx4 v2, s[16:19], s55 offen offset:1024 lds
    v_mfma_f32_16x16x32_bf16 v[64:67], v[144:147], v[48:51], v[64:67]
    v_mfma_f32_16x16x32_bf16 v[68:71], v[144:147], v[52:55], v[68:71]
    ds_read_b128 v[144:147], v232 offset:57344
    v_mfma_f32_16x16x32_bf16 v[72:75], v[148:151], v[48:51], v[72:75]
    v_mfma_f32_16x16x32_bf16 v[76:79], v[148:151], v[52:55], v[76:79]
    ds_read_b128 v[148:151], v232 offset:59392
    buffer_load_dwordx4 v2, s[16:19], s55 offen offset:2048 lds
    v_mfma_f32_16x16x32_bf16 v[64:67], v[152:155], v[56:59], v[64:67]
    v_mfma_f32_16x16x32_bf16 v[68:71], v[152:155], v[60:63], v[68:71]
    ds_read_b128 v[152:155], v232 offset:61440
    v_mfma_f32_16x16x32_bf16 v[72:75], v[156:159], v[56:59], v[72:75]
    v_mfma_f32_16x16x32_bf16 v[76:79], v[156:159], v[60:63], v[76:79]
    s_setprio 0
    ds_read_b128 v[156:159], v232 offset:63488
    buffer_load_dwordx4 v2, s[16:19], s55 offen offset:3072 lds
    v_exp_f32 v80, v80
    v_exp_f32 v81, v81
    v_exp_f32 v82, v82
    v_exp_f32 v83, v83
    v_cvt_pk_bf16_f32 v104, v80, v81
    v_exp_f32 v88, v88
    v_exp_f32 v89, v89
    v_cvt_pk_bf16_f32 v105, v82, v83
    v_exp_f32 v90, v90
    v_exp_f32 v91, v91
    v_cvt_pk_bf16_f32 v106, v88, v89
    v_exp_f32 v84, v84
    v_exp_f32 v85, v85
    v_cvt_pk_bf16_f32 v107, v90, v91
    v_exp_f32 v86, v86
    s_waitcnt lgkmcnt(0)
    v_mfma_f32_16x16x32_bf16 v[224:227], v[120:123], v[96:99], v[224:227]
    v_mfma_f32_16x16x32_bf16 v[228:231], v[120:123], v[100:103], v[228:231]
    s_setprio 2
    v_mfma_f32_16x16x32_bf16 v[160:163], v[128:131], v[96:99], v[160:163]
    v_mfma_f32_16x16x32_bf16 v[164:167], v[128:131], v[100:103], v[164:167]
    ds_read_b128 v[128:131], v232 offset:8192
    s_add_u32 m0, s48, 32768
    s_nop 0
    buffer_load_dwordx4 v2, s[16:19], s56 offen offset:0 lds
    v_mfma_f32_16x16x32_bf16 v[168:171], v[132:135], v[96:99], v[168:171]
    v_mfma_f32_16x16x32_bf16 v[172:175], v[132:135], v[100:103], v[172:175]
    ds_read_b128 v[132:135], v232 offset:12288
    buffer_load_dwordx4 v2, s[16:19], s56 offen offset:1024 lds
    v_mfma_f32_16x16x32_bf16 v[176:179], v[136:139], v[96:99], v[176:179]
    v_mfma_f32_16x16x32_bf16 v[180:183], v[136:139], v[100:103], v[180:183]
    ds_read_b128 v[136:139], v232 offset:9216
    buffer_load_dwordx4 v2, s[16:19], s56 offen offset:2048 lds
    v_mfma_f32_16x16x32_bf16 v[184:187], v[140:143], v[96:99], v[184:187]
    v_mfma_f32_16x16x32_bf16 v[188:191], v[140:143], v[100:103], v[188:191]
    ds_read_b128 v[140:143], v232 offset:13312
    buffer_load_dwordx4 v2, s[16:19], s56 offen offset:3072 lds
    v_mfma_f32_16x16x32_bf16 v[192:195], v[144:147], v[96:99], v[192:195]
    v_mfma_f32_16x16x32_bf16 v[196:199], v[144:147], v[100:103], v[196:199]
    ds_read_b128 v[144:147], v232 offset:10240
    s_cmp_eq_u32 s41, s42
    s_cselect_b64 s[28:29], -1, s[30:31]
    v_mfma_f32_16x16x32_bf16 v[200:203], v[148:151], v[96:99], v[200:203]
    v_mfma_f32_16x16x32_bf16 v[204:207], v[148:151], v[100:103], v[204:207]
    ds_read_b128 v[148:151], v232 offset:14336
    s_add_u32 s41, s41, 32
    v_mfma_f32_16x16x32_bf16 v[208:211], v[152:155], v[96:99], v[208:211]
    v_mfma_f32_16x16x32_bf16 v[212:215], v[152:155], v[100:103], v[212:215]
    ds_read_b128 v[152:155], v232 offset:11264
    v_mfma_f32_16x16x32_bf16 v[216:219], v[156:159], v[96:99], v[216:219]
    v_mfma_f32_16x16x32_bf16 v[220:223], v[156:159], v[100:103], v[220:223]
    s_setprio 0
    ds_read_b128 v[156:159], v232 offset:15360
    v_exp_f32 v87, v87
    v_cvt_pk_bf16_f32 v108, v84, v85
    v_exp_f32 v92, v92
    v_exp_f32 v93, v93
    v_cvt_pk_bf16_f32 v109, v86, v87
    v_exp_f32 v94, v94
    v_exp_f32 v95, v95
    v_cvt_pk_bf16_f32 v110, v92, v93
    v_cvt_pk_bf16_f32 v111, v94, v95
    v_max3_f32 v4, v64, v65, v66
    v_max3_f32 v5, v67, v68, v69
    v_max3_f32 v4, v4, v70, v71
    v_max3_f32 v5, v5, v72, v73
    v_max3_f32 v4, v4, v74, v75
    v_max3_f32 v5, v5, v76, v77
    v_max3_f32 v4, v4, v78, v79
    v_max_f32 v4, v4, v5
    v_cmp_lt_f32 vcc, 0x41000000, v4
    s_or_b64 s[32:33], vcc, s[28:29]
    s_cbranch_scc1 L_k2_attn_kernel_slow_23
L_k2_attn_kernel_slowret_24:
    s_cmp_eq_u32 s45, s84
    s_cbranch_scc1 L_k2_attn_kernel_rps_25
L_k2_attn_kernel_rpret_26:
    s_waitcnt lgkmcnt(0)
    v_mfma_f32_16x16x32_bf16 v[80:83], v[128:131], v[32:35], v[112:115]
    v_mfma_f32_16x16x32_bf16 v[84:87], v[128:131], v[36:39], v[116:119]
    s_setprio 2
    ds_read_b128 v[128:131], v232 offset:50176
    v_mfma_f32_16x16x32_bf16 v[88:91], v[132:135], v[32:35], v[112:115]
    v_mfma_f32_16x16x32_bf16 v[92:95], v[132:135], v[36:39], v[116:119]
    ds_read_b128 v[132:135], v232 offset:52224
    s_add_u32 s56, s55, 16777216
    s_add_u32 s87, s87, 1
    s_cmp_eq_u32 s87, s53
    s_cselect_b32 s40, s54, 0x4000
    v_mfma_f32_16x16x32_bf16 v[80:83], v[136:139], v[40:43], v[80:83]
    v_mfma_f32_16x16x32_bf16 v[84:87], v[136:139], v[44:47], v[84:87]
    ds_read_b128 v[136:139], v232 offset:54272
    v_mfma_f32_16x16x32_bf16 v[88:91], v[140:143], v[40:43], v[88:91]
    v_mfma_f32_16x16x32_bf16 v[92:95], v[140:143], v[44:47], v[92:95]
    ds_read_b128 v[140:143], v232 offset:56320
    s_add_u32 s55, s55, s40
    s_cmp_gt_u32 s87, 16
    s_cselect_b32 s55, 0x70000000, s55
    v_mfma_f32_16x16x32_bf16 v[80:83], v[144:147], v[48:51], v[80:83]
    v_mfma_f32_16x16x32_bf16 v[84:87], v[144:147], v[52:55], v[84:87]
    ds_read_b128 v[144:147], v232 offset:58368
    v_mfma_f32_16x16x32_bf16 v[88:91], v[148:151], v[48:51], v[88:91]
    v_mfma_f32_16x16x32_bf16 v[92:95], v[148:151], v[52:55], v[92:95]
    ds_read_b128 v[148:151], v232 offset:60416
    v_mfma_f32_16x16x32_bf16 v[80:83], v[152:155], v[56:59], v[80:83]
    v_mfma_f32_16x16x32_bf16 v[84:87], v[152:155], v[60:63], v[84:87]
    ds_read_b128 v[152:155], v232 offset:62464
    v_mfma_f32_16x16x32_bf16 v[88:91], v[156:159], v[56:59], v[88:91]
    v_mfma_f32_16x16x32_bf16 v[92:95], v[156:159], v[60:63], v[92:95]
    s_setprio 0
    ds_read_b128 v[156:159], v232 offset:64512
    v_exp_f32 v64, v64
    v_exp_f32 v65, v65
    v_exp_f32 v66, v66
    v_exp_f32 v67, v67
    v_cvt_pk_bf16_f32 v96, v64, v65
    v_exp_f32 v72, v72
    v_exp_f32 v73, v73
    v_cvt_pk_bf16_f32 v97, v66, v67
    v_exp_f32 v74, v74
    v_exp_f32 v75, v75
    v_cvt_pk_bf16_f32 v98, v72, v73
    v_exp_f32 v68, v68
    v_exp_f32 v69, v69
    v_cvt_pk_bf16_f32 v99, v74, v75
    v_exp_f32 v70, v70
    s_waitcnt lgkmcnt(0)
    v_mfma_f32_16x16x32_bf16 v[224:227], v[120:123], v[104:107], v[224:227]
    v_mfma_f32_16x16x32_bf16 v[228:231], v[120:123], v[108:111], v[228:231]
    s_setprio 2
    v_mfma_f32_16x16x32_bf16 v[160:163], v[128:131], v[104:107], v[160:163]
    v_mfma_f32_16x16x32_bf16 v[164:167], v[128:131], v[108:111], v[164:167]
    s_cmp_eq_u32 s41, s42
    s_cselect_b64 s[28:29], -1, s[30:31]
    v_mfma_f32_16x16x32_bf16 v[168:171], v[132:135], v[104:107], v[168:171]
    v_mfma_f32_16x16x32_bf16 v[172:175], v[132:135], v[108:111], v[172:175]
    s_add_u32 s45, s45, 1
    s_add_u32 s41, s41, 32
    v_mfma_f32_16x16x32_bf16 v[176:179], v[136:139], v[104:107], v[176:179]
    v_mfma_f32_16x16x32_bf16 v[180:183], v[136:139], v[108:111], v[180:183]
    v_mfma_f32_16x16x32_bf16 v[184:187], v[140:143], v[104:107], v[184:187]
    v_mfma_f32_16x16x32_bf16 v[188:191], v[140:143], v[108:111], v[188:191]
    v_mfma_f32_16x16x32_bf16 v[192:195], v[144:147], v[104:107], v[192:195]
    v_mfma_f32_16x16x32_bf16 v[196:199], v[144:147], v[108:111], v[196:199]
    v_mfma_f32_16x16x32_bf16 v[200:203], v[148:151], v[104:107], v[200:203]
    v_mfma_f32_16x16x32_bf16 v[204:207], v[148:151], v[108:111], v[204:207]
    v_mfma_f32_16x16x32_bf16 v[208:211], v[152:155], v[104:107], v[208:211]
    v_mfma_f32_16x16x32_bf16 v[212:215], v[152:155], v[108:111], v[212:215]
    v_mfma_f32_16x16x32_bf16 v[216:219], v[156:159], v[104:107], v[216:219]
    v_mfma_f32_16x16x32_bf16 v[220:223], v[156:159], v[108:111], v[220:223]
    s_setprio 0
    s_cmp_lg_u32 s85, 0
    s_cbranch_scc1 L_k2_attn_kernel_vwalt_27
    s_waitcnt vmcnt(0)
L_k2_attn_kernel_vwret_28:
    s_barrier
    ds_read_b128 v[128:131], v232 offset:16384
    ds_read_b128 v[132:135], v232 offset:20480
    ds_read_b128 v[136:139], v232 offset:17408
    ds_read_b128 v[140:143], v232 offset:21504
    ds_read_b128 v[144:147], v232 offset:18432
    ds_read_b128 v[148:151], v232 offset:22528
    ds_read_b128 v[152:155], v232 offset:19456
    ds_read_b128 v[156:159], v232 offset:23552
    v_exp_f32 v71, v71
    v_cvt_pk_bf16_f32 v100, v68, v69
    v_exp_f32 v76, v76
    v_exp_f32 v77, v77
    v_cvt_pk_bf16_f32 v101, v70, v71
    v_exp_f32 v78, v78
    v_exp_f32 v79, v79
    v_cvt_pk_bf16_f32 v102, v76, v77
    v_cvt_pk_bf16_f32 v103, v78, v79
    v_max3_f32 v4, v80, v81, v82
    v_max3_f32 v5, v83, v84, v85
    v_max3_f32 v4, v4, v86, v87
    v_max3_f32 v5, v5, v88, v89
    v_max3_f32 v4, v4, v90, v91
    v_max3_f32 v5, v5, v92, v93
    v_max3_f32 v4, v4, v94, v95
    v_max_f32 v4, v4, v5
    v_cmp_lt_f32 vcc, 0x41000000, v4
    s_or_b64 s[32:33], vcc, s[28:29]
    s_cbranch_scc1 L_k2_attn_kernel_slow_29
L_k2_attn_kernel_slowret_30:
    s_cmp_lt_u32 s45, 17
    s_cbranch_scc1 L_k2_attn_kernel_loop_14
    s_waitcnt lgkmcnt(0)
    ds_read_b128 v[128:131], v232 offset:32768
    ds_read_b128 v[132:135], v232 offset:34816
    ds_read_b128 v[136:139], v232 offset:36864
    ds_read_b128 v[140:143], v232 offset:38912
    ds_read_b128 v[144:147], v232 offset:40960
    ds_read_b128 v[148:151], v232 offset:43008
    ds_read_b128 v[152:155], v232 offset:45056
    ds_read_b128 v[156:159], v232 offset:47104
    v_exp_f32 v80, v80
    v_exp_f32 v81, v81
    v_exp_f32 v82, v82
    v_exp_f32 v83, v83
    v_cvt_pk_bf16_f32 v104, v80, v81
    v_exp_f32 v88, v88
    v_exp_f32 v89, v89
    v_cvt_pk_bf16_f32 v105, v82, v83
    v_exp_f32 v90, v90
    v_exp_f32 v91, v91
    v_cvt_pk_bf16_f32 v106, v88, v89
    v_exp_f32 v84, v84
    v_exp_f32 v85, v85
    v_cvt_pk_bf16_f32 v107, v90, v91
    v_exp_f32 v86, v86
    s_waitcnt lgkmcnt(0)
    v_mfma_f32_16x16x32_bf16 v[224:227], v[120:123], v[96:99], v[224:227]
    v_mfma_f32_16x16x32_bf16 v[228:231], v[120:123], v[100:103], v[228:231]
    s_setprio 2
    v_mfma_f32_16x16x32_bf16 v[160:163], v[128:131], v[96:99], v[160:163]
    v_mfma_f32_16x16x32_bf16 v[164:167], v[128:131], v[100:103], v[164:167]
    v_mfma_f32_16x16x32_bf16 v[168:171], v[132:135], v[96:99], v[168:171]
    v_mfma_f32_16x16x32_bf16 v[172:175], v[132:135], v[100:103], v[172:175]
    v_mfma_f32_16x16x32_bf16 v[176:179], v[136:139], v[96:99], v[176:179]
    v_mfma_f32_16x16x32_bf16 v[180:183], v[136:139], v[100:103], v[180:183]
    v_mfma_f32_16x16x32_bf16 v[184:187], v[140:143], v[96:99], v[184:187]
    v_mfma_f32_16x16x32_bf16 v[188:191], v[140:143], v[100:103], v[188:191]
    v_mfma_f32_16x16x32_bf16 v[192:195], v[144:147], v[96:99], v[192:195]
    v_mfma_f32_16x16x32_bf16 v[196:199], v[144:147], v[100:103], v[196:199]
    v_mfma_f32_16x16x32_bf16 v[200:203], v[148:151], v[96:99], v[200:203]
    v_mfma_f32_16x16x32_bf16 v[204:207], v[148:151], v[100:103], v[204:207]
    v_mfma_f32_16x16x32_bf16 v[208:211], v[152:155], v[96:99], v[208:211]
    v_mfma_f32_16x16x32_bf16 v[212:215], v[152:155], v[100:103], v[212:215]
    v_mfma_f32_16x16x32_bf16 v[216:219], v[156:159], v[96:99], v[216:219]
    v_mfma_f32_16x16x32_bf16 v[220:223], v[156:159], v[100:103], v[220:223]
    s_setprio 0
    v_exp_f32 v87, v87
    v_cvt_pk_bf16_f32 v108, v84, v85
    v_exp_f32 v92, v92
    v_exp_f32 v93, v93
    v_cvt_pk_bf16_f32 v109, v86, v87
    v_exp_f32 v94, v94
    v_exp_f32 v95, v95
    v_cvt_pk_bf16_f32 v110, v92, v93
    v_cvt_pk_bf16_f32 v111, v94, v95
    s_or_b64 s[32:33], s[30:31], s[30:31]
    s_cbranch_scc1 L_k2_attn_kernel_slow_31
L_k2_attn_kernel_slowret_32:
    ds_read_b128 v[128:131], v232 offset:33792
    ds_read_b128 v[132:135], v232 offset:35840
    ds_read_b128 v[136:139], v232 offset:37888
    ds_read_b128 v[140:143], v232 offset:39936
    ds_read_b128 v[144:147], v232 offset:41984
    ds_read_b128 v[148:151], v232 offset:44032
    ds_read_b128 v[152:155], v232 offset:46080
    ds_read_b128 v[156:159], v232 offset:48128
    s_waitcnt lgkmcnt(0)
    v_mfma_f32_16x16x32_bf16 v[224:227], v[120:123], v[104:107], v[224:227]
    v_mfma_f32_16x16x32_bf16 v[228:231], v[120:123], v[108:111], v[228:231]
    s_setprio 2
    v_mfma_f32_16x16x32_bf16 v[160:163], v[128:131], v[104:107], v[160:163]
    v_mfma_f32_16x16x32_bf16 v[164:167], v[128:131], v[108:111], v[164:167]
    v_mfma_f32_16x16x32_bf16 v[168:171], v[132:135], v[104:107], v[168:171]
    v_mfma_f32_16x16x32_bf16 v[172:175], v[132:135], v[108:111], v[172:175]
    v_mfma_f32_16x16x32_bf16 v[176:179], v[136:139], v[104:107], v[176:179]
    v_mfma_f32_16x16x32_bf16 v[180:183], v[136:139], v[108:111], v[180:183]
    v_mfma_f32_16x16x32_bf16 v[184:187], v[140:143], v[104:107], v[184:187]
    v_mfma_f32_16x16x32_bf16 v[188:191], v[140:143], v[108:111], v[188:191]
    v_mfma_f32_16x16x32_bf16 v[192:195], v[144:147], v[104:107], v[192:195]
    v_mfma_f32_16x16x32_bf16 v[196:199], v[144:147], v[108:111], v[196:199]
    v_mfma_f32_16x16x32_bf16 v[200:203], v[148:151], v[104:107], v[200:203]
    v_mfma_f32_16x16x32_bf16 v[204:207], v[148:151], v[108:111], v[204:207]
    v_mfma_f32_16x16x32_bf16 v[208:211], v[152:155], v[104:107], v[208:211]
    v_mfma_f32_16x16x32_bf16 v[212:215], v[152:155], v[108:111], v[212:215]
    v_mfma_f32_16x16x32_bf16 v[216:219], v[156:159], v[104:107], v[216:219]
    v_mfma_f32_16x16x32_bf16 v[220:223], v[156:159], v[108:111], v[220:223]
    s_setprio 0
    s_or_b64 s[32:33], s[30:31], s[30:31]
    s_cbranch_scc1 L_k2_attn_kernel_slow_33
L_k2_attn_kernel_slowret_34:
    s_branch L_k2_attn_kernel_grpjoin_7
L_k2_attn_kernel_grp1_6:
    s_waitcnt lgkmcnt(0)
    v_mfma_f32_16x16x32_bf16 v[64:67], v[128:131], v[32:35], v[112:115]
    v_mfma_f32_16x16x32_bf16 v[68:71], v[128:131], v[36:39], v[116:119]
    s_setprio 2
    v_mfma_f32_16x16x32_bf16 v[72:75], v[132:135], v[32:35], v[112:115]
    v_mfma_f32_16x16x32_bf16 v[76:79], v[132:135], v[36:39], v[116:119]
    v_mfma_f32_16x16x32_bf16 v[64:67], v[136:139], v[40:43], v[64:67]
    v_mfma_f32_16x16x32_bf16 v[68:71], v[136:139], v[44:47], v[68:71]
    v_mfma_f32_16x16x32_bf16 v[72:75], v[140:143], v[40:43], v[72:75]
    v_mfma_f32_16x16x32_bf16 v[76:79], v[140:143], v[44:47], v[76:79]
    v_mfma_f32_16x16x32_bf16 v[64:67], v[144:147], v[48:51], v[64:67]
    v_mfma_f32_16x16x32_bf16 v[68:71], v[144:147], v[52:55], v[68:71]
    v_mfma_f32_16x16x32_bf16 v[72:75], v[148:151], v[48:51], v[72:75]
    v_mfma_f32_16x16x32_bf16 v[76:79], v[148:151], v[52:55], v[76:79]
    v_mfma_f32_16x16x32_bf16 v[64:67], v[152:155], v[56:59], v[64:67]
    v_mfma_f32_16x16x32_bf16 v[68:71], v[152:155], v[60:63], v[68:71]
    v_mfma_f32_16x16x32_bf16 v[72:75], v[156:159], v[56:59], v[72:75]
    v_mfma_f32_16x16x32_bf16 v[76:79], v[156:159], v[60:63], v[76:79]
    s_setprio 0
    v_mov_b32 v160, 0
    v_mov_b32 v161, 0
    v_mov_b32 v162, 0
    v_mov_b32 v163, 0
    v_mov_b32 v164, 0
    v_mov_b32 v165, 0
    v_mov_b32 v166, 0
    v_mov_b32 v167, 0
    v_mov_b32 v168, 0
    v_mov_b32 v169, 0
    v_mov_b32 v170, 0
    v_mov_b32 v171, 0
    v_mov_b32 v172, 0
    v_mov_b32 v173, 0
    v_mov_b32 v174, 0
    v_mov_b32 v175, 0
    v_mov_b32 v176, 0
    v_mov_b32 v177, 0
    v_mov_b32 v178, 0
    v_mov_b32 v179, 0
    v_mov_b32 v180, 0
    v_mov_b32 v181, 0
    v_mov_b32 v182, 0
    v_mov_b32 v183, 0
    v_mov_b32 v184, 0
    v_mov_b32 v185, 0
    v_mov_b32 v186, 0
    v_mov_b32 v187, 0
    v_mov_b32 v188, 0
    v_mov_b32 v189, 0
    v_mov_b32 v190, 0
    v_mov_b32 v191, 0
    v_mov_b32 v192, 0
    v_mov_b32 v193, 0
    v_mov_b32 v194, 0
    v_mov_b32 v195, 0
    v_mov_b32 v196, 0
    v_mov_b32 v197, 0
    v_mov_b32 v198, 0
    v_mov_b32 v199, 0
    v_mov_b32 v200, 0
    v_mov_b32 v201, 0
    v_mov_b32 v202, 0
    v_mov_b32 v203, 0
    v_mov_b32 v204, 0
    v_mov_b32 v205, 0
    v_mov_b32 v206, 0
    v_mov_b32 v207, 0
    v_mov_b32 v208, 0
    v_mov_b32 v209, 0
    v_mov_b32 v210, 0
    v_mov_b32 v211, 0
    v_mov_b32 v212, 0
    v_mov_b32 v213, 0
    v_mov_b32 v214, 0
    v_mov_b32 v215, 0
    v_mov_b32 v216, 0
    v_mov_b32 v217, 0
    v_mov_b32 v218, 0
    v_mov_b32 v219, 0
    v_mov_b32 v220, 0
    v_mov_b32 v221, 0
    v_mov_b32 v222, 0
    v_mov_b32 v223, 0
    v_mov_b32 v224, 0
    v_mov_b32 v225, 0
    v_mov_b32 v226, 0
    v_mov_b32 v227, 0
    v_mov_b32 v228, 0
    v_mov_b32 v229, 0
    v_mov_b32 v230, 0
    v_mov_b32 v231, 0
    v_mov_b32 v120, 0x3f803f80
    v_mov_b32 v121, 0x3f803f80
    v_mov_b32 v122, 0x3f803f80
    v_mov_b32 v123, 0x3f803f80
    ds_read_b128 v[128:131], v232 offset:8192
    s_cmp_eq_u32 s41, s42
    s_cselect_b64 s[28:29], -1, s[30:31]
    ds_read_b128 v[132:135], v232 offset:12288
    s_add_u32 s41, s41, 32
    ds_read_b128 v[136:139], v232 offset:9216
    ds_read_b128 v[140:143], v232 offset:13312
    ds_read_b128 v[144:147], v232 offset:10240
    ds_read_b128 v[148:151], v232 offset:14336
    ds_read_b128 v[152:155], v232 offset:11264
    ds_read_b128 v[156:159], v232 offset:15360
    v_max3_f32 v4, v64, v65, v66
    v_max3_f32 v5, v67, v68, v69
    v_max3_f32 v4, v4, v70, v71
    v_max3_f32 v5, v5, v72, v73
    v_max3_f32 v4, v4, v74, v75
    v_max3_f32 v5, v5, v76, v77
    v_max3_f32 v4, v4, v78, v79
    v_max_f32 v4, v4, v5
    v_cmp_lt_f32 vcc, 0x41000000, v4
    s_or_b64 s[32:33], vcc, s[28:29]
    s_cbranch_scc1 L_k2_attn_kernel_slow_35
L_k2_attn_kernel_slowret_36:
    s_waitcnt lgkmcnt(0)
    v_mfma_f32_16x16x32_bf16 v[80:83], v[128:131], v[32:35], v[112:115]
    v_mfma_f32_16x16x32_bf16 v[84:87], v[128:131], v[36:39], v[116:119]
    s_setprio 2
    v_mfma_f32_16x16x32_bf16 v[88:91], v[132:135], v[32:35], v[112:115]
    v_mfma_f32_16x16x32_bf16 v[92:95], v[132:135], v[36:39], v[116:119]
    s_add_u32 s56, s55, 16777216
    s_add_u32 s87, s87, 1
    s_cmp_eq_u32 s87, s53
    s_cselect_b32 s40, s54, 0x4000
    v_mfma_f32_16x16x32_bf16 v[80:83], v[136:139], v[40:43], v[80:83]
    v_mfma_f32_16x16x32_bf16 v[84:87], v[136:139], v[44:47], v[84:87]
    v_mfma_f32_16x16x32_bf16 v[88:91], v[140:143], v[40:43], v[88:91]
    v_mfma_f32_16x16x32_bf16 v[92:95], v[140:143], v[44:47], v[92:95]
    s_add_u32 s55, s55, s40
    s_cmp_gt_u32 s87, 16
    s_cselect_b32 s55, 0x70000000, s55
    v_mfma_f32_16x16x32_bf16 v[80:83], v[144:147], v[48:51], v[80:83]
    v_mfma_f32_16x16x32_bf16 v[84:87], v[144:147], v[52:55], v[84:87]
    v_mfma_f32_16x16x32_bf16 v[88:91], v[148:151], v[48:51], v[88:91]
    v_mfma_f32_16x16x32_bf16 v[92:95], v[148:151], v[52:55], v[92:95]
    v_mfma_f32_16x16x32_bf16 v[80:83], v[152:155], v[56:59], v[80:83]
    v_mfma_f32_16x16x32_bf16 v[84:87], v[152:155], v[60:63], v[84:87]
    v_mfma_f32_16x16x32_bf16 v[88:91], v[156:159], v[56:59], v[88:91]
    v_mfma_f32_16x16x32_bf16 v[92:95], v[156:159], v[60:63], v[92:95]
    s_setprio 0
    v_exp_f32 v64, v64
    v_exp_f32 v65, v65
    v_exp_f32 v66, v66
    v_exp_f32 v67, v67
    v_cvt_pk_bf16_f32 v96, v64, v65
    v_exp_f32 v72, v72
    v_exp_f32 v73, v73
    v_cvt_pk_bf16_f32 v97, v66, v67
    v_exp_f32 v74, v74
    v_exp_f32 v75, v75
    v_cvt_pk_bf16_f32 v98, v72, v73
    v_exp_f32 v68, v68
    v_exp_f32 v69, v69
    v_cvt_pk_bf16_f32 v99, v74, v75
    v_exp_f32 v70, v70
    s_cmp_lg_u32 s85, 0
    s_cbranch_scc1 L_k2_attn_kernel_vwalt_37
    s_waitcnt vmcnt(0)
L_k2_attn_kernel_vwret_38:
    s_waitcnt lgkmcnt(0)
    s_barrier
    ds_read_b128 v[128:131], v232 offset:16384
    s_add_u32 m0, s48, 0
    s_nop 0
    buffer_load_dwordx4 v2, s[16:19], s55 offen offset:0 lds
    ds_read_b128 v[132:135], v232 offset:20480
    buffer_load_dwordx4 v2, s[16:19], s55 offen offset:1024 lds
    ds_read_b128 v[136:139], v232 offset:17408
    buffer_load_dwordx4 v2, s[16:19], s55 offen offset:2048 lds
    ds_read_b128 v[140:143], v232 offset:21504
    buffer_load_dwordx4 v2, s[16:19], s55 offen offset:3072 lds
    ds_read_b128 v[144:147], v232 offset:18432
    s_cmp_eq_u32 s41, s42
    s_cselect_b64 s[28:29], -1, s[30:31]
    ds_read_b128 v[148:151], v232 offset:22528
    s_add_u32 s45, s45, 1
    s_cmp_eq_u32 s45, s53
    s_cselect_b64 s[28:29], -1, s[28:29]
    s_add_u32 s41, s41, 32
    ds_read_b128 v[152:155], v232 offset:19456
    ds_read_b128 v[156:159], v232 offset:23552
    v_exp_f32 v71, v71
    v_cvt_pk_bf16_f32 v100, v68, v69
    v_exp_f32 v76, v76
    v_exp_f32 v77, v77
    v_cvt_pk_bf16_f32 v101, v70, v71
    v_exp_f32 v78, v78
    v_exp_f32 v79, v79
    v_cvt_pk_bf16_f32 v102, v76, v77
    v_cvt_pk_bf16_f32 v103, v78, v79
    v_max3_f32 v4, v80, v81, v82
    v_max3_f32 v5, v83, v84, v85
    v_max3_f32 v4, v4, v86, v87
    v_max3_f32 v5, v5, v88, v89
    v_max3_f32 v4, v4, v90, v91
    v_max3_f32 v5, v5, v92, v93
    v_max3_f32 v4, v4, v94, v95
    v_max_f32 v4, v4, v5
    v_cmp_lt_f32 vcc, 0x41000000, v4
    s_or_b64 s[32:33], vcc, s[28:29]
    s_cbranch_scc1 L_k2_attn_kernel_slow_39
L_k2_attn_kernel_slowret_40:
L_k2_attn_kernel_loop_41:
    s_waitcnt lgkmcnt(0)
    v_mfma_f32_16x16x32_bf16 v[64:67], v[128:131], v[32:35], v[112:115]
    v_mfma_f32_16x16x32_bf16 v[68:71], v[128:131], v[36:39], v[116:119]
    s_setprio 2
    ds_read_b128 v[128:131], v232 offset:32768
    v_mfma_f32_16x16x32_bf16 v[72:75], v[132:135], v[32:35], v[112:115]
    v_mfma_f32_16x16x32_bf16 v[76:79], v[132:135], v[36:39], v[116:119]
    ds_read_b128 v[132:135], v232 offset:34816
    s_add_u32 m0, s48, 49152
    s_nop 0
    buffer_load_dwordx4 v2, s[16:19], s56 offen offset:0 lds
    v_mfma_f32_16x16x32_bf16 v[64:67], v[136:139], v[40:43], v[64:67]
    v_mfma_f32_16x16x32_bf16 v[68:71], v[136:139], v[44:47], v[68:71]
    ds_read_b128 v[136:139], v232 offset:36864
    v_mfma_f32_16x16x32_bf16 v[72:75], v[140:143], v[40:43], v[72:75]
    v_mfma_f32_16x16x32_bf16 v[76:79], v[140:143], v[44:47], v[76:79]
    ds_read_b128 v[140:143], v232 offset:38912
    buffer_load_dwordx4 v2, s[16:19], s56 offen offset:1024 lds
    v_mfma_f32_16x16x32_bf16 v[64:67], v[144:147], v[48:51], v[64:67]
    v_mfma_f32_16x16x32_bf16 v[68:71], v[144:147], v[52:55], v[68:71]
    ds_read_b128 v[144:147], v232 offset:40960
    v_mfma_f32_16x16x32_bf16 v[72:75], v[148:151], v[48:51], v[72:75]
    v_mfma_f32_16x16x32_bf16 v[76:79], v[148:151], v[52:55], v[76:79]
    ds_read_b128 v[148:151], v232 offset:43008
    buffer_load_dwordx4 v2, s[16:19], s56 offen offset:2048 lds
    v_mfma_f32_16x16x32_bf16 v[64:67], v[152:155], v[56:59], v[64:67]
    v_mfma_f32_16x16x32_bf16 v[68:71], v[152:155], v[60:63], v[68:71]
    ds_read_b128 v[152:155], v232 offset:45056
    v_mfma_f32_16x16x32_bf16 v[72:75], v[156:159], v[56:59], v[72:75]
    v_mfma_f32_16x16x32_bf16 v[76:79], v[156:159], v[60:63], v[76:79]
    s_setprio 0
    ds_read_b128 v[156:159], v232 offset:47104
    buffer_load_dwordx4 v2, s[16:19], s56 offen offset:3072 lds
    v_exp_f32 v80, v80
    v_exp_f32 v81, v81
    v_exp_f32 v82, v82
    v_exp_f32 v83, v83
    v_cvt_pk_bf16_f32 v104, v80, v81
    v_exp_f32 v88, v88
    v_exp_f32 v89, v89
    v_cvt_pk_bf16_f32 v105, v82, v83
    v_exp_f32 v90, v90
    v_exp_f32 v91, v91
    v_cvt_pk_bf16_f32 v106, v88, v89
    v_exp_f32 v84, v84
    v_exp_f32 v85, v85
    v_cvt_pk_bf16_f32 v107, v90, v91
    v_exp_f32 v86, v86
    s_waitcnt lgkmcnt(0)
    v_mfma_f32_16x16x32_bf16 v[224:227], v[120:123], v[96:99], v[224:227]
    v_mfma_f32_16x16x32_bf16 v[228:231], v[120:123], v[100:103], v[228:231]
    s_setprio 2
    v_mfma_f32_16x16x32_bf16 v[160:163], v[128:131], v[96:99], v[160:163]
    v_mfma_f32_16x16x32_bf16 v[164:167], v[128:131], v[100:103], v[164:167]
    ds_read_b128 v[128:131], v232 offset:24576
    s_cmp_eq_u32 s41, s42
    s_cselect_b64 s[28:29], -1, s[30:31]
    v_mfma_f32_16x16x32_bf16 v[168:171], v[132:135], v[96:99], v[168:171]
    v_mfma_f32_16x16x32_bf16 v[172:175], v[132:135], v[100:103], v[172:175]
    ds_read_b128 v[132:135], v232 offset:28672
    s_add_u32 s41, s41, 32
    v_mfma_f32_16x16x32_bf16 v[176:179], v[136:139], v[96:99], v[176:179]
    v_mfma_f32_16x16x32_bf16 v[180:183], v[136:139], v[100:103], v[180:183]
    ds_read_b128 v[136:139], v232 offset:25600
    v_mfma_f32_16x16x32_bf16 v[184:187], v[140:143], v[96:99], v[184:187]
    v_mfma_f32_16x16x32_bf16 v[188:191], v[140:143], v[100:103], v[188:191]
    ds_read_b128 v[140:143], v232 offset:29696
    v_mfma_f32_16x16x32_bf16 v[192:195], v[144:147], v[96:99], v[192:195]
    v_mfma_f32_16x16x32_bf16 v[196:199], v[144:147], v[100:103], v[196:199]
    ds_read_b128 v[144:147], v232 offset:26624
    v_mfma_f32_16x16x32_bf16 v[200:203], v[148:151], v[96:99], v[200:203]
    v_mfma_f32_16x16x32_bf16 v[204:207], v[148:151], v[100:103], v[204:207]
    ds_read_b128 v[148:151], v232 offset:30720
    v_mfma_f32_16x16x32_bf16 v[208:211], v[152:155], v[96:99], v[208:211]
    v_mfma_f32_16x16x32_bf16 v[212:215], v[152:155], v[100:103], v[212:215]
    ds_read_b128 v[152:155], v232 offset:27648
    v_mfma_f32_16x16x32_bf16 v[216:219], v[156:159], v[96:99], v[216:219]
    v_mfma_f32_16x16x32_bf16 v[220:223], v[156:159], v[100:103], v[220:223]
    s_setprio 0
    ds_read_b128 v[156:159], v232 offset:31744
    v_exp_f32 v87, v87
    v_cvt_pk_bf16_f32 v108, v84, v85
    v_exp_f32 v92, v92
    v_exp_f32 v93, v93
    v_cvt_pk_bf16_f32 v109, v86, v87
    v_exp_f32 v94, v94
    v_exp_f32 v95, v95
    v_cvt_pk_bf16_f32 v110, v92, v93
    v_cvt_pk_bf16_f32 v111, v94, v95
    v_max3_f32 v4, v64, v65, v66
    v_max3_f32 v5, v67, v68, v69
    v_max3_f32 v4, v4, v70, v71
    v_max3_f32 v5, v5, v72, v73
    v_max3_f32 v4, v4, v74, v75
    v_max3_f32 v5, v5, v76, v77
    v_max3_f32 v4, v4, v78, v79
    v_max_f32 v4, v4, v5
    v_cmp_lt_f32 vcc, 0x41000000, v4
    s_or_b64 s[32:33], vcc, s[28:29]
    s_cbranch_scc1 L_k2_attn_kernel_slow_42
L_k2_attn_kernel_slowret_43:
    s_cmp_eq_u32 s45, s84
    s_cbranch_scc1 L_k2_attn_kernel_rps_44
L_k2_attn_kernel_rpret_45:
    s_waitcnt lgkmcnt(0)
    v_mfma_f32_16x16x32_bf16 v[80:83], v[128:131], v[32:35], v[112:115]
    v_mfma_f32_16x16x32_bf16 v[84:87], v[128:131], v[36:39], v[116:119]
    s_setprio 2
    ds_read_b128 v[128:131], v232 offset:33792
    v_mfma_f32_16x16x32_bf16 v[88:91], v[132:135], v[32:35], v[112:115]
    v_mfma_f32_16x16x32_bf16 v[92:95], v[132:135], v[36:39], v[116:119]
    ds_read_b128 v[132:135], v232 offset:35840
    s_add_u32 s56, s55, 16777216
    s_add_u32 s87, s87, 1
    s_cmp_eq_u32 s87, s53
    s_cselect_b32 s40, s54, 0x4000
    v_mfma_f32_16x16x32_bf16 v[80:83], v[136:139], v[40:43], v[80:83]
    v_mfma_f32_16x16x32_bf16 v[84:87], v[136:139], v[44:47], v[84:87]
    ds_read_b128 v[136:139], v232 offset:37888
    v_mfma_f32_16x16x32_bf16 v[88:91], v[140:143], v[40:43], v[88:91]
    v_mfma_f32_16x16x32_bf16 v[92:95], v[140:143], v[44:47], v[92:95]
    ds_read_b128 v[140:143], v232 offset:39936
    s_add_u32 s55, s55, s40
    s_cmp_gt_u32 s87, 16
    s_cselect_b32 s55, 0x70000000, s55
    v_mfma_f32_16x16x32_bf16 v[80:83], v[144:147], v[48:51], v[80:83]
    v_mfma_f32_16x16x32_bf16 v[84:87], v[144:147], v[52:55], v[84:87]
    ds_read_b128 v[144:147], v232 offset:41984
    v_mfma_f32_16x16x32_bf16 v[88:91], v[148:151], v[48:51], v[88:91]
    v_mfma_f32_16x16x32_bf16 v[92:95], v[148:151], v[52:55], v[92:95]
    ds_read_b128 v[148:151], v232 offset:44032
    v_mfma_f32_16x16x32_bf16 v[80:83], v[152:155], v[56:59], v[80:83]
    v_mfma_f32_16x16x32_bf16 v[84:87], v[152:155], v[60:63], v[84:87]
    ds_read_b128 v[152:155], v232 offset:46080
    v_mfma_f32_16x16x32_bf16 v[88:91], v[156:159], v[56:59], v[88:91]
    v_mfma_f32_16x16x32_bf16 v[92:95], v[156:159], v[60:63], v[92:95]
    s_setprio 0
    ds_read_b128 v[156:159], v232 offset:48128
    v_exp_f32 v64, v64
    v_exp_f32 v65, v65
    v_exp_f32 v66, v66
    v_exp_f32 v67, v67
    v_cvt_pk_bf16_f32 v96, v64, v65
    v_exp_f32 v72, v72
    v_exp_f32 v73, v73
    v_cvt_pk_bf16_f32 v97, v66, v67
    v_exp_f32 v74, v74
    v_exp_f32 v75, v75
    v_cvt_pk_bf16_f32 v98, v72, v73
    v_exp_f32 v68, v68
    v_exp_f32 v69, v69
    v_cvt_pk_bf16_f32 v99, v74, v75
    v_exp_f32 v70, v70
    s_cmp_lg_u32 s85, 0
    s_cbranch_scc1 L_k2_attn_kernel_vwalt_46
    s_waitcnt vmcnt(0)
L_k2_attn_kernel_vwret_47:
    s_waitcnt lgkmcnt(0)
    s_barrier
    v_mfma_f32_16x16x32_bf16 v[224:227], v[120:123], v[104:107], v[224:227]
    v_mfma_f32_16x16x32_bf16 v[228:231], v[120:123], v[108:111], v[228:231]
    s_setprio 2
    v_mfma_f32_16x16x32_bf16 v[160:163], v[128:131], v[104:107], v[160:163]
    v_mfma_f32_16x16x32_bf16 v[164:167], v[128:131], v[108:111], v[164:167]
    ds_read_b128 v[128:131], v232 offset:0
    s_add_u32 m0, s48, 16384
    s_nop 0
    buffer_load_dwordx4 v2, s[16:19], s55 offen offset:0 lds
    v_mfma_f32_16x16x32_bf16 v[168:171], v[132:135], v[104:107], v[168:171]
    v_mfma_f32_16x16x32_bf16 v[172:175], v[132:135], v[108:111], v[172:175]
    ds_read_b128 v[132:135], v232 offset:4096
    buffer_load_dwordx4 v2, s[16:19], s55 offen offset:1024 lds
    v_mfma_f32_16x16x32_bf16 v[176:179], v[136:139], v[104:107], v[176:179]
    v_mfma_f32_16x16x32_bf16 v[180:183], v[136:139], v[108:111], v[180:183]
    ds_read_b128 v[136:139], v232 offset:1024
    buffer_load_dwordx4 v2, s[16:19], s55 offen offset:2048 lds
    v_mfma_f32_16x16x32_bf16 v[184:187], v[140:143], v[104:107], v[184:187]
    v_mfma_f32_16x16x32_bf16 v[188:191], v[140:143], v[108:111], v[188:191]
    ds_read_b128 v[140:143], v232 offset:5120
    buffer_load_dwordx4 v2, s[16:19], s55 offen offset:3072 lds
    v_mfma_f32_16x16x32_bf16 v[192:195], v[144:147], v[104:107], v[192:195]
    v_mfma_f32_16x16x32_bf16 v[196:199], v[144:147], v[108:111], v[196:199]
    ds_read_b128 v[144:147], v232 offset:2048
    s_cmp_eq_u32 s41, s42
    s_cselect_b64 s[28:29], -1, s[30:31]
    v_mfma_f32_16x16x32_bf16 v[200:203], v[148:151], v[104:107], v[200:203]
    v_mfma_f32_16x16x32_bf16 v[204:207], v[148:151], v[108:111], v[204:207]
    ds_read_b128 v[148:151], v232 offset:6144
    s_add_u32 s45, s45, 1
    s_cmp_eq_u32 s45, s53
    s_cselect_b64 s[28:29], -1, s[28:29]
    s_add_u32 s41, s41, 32
    v_mfma_f32_16x16x32_bf16 v[208:211], v[152:155], v[104:107], v[208:211]
    v_mfma_f32_16x16x32_bf16 v[212:215], v[152:155], v[108:111], v[212:215]
    ds_read_b128 v[152:155], v232 offset:3072
    v_mfma_f32_16x16x32_bf16 v[216:219], v[156:159], v[104:107], v[216:219]
    v_mfma_f32_16x16x32_bf16 v[220:223], v[156:159], v[108:111], v[220:223]
    s_setprio 0
    ds_read_b128 v[156:159], v232 offset:7168
    v_exp_f32 v71, v71
    v_cvt_pk_bf16_f32 v100, v68, v69
    v_exp_f32 v76, v76
    v_exp_f32 v77, v77
    v_cvt_pk_bf16_f32 v101, v70, v71
    v_exp_f32 v78, v78
    v_exp_f32 v79, v79
    v_cvt_pk_bf16_f32 v102, v76, v77
    v_cvt_pk_bf16_f32 v103, v78, v79
    v_max3_f32 v4, v80, v81, v82
    v_max3_f32 v5, v83, v84, v85
    v_max3_f32 v4, v4, v86, v87
    v_max3_f32 v5, v5, v88, v89
    v_max3_f32 v4, v4, v90, v91
    v_max3_f32 v5, v5, v92, v93
    v_max3_f32 v4, v4, v94, v95
    v_max_f32 v4, v4, v5
    v_cmp_lt_f32 vcc, 0x41000000, v4
    s_or_b64 s[32:33], vcc, s[28:29]
    s_cbranch_scc1 L_k2_attn_kernel_slow_48
L_k2_attn_kernel_slowret_49:
    s_waitcnt lgkmcnt(0)
    v_mfma_f32_16x16x32_bf16 v[64:67], v[128:131], v[32:35], v[112:115]
    v_mfma_f32_16x16x32_bf16 v[68:71], v[128:131], v[36:39], v[116:119]
    s_setprio 2
    ds_read_b128 v[128:131], v232 offset:49152
    v_mfma_f32_16x16x32_bf16 v[72:75], v[132:135], v[32:35], v[112:115]
    v_mfma_f32_16x16x32_bf16 v[76:79], v[132:135], v[36:39], v[116:119]
    ds_read_b128 v[132:135], v232 offset:51200
    s_add_u32 m0, s48, 32768
    s_nop 0
    buffer_load_dwordx4 v2, s[16:19], s56 offen offset:0 lds
    v_mfma_f32_16x16x32_bf16 v[64:67], v[136:139], v[40:43], v[64:67]
    v_mfma_f32_16x16x32_bf16 v[68:71], v[136:139], v[44:47], v[68:71]
    ds_read_b128 v[136:139], v232 offset:53248
    v_mfma_f32_16x16x32_bf16 v[72:75], v[140:143], v[40:43], v[72:75]
    v_mfma_f32_16x16x32_bf16 v[76:79], v[140:143], v[44:47], v[76:79]
    ds_read_b128 v[140:143], v232 offset:55296
    buffer_load_dwordx4 v2, s[16:19], s56 offen offset:1024 lds
    v_mfma_f32_16x16x32_bf16 v[64:67], v[144:147], v[48:51], v[64:67]
    v_mfma_f32_16x16x32_bf16 v[68:71], v[144:147], v[52:55], v[68:71]
    ds_read_b128 v[144:147], v232 offset:57344
    v_mfma_f32_16x16x32_bf16 v[72:75], v[148:151], v[48:51], v[72:75]
    v_mfma_f32_16x16x32_bf16 v[76:79], v[148:151], v[52:55], v[76:79]
    ds_read_b128 v[148:151], v232 offset:59392
    buffer_load_dwordx4 v2, s[16:19], s56 offen offset:2048 lds
    v_mfma_f32_16x16x32_bf16 v[64:67], v[152:155], v[56:59], v[64:67]
    v_mfma_f32_16x16x32_bf16 v[68:71], v[152:155], v[60:63], v[68:71]
    ds_read_b128 v[152:155], v232 offset:61440
    v_mfma_f32_16x16x32_bf16 v[72:75], v[156:159], v[56:59], v[72:75]
    v_mfma_f32_16x16x32_bf16 v[76:79], v[156:159], v[60:63], v[76:79]
    s_setprio 0
    ds_read_b128 v[156:159], v232 offset:63488
    buffer_load_dwordx4 v2, s[16:19], s56 offen offset:3072 lds
    v_exp_f32 v80, v80
    v_exp_f32 v81, v81
    v_exp_f32 v82, v82
    v_exp_f32 v83, v83
    v_cvt_pk_bf16_f32 v104, v80, v81
    v_exp_f32 v88, v88
    v_exp_f32 v89, v89
    v_cvt_pk_bf16_f32 v105, v82, v83
    v_exp_f32 v90, v90
    v_exp_f32 v91, v91
    v_cvt_pk_bf16_f32 v106, v88, v89
    v_exp_f32 v84, v84
    v_exp_f32 v85, v85
    v_cvt_pk_bf16_f32 v107, v90, v91
    v_exp_f32 v86, v86
    s_waitcnt lgkmcnt(0)
    v_mfma_f32_16x16x32_bf16 v[224:227], v[120:123], v[96:99], v[224:227]
    v_mfma_f32_16x16x32_bf16 v[228:231], v[120:123], v[100:103], v[228:231]
    s_setprio 2
    v_mfma_f32_16x16x32_bf16 v[160:163], v[128:131], v[96:99], v[160:163]
    v_mfma_f32_16x16x32_bf16 v[164:167], v[128:131], v[100:103], v[164:167]
    ds_read_b128 v[128:131], v232 offset:8192
    s_cmp_eq_u32 s41, s42
    s_cselect_b64 s[28:29], -1, s[30:31]
    v_mfma_f32_16x16x32_bf16 v[168:171], v[132:135], v[96:99], v[168:171]
    v_mfma_f32_16x16x32_bf16 v[172:175], v[132:135], v[100:103], v[172:175]
    ds_read_b128 v[132:135], v232 offset:12288
    s_add_u32 s41, s41, 32
    v_mfma_f32_16x16x32_bf16 v[176:179], v[136:139], v[96:99], v[176:179]
    v_mfma_f32_16x16x32_bf16 v[180:183], v[136:139], v[100:103], v[180:183]
    ds_read_b128 v[136:139], v232 offset:9216
    v_mfma_f32_16x16x32_bf16 v[184:187], v[140:143], v[96:99], v[184:187]
    v_mfma_f32_16x16x32_bf16 v[188:191], v[140:143], v[100:103], v[188:191]
    ds_read_b128 v[140:143], v232 offset:13312
    v_mfma_f32_16x16x32_bf16 v[192:195], v[144:147], v[96:99], v[192:195]
    v_mfma_f32_16x16x32_bf16 v[196:199], v[144:147], v[100:103], v[196:199]
    ds_read_b128 v[144:147], v232 offset:10240
    v_mfma_f32_16x16x32_bf16 v[200:203], v[148:151], v[96:99], v[200:203]
    v_mfma_f32_16x16x32_bf16 v[204:207], v[148:151], v[100:103], v[204:207]
    ds_read_b128 v[148:151], v232 offset:14336
    v_mfma_f32_16x16x32_bf16 v[208:211], v[152:155], v[96:99], v[208:211]
    v_mfma_f32_16x16x32_bf16 v[212:215], v[152:155], v[100:103], v[212:215]
    ds_read_b128 v[152:155], v232 offset:11264
    v_mfma_f32_16x16x32_bf16 v[216:219], v[156:159], v[96:99], v[216:219]
    v_mfma_f32_16x16x32_bf16 v[220:223], v[156:159], v[100:103], v[220:223]
    s_setprio 0
    ds_read_b128 v[156:159], v232 offset:15360
    v_exp_f32 v87, v87
    v_cvt_pk_bf16_f32 v108, v84, v85
    v_exp_f32 v92, v92
    v_exp_f32 v93, v93
    v_cvt_pk_bf16_f32 v109, v86, v87
    v_exp_f32 v94, v94
    v_exp_f32 v95, v95
    v_cvt_pk_bf16_f32 v110, v92, v93
    v_cvt_pk_bf16_f32 v111, v94, v95
    v_max3_f32 v4, v64, v65, v66
    v_max3_f32 v5, v67, v68, v69
    v_max3_f32 v4, v4, v70, v71
    v_max3_f32 v5, v5, v72, v73
    v_max3_f32 v4, v4, v74, v75
    v_max3_f32 v5, v5, v76, v77
    v_max3_f32 v4, v4, v78, v79
    v_max_f32 v4, v4, v5
    v_cmp_lt_f32 vcc, 0x41000000, v4
    s_or_b64 s[32:33], vcc, s[28:29]
    s_cbranch_scc1 L_k2_attn_kernel_slow_50
L_k2_attn_kernel_slowret_51:
    s_cmp_eq_u32 s45, s84
    s_cbranch_scc1 L_k2_attn_kernel_rps_52
L_k2_attn_kernel_rpret_53:
    s_waitcnt lgkmcnt(0)
    v_mfma_f32_16x16x32_bf16 v[80:83], v[128:131], v[32:35], v[112:115]
    v_mfma_f32_16x16x32_bf16 v[84:87], v[128:131], v[36:39], v[116:119]
    s_setprio 2
    ds_read_b128 v[128:131], v232 offset:50176
    v_mfma_f32_16x16x32_bf16 v[88:91], v[132:135], v[32:35], v[112:115]
    v_mfma_f32_16x16x32_bf16 v[92:95], v[132:135], v[36:39], v[116:119]
    ds_read_b128 v[132:135], v232 offset:52224
    s_add_u32 s56, s55, 16777216
    s_add_u32 s87, s87, 1
    s_cmp_eq_u32 s87, s53
    s_cselect_b32 s40, s54, 0x4000
    v_mfma_f32_16x16x32_bf16 v[80:83], v[136:139], v[40:43], v[80:83]
    v_mfma_f32_16x16x32_bf16 v[84:87], v[136:139], v[44:47], v[84:87]
    ds_read_b128 v[136:139], v232 offset:54272
    v_mfma_f32_16x16x32_bf16 v[88:91], v[140:143], v[40:43], v[88:91]
    v_mfma_f32_16x16x32_bf16 v[92:95], v[140:143], v[44:47], v[92:95]
    ds_read_b128 v[140:143], v232 offset:56320
    s_add_u32 s55, s55, s40
    s_cmp_gt_u32 s87, 16
    s_cselect_b32 s55, 0x70000000, s55
    v_mfma_f32_16x16x32_bf16 v[80:83], v[144:147], v[48:51], v[80:83]
    v_mfma_f32_16x16x32_bf16 v[84:87], v[144:147], v[52:55], v[84:87]
    ds_read_b128 v[144:147], v232 offset:58368
    v_mfma_f32_16x16x32_bf16 v[88:91], v[148:151], v[48:51], v[88:91]
    v_mfma_f32_16x16x32_bf16 v[92:95], v[148:151], v[52:55], v[92:95]
    ds_read_b128 v[148:151], v232 offset:60416
    v_mfma_f32_16x16x32_bf16 v[80:83], v[152:155], v[56:59], v[80:83]
    v_mfma_f32_16x16x32_bf16 v[84:87], v[152:155], v[60:63], v[84:87]
    ds_read_b128 v[152:155], v232 offset:62464
    v_mfma_f32_16x16x32_bf16 v[88:91], v[156:159], v[56:59], v[88:91]
    v_mfma_f32_16x16x32_bf16 v[92:95], v[156:159], v[60:63], v[92:95]
    s_setprio 0
    ds_read_b128 v[156:159], v232 offset:64512
    v_exp_f32 v64, v64
    v_exp_f32 v65, v65
    v_exp_f32 v66, v66
    v_exp_f32 v67, v67
    v_cvt_pk_bf16_f32 v96, v64, v65
    v_exp_f32 v72, v72
    v_exp_f32 v73, v73
    v_cvt_pk_bf16_f32 v97, v66, v67
    v_exp_f32 v74, v74
    v_exp_f32 v75, v75
    v_cvt_pk_bf16_f32 v98, v72, v73
    v_exp_f32 v68, v68
    v_exp_f32 v69, v69
    v_cvt_pk_bf16_f32 v99, v74, v75
    v_exp_f32 v70, v70
    s_cmp_lg_u32 s85, 0
    s_cbranch_scc1 L_k2_attn_kernel_vwalt_54
    s_waitcnt vmcnt(0)
L_k2_attn_kernel_vwret_55:
    s_waitcnt lgkmcnt(0)
    s_barrier
    v_mfma_f32_16x16x32_bf16 v[224:227], v[120:123], v[104:107], v[224:227]
    v_mfma_f32_16x16x32_bf16 v[228:231], v[120:123], v[108:111], v[228:231]
    s_setprio 2
    v_mfma_f32_16x16x32_bf16 v[160:163], v[128:131], v[104:107], v[160:163]
    v_mfma_f32_16x16x32_bf16 v[164:167], v[128:131], v[108:111], v[164:167]
    ds_read_b128 v[128:131], v232 offset:16384
    s_add_u32 m0, s48, 0
    s_nop 0
    buffer_load_dwordx4 v2, s[16:19], s55 offen offset:0 lds
    v_mfma_f32_16x16x32_bf16 v[168:171], v[132:135], v[104:107], v[168:171]
    v_mfma_f32_16x16x32_bf16 v[172:175], v[132:135], v[108:111], v[172:175]
    ds_read_b128 v[132:135], v232 offset:20480
    buffer_load_dwordx4 v2, s[16:19], s55 offen offset:1024 lds
    v_mfma_f32_16x16x32_bf16 v[176:179], v[136:139], v[104:107], v[176:179]
    v_mfma_f32_16x16x32_bf16 v[180:183], v[136:139], v[108:111], v[180:183]
    ds_read_b128 v[136:139], v232 offset:17408
    buffer_load_dwordx4 v2, s[16:19], s55 offen offset:2048 lds
    v_mfma_f32_16x16x32_bf16 v[184:187], v[140:143], v[104:107], v[184:187]
    v_mfma_f32_16x16x32_bf16 v[188:191], v[140:143], v[108:111], v[188:191]
    ds_read_b128 v[140:143], v232 offset:21504
    buffer_load_dwordx4 v2, s[16:19], s55 offen offset:3072 lds
    v_mfma_f32_16x16x32_bf16 v[192:195], v[144:147], v[104:107], v[192:195]
    v_mfma_f32_16x16x32_bf16 v[196:199], v[144:147], v[108:111], v[196:199]
    ds_read_b128 v[144:147], v232 offset:18432
    s_cmp_eq_u32 s41, s42
    s_cselect_b64 s[28:29], -1, s[30:31]
    v_mfma_f32_16x16x32_bf16 v[200:203], v[148:151], v[104:107], v[200:203]
    v_mfma_f32_16x16x32_bf16 v[204:207], v[148:151], v[108:111], v[204:207]
    ds_read_b128 v[148:151], v232 offset:22528
    s_add_u32 s45, s45, 1
    s_cmp_eq_u32 s45, s53
    s_cselect_b64 s[28:29], -1, s[28:29]
    s_add_u32 s41, s41, 32
    v_mfma_f32_16x16x32_bf16 v[208:211], v[152:155], v[104:107], v[208:211]
    v_mfma_f32_16x16x32_bf16 v[212:215], v[152:155], v[108:111], v[212:215]
    ds_read_b128 v[152:155], v232 offset:19456
    v_mfma_f32_16x16x32_bf16 v[216:219], v[156:159], v[104:107], v[216:219]
    v_mfma_f32_16x16x32_bf16 v[220:223], v[156:159], v[108:111], v[220:223]
    s_setprio 0
    ds_read_b128 v[156:159], v232 offset:23552
    v_exp_f32 v71, v71
    v_cvt_pk_bf16_f32 v100, v68, v69
    v_exp_f32 v76, v76
    v_exp_f32 v77, v77
    v_cvt_pk_bf16_f32 v101, v70, v71
    v_exp_f32 v78, v78
    v_exp_f32 v79, v79
    v_cvt_pk_bf16_f32 v102, v76, v77
    v_cvt_pk_bf16_f32 v103, v78, v79
    v_max3_f32 v4, v80, v81, v82
    v_max3_f32 v5, v83, v84, v85
    v_max3_f32 v4, v4, v86, v87
    v_max3_f32 v5, v5, v88, v89
    v_max3_f32 v4, v4, v90, v91
    v_max3_f32 v5, v5, v92, v93
    v_max3_f32 v4, v4, v94, v95
    v_max_f32 v4, v4, v5
    v_cmp_lt_f32 vcc, 0x41000000, v4
    s_or_b64 s[32:33], vcc, s[28:29]
    s_cbranch_scc1 L_k2_attn_kernel_slow_56
L_k2_attn_kernel_slowret_57:
    s_cmp_lt_u32 s45, 17
    s_cbranch_scc1 L_k2_attn_kernel_loop_41
    s_waitcnt lgkmcnt(0)
    ds_read_b128 v[128:131], v232 offset:32768
    ds_read_b128 v[132:135], v232 offset:34816
    ds_read_b128 v[136:139], v232 offset:36864
    ds_read_b128 v[140:143], v232 offset:38912
    ds_read_b128 v[144:147], v232 offset:40960
    ds_read_b128 v[148:151], v232 offset:43008
    ds_read_b128 v[152:155], v232 offset:45056
    ds_read_b128 v[156:159], v232 offset:47104
    v_exp_f32 v80, v80
    v_exp_f32 v81, v81
    v_exp_f32 v82, v82
    v_exp_f32 v83, v83
    v_cvt_pk_bf16_f32 v104, v80, v81
    v_exp_f32 v88, v88
    v_exp_f32 v89, v89
    v_cvt_pk_bf16_f32 v105, v82, v83
    v_exp_f32 v90, v90
    v_exp_f32 v91, v91
    v_cvt_pk_bf16_f32 v106, v88, v89
    v_exp_f32 v84, v84
    v_exp_f32 v85, v85
    v_cvt_pk_bf16_f32 v107, v90, v91
    v_exp_f32 v86, v86
    s_waitcnt lgkmcnt(0)
    v_mfma_f32_16x16x32_bf16 v[224:227], v[120:123], v[96:99], v[224:227]
    v_mfma_f32_16x16x32_bf16 v[228:231], v[120:123], v[100:103], v[228:231]
    s_setprio 2
    v_mfma_f32_16x16x32_bf16 v[160:163], v[128:131], v[96:99], v[160:163]
    v_mfma_f32_16x16x32_bf16 v[164:167], v[128:131], v[100:103], v[164:167]
    v_mfma_f32_16x16x32_bf16 v[168:171], v[132:135], v[96:99], v[168:171]
    v_mfma_f32_16x16x32_bf16 v[172:175], v[132:135], v[100:103], v[172:175]
    v_mfma_f32_16x16x32_bf16 v[176:179], v[136:139], v[96:99], v[176:179]
    v_mfma_f32_16x16x32_bf16 v[180:183], v[136:139], v[100:103], v[180:183]
    v_mfma_f32_16x16x32_bf16 v[184:187], v[140:143], v[96:99], v[184:187]
    v_mfma_f32_16x16x32_bf16 v[188:191], v[140:143], v[100:103], v[188:191]
    v_mfma_f32_16x16x32_bf16 v[192:195], v[144:147], v[96:99], v[192:195]
    v_mfma_f32_16x16x32_bf16 v[196:199], v[144:147], v[100:103], v[196:199]
    v_mfma_f32_16x16x32_bf16 v[200:203], v[148:151], v[96:99], v[200:203]
    v_mfma_f32_16x16x32_bf16 v[204:207], v[148:151], v[100:103], v[204:207]
    v_mfma_f32_16x16x32_bf16 v[208:211], v[152:155], v[96:99], v[208:211]
    v_mfma_f32_16x16x32_bf16 v[212:215], v[152:155], v[100:103], v[212:215]
    v_mfma_f32_16x16x32_bf16 v[216:219], v[156:159], v[96:99], v[216:219]
    v_mfma_f32_16x16x32_bf16 v[220:223], v[156:159], v[100:103], v[220:223]
    s_setprio 0
    v_exp_f32 v87, v87
    v_cvt_pk_bf16_f32 v108, v84, v85
    v_exp_f32 v92, v92
    v_exp_f32 v93, v93
    v_cvt_pk_bf16_f32 v109, v86, v87
    v_exp_f32 v94, v94
    v_exp_f32 v95, v95
    v_cvt_pk_bf16_f32 v110, v92, v93
    v_cvt_pk_bf16_f32 v111, v94, v95
    s_or_b64 s[32:33], s[30:31], s[30:31]
    s_cbranch_scc1 L_k2_attn_kernel_slow_58
L_k2_attn_kernel_slowret_59:
    ds_read_b128 v[128:131], v232 offset:33792
    ds_read_b128 v[132:135], v232 offset:35840
    ds_read_b128 v[136:139], v232 offset:37888
    ds_read_b128 v[140:143], v232 offset:39936
    ds_read_b128 v[144:147], v232 offset:41984
    ds_read_b128 v[148:151], v232 offset:44032
    ds_read_b128 v[152:155], v232 offset:46080
    ds_read_b128 v[156:159], v232 offset:48128
    s_waitcnt lgkmcnt(0)
    v_mfma_f32_16x16x32_bf16 v[224:227], v[120:123], v[104:107], v[224:227]
    v_mfma_f32_16x16x32_bf16 v[228:231], v[120:123], v[108:111], v[228:231]
    s_setprio 2
    v_mfma_f32_16x16x32_bf16 v[160:163], v[128:131], v[104:107], v[160:163]
    v_mfma_f32_16x16x32_bf16 v[164:167], v[128:131], v[108:111], v[164:167]
    v_mfma_f32_16x16x32_bf16 v[168:171], v[132:135], v[104:107], v[168:171]
    v_mfma_f32_16x16x32_bf16 v[172:175], v[132:135], v[108:111], v[172:175]
    v_mfma_f32_16x16x32_bf16 v[176:179], v[136:139], v[104:107], v[176:179]
    v_mfma_f32_16x16x32_bf16 v[180:183], v[136:139], v[108:111], v[180:183]
    v_mfma_f32_16x16x32_bf16 v[184:187], v[140:143], v[104:107], v[184:187]
    v_mfma_f32_16x16x32_bf16 v[188:191], v[140:143], v[108:111], v[188:191]
    v_mfma_f32_16x16x32_bf16 v[192:195], v[144:147], v[104:107], v[192:195]
    v_mfma_f32_16x16x32_bf16 v[196:199], v[144:147], v[108:111], v[196:199]
    v_mfma_f32_16x16x32_bf16 v[200:203], v[148:151], v[104:107], v[200:203]
    v_mfma_f32_16x16x32_bf16 v[204:207], v[148:151], v[108:111], v[204:207]
    v_mfma_f32_16x16x32_bf16 v[208:211], v[152:155], v[104:107], v[208:211]
    v_mfma_f32_16x16x32_bf16 v[212:215], v[152:155], v[108:111], v[212:215]
    v_mfma_f32_16x16x32_bf16 v[216:219], v[156:159], v[104:107], v[216:219]
    v_mfma_f32_16x16x32_bf16 v[220:223], v[156:159], v[108:111], v[220:223]
    s_setprio 0
    s_or_b64 s[32:33], s[30:31], s[30:31]
    s_cbranch_scc1 L_k2_attn_kernel_slow_60
L_k2_attn_kernel_slowret_61:
L_k2_attn_kernel_grpjoin_7:
    s_nop 7
    s_waitcnt vmcnt(0)
    s_barrier
    v_mov_b32 v14, v224
    v_cmp_eq_f32 vcc, 0, v14
    v_mov_b32 v6, 0xf149f2ca
    s_nop 0
    v_cndmask_b32 v16, v18, v6, vcc
    v_mov_b32 v15, v228
    v_cmp_eq_f32 vcc, 0, v15
    v_mov_b32 v6, 0xf149f2ca
    s_nop 0
    v_cndmask_b32 v17, v19, v6, vcc
    s_mul_i32 s39, s36, 9216
    v_add_u32 v5, s39, v2
    s_xor_b32 s40, s36, 4
    s_mul_i32 s40, s40, 9216
    v_add_u32 v6, s40, v2
    ds_write_b128 v5, v[14:17] offset:8192
    s_cmp_lg_u32 s38, 0
    s_cbranch_scc1 L_k2_attn_kernel_mg1_62
    ds_write_b128 v5, v[192:195] offset:0
    ds_write_b128 v5, v[196:199] offset:1024
    ds_write_b128 v5, v[200:203] offset:2048
    ds_write_b128 v5, v[204:207] offset:3072
    ds_write_b128 v5, v[208:211] offset:4096
    ds_write_b128 v5, v[212:215] offset:5120
    ds_write_b128 v5, v[216:219] offset:6144
    ds_write_b128 v5, v[220:223] offset:7168
    s_waitcnt lgkmcnt(0)
    s_barrier
    ds_read_b128 v[96:99], v6 offset:8192
    ds_read_b128 v[64:67], v6 offset:0
    ds_read_b128 v[68:71], v6 offset:1024
    ds_read_b128 v[72:75], v6 offset:2048
    ds_read_b128 v[76:79], v6 offset:3072
    ds_read_b128 v[80:83], v6 offset:4096
    ds_read_b128 v[84:87], v6 offset:5120
    ds_read_b128 v[88:91], v6 offset:6144
    ds_read_b128 v[92:95], v6 offset:7168
    s_waitcnt lgkmcnt(8)
    v_max_f32 v18, v16, v98
    v_sub_f32 v16, v16, v18
    v_sub_f32 v98, v98, v18
    v_exp_f32 v16, v16
    v_exp_f32 v98, v98
    v_mul_f32 v14, v14, v16
    v_fmac_f32 v14, v96, v98
    v_rcp_f32 v14, v14
    v_max_f32 v19, v17, v99
    v_sub_f32 v17, v17, v19
    v_sub_f32 v99, v99, v19
    v_exp_f32 v17, v17
    v_exp_f32 v99, v99
    v_mul_f32 v15, v15, v17
    v_fmac_f32 v15, v97, v99
    v_rcp_f32 v15, v15
    s_waitcnt lgkmcnt(0)
    v_mul_f32 v160, v160, v16
    v_fmac_f32 v160, v64, v98
    v_mul_f32 v161, v161, v16
    v_fmac_f32 v161, v65, v98
    v_mul_f32 v162, v162, v16
    v_fmac_f32 v162, v66, v98
    v_mul_f32 v163, v163, v16
    v_fmac_f32 v163, v67, v98
    v_mul_f32 v164, v164, v17
    v_fmac_f32 v164, v68, v99
    v_mul_f32 v165, v165, v17
    v_fmac_f32 v165, v69, v99
    v_mul_f32 v166, v166, v17
    v_fmac_f32 v166, v70, v99
    v_mul_f32 v167, v167, v17
    v_fmac_f32 v167, v71, v99
    v_mul_f32 v168, v168, v16
    v_fmac_f32 v168, v72, v98
    v_mul_f32 v169, v169, v16
    v_fmac_f32 v169, v73, v98
    v_mul_f32 v170, v170, v16
    v_fmac_f32 v170, v74, v98
    v_mul_f32 v171, v171, v16
    v_fmac_f32 v171, v75, v98
    v_mul_f32 v172, v172, v17
    v_fmac_f32 v172, v76, v99
    v_mul_f32 v173, v173, v17
    v_fmac_f32 v173, v77, v99
    v_mul_f32 v174, v174, v17
    v_fmac_f32 v174, v78, v99
    v_mul_f32 v175, v175, v17
    v_fmac_f32 v175, v79, v99
    v_mul_f32 v176, v176, v16
    v_fmac_f32 v176, v80, v98
    v_mul_f32 v177, v177, v16
    v_fmac_f32 v177, v81, v98
    v_mul_f32 v178, v178, v16
    v_fmac_f32 v178, v82, v98
    v_mul_f32 v179, v179, v16
    v_fmac_f32 v179, v83, v98
    v_mul_f32 v180, v180, v17
    v_fmac_f32 v180, v84, v99
    v_mul_f32 v181, v181, v17
    v_fmac_f32 v181, v85, v99
    v_mul_f32 v182, v182, v17
    v_fmac_f32 v182, v86, v99
    v_mul_f32 v183, v183, v17
    v_fmac_f32 v183, v87, v99
    v_mul_f32 v184, v184, v16
    v_fmac_f32 v184, v88, v98
    v_mul_f32 v185, v185, v16
    v_fmac_f32 v185, v89, v98
    v_mul_f32 v186, v186, v16
    v_fmac_f32 v186, v90, v98
    v_mul_f32 v187, v187, v16
    v_fmac_f32 v187, v91, v98
    v_mul_f32 v188, v188, v17
    v_fmac_f32 v188, v92, v99
    v_mul_f32 v189, v189, v17
    v_fmac_f32 v189, v93, v99
    v_mul_f32 v190, v190, v17
    v_fmac_f32 v190, v94, v99
    v_mul_f32 v191, v191, v17
    v_fmac_f32 v191, v95, v99
    s_lshl_b32 s50, s49, 13
    s_lshl_b32 s52, s34, 12
    s_add_u32 s50, s50, s52
    s_add_u32 s52, s50, 131072
    v_mul_f32 v160, v160, v14
    v_mul_f32 v168, v168, v14
    v_mul_f32 v161, v161, v14
    v_mul_f32 v169, v169, v14
    v_mul_f32 v162, v162, v14
    v_mul_f32 v170, v170, v14
    v_mul_f32 v163, v163, v14
    v_mul_f32 v171, v171, v14
    v_cvt_pk_bf16_f32 v160, v160, v161
    v_cvt_pk_bf16_f32 v161, v162, v163
    v_cvt_pk_bf16_f32 v162, v168, v169
    v_cvt_pk_bf16_f32 v163, v170, v171
    buffer_store_dwordx4 v[160:163], v2, s[20:23], s50 offen offset:0 sc1
    v_mul_f32 v164, v164, v15
    v_mul_f32 v172, v172, v15
    v_mul_f32 v165, v165, v15
    v_mul_f32 v173, v173, v15
    v_mul_f32 v166, v166, v15
    v_mul_f32 v174, v174, v15
    v_mul_f32 v167, v167, v15
    v_mul_f32 v175, v175, v15
    v_cvt_pk_bf16_f32 v164, v164, v165
    v_cvt_pk_bf16_f32 v165, v166, v167
    v_cvt_pk_bf16_f32 v166, v172, v173
    v_cvt_pk_bf16_f32 v167, v174, v175
    buffer_store_dwordx4 v[164:167], v2, s[20:23], s52 offen offset:0 sc1
    v_mul_f32 v176, v176, v14
    v_mul_f32 v184, v184, v14
    v_mul_f32 v177, v177, v14
    v_mul_f32 v185, v185, v14
    v_mul_f32 v178, v178, v14
    v_mul_f32 v186, v186, v14
    v_mul_f32 v179, v179, v14
    v_mul_f32 v187, v187, v14
    v_cvt_pk_bf16_f32 v176, v176, v177
    v_cvt_pk_bf16_f32 v177, v178, v179
    v_cvt_pk_bf16_f32 v178, v184, v185
    v_cvt_pk_bf16_f32 v179, v186, v187
    buffer_store_dwordx4 v[176:179], v2, s[20:23], s50 offen offset:1024 sc1
    v_mul_f32 v180, v180, v15
    v_mul_f32 v188, v188, v15
    v_mul_f32 v181, v181, v15
    v_mul_f32 v189, v189, v15
    v_mul_f32 v182, v182, v15
    v_mul_f32 v190, v190, v15
    v_mul_f32 v183, v183, v15
    v_mul_f32 v191, v191, v15
    v_cvt_pk_bf16_f32 v180, v180, v181
    v_cvt_pk_bf16_f32 v181, v182, v183
    v_cvt_pk_bf16_f32 v182, v188, v189
    v_cvt_pk_bf16_f32 v183, v190, v191
    buffer_store_dwordx4 v[180:183], v2, s[20:23], s52 offen offset:1024 sc1
    s_branch L_k2_attn_kernel_mgj_63
L_k2_attn_kernel_mg1_62:
    ds_write_b128 v5, v[160:163] offset:0
    ds_write_b128 v5, v[164:167] offset:1024
    ds_write_b128 v5, v[168:171] offset:2048
    ds_write_b128 v5, v[172:175] offset:3072
    ds_write_b128 v5, v[176:179] offset:4096
    ds_write_b128 v5, v[180:183] offset:5120
    ds_write_b128 v5, v[184:187] offset:6144
    ds_write_b128 v5, v[188:191] offset:7168
    s_waitcnt lgkmcnt(0)
    s_barrier
    ds_read_b128 v[96:99], v6 offset:8192
    ds_read_b128 v[64:67], v6 offset:0
    ds_read_b128 v[68:71], v6 offset:1024
    ds_read_b128 v[72:75], v6 offset:2048
    ds_read_b128 v[76:79], v6 offset:3072
    ds_read_b128 v[80:83], v6 offset:4096
    ds_read_b128 v[84:87], v6 offset:5120
    ds_read_b128 v[88:91], v6 offset:6144
    ds_read_b128 v[92:95], v6 offset:7168
    s_waitcnt lgkmcnt(8)
    v_max_f32 v18, v16, v98
    v_sub_f32 v16, v16, v18
    v_sub_f32 v98, v98, v18
    v_exp_f32 v16, v16
    v_exp_f32 v98, v98
    v_mul_f32 v14, v14, v16
    v_fmac_f32 v14, v96, v98
    v_rcp_f32 v14, v14
    v_max_f32 v19, v17, v99
    v_sub_f32 v17, v17, v19
    v_sub_f32 v99, v99, v19
    v_exp_f32 v17, v17
    v_exp_f32 v99, v99
    v_mul_f32 v15, v15, v17
    v_fmac_f32 v15, v97, v99
    v_rcp_f32 v15, v15
    s_waitcnt lgkmcnt(0)
    v_mul_f32 v192, v192, v16
    v_fmac_f32 v192, v64, v98
    v_mul_f32 v193, v193, v16
    v_fmac_f32 v193, v65, v98
    v_mul_f32 v194, v194, v16
    v_fmac_f32 v194, v66, v98
    v_mul_f32 v195, v195, v16
    v_fmac_f32 v195, v67, v98
    v_mul_f32 v196, v196, v17
    v_fmac_f32 v196, v68, v99
    v_mul_f32 v197, v197, v17
    v_fmac_f32 v197, v69, v99
    v_mul_f32 v198, v198, v17
    v_fmac_f32 v198, v70, v99
    v_mul_f32 v199, v199, v17
    v_fmac_f32 v199, v71, v99
    v_mul_f32 v200, v200, v16
    v_fmac_f32 v200, v72, v98
    v_mul_f32 v201, v201, v16
    v_fmac_f32 v201, v73, v98
    v_mul_f32 v202, v202, v16
    v_fmac_f32 v202, v74, v98
    v_mul_f32 v203, v203, v16
    v_fmac_f32 v203, v75, v98
    v_mul_f32 v204, v204, v17
    v_fmac_f32 v204, v76, v99
    v_mul_f32 v205, v205, v17
    v_fmac_f32 v205, v77, v99
    v_mul_f32 v206, v206, v17
    v_fmac_f32 v206, v78, v99
    v_mul_f32 v207, v207, v17
    v_fmac_f32 v207, v79, v99
    v_mul_f32 v208, v208, v16
    v_fmac_f32 v208, v80, v98
    v_mul_f32 v209, v209, v16
    v_fmac_f32 v209, v81, v98
    v_mul_f32 v210, v210, v16
    v_fmac_f32 v210, v82, v98
    v_mul_f32 v211, v211, v16
    v_fmac_f32 v211, v83, v98
    v_mul_f32 v212, v212, v17
    v_fmac_f32 v212, v84, v99
    v_mul_f32 v213, v213, v17
    v_fmac_f32 v213, v85, v99
    v_mul_f32 v214, v214, v17
    v_fmac_f32 v214, v86, v99
    v_mul_f32 v215, v215, v17
    v_fmac_f32 v215, v87, v99
    v_mul_f32 v216, v216, v16
    v_fmac_f32 v216, v88, v98
    v_mul_f32 v217, v217, v16
    v_fmac_f32 v217, v89, v98
    v_mul_f32 v218, v218, v16
    v_fmac_f32 v218, v90, v98
    v_mul_f32 v219, v219, v16
    v_fmac_f32 v219, v91, v98
    v_mul_f32 v220, v220, v17
    v_fmac_f32 v220, v92, v99
    v_mul_f32 v221, v221, v17
    v_fmac_f32 v221, v93, v99
    v_mul_f32 v222, v222, v17
    v_fmac_f32 v222, v94, v99
    v_mul_f32 v223, v223, v17
    v_fmac_f32 v223, v95, v99
    s_lshl_b32 s50, s49, 13
    s_lshl_b32 s52, s34, 12
    s_add_u32 s50, s50, s52
    s_add_u32 s52, s50, 131072
    v_mul_f32 v192, v192, v14
    v_mul_f32 v200, v200, v14
    v_mul_f32 v193, v193, v14
    v_mul_f32 v201, v201, v14
    v_mul_f32 v194, v194, v14
    v_mul_f32 v202, v202, v14
    v_mul_f32 v195, v195, v14
    v_mul_f32 v203, v203, v14
    v_cvt_pk_bf16_f32 v192, v192, v193
    v_cvt_pk_bf16_f32 v193, v194, v195
    v_cvt_pk_bf16_f32 v194, v200, v201
    v_cvt_pk_bf16_f32 v195, v202, v203
    buffer_store_dwordx4 v[192:195], v2, s[20:23], s50 offen offset:2048 sc1
    v_mul_f32 v196, v196, v15
    v_mul_f32 v204, v204, v15
    v_mul_f32 v197, v197, v15
    v_mul_f32 v205, v205, v15
    v_mul_f32 v198, v198, v15
    v_mul_f32 v206, v206, v15
    v_mul_f32 v199, v199, v15
    v_mul_f32 v207, v207, v15
    v_cvt_pk_bf16_f32 v196, v196, v197
    v_cvt_pk_bf16_f32 v197, v198, v199
    v_cvt_pk_bf16_f32 v198, v204, v205
    v_cvt_pk_bf16_f32 v199, v206, v207
    buffer_store_dwordx4 v[196:199], v2, s[20:23], s52 offen offset:2048 sc1
    v_mul_f32 v208, v208, v14
    v_mul_f32 v216, v216, v14
    v_mul_f32 v209, v209, v14
    v_mul_f32 v217, v217, v14
    v_mul_f32 v210, v210, v14
    v_mul_f32 v218, v218, v14
    v_mul_f32 v211, v211, v14
    v_mul_f32 v219, v219, v14
    v_cvt_pk_bf16_f32 v208, v208, v209
    v_cvt_pk_bf16_f32 v209, v210, v211
    v_cvt_pk_bf16_f32 v210, v216, v217
    v_cvt_pk_bf16_f32 v211, v218, v219
    buffer_store_dwordx4 v[208:211], v2, s[20:23], s50 offen offset:3072 sc1
    v_mul_f32 v212, v212, v15
    v_mul_f32 v220, v220, v15
    v_mul_f32 v213, v213, v15
    v_mul_f32 v221, v221, v15
    v_mul_f32 v214, v214, v15
    v_mul_f32 v222, v222, v15
    v_mul_f32 v215, v215, v15
    v_mul_f32 v223, v223, v15
    v_cvt_pk_bf16_f32 v212, v212, v213
    v_cvt_pk_bf16_f32 v213, v214, v215
    v_cvt_pk_bf16_f32 v214, v220, v221
    v_cvt_pk_bf16_f32 v215, v222, v223
    buffer_store_dwordx4 v[212:215], v2, s[20:23], s52 offen offset:3072 sc1
L_k2_attn_kernel_mgj_63:
L_k2_attn_kernel_done_1:
    s_endpgm
L_k2_attn_kernel_slow_8:
    s_call_b64 s[90:91], L_k2_attn_kernel_SLOW1_3
    s_branch L_k2_attn_kernel_slowret_9
L_k2_attn_kernel_vwalt_10:
    s_cmp_eq_u32 s85, 8
    s_mov_b32 s85, 0
    s_cbranch_scc1 L_k2_attn_kernel_vw8_64
    s_waitcnt vmcnt(4)
    s_branch L_k2_attn_kernel_vwret_11
L_k2_attn_kernel_vw8_64:
    s_waitcnt vmcnt(8)
    s_branch L_k2_attn_kernel_vwret_11
L_k2_attn_kernel_slow_12:
    s_call_b64 s[90:91], L_k2_attn_kernel_SLOW0_2
    s_branch L_k2_attn_kernel_slowret_13
L_k2_attn_kernel_slow_15:
    s_call_b64 s[90:91], L_k2_attn_kernel_SLOW1_3
    s_branch L_k2_attn_kernel_slowret_16
L_k2_attn_kernel_rps_17:
    s_call_b64 s[90:91], L_k2_attn_kernel_RPK_5
    s_branch L_k2_attn_kernel_rpret_18
L_k2_attn_kernel_vwalt_19:
    s_cmp_eq_u32 s85, 8
    s_mov_b32 s85, 0
    s_cbranch_scc1 L_k2_attn_kernel_vw8_65
    s_waitcnt vmcnt(4)
    s_branch L_k2_attn_kernel_vwret_20
L_k2_attn_kernel_vw8_65:
    s_waitcnt vmcnt(8)
    s_branch L_k2_attn_kernel_vwret_20
L_k2_attn_kernel_slow_21:
    s_call_b64 s[90:91], L_k2_attn_kernel_SLOW0_2
    s_branch L_k2_attn_kernel_slowret_22
L_k2_attn_kernel_slow_23:
    s_call_b64 s[90:91], L_k2_attn_kernel_SLOW1_3
    s_branch L_k2_attn_kernel_slowret_24
L_k2_attn_kernel_rps_25:
    s_call_b64 s[90:91], L_k2_attn_kernel_RPK_5
    s_branch L_k2_attn_kernel_rpret_26
L_k2_attn_kernel_vwalt_27:
    s_cmp_eq_u32 s85, 8
    s_mov_b32 s85, 0
    s_cbranch_scc1 L_k2_attn_kernel_vw8_66
    s_waitcnt vmcnt(4)
    s_branch L_k2_attn_kernel_vwret_28
L_k2_attn_kernel_vw8_66:
    s_waitcnt vmcnt(8)
    s_branch L_k2_attn_kernel_vwret_28
L_k2_attn_kernel_slow_29:
    s_call_b64 s[90:91], L_k2_attn_kernel_SLOW0_2
    s_branch L_k2_attn_kernel_slowret_30
L_k2_attn_kernel_slow_31:
    s_call_b64 s[90:91], L_k2_attn_kernel_SLOWP_4
    s_branch L_k2_attn_kernel_slowret_32
L_k2_attn_kernel_slow_33:
    s_call_b64 s[90:91], L_k2_attn_kernel_SLOWP_4
    s_branch L_k2_attn_kernel_slowret_34
L_k2_attn_kernel_slow_35:
    s_call_b64 s[90:91], L_k2_attn_kernel_SLOW1_3
    s_branch L_k2_attn_kernel_slowret_36
L_k2_attn_kernel_vwalt_37:
    s_cmp_eq_u32 s85, 8
    s_mov_b32 s85, 0
    s_cbranch_scc1 L_k2_attn_kernel_vw8_67
    s_waitcnt vmcnt(4)
    s_branch L_k2_attn_kernel_vwret_38
L_k2_attn_kernel_vw8_67:
    s_waitcnt vmcnt(8)
    s_branch L_k2_attn_kernel_vwret_38
L_k2_attn_kernel_slow_39:
    s_call_b64 s[90:91], L_k2_attn_kernel_SLOW0_2
    s_branch L_k2_attn_kernel_slowret_40
L_k2_attn_kernel_slow_42:
    s_call_b64 s[90:91], L_k2_attn_kernel_SLOW1_3
    s_branch L_k2_attn_kernel_slowret_43
L_k2_attn_kernel_rps_44:
    s_call_b64 s[90:91], L_k2_attn_kernel_RPK_5
    s_branch L_k2_attn_kernel_rpret_45
L_k2_attn_kernel_vwalt_46:
    s_cmp_eq_u32 s85, 8
    s_mov_b32 s85, 0
    s_cbranch_scc1 L_k2_attn_kernel_vw8_68
    s_waitcnt vmcnt(4)
    s_branch L_k2_attn_kernel_vwret_47
L_k2_attn_kernel_vw8_68:
    s_waitcnt vmcnt(8)
    s_branch L_k2_attn_kernel_vwret_47
L_k2_attn_kernel_slow_48:
    s_call_b64 s[90:91], L_k2_attn_kernel_SLOW0_2
    s_branch L_k2_attn_kernel_slowret_49
L_k2_attn_kernel_slow_50:
    s_call_b64 s[90:91], L_k2_attn_kernel_SLOW1_3
    s_branch L_k2_attn_kernel_slowret_51
L_k2_attn_kernel_rps_52:
    s_call_b64 s[90:91], L_k2_attn_kernel_RPK_5
    s_branch L_k2_attn_kernel_rpret_53
L_k2_attn_kernel_vwalt_54:
    s_cmp_eq_u32 s85, 8
    s_mov_b32 s85, 0
    s_cbranch_scc1 L_k2_attn_kernel_vw8_69
    s_waitcnt vmcnt(4)
    s_branch L_k2_attn_kernel_vwret_55
L_k2_attn_kernel_vw8_69:
    s_waitcnt vmcnt(8)
    s_branch L_k2_attn_kernel_vwret_55
L_k2_attn_kernel_slow_56:
    s_call_b64 s[90:91], L_k2_attn_kernel_SLOW0_2
    s_branch L_k2_attn_kernel_slowret_57
L_k2_attn_kernel_slow_58:
    s_call_b64 s[90:91], L_k2_attn_kernel_SLOWP_4
    s_branch L_k2_attn_kernel_slowret_59
L_k2_attn_kernel_slow_60:
    s_call_b64 s[90:91], L_k2_attn_kernel_SLOWP_4
    s_branch L_k2_attn_kernel_slowret_61
L_k2_attn_kernel_SLOW0_2:
    s_nop 7
    s_mov_b64 s[30:31], 0
    s_cmp_eq_u32 s44, 0
    s_cbranch_scc1 L_k2_attn_kernel_np_70
    v_mul_f32 v160, v160, v20
    v_mul_f32 v161, v161, v20
    v_mul_f32 v162, v162, v20
    v_mul_f32 v163, v163, v20
    v_mul_f32 v164, v164, v21
    v_mul_f32 v165, v165, v21
    v_mul_f32 v166, v166, v21
    v_mul_f32 v167, v167, v21
    v_mul_f32 v168, v168, v20
    v_mul_f32 v169, v169, v20
    v_mul_f32 v170, v170, v20
    v_mul_f32 v171, v171, v20
    v_mul_f32 v172, v172, v21
    v_mul_f32 v173, v173, v21
    v_mul_f32 v174, v174, v21
    v_mul_f32 v175, v175, v21
    v_mul_f32 v176, v176, v20
    v_mul_f32 v177, v177, v20
    v_mul_f32 v178, v178, v20
    v_mul_f32 v179, v179, v20
    v_mul_f32 v180, v180, v21
    v_mul_f32 v181, v181, v21
    v_mul_f32 v182, v182, v21
    v_mul_f32 v183, v183, v21
    v_mul_f32 v184, v184, v20
    v_mul_f32 v185, v185, v20
    v_mul_f32 v186, v186, v20
    v_mul_f32 v187, v187, v20
    v_mul_f32 v188, v188, v21
    v_mul_f32 v189, v189, v21
    v_mul_f32 v190, v190, v21
    v_mul_f32 v191, v191, v21
    v_mul_f32 v192, v192, v20
    v_mul_f32 v193, v193, v20
    v_mul_f32 v194, v194, v20
    v_mul_f32 v195, v195, v20
    v_mul_f32 v196, v196, v21
    v_mul_f32 v197, v197, v21
    v_mul_f32 v198, v198, v21
    v_mul_f32 v199, v199, v21
    v_mul_f32 v200, v200, v20
    v_mul_f32 v201, v201, v20
    v_mul_f32 v202, v202, v20
    v_mul_f32 v203, v203, v20
    v_mul_f32 v204, v204, v21
    v_mul_f32 v205, v205, v21
    v_mul_f32 v206, v206, v21
    v_mul_f32 v207, v207, v21
    v_mul_f32 v208, v208, v20
    v_mul_f32 v209, v209, v20
    v_mul_f32 v210, v210, v20
    v_mul_f32 v211, v211, v20
    v_mul_f32 v212, v212, v21
    v_mul_f32 v213, v213, v21
    v_mul_f32 v214, v214, v21
    v_mul_f32 v215, v215, v21
    v_mul_f32 v216, v216, v20
    v_mul_f32 v217, v217, v20
    v_mul_f32 v218, v218, v20
    v_mul_f32 v219, v219, v20
    v_mul_f32 v220, v220, v21
    v_mul_f32 v221, v221, v21
    v_mul_f32 v222, v222, v21
    v_mul_f32 v223, v223, v21
    v_mul_f32 v224, v224, v20
    v_mul_f32 v225, v225, v20
    v_mul_f32 v226, v226, v20
    v_mul_f32 v227, v227, v20
    v_mul_f32 v228, v228, v21
    v_mul_f32 v229, v229, v21
    v_mul_f32 v230, v230, v21
    v_mul_f32 v231, v231, v21
    s_mov_b32 s44, 0
L_k2_attn_kernel_np_70:
    s_cmp_eq_u32 s57, 0
    s_cbranch_scc1 L_k2_attn_kernel_nh3_71
    s_mov_b32 s57, 0
    v_rcp_f32 v16, v224
    v_rcp_f32 v17, v228
    s_lshl_b32 s39, s35, 7
    s_lshl_b32 s50, s37, 5
    s_add_u32 s39, s39, s50
    s_lshl_b32 s50, s39, 13
    s_lshl_b32 s52, s34, 12
    s_add_u32 s50, s50, s52
    s_add_u32 s52, s50, 131072
    v_mul_f32 v160, v160, v16
    v_mul_f32 v168, v168, v16
    v_mul_f32 v161, v161, v16
    v_mul_f32 v169, v169, v16
    v_mul_f32 v162, v162, v16
    v_mul_f32 v170, v170, v16
    v_mul_f32 v163, v163, v16
    v_mul_f32 v171, v171, v16
    v_cvt_pk_bf16_f32 v160, v160, v161
    v_cvt_pk_bf16_f32 v161, v162, v163
    v_cvt_pk_bf16_f32 v162, v168, v169
    v_cvt_pk_bf16_f32 v163, v170, v171
    buffer_store_dwordx4 v[160:163], v2, s[20:23], s50 offen offset:0 sc1
    v_mul_f32 v164, v164, v17
    v_mul_f32 v172, v172, v17
    v_mul_f32 v165, v165, v17
    v_mul_f32 v173, v173, v17
    v_mul_f32 v166, v166, v17
    v_mul_f32 v174, v174, v17
    v_mul_f32 v167, v167, v17
    v_mul_f32 v175, v175, v17
    v_cvt_pk_bf16_f32 v164, v164, v165
    v_cvt_pk_bf16_f32 v165, v166, v167
    v_cvt_pk_bf16_f32 v166, v172, v173
    v_cvt_pk_bf16_f32 v167, v174, v175
    buffer_store_dwordx4 v[164:167], v2, s[20:23], s52 offen offset:0 sc1
    v_mul_f32 v176, v176, v16
    v_mul_f32 v184, v184, v16
    v_mul_f32 v177, v177, v16
    v_mul_f32 v185, v185, v16
    v_mul_f32 v178, v178, v16
    v_mul_f32 v186, v186, v16
    v_mul_f32 v179, v179, v16
    v_mul_f32 v187, v187, v16
    v_cvt_pk_bf16_f32 v176, v176, v177
    v_cvt_pk_bf16_f32 v177, v178, v179
    v_cvt_pk_bf16_f32 v178, v184, v185
    v_cvt_pk_bf16_f32 v179, v186, v187
    buffer_store_dwordx4 v[176:179], v2, s[20:23], s50 offen offset:1024 sc1
    v_mul_f32 v180, v180, v17
    v_mul_f32 v188, v188, v17
    v_mul_f32 v181, v181, v17
    v_mul_f32 v189, v189, v17
    v_mul_f32 v182, v182, v17
    v_mul_f32 v190, v190, v17
    v_mul_f32 v183, v183, v17
    v_mul_f32 v191, v191, v17
    v_cvt_pk_bf16_f32 v180, v180, v181
    v_cvt_pk_bf16_f32 v181, v182, v183
    v_cvt_pk_bf16_f32 v182, v188, v189
    v_cvt_pk_bf16_f32 v183, v190, v191
    buffer_store_dwordx4 v[180:183], v2, s[20:23], s52 offen offset:1024 sc1
    v_mul_f32 v192, v192, v16
    v_mul_f32 v200, v200, v16
    v_mul_f32 v193, v193, v16
    v_mul_f32 v201, v201, v16
    v_mul_f32 v194, v194, v16
    v_mul_f32 v202, v202, v16
    v_mul_f32 v195, v195, v16
    v_mul_f32 v203, v203, v16
    v_cvt_pk_bf16_f32 v192, v192, v193
    v_cvt_pk_bf16_f32 v193, v194, v195
    v_cvt_pk_bf16_f32 v194, v200, v201
    v_cvt_pk_bf16_f32 v195, v202, v203
    buffer_store_dwordx4 v[192:195], v2, s[20:23], s50 offen offset:2048 sc1
    v_mul_f32 v196, v196, v17
    v_mul_f32 v204, v204, v17
    v_mul_f32 v197, v197, v17
    v_mul_f32 v205, v205, v17
    v_mul_f32 v198, v198, v17
    v_mul_f32 v206, v206, v17
    v_mul_f32 v199, v199, v17
    v_mul_f32 v207, v207, v17
    v_cvt_pk_bf16_f32 v196, v196, v197
    v_cvt_pk_bf16_f32 v197, v198, v199
    v_cvt_pk_bf16_f32 v198, v204, v205
    v_cvt_pk_bf16_f32 v199, v206, v207
    buffer_store_dwordx4 v[196:199], v2, s[20:23], s52 offen offset:2048 sc1
    v_mul_f32 v208, v208, v16
    v_mul_f32 v216, v216, v16
    v_mul_f32 v209, v209, v16
    v_mul_f32 v217, v217, v16
    v_mul_f32 v210, v210, v16
    v_mul_f32 v218, v218, v16
    v_mul_f32 v211, v211, v16
    v_mul_f32 v219, v219, v16
    v_cvt_pk_bf16_f32 v208, v208, v209
    v_cvt_pk_bf16_f32 v209, v210, v211
    v_cvt_pk_bf16_f32 v210, v216, v217
    v_cvt_pk_bf16_f32 v211, v218, v219
    buffer_store_dwordx4 v[208:211], v2, s[20:23], s50 offen offset:3072 sc1
    v_mul_f32 v212, v212, v17
    v_mul_f32 v220, v220, v17
    v_mul_f32 v213, v213, v17
    v_mul_f32 v221, v221, v17
    v_mul_f32 v214, v214, v17
    v_mul_f32 v222, v222, v17
    v_mul_f32 v215, v215, v17
    v_mul_f32 v223, v223, v17
    v_cvt_pk_bf16_f32 v212, v212, v213
    v_cvt_pk_bf16_f32 v213, v214, v215
    v_cvt_pk_bf16_f32 v214, v220, v221
    v_cvt_pk_bf16_f32 v215, v222, v223
    buffer_store_dwordx4 v[212:215], v2, s[20:23], s52 offen offset:3072 sc1
    v_mov_b32 v160, 0
    v_mov_b32 v161, 0
    v_mov_b32 v162, 0
    v_mov_b32 v163, 0
    v_mov_b32 v164, 0
    v_mov_b32 v165, 0
    v_mov_b32 v166, 0
    v_mov_b32 v167, 0
    v_mov_b32 v168, 0
    v_mov_b32 v169, 0
    v_mov_b32 v170, 0
    v_mov_b32 v171, 0
    v_mov_b32 v172, 0
    v_mov_b32 v173, 0
    v_mov_b32 v174, 0
    v_mov_b32 v175, 0
    v_mov_b32 v176, 0
    v_mov_b32 v177, 0
    v_mov_b32 v178, 0
    v_mov_b32 v179, 0
    v_mov_b32 v180, 0
    v_mov_b32 v181, 0
    v_mov_b32 v182, 0
    v_mov_b32 v183, 0
    v_mov_b32 v184, 0
    v_mov_b32 v185, 0
    v_mov_b32 v186, 0
    v_mov_b32 v187, 0
    v_mov_b32 v188, 0
    v_mov_b32 v189, 0
    v_mov_b32 v190, 0
    v_mov_b32 v191, 0
    v_mov_b32 v192, 0
    v_mov_b32 v193, 0
    v_mov_b32 v194, 0
    v_mov_b32 v195, 0
    v_mov_b32 v196, 0
    v_mov_b32 v197, 0
    v_mov_b32 v198, 0
    v_mov_b32 v199, 0
    v_mov_b32 v200, 0
    v_mov_b32 v201, 0
    v_mov_b32 v202, 0
    v_mov_b32 v203, 0
    v_mov_b32 v204, 0
    v_mov_b32 v205, 0
    v_mov_b32 v206, 0
    v_mov_b32 v207, 0
    v_mov_b32 v208, 0
    v_mov_b32 v209, 0
    v_mov_b32 v210, 0
    v_mov_b32 v211, 0
    v_mov_b32 v212, 0
    v_mov_b32 v213, 0
    v_mov_b32 v214, 0
    v_mov_b32 v215, 0
    v_mov_b32 v216, 0
    v_mov_b32 v217, 0
    v_mov_b32 v218, 0
    v_mov_b32 v219, 0
    v_mov_b32 v220, 0
    v_mov_b32 v221, 0
    v_mov_b32 v222, 0
    v_mov_b32 v223, 0
    v_mov_b32 v224, 0
    v_mov_b32 v225, 0
    v_mov_b32 v226, 0
    v_mov_b32 v227, 0
    v_mov_b32 v228, 0
    v_mov_b32 v229, 0
    v_mov_b32 v230, 0
    v_mov_b32 v231, 0
L_k2_attn_kernel_nh3_71:
    s_sub_u32 s39, s41, 32
    s_cmp_lt_u32 s39, s42
    s_cbranch_scc1 L_k2_attn_kernel_nm_72
    v_mov_b32 v7, 0xff800000
    s_cmp_gt_u32 s39, s42
    s_cbranch_scc1 L_k2_attn_kernel_allm_73
    v_cndmask_b32 v80, v80, v7, s[58:59]
    v_cndmask_b32 v92, v92, v7, s[58:59]
    v_mov_b32 v88, v7
    v_cndmask_b32 v81, v81, v7, s[60:61]
    v_cndmask_b32 v93, v93, v7, s[60:61]
    v_mov_b32 v89, v7
    v_cndmask_b32 v82, v82, v7, s[62:63]
    v_cndmask_b32 v94, v94, v7, s[62:63]
    v_mov_b32 v90, v7
    v_cndmask_b32 v83, v83, v7, s[64:65]
    v_cndmask_b32 v95, v95, v7, s[64:65]
    v_mov_b32 v91, v7
    s_branch L_k2_attn_kernel_nm_72
L_k2_attn_kernel_allm_73:
    v_mov_b32 v80, v7
    v_mov_b32 v81, v7
    v_mov_b32 v82, v7
    v_mov_b32 v83, v7
    v_mov_b32 v84, v7
    v_mov_b32 v85, v7
    v_mov_b32 v86, v7
    v_mov_b32 v87, v7
    v_mov_b32 v88, v7
    v_mov_b32 v89, v7
    v_mov_b32 v90, v7
    v_mov_b32 v91, v7
    v_mov_b32 v92, v7
    v_mov_b32 v93, v7
    v_mov_b32 v94, v7
    v_mov_b32 v95, v7
L_k2_attn_kernel_nm_72:
    v_max3_f32 v8, v80, v81, v82
    v_max3_f32 v8, v8, v83, v88
    v_max3_f32 v8, v8, v89, v90
    v_max_f32 v8, v8, v91
    v_max3_f32 v9, v84, v85, v86
    v_max3_f32 v9, v9, v87, v92
    v_max3_f32 v9, v9, v93, v94
    v_max_f32 v9, v9, v95
    v_max_f32 v4, v8, v9
    v_cmp_lt_f32 vcc, 0x41000000, v4
    s_cmp_lg_u32 s43, 0
    s_cbranch_scc1 L_k2_attn_kernel_resc_77
    s_cbranch_vccz L_k2_attn_kernel_nr_74
L_k2_attn_kernel_resc_77:
    v_mov_b32 v6, v8
    s_nop 1
    v_permlane16_swap_b32 v8, v6
    v_max_f32 v8, v8, v6
    v_mov_b32 v6, v8
    s_nop 1
    v_permlane32_swap_b32 v8, v6
    v_max_f32 v8, v8, v6
    v_mov_b32 v6, v9
    s_nop 1
    v_permlane16_swap_b32 v9, v6
    v_max_f32 v9, v9, v6
    v_mov_b32 v6, v9
    s_nop 1
    v_permlane32_swap_b32 v9, v6
    v_max_f32 v9, v9, v6
    s_cmp_lg_u32 s43, 0
    s_cbranch_scc1 L_k2_attn_kernel_first_75
    v_max_f32 v8, 0, v8
    v_sub_f32 v20, 0, v8
    v_exp_f32 v20, v20
    v_max_f32 v9, 0, v9
    v_sub_f32 v21, 0, v9
    v_exp_f32 v21, v21
    s_mov_b32 s44, 1
    s_mov_b64 s[30:31], -1
    s_branch L_k2_attn_kernel_join_76
L_k2_attn_kernel_first_75:
    s_mov_b32 s43, 0
    v_cmp_eq_f32 vcc, 0xff800000, v8
    s_nop 1
    v_cndmask_b32 v8, v8, 0, vcc
    v_cmp_eq_f32 vcc, 0xff800000, v9
    s_nop 1
    v_cndmask_b32 v9, v9, 0, vcc
L_k2_attn_kernel_join_76:
    v_add_f32 v18, v18, v8
    v_sub_f32 v80, v80, v8
    v_sub_f32 v81, v81, v8
    v_sub_f32 v82, v82, v8
    v_sub_f32 v83, v83, v8
    v_sub_f32 v88, v88, v8
    v_sub_f32 v89, v89, v8
    v_sub_f32 v90, v90, v8
    v_sub_f32 v91, v91, v8
    v_sub_f32 v112, 0, v18
    v_sub_f32 v113, 0, v18
    v_sub_f32 v114, 0, v18
    v_sub_f32 v115, 0, v18
    v_add_f32 v19, v19, v9
    v_sub_f32 v84, v84, v9
    v_sub_f32 v85, v85, v9
    v_sub_f32 v86, v86, v9
    v_sub_f32 v87, v87, v9
    v_sub_f32 v92, v92, v9
    v_sub_f32 v93, v93, v9
    v_sub_f32 v94, v94, v9
    v_sub_f32 v95, v95, v9
    v_sub_f32 v116, 0, v19
    v_sub_f32 v117, 0, v19
    v_sub_f32 v118, 0, v19
    v_sub_f32 v119, 0, v19
L_k2_attn_kernel_nr_74:
    s_cmp_le_u32 s41, s42
    s_cbranch_scc1 L_k2_attn_kernel_ninf_78
    v_mov_b32 v112, 0xff800000
    v_mov_b32 v113, 0xff800000
    v_mov_b32 v114, 0xff800000
    v_mov_b32 v115, 0xff800000
    v_mov_b32 v116, 0xff800000
    v_mov_b32 v117, 0xff800000
    v_mov_b32 v118, 0xff800000
    v_mov_b32 v119, 0xff800000
L_k2_attn_kernel_ninf_78:
    s_cmp_lg_u32 s45, s53
    s_cbranch_scc1 L_k2_attn_kernel_nh1_79
    s_add_u32 s39, s89, 4096
    buffer_load_dwordx4 v[32:35], v2, s[12:15], s89 offen offset:0 sc1
    buffer_load_dwordx4 v[36:39], v2, s[12:15], s89 offen offset:1024 sc1
    buffer_load_dwordx4 v[40:43], v2, s[12:15], s89 offen offset:2048 sc1
    buffer_load_dwordx4 v[44:47], v2, s[12:15], s89 offen offset:3072 sc1
    buffer_load_dwordx4 v[48:51], v2, s[12:15], s39 offen offset:0 sc1
    buffer_load_dwordx4 v[52:55], v2, s[12:15], s39 offen offset:1024 sc1
    buffer_load_dwordx4 v[56:59], v2, s[12:15], s39 offen offset:2048 sc1
    buffer_load_dwordx4 v[60:63], v2, s[12:15], s39 offen offset:3072 sc1
    v_mov_b32 v112, 0
    v_mov_b32 v113, 0
    v_mov_b32 v114, 0
    v_mov_b32 v115, 0
    v_mov_b32 v116, 0
    v_mov_b32 v117, 0
    v_mov_b32 v118, 0
    v_mov_b32 v119, 0
    v_mov_b32 v18, 0
    v_mov_b32 v19, 0
    s_mov_b32 s43, 1
    s_mov_b64 s[30:31], -1
    s_mov_b32 s42, s49
    s_movk_i32 s41, 1088
    s_waitcnt vmcnt(0)
L_k2_attn_kernel_nh1_79:
    s_nop 1
    s_setpc_b64 s[90:91]
L_k2_attn_kernel_SLOW1_3:
    s_nop 7
    s_mov_b64 s[30:31], 0
    s_cmp_eq_u32 s44, 0
    s_cbranch_scc1 L_k2_attn_kernel_np_80
    v_mul_f32 v160, v160, v20
    v_mul_f32 v161, v161, v20
    v_mul_f32 v162, v162, v20
    v_mul_f32 v163, v163, v20
    v_mul_f32 v164, v164, v21
    v_mul_f32 v165, v165, v21
    v_mul_f32 v166, v166, v21
    v_mul_f32 v167, v167, v21
    v_mul_f32 v168, v168, v20
    v_mul_f32 v169, v169, v20
    v_mul_f32 v170, v170, v20
    v_mul_f32 v171, v171, v20
    v_mul_f32 v172, v172, v21
    v_mul_f32 v173, v173, v21
    v_mul_f32 v174, v174, v21
    v_mul_f32 v175, v175, v21
    v_mul_f32 v176, v176, v20
    v_mul_f32 v177, v177, v20
    v_mul_f32 v178, v178, v20
    v_mul_f32 v179, v179, v20
    v_mul_f32 v180, v180, v21
    v_mul_f32 v181, v181, v21
    v_mul_f32 v182, v182, v21
    v_mul_f32 v183, v183, v21
    v_mul_f32 v184, v184, v20
    v_mul_f32 v185, v185, v20
    v_mul_f32 v186, v186, v20
    v_mul_f32 v187, v187, v20
    v_mul_f32 v188, v188, v21
    v_mul_f32 v189, v189, v21
    v_mul_f32 v190, v190, v21
    v_mul_f32 v191, v191, v21
    v_mul_f32 v192, v192, v20
    v_mul_f32 v193, v193, v20
    v_mul_f32 v194, v194, v20
    v_mul_f32 v195, v195, v20
    v_mul_f32 v196, v196, v21
    v_mul_f32 v197, v197, v21
    v_mul_f32 v198, v198, v21
    v_mul_f32 v199, v199, v21
    v_mul_f32 v200, v200, v20
    v_mul_f32 v201, v201, v20
    v_mul_f32 v202, v202, v20
    v_mul_f32 v203, v203, v20
    v_mul_f32 v204, v204, v21
    v_mul_f32 v205, v205, v21
    v_mul_f32 v206, v206, v21
    v_mul_f32 v207, v207, v21
    v_mul_f32 v208, v208, v20
    v_mul_f32 v209, v209, v20
    v_mul_f32 v210, v210, v20
    v_mul_f32 v211, v211, v20
    v_mul_f32 v212, v212, v21
    v_mul_f32 v213, v213, v21
    v_mul_f32 v214, v214, v21
    v_mul_f32 v215, v215, v21
    v_mul_f32 v216, v216, v20
    v_mul_f32 v217, v217, v20
    v_mul_f32 v218, v218, v20
    v_mul_f32 v219, v219, v20
    v_mul_f32 v220, v220, v21
    v_mul_f32 v221, v221, v21
    v_mul_f32 v222, v222, v21
    v_mul_f32 v223, v223, v21
    v_mul_f32 v224, v224, v20
    v_mul_f32 v225, v225, v20
    v_mul_f32 v226, v226, v20
    v_mul_f32 v227, v227, v20
    v_mul_f32 v228, v228, v21
    v_mul_f32 v229, v229, v21
    v_mul_f32 v230, v230, v21
    v_mul_f32 v231, v231, v21
    s_mov_b32 s44, 0
L_k2_attn_kernel_np_80:
    s_cmp_lg_u32 s45, s53
    s_cbranch_scc1 L_k2_attn_kernel_nh2_81
    s_mov_b32 s57, 1
    s_mov_b64 s[30:31], -1
L_k2_attn_kernel_nh2_81:
    s_sub_u32 s39, s41, 32
    s_cmp_lt_u32 s39, s42
    s_cbranch_scc1 L_k2_attn_kernel_nm_82
    v_mov_b32 v7, 0xff800000
    s_cmp_gt_u32 s39, s42
    s_cbranch_scc1 L_k2_attn_kernel_allm_83
    v_cndmask_b32 v64, v64, v7, s[58:59]
    v_cndmask_b32 v76, v76, v7, s[58:59]
    v_mov_b32 v72, v7
    v_cndmask_b32 v65, v65, v7, s[60:61]
    v_cndmask_b32 v77, v77, v7, s[60:61]
    v_mov_b32 v73, v7
    v_cndmask_b32 v66, v66, v7, s[62:63]
    v_cndmask_b32 v78, v78, v7, s[62:63]
    v_mov_b32 v74, v7
    v_cndmask_b32 v67, v67, v7, s[64:65]
    v_cndmask_b32 v79, v79, v7, s[64:65]
    v_mov_b32 v75, v7
    s_branch L_k2_attn_kernel_nm_82
L_k2_attn_kernel_allm_83:
    v_mov_b32 v64, v7
    v_mov_b32 v65, v7
    v_mov_b32 v66, v7
    v_mov_b32 v67, v7
    v_mov_b32 v68, v7
    v_mov_b32 v69, v7
    v_mov_b32 v70, v7
    v_mov_b32 v71, v7
    v_mov_b32 v72, v7
    v_mov_b32 v73, v7
    v_mov_b32 v74, v7
    v_mov_b32 v75, v7
    v_mov_b32 v76, v7
    v_mov_b32 v77, v7
    v_mov_b32 v78, v7
    v_mov_b32 v79, v7
L_k2_attn_kernel_nm_82:
    v_max3_f32 v8, v64, v65, v66
    v_max3_f32 v8, v8, v67, v72
    v_max3_f32 v8, v8, v73, v74
    v_max_f32 v8, v8, v75
    v_max3_f32 v9, v68, v69, v70
    v_max3_f32 v9, v9, v71, v76
    v_max3_f32 v9, v9, v77, v78
    v_max_f32 v9, v9, v79
    v_max_f32 v4, v8, v9
    v_cmp_lt_f32 vcc, 0x41000000, v4
    s_cmp_lg_u32 s43, 0
    s_cbranch_scc1 L_k2_attn_kernel_resc_87
    s_cbranch_vccz L_k2_attn_kernel_nr_84
L_k2_attn_kernel_resc_87:
    v_mov_b32 v6, v8
    s_nop 1
    v_permlane16_swap_b32 v8, v6
    v_max_f32 v8, v8, v6
    v_mov_b32 v6, v8
    s_nop 1
    v_permlane32_swap_b32 v8, v6
    v_max_f32 v8, v8, v6
    v_mov_b32 v6, v9
    s_nop 1
    v_permlane16_swap_b32 v9, v6
    v_max_f32 v9, v9, v6
    v_mov_b32 v6, v9
    s_nop 1
    v_permlane32_swap_b32 v9, v6
    v_max_f32 v9, v9, v6
    s_cmp_lg_u32 s43, 0
    s_cbranch_scc1 L_k2_attn_kernel_first_85
    v_max_f32 v8, 0, v8
    v_sub_f32 v20, 0, v8
    v_exp_f32 v20, v20
    v_max_f32 v9, 0, v9
    v_sub_f32 v21, 0, v9
    v_exp_f32 v21, v21
    s_mov_b32 s44, 1
    s_mov_b64 s[30:31], -1
    s_branch L_k2_attn_kernel_join_86
L_k2_attn_kernel_first_85:
    s_mov_b32 s43, 0
    v_cmp_eq_f32 vcc, 0xff800000, v8
    s_nop 1
    v_cndmask_b32 v8, v8, 0, vcc
    v_cmp_eq_f32 vcc, 0xff800000, v9
    s_nop 1
    v_cndmask_b32 v9, v9, 0, vcc
L_k2_attn_kernel_join_86:
    v_add_f32 v18, v18, v8
    v_sub_f32 v64, v64, v8
    v_sub_f32 v65, v65, v8
    v_sub_f32 v66, v66, v8
    v_sub_f32 v67, v67, v8
    v_sub_f32 v72, v72, v8
    v_sub_f32 v73, v73, v8
    v_sub_f32 v74, v74, v8
    v_sub_f32 v75, v75, v8
    v_sub_f32 v112, 0, v18
    v_sub_f32 v113, 0, v18
    v_sub_f32 v114, 0, v18
    v_sub_f32 v115, 0, v18
    v_add_f32 v19, v19, v9
    v_sub_f32 v68, v68, v9
    v_sub_f32 v69, v69, v9
    v_sub_f32 v70, v70, v9
    v_sub_f32 v71, v71, v9
    v_sub_f32 v76, v76, v9
    v_sub_f32 v77, v77, v9
    v_sub_f32 v78, v78, v9
    v_sub_f32 v79, v79, v9
    v_sub_f32 v116, 0, v19
    v_sub_f32 v117, 0, v19
    v_sub_f32 v118, 0, v19
    v_sub_f32 v119, 0, v19
L_k2_attn_kernel_nr_84:
    s_cmp_le_u32 s41, s42
    s_cbranch_scc1 L_k2_attn_kernel_ninf_88
    v_mov_b32 v112, 0xff800000
    v_mov_b32 v113, 0xff800000
    v_mov_b32 v114, 0xff800000
    v_mov_b32 v115, 0xff800000
    v_mov_b32 v116, 0xff800000
    v_mov_b32 v117, 0xff800000
    v_mov_b32 v118, 0xff800000
    v_mov_b32 v119, 0xff800000
L_k2_attn_kernel_ninf_88:
    s_nop 1
    s_setpc_b64 s[90:91]
L_k2_attn_kernel_SLOWP_4:
    s_nop 7
    s_mov_b64 s[30:31], 0
    s_cmp_eq_u32 s44, 0
    s_cbranch_scc1 L_k2_attn_kernel_np_89
    v_mul_f32 v160, v160, v20
    v_mul_f32 v161, v161, v20
    v_mul_f32 v162, v162, v20
    v_mul_f32 v163, v163, v20
    v_mul_f32 v164, v164, v21
    v_mul_f32 v165, v165, v21
    v_mul_f32 v166, v166, v21
    v_mul_f32 v167, v167, v21
    v_mul_f32 v168, v168, v20
    v_mul_f32 v169, v169, v20
    v_mul_f32 v170, v170, v20
    v_mul_f32 v171, v171, v20
    v_mul_f32 v172, v172, v21
    v_mul_f32 v173, v173, v21
    v_mul_f32 v174, v174, v21
    v_mul_f32 v175, v175, v21
    v_mul_f32 v176, v176, v20
    v_mul_f32 v177, v177, v20
    v_mul_f32 v178, v178, v20
    v_mul_f32 v179, v179, v20
    v_mul_f32 v180, v180, v21
    v_mul_f32 v181, v181, v21
    v_mul_f32 v182, v182, v21
    v_mul_f32 v183, v183, v21
    v_mul_f32 v184, v184, v20
    v_mul_f32 v185, v185, v20
    v_mul_f32 v186, v186, v20
    v_mul_f32 v187, v187, v20
    v_mul_f32 v188, v188, v21
    v_mul_f32 v189, v189, v21
    v_mul_f32 v190, v190, v21
    v_mul_f32 v191, v191, v21
    v_mul_f32 v192, v192, v20
    v_mul_f32 v193, v193, v20
    v_mul_f32 v194, v194, v20
    v_mul_f32 v195, v195, v20
    v_mul_f32 v196, v196, v21
    v_mul_f32 v197, v197, v21
    v_mul_f32 v198, v198, v21
    v_mul_f32 v199, v199, v21
    v_mul_f32 v200, v200, v20
    v_mul_f32 v201, v201, v20
    v_mul_f32 v202, v202, v20
    v_mul_f32 v203, v203, v20
    v_mul_f32 v204, v204, v21
    v_mul_f32 v205, v205, v21
    v_mul_f32 v206, v206, v21
    v_mul_f32 v207, v207, v21
    v_mul_f32 v208, v208, v20
    v_mul_f32 v209, v209, v20
    v_mul_f32 v210, v210, v20
    v_mul_f32 v211, v211, v20
    v_mul_f32 v212, v212, v21
    v_mul_f32 v213, v213, v21
    v_mul_f32 v214, v214, v21
    v_mul_f32 v215, v215, v21
    v_mul_f32 v216, v216, v20
    v_mul_f32 v217, v217, v20
    v_mul_f32 v218, v218, v20
    v_mul_f32 v219, v219, v20
    v_mul_f32 v220, v220, v21
    v_mul_f32 v221, v221, v21
    v_mul_f32 v222, v222, v21
    v_mul_f32 v223, v223, v21
    v_mul_f32 v224, v224, v20
    v_mul_f32 v225, v225, v20
    v_mul_f32 v226, v226, v20
    v_mul_f32 v227, v227, v20
    v_mul_f32 v228, v228, v21
    v_mul_f32 v229, v229, v21
    v_mul_f32 v230, v230, v21
    v_mul_f32 v231, v231, v21
    s_mov_b32 s44, 0
L_k2_attn_kernel_np_89:
    s_nop 1
    s_setpc_b64 s[90:91]
L_k2_attn_kernel_RPK_5:
    s_add_u32 s84, s84, 2
    s_cmp_eq_u32 s75, -1
    s_cbranch_scc1 L_k2_attn_kernel_rp1_90
    s_cmp_eq_u32 s83, -1
    s_cselect_b32 s74, 9, 10
    s_cselect_b32 s77, 4, 1
    s_lshl_b32 s77, s77, 9
    v_lshrrev_b32 v6, 4, v1
    v_lshlrev_b32 v7, s74, v6
    v_bfe_u32 v8, v1, 2, 2
    v_lshl_add_u32 v7, v8, 7, v7
    v_and_b32 v8, 3, v1
    v_lshl_add_u32 v7, v8, 3, v7
    v_add_u32 v7, s88, v7
    v_add_u32 v8, s77, v7
    ds_read_b64_tr_b16 v[80:81], v7 offset:0
    ds_read_b64_tr_b16 v[82:83], v8 offset:0
    ds_read_b64_tr_b16 v[84:85], v7 offset:32
    ds_read_b64_tr_b16 v[86:87], v8 offset:32
    ds_read_b64_tr_b16 v[88:89], v7 offset:64
    ds_read_b64_tr_b16 v[90:91], v8 offset:64
    ds_read_b64_tr_b16 v[92:93], v7 offset:96
    ds_read_b64_tr_b16 v[94:95], v8 offset:96
    v_mul_u32_u24 v7, s81, v6
    v_bfe_u32 v8, v1, 3, 1
    v_mul_u32_u24 v8, s80, v8
    v_and_b32 v9, 7, v1
    v_lshlrev_b32 v9, 4, v9
    v_add3_u32 v7, v7, v8, v9
    s_waitcnt lgkmcnt(0)
    buffer_store_dwordx4 v[80:83], v7, s[12:15], s79 offen sc1
    s_add_u32 s79, s79, s82
    buffer_store_dwordx4 v[84:87], v7, s[12:15], s79 offen sc1
    s_add_u32 s79, s79, s82
    buffer_store_dwordx4 v[88:91], v7, s[12:15], s79 offen sc1
    s_add_u32 s79, s79, s82
    buffer_store_dwordx4 v[92:95], v7, s[12:15], s79 offen sc1
    s_cmp_eq_u32 s83, -1
    s_cbranch_scc1 L_k2_attn_kernel_uE_92
    s_cmp_eq_u32 s80, 128
    s_cselect_b32 s74, 32, 576
    v_lshrrev_b32 v7, 1, v6
    v_mul_u32_u24 v7, s74, v7
    v_and_b32 v8, 1, v6
    v_lshl_add_u32 v7, v8, 4, v7
    v_and_b32 v8, 15, v1
    v_cmp_eq_u32 vcc, 0, v8
    v_mov_b32 v8, 0x7f000000
    s_nop 0
    v_cndmask_b32 v7, v8, v7, vcc
    s_lshl_b32 s74, s74, 1
    v_mfma_f32_16x16x32_bf16 v[124:127], v[80:83], v[120:123], 0
    v_mfma_f32_16x16x32_bf16 v[80:83], v[84:87], v[120:123], 0
    v_mfma_f32_16x16x32_bf16 v[84:87], v[88:91], v[120:123], 0
    v_mfma_f32_16x16x32_bf16 v[88:91], v[92:95], v[120:123], 0
    s_nop 4
    buffer_store_dwordx4 v[124:127], v7, s[12:15], s83 offen sc1
    s_add_u32 s83, s83, s74
    buffer_store_dwordx4 v[80:83], v7, s[12:15], s83 offen sc1
    s_add_u32 s83, s83, s74
    buffer_store_dwordx4 v[84:87], v7, s[12:15], s83 offen sc1
    s_add_u32 s83, s83, s74
    buffer_store_dwordx4 v[88:91], v7, s[12:15], s83 offen sc1
L_k2_attn_kernel_uE_92:
    s_mov_b32 s85, 4
L_k2_attn_kernel_rp1_90:
    s_cmp_ge_u32 s86, 5040
    s_cbranch_scc1 L_k2_attn_kernel_rpskip_91
    s_cmp_ge_u32 s86, 2448
    s_cbranch_scc1 L_k2_attn_kernel_uC_93
    s_cmp_ge_u32 s86, 1152
    s_cselect_b32 s74, 1152, 0
    s_cselect_b32 s8, s68, s66
    s_cselect_b32 s9, s69, s67
    s_cselect_b32 s82, 9, 8
    s_cselect_b32 s79, 6, 0
    s_mul_i32 s10, s82, 589824
    s_sub_u32 s74, s86, s74
    s_mul_i32 s75, s74, 7282
    s_lshr_b32 s75, s75, 16
    s_mul_i32 s76, s75, 9
    s_sub_u32 s76, s74, s76
    s_movk_i32 s78, 1152
    s_lshl_b32 s79, s79, 20
    s_add_u32 s79, s79, 88080384
    s_mul_i32 s80, s82, 73728
    s_mul_i32 s74, s75, 4608
    s_add_u32 s79, s79, s74
    s_mul_i32 s74, s76, s80
    s_cmp_eq_u32 s76, 8
    s_cselect_b32 s74, 4096, s74
    s_add_u32 s79, s79, s74
    s_lshl_b32 s82, s80, 1
    s_cmp_eq_u32 s76, 8
    s_cselect_b32 s82, s82, 1024
    s_cselect_b32 s80, s80, 128
    s_cselect_b32 s81, 1, 2
    s_lshl_b32 s81, s81, 7
    s_mov_b32 s83, -1
    s_branch L_k2_attn_kernel_uJ_94
L_k2_attn_kernel_uC_93:
    s_sub_u32 s74, s86, 2448
    s_cmp_ge_u32 s74, 1296
    s_cselect_b32 s81, 1296, 0
    s_cselect_b32 s8, s72, s70
    s_cselect_b32 s9, s73, s71
    s_cselect_b32 s82, 1, 0
    s_mov_b32 s10, 5308416
    s_sub_u32 s74, s74, s81
    s_mul_i32 s75, s74, 3641
    s_lshr_b32 s75, s75, 18
    s_mul_i32 s76, s75, 72
    s_sub_u32 s76, s74, s76
    s_movk_i32 s78, 9216
    s_mul_i32 s74, s76, 144
    s_lshl_b32 s80, s82, 6
    s_add_u32 s74, s74, s80
    s_sub_u32 s80, s76, 64
    s_mul_i32 s80, s80, 1152
    s_add_u32 s80, s80, 128
    s_lshl_b32 s81, s82, 3
    s_cmp_ge_u32 s76, 64
    s_cselect_b32 s74, s80, s74
    s_cselect_b32 s81, s81, 0
    s_mul_i32 s79, s74, 1152
    s_add_u32 s83, s74, s81
    s_lshl_b32 s81, s81, 4
    s_add_u32 s79, s79, s81
    s_lshl_b32 s74, s75, 10
    s_add_u32 s79, s79, s74
    s_add_u32 s79, s79, 100663296
    s_mul_i32 s74, s75, 9216
    s_add_u32 s83, s83, s74
    s_lshl_b32 s83, s83, 2
    s_add_u32 s83, s83, 130023424
    s_movk_i32 s81, 256
    s_cmp_ge_u32 s76, 64
    s_cselect_b32 s80, 1296, 1
    s_cselect_b32 s82, 18, 1
    s_lshl_b32 s80, s80, 7
    s_mul_i32 s82, s82, 18432
L_k2_attn_kernel_uJ_94:
    s_mov_b32 s11, 0x00020000
    s_mul_i32 s77, s75, s78
    s_lshl_b32 s77, s77, 5
    s_lshl_b32 s74, s76, 7
    s_add_u32 s77, s77, s74
    v_lshrrev_b32 v6, 3, v1
    v_mul_u32_u24 v6, s78, v6
    v_and_b32 v7, 7, v1
    v_lshl_add_u32 v6, v7, 4, v6
    s_lshl_b32 s74, s78, 3
    s_sub_u32 s74, s74, 1024
    s_mov_b32 m0, s88
    s_nop 0
    buffer_load_dwordx4 v6, s[8:11], s77 offen offset:0 lds
    s_add_u32 s77, s77, s74
    buffer_load_dwordx4 v6, s[8:11], s77 offen offset:1024 lds
    s_add_u32 s77, s77, s74
    buffer_load_dwordx4 v6, s[8:11], s77 offen offset:2048 lds
    s_add_u32 s77, s77, s74
    buffer_load_dwordx4 v6, s[8:11], s77 offen offset:3072 lds
    s_add_u32 s86, s86, 2048
    s_add_u32 s85, s85, 4
    s_nop 1
    s_setpc_b64 s[90:91]
L_k2_attn_kernel_rpskip_91:
    s_mov_b32 s84, 99
    s_nop 1
    s_setpc_b64 s[90:91]

.section .rodata,"a"
.p2align 6
.amdhsa_kernel k2_attn_kernel
  .amdhsa_next_free_vgpr 240
  .amdhsa_next_free_sgpr 102
  .amdhsa_accum_offset 240
  .amdhsa_group_segment_fixed_size 0
  .amdhsa_kernarg_size 104
  .amdhsa_user_sgpr_count 2
  .amdhsa_user_sgpr_kernarg_segment_ptr 1
  .amdhsa_system_sgpr_workgroup_id_x 1
.end_amdhsa_kernel
.text
.globl k3_outproj_kernel
.p2align 8
.type k3_outproj_kernel,@function
k3_outproj_kernel:
    s_cmp_ge_u32 s2, 256
    s_cbranch_scc1 L_k3_outproj_kernel_done_1
    s_load_dwordx2 s[28:29], s[0:1], 96
    s_load_dwordx2 s[30:31], s[0:1], 0
    s_load_dwordx2 s[32:33], s[0:1], 96
    v_lshrrev_b32 v8, 6, v0
    v_and_b32 v1, 63, v0
    v_readfirstlane_b32 s36, v8
    s_and_b32 s41, s2, 7
    s_lshr_b32 s34, s41, 0
    s_lshl_b32 s34, s34, 2
    s_and_b32 s35, s41, 0
    s_lshl_b32 s35, s35, 3
    s_lshr_b32 s41, s2, 3
    s_and_b32 s42, s41, 3
    s_add_u32 s34, s34, s42
    s_lshr_b32 s41, s41, 2
    s_add_u32 s35, s35, s41
    v_lshlrev_b32 v2, 4, v1
    v_add_u32 v3, 131072, v2
    v_add_u32 v4, 262144, v2
    v_add_u32 v5, 393216, v2
    v_mov_b32 v6, v2
    v_lshrrev_b32 v8, 4, v1
    v_and_b32 v9, 15, v1
    v_lshl_add_u32 v8, v8, 3, v9
    v_lshlrev_b32 v8, 4, v8
    v_add_u32 v8, 4096, v8
    v_cmp_gt_u32 vcc, 8, v9
    v_mov_b32 v10, 0x7f000000
    s_nop 0
    v_cndmask_b32 v7, v10, v8, vcc
    s_mul_i32 s39, s36, 21504
    s_waitcnt lgkmcnt(0)
    s_add_u32 s8, s28, 50331648
    s_addc_u32 s9, s29, 0
    s_mov_b32 s10, 16777216
    s_mov_b32 s11, 0x00020000
    s_add_u32 s12, s28, 88080384
    s_addc_u32 s13, s29, 0
    s_mov_b32 s14, 4718592
    s_mov_b32 s15, 0x00020000
    s_mul_i32 s37, s34, 512
    s_add_u32 s37, s37, s36
    s_lshl_b32 s37, s37, 10
    s_mul_i32 s38, s35, 128
    s_add_u32 s38, s38, s36
    s_mul_i32 s38, s38, 4608
    buffer_load_dwordx4 v[16:19], v2, s[8:11], s37 offen
    buffer_load_dwordx4 v[20:23], v3, s[8:11], s37 offen
    buffer_load_dwordx4 v[24:27], v4, s[8:11], s37 offen
    buffer_load_dwordx4 v[28:31], v5, s[8:11], s37 offen
    buffer_load_dwordx4 v[32:35], v6, s[12:15], s38 offen offset:0
    buffer_load_dwordx4 v[36:39], v6, s[12:15], s38 offen offset:1024
    buffer_load_dwordx4 v[40:43], v6, s[12:15], s38 offen offset:2048
    buffer_load_dwordx4 v[44:47], v6, s[12:15], s38 offen offset:3072
    buffer_load_dwordx4 v[48:51], v7, s[12:15], s38 offen
    s_add_u32 s37, s37, 4096
    s_add_u32 s38, s38, 18432
    buffer_load_dwordx4 v[52:55], v2, s[8:11], s37 offen
    buffer_load_dwordx4 v[56:59], v3, s[8:11], s37 offen
    buffer_load_dwordx4 v[60:63], v4, s[8:11], s37 offen
    buffer_load_dwordx4 v[64:67], v5, s[8:11], s37 offen
    buffer_load_dwordx4 v[68:71], v6, s[12:15], s38 offen offset:0
    buffer_load_dwordx4 v[72:75], v6, s[12:15], s38 offen offset:1024
    buffer_load_dwordx4 v[76:79], v6, s[12:15], s38 offen offset:2048
    buffer_load_dwordx4 v[80:83], v6, s[12:15], s38 offen offset:3072
    buffer_load_dwordx4 v[84:87], v7, s[12:15], s38 offen
    s_add_u32 s37, s37, 4096
    s_add_u32 s38, s38, 18432
    buffer_load_dwordx4 v[88:91], v2, s[8:11], s37 offen
    buffer_load_dwordx4 v[92:95], v3, s[8:11], s37 offen
    buffer_load_dwordx4 v[96:99], v4, s[8:11], s37 offen
    buffer_load_dwordx4 v[100:103], v5, s[8:11], s37 offen
    buffer_load_dwordx4 v[104:107], v6, s[12:15], s38 offen offset:0
    buffer_load_dwordx4 v[108:111], v6, s[12:15], s38 offen offset:1024
    buffer_load_dwordx4 v[112:115], v6, s[12:15], s38 offen offset:2048
    buffer_load_dwordx4 v[116:119], v6, s[12:15], s38 offen offset:3072
    buffer_load_dwordx4 v[120:123], v7, s[12:15], s38 offen
    s_add_u32 s37, s37, 4096
    s_add_u32 s38, s38, 18432
    s_add_u32 s20, s32, 4194304
    s_addc_u32 s21, s33, 0
    s_mov_b32 s22, 2359296
    s_mov_b32 s23, 0x00020000
    s_add_u32 s24, s28, 8388608
    s_addc_u32 s25, s29, 0
    s_mov_b32 s26, 4325376
    s_mov_b32 s27, 0x00020000
    s_lshl_b32 s49, s34, 6
    s_mul_i32 s49, s49, 1152
    s_mul_i32 s50, s34, 73728
    s_lshl_b32 s42, s35, 3
    s_add_u32 s41, s35, 64
    s_mov_b32 s16, s30
    s_mov_b32 s17, s31
    s_mov_b32 s18, 2359296
    s_mov_b32 s19, 0x00020000
    v_mul_u32_u24 v240, 336, v1
    v_mul_u32_u24 v241, 1152, v1
    v_lshrrev_b32 v8, 4, v1
    v_mul_u32_u24 v242, 18432, v8
    v_and_b32 v8, 15, v1
    v_lshl_add_u32 v242, v8, 4, v242
    s_add_u32 s42, s42, s36
    s_lshl_b32 s40, s42, 4
    s_add_u32 s40, s40, s49
    buffer_load_dwordx4 a[0:3], v241, s[16:19], s40 offen
    buffer_load_dwordx4 a[4:7], v241, s[16:19], s40 offen offset:64
    s_lshl_b32 s40, s41, 4
    s_add_u32 s40, s40, s49
    buffer_load_dwordx4 a[8:11], v241, s[16:19], s40 offen
    s_add_u32 s16, s28, 130023424
    s_addc_u32 s17, s29, 0
    s_mov_b32 s18, 663552
    s_mov_b32 s19, 0x00020000
    v_lshlrev_b32 v243, 2, v1
    v_cmp_gt_u32 vcc, 9, v1
    v_mov_b32 v8, 0x7f000000
    s_nop 0
    v_cndmask_b32 v243, v8, v243, vcc
    s_lshl_b32 s51, s2, 2
    s_add_u32 s51, s51, s36
    s_mul_i32 s51, s51, 36
    s_mov_b32 s40, s51
    buffer_load_dword a12, v243, s[16:19], s40 offen
    s_add_u32 s40, s40, 36864
    buffer_load_dword a13, v243, s[16:19], s40 offen
    s_add_u32 s40, s40, 36864
    buffer_load_dword a14, v243, s[16:19], s40 offen
    s_add_u32 s40, s40, 36864
    buffer_load_dword a15, v243, s[16:19], s40 offen
    s_add_u32 s40, s40, 36864
    buffer_load_dword a16, v243, s[16:19], s40 offen
    s_add_u32 s40, s40, 36864
    buffer_load_dword a17, v243, s[16:19], s40 offen
    s_add_u32 s40, s40, 36864
    buffer_load_dword a18, v243, s[16:19], s40 offen
    s_add_u32 s40, s40, 36864
    buffer_load_dword a19, v243, s[16:19], s40 offen
    s_add_u32 s40, s40, 36864
    buffer_load_dword a20, v243, s[16:19], s40 offen
    s_add_u32 s40, s40, 36864
    buffer_load_dword a21, v243, s[16:19], s40 offen
    s_add_u32 s40, s40, 36864
    buffer_load_dword a22, v243, s[16:19], s40 offen
    s_add_u32 s40, s40, 36864
    buffer_load_dword a23, v243, s[16:19], s40 offen
    s_add_u32 s40, s40, 36864
    buffer_load_dword a24, v243, s[16:19], s40 offen
    s_add_u32 s40, s40, 36864
    buffer_load_dword a25, v243, s[16:19], s40 offen
    s_add_u32 s40, s40, 36864
    buffer_load_dword a26, v243, s[16:19], s40 offen
    s_add_u32 s40, s40, 36864
    buffer_load_dword a27, v243, s[16:19], s40 offen
    s_add_u32 s40, s40, 36864
    buffer_load_dword a28, v243, s[16:19], s40 offen
    s_add_u32 s40, s40, 36864
    buffer_load_dword a29, v243, s[16:19], s40 offen
    s_add_u32 s16, s28, 13631488
    s_addc_u32 s17, s29, 0
    s_mov_b32 s18, 36864
    s_mov_b32 s19, 0x00020000
    v_and_b32 v8, 15, v1
    v_mul_u32_u24 v8, 336, v8
    v_lshrrev_b32 v9, 4, v1
    v_lshl_add_u32 v8, v9, 4, v8
    v_add_u32 v248, s39, v8
    v_mov_b32 v160, 0
    v_mov_b32 v161, 0
    v_mov_b32 v162, 0
    v_mov_b32 v163, 0
    v_mov_b32 v164, 0
    v_mov_b32 v165, 0
    v_mov_b32 v166, 0
    v_mov_b32 v167, 0
    v_mov_b32 v168, 0
    v_mov_b32 v169, 0
    v_mov_b32 v170, 0
    v_mov_b32 v171, 0
    v_mov_b32 v172, 0
    v_mov_b32 v173, 0
    v_mov_b32 v174, 0
    v_mov_b32 v175, 0
    v_mov_b32 v176, 0
    v_mov_b32 v177, 0
    v_mov_b32 v178, 0
    v_mov_b32 v179, 0
    v_mov_b32 v180, 0
    v_mov_b32 v181, 0
    v_mov_b32 v182, 0
    v_mov_b32 v183, 0
    v_mov_b32 v184, 0
    v_mov_b32 v185, 0
    v_mov_b32 v186, 0
    v_mov_b32 v187, 0
    v_mov_b32 v188, 0
    v_mov_b32 v189, 0
    v_mov_b32 v190, 0
    v_mov_b32 v191, 0
    v_mov_b32 v192, 0
    v_mov_b32 v193, 0
    v_mov_b32 v194, 0
    v_mov_b32 v195, 0
    v_mov_b32 v196, 0
    v_mov_b32 v197, 0
    v_mov_b32 v198, 0
    v_mov_b32 v199, 0
    v_mov_b32 v200, 0
    v_mov_b32 v201, 0
    v_mov_b32 v202, 0
    v_mov_b32 v203, 0
    v_mov_b32 v204, 0
    v_mov_b32 v205, 0
    v_mov_b32 v206, 0
    v_mov_b32 v207, 0
    v_mov_b32 v208, 0
    v_mov_b32 v209, 0
    v_mov_b32 v210, 0
    v_mov_b32 v211, 0
    v_mov_b32 v212, 0
    v_mov_b32 v213, 0
    v_mov_b32 v214, 0
    v_mov_b32 v215, 0
    v_mov_b32 v216, 0
    v_mov_b32 v217, 0
    v_mov_b32 v218, 0
    v_mov_b32 v219, 0
    v_mov_b32 v220, 0
    v_mov_b32 v221, 0
    v_mov_b32 v222, 0
    v_mov_b32 v223, 0
    v_mov_b32 v224, 0
    v_mov_b32 v225, 0
    v_mov_b32 v226, 0
    v_mov_b32 v227, 0
    v_mov_b32 v228, 0
    v_mov_b32 v229, 0
    v_mov_b32 v230, 0
    v_mov_b32 v231, 0
    v_mov_b32 v232, 0
    v_mov_b32 v233, 0
    v_mov_b32 v234, 0
    v_mov_b32 v235, 0
    v_mov_b32 v236, 0
    v_mov_b32 v237, 0
    v_mov_b32 v238, 0
    v_mov_b32 v239, 0
    s_mov_b32 s40, 7
L_k3_outproj_kernel_loop_2:
    buffer_load_dwordx4 v[124:127], v2, s[8:11], s37 offen
    buffer_load_dwordx4 v[128:131], v3, s[8:11], s37 offen
    buffer_load_dwordx4 v[132:135], v4, s[8:11], s37 offen
    buffer_load_dwordx4 v[136:139], v5, s[8:11], s37 offen
    buffer_load_dwordx4 v[140:143], v6, s[12:15], s38 offen offset:0
    buffer_load_dwordx4 v[144:147], v6, s[12:15], s38 offen offset:1024
    buffer_load_dwordx4 v[148:151], v6, s[12:15], s38 offen offset:2048
    buffer_load_dwordx4 v[152:155], v6, s[12:15], s38 offen offset:3072
    buffer_load_dwordx4 v[156:159], v7, s[12:15], s38 offen
    s_add_u32 s37, s37, 4096
    s_add_u32 s38, s38, 18432
    s_waitcnt vmcnt(27)
    v_mfma_f32_16x16x32_bf16 v[160:163], v[32:35], v[16:19], v[160:163]
    v_mfma_f32_16x16x32_bf16 v[164:167], v[32:35], v[20:23], v[164:167]
    v_mfma_f32_16x16x32_bf16 v[168:171], v[32:35], v[24:27], v[168:171]
    v_mfma_f32_16x16x32_bf16 v[172:175], v[32:35], v[28:31], v[172:175]
    v_mfma_f32_16x16x32_bf16 v[176:179], v[36:39], v[16:19], v[176:179]
    v_mfma_f32_16x16x32_bf16 v[180:183], v[36:39], v[20:23], v[180:183]
    v_mfma_f32_16x16x32_bf16 v[184:187], v[36:39], v[24:27], v[184:187]
    v_mfma_f32_16x16x32_bf16 v[188:191], v[36:39], v[28:31], v[188:191]
    v_mfma_f32_16x16x32_bf16 v[192:195], v[40:43], v[16:19], v[192:195]
    v_mfma_f32_16x16x32_bf16 v[196:199], v[40:43], v[20:23], v[196:199]
    v_mfma_f32_16x16x32_bf16 v[200:203], v[40:43], v[24:27], v[200:203]
    v_mfma_f32_16x16x32_bf16 v[204:207], v[40:43], v[28:31], v[204:207]
    v_mfma_f32_16x16x32_bf16 v[208:211], v[44:47], v[16:19], v[208:211]
    v_mfma_f32_16x16x32_bf16 v[212:215], v[44:47], v[20:23], v[212:215]
    v_mfma_f32_16x16x32_bf16 v[216:219], v[44:47], v[24:27], v[216:219]
    v_mfma_f32_16x16x32_bf16 v[220:223], v[44:47], v[28:31], v[220:223]
    v_mfma_f32_16x16x32_bf16 v[224:227], v[48:51], v[16:19], v[224:227]
    v_mfma_f32_16x16x32_bf16 v[228:231], v[48:51], v[20:23], v[228:231]
    v_mfma_f32_16x16x32_bf16 v[232:235], v[48:51], v[24:27], v[232:235]
    v_mfma_f32_16x16x32_bf16 v[236:239], v[48:51], v[28:31], v[236:239]
    buffer_load_dwordx4 v[16:19], v2, s[8:11], s37 offen
    buffer_load_dwordx4 v[20:23], v3, s[8:11], s37 offen
    buffer_load_dwordx4 v[24:27], v4, s[8:11], s37 offen
    buffer_load_dwordx4 v[28:31], v5, s[8:11], s37 offen
    buffer_load_dwordx4 v[32:35], v6, s[12:15], s38 offen offset:0
    buffer_load_dwordx4 v[36:39], v6, s[12:15], s38 offen offset:1024
    buffer_load_dwordx4 v[40:43], v6, s[12:15], s38 offen offset:2048
    buffer_load_dwordx4 v[44:47], v6, s[12:15], s38 offen offset:3072
    buffer_load_dwordx4 v[48:51], v7, s[12:15], s38 offen
    s_add_u32 s37, s37, 4096
    s_add_u32 s38, s38, 18432
    s_waitcnt vmcnt(27)
    v_mfma_f32_16x16x32_bf16 v[160:163], v[68:71], v[52:55], v[160:163]
    v_mfma_f32_16x16x32_bf16 v[164:167], v[68:71], v[56:59], v[164:167]
    v_mfma_f32_16x16x32_bf16 v[168:171], v[68:71], v[60:63], v[168:171]
    v_mfma_f32_16x16x32_bf16 v[172:175], v[68:71], v[64:67], v[172:175]
    v_mfma_f32_16x16x32_bf16 v[176:179], v[72:75], v[52:55], v[176:179]
    v_mfma_f32_16x16x32_bf16 v[180:183], v[72:75], v[56:59], v[180:183]
    v_mfma_f32_16x16x32_bf16 v[184:187], v[72:75], v[60:63], v[184:187]
    v_mfma_f32_16x16x32_bf16 v[188:191], v[72:75], v[64:67], v[188:191]
    v_mfma_f32_16x16x32_bf16 v[192:195], v[76:79], v[52:55], v[192:195]
    v_mfma_f32_16x16x32_bf16 v[196:199], v[76:79], v[56:59], v[196:199]
    v_mfma_f32_16x16x32_bf16 v[200:203], v[76:79], v[60:63], v[200:203]
    v_mfma_f32_16x16x32_bf16 v[204:207], v[76:79], v[64:67], v[204:207]
    v_mfma_f32_16x16x32_bf16 v[208:211], v[80:83], v[52:55], v[208:211]
    v_mfma_f32_16x16x32_bf16 v[212:215], v[80:83], v[56:59], v[212:215]
    v_mfma_f32_16x16x32_bf16 v[216:219], v[80:83], v[60:63], v[216:219]
    v_mfma_f32_16x16x32_bf16 v[220:223], v[80:83], v[64:67], v[220:223]
    v_mfma_f32_16x16x32_bf16 v[224:227], v[84:87], v[52:55], v[224:227]
    v_mfma_f32_16x16x32_bf16 v[228:231], v[84:87], v[56:59], v[228:231]
    v_mfma_f32_16x16x32_bf16 v[232:235], v[84:87], v[60:63], v[232:235]
    v_mfma_f32_16x16x32_bf16 v[236:239], v[84:87], v[64:67], v[236:239]
    buffer_load_dwordx4 v[52:55], v2, s[8:11], s37 offen
    buffer_load_dwordx4 v[56:59], v3, s[8:11], s37 offen
    buffer_load_dwordx4 v[60:63], v4, s[8:11], s37 offen
    buffer_load_dwordx4 v[64:67], v5, s[8:11], s37 offen
    buffer_load_dwordx4 v[68:71], v6, s[12:15], s38 offen offset:0
    buffer_load_dwordx4 v[72:75], v6, s[12:15], s38 offen offset:1024
    buffer_load_dwordx4 v[76:79], v6, s[12:15], s38 offen offset:2048
    buffer_load_dwordx4 v[80:83], v6, s[12:15], s38 offen offset:3072
    buffer_load_dwordx4 v[84:87], v7, s[12:15], s38 offen
    s_add_u32 s37, s37, 4096
    s_add_u32 s38, s38, 18432
    s_waitcnt vmcnt(27)
    v_mfma_f32_16x16x32_bf16 v[160:163], v[104:107], v[88:91], v[160:163]
    v_mfma_f32_16x16x32_bf16 v[164:167], v[104:107], v[92:95], v[164:167]
    v_mfma_f32_16x16x32_bf16 v[168:171], v[104:107], v[96:99], v[168:171]
    v_mfma_f32_16x16x32_bf16 v[172:175], v[104:107], v[100:103], v[172:175]
    v_mfma_f32_16x16x32_bf16 v[176:179], v[108:111], v[88:91], v[176:179]
    v_mfma_f32_16x16x32_bf16 v[180:183], v[108:111], v[92:95], v[180:183]
    v_mfma_f32_16x16x32_bf16 v[184:187], v[108:111], v[96:99], v[184:187]
    v_mfma_f32_16x16x32_bf16 v[188:191], v[108:111], v[100:103], v[188:191]
    v_mfma_f32_16x16x32_bf16 v[192:195], v[112:115], v[88:91], v[192:195]
    v_mfma_f32_16x16x32_bf16 v[196:199], v[112:115], v[92:95], v[196:199]
    v_mfma_f32_16x16x32_bf16 v[200:203], v[112:115], v[96:99], v[200:203]
    v_mfma_f32_16x16x32_bf16 v[204:207], v[112:115], v[100:103], v[204:207]
    v_mfma_f32_16x16x32_bf16 v[208:211], v[116:119], v[88:91], v[208:211]
    v_mfma_f32_16x16x32_bf16 v[212:215], v[116:119], v[92:95], v[212:215]
    v_mfma_f32_16x16x32_bf16 v[216:219], v[116:119], v[96:99], v[216:219]
    v_mfma_f32_16x16x32_bf16 v[220:223], v[116:119], v[100:103], v[220:223]
    v_mfma_f32_16x16x32_bf16 v[224:227], v[120:123], v[88:91], v[224:227]
    v_mfma_f32_16x16x32_bf16 v[228:231], v[120:123], v[92:95], v[228:231]
    v_mfma_f32_16x16x32_bf16 v[232:235], v[120:123], v[96:99], v[232:235]
    v_mfma_f32_16x16x32_bf16 v[236:239], v[120:123], v[100:103], v[236:239]
    buffer_load_dwordx4 v[88:91], v2, s[8:11], s37 offen
    buffer_load_dwordx4 v[92:95], v3, s[8:11], s37 offen
    buffer_load_dwordx4 v[96:99], v4, s[8:11], s37 offen
    buffer_load_dwordx4 v[100:103], v5, s[8:11], s37 offen
    buffer_load_dwordx4 v[104:107], v6, s[12:15], s38 offen offset:0
    buffer_load_dwordx4 v[108:111], v6, s[12:15], s38 offen offset:1024
    buffer_load_dwordx4 v[112:115], v6, s[12:15], s38 offen offset:2048
    buffer_load_dwordx4 v[116:119], v6, s[12:15], s38 offen offset:3072
    buffer_load_dwordx4 v[120:123], v7, s[12:15], s38 offen
    s_add_u32 s37, s37, 4096
    s_add_u32 s38, s38, 18432
    s_waitcnt vmcnt(27)
    v_mfma_f32_16x16x32_bf16 v[160:163], v[140:143], v[124:127], v[160:163]
    v_mfma_f32_16x16x32_bf16 v[164:167], v[140:143], v[128:131], v[164:167]
    v_mfma_f32_16x16x32_bf16 v[168:171], v[140:143], v[132:135], v[168:171]
    v_mfma_f32_16x16x32_bf16 v[172:175], v[140:143], v[136:139], v[172:175]
    v_mfma_f32_16x16x32_bf16 v[176:179], v[144:147], v[124:127], v[176:179]
    v_mfma_f32_16x16x32_bf16 v[180:183], v[144:147], v[128:131], v[180:183]
    v_mfma_f32_16x16x32_bf16 v[184:187], v[144:147], v[132:135], v[184:187]
    v_mfma_f32_16x16x32_bf16 v[188:191], v[144:147], v[136:139], v[188:191]
    v_mfma_f32_16x16x32_bf16 v[192:195], v[148:151], v[124:127], v[192:195]
    v_mfma_f32_16x16x32_bf16 v[196:199], v[148:151], v[128:131], v[196:199]
    v_mfma_f32_16x16x32_bf16 v[200:203], v[148:151], v[132:135], v[200:203]
    v_mfma_f32_16x16x32_bf16 v[204:207], v[148:151], v[136:139], v[204:207]
    v_mfma_f32_16x16x32_bf16 v[208:211], v[152:155], v[124:127], v[208:211]
    v_mfma_f32_16x16x32_bf16 v[212:215], v[152:155], v[128:131], v[212:215]
    v_mfma_f32_16x16x32_bf16 v[216:219], v[152:155], v[132:135], v[216:219]
    v_mfma_f32_16x16x32_bf16 v[220:223], v[152:155], v[136:139], v[220:223]
    v_mfma_f32_16x16x32_bf16 v[224:227], v[156:159], v[124:127], v[224:227]
    v_mfma_f32_16x16x32_bf16 v[228:231], v[156:159], v[128:131], v[228:231]
    v_mfma_f32_16x16x32_bf16 v[232:235], v[156:159], v[132:135], v[232:235]
    v_mfma_f32_16x16x32_bf16 v[236:239], v[156:159], v[136:139], v[236:239]
    s_sub_u32 s40, s40, 1
    s_cmp_lg_u32 s40, 0
    s_cbranch_scc1 L_k3_outproj_kernel_loop_2
    buffer_load_dwordx4 v[124:127], v2, s[8:11], s37 offen
    buffer_load_dwordx4 v[128:131], v3, s[8:11], s37 offen
    buffer_load_dwordx4 v[132:135], v4, s[8:11], s37 offen
    buffer_load_dwordx4 v[136:139], v5, s[8:11], s37 offen
    buffer_load_dwordx4 v[140:143], v6, s[12:15], s38 offen offset:0
    buffer_load_dwordx4 v[144:147], v6, s[12:15], s38 offen offset:1024
    buffer_load_dwordx4 v[148:151], v6, s[12:15], s38 offen offset:2048
    buffer_load_dwordx4 v[152:155], v6, s[12:15], s38 offen offset:3072
    buffer_load_dwordx4 v[156:159], v7, s[12:15], s38 offen
    s_add_u32 s37, s37, 4096
    s_add_u32 s38, s38, 18432
    s_waitcnt vmcnt(27)
    v_mfma_f32_16x16x32_bf16 v[160:163], v[32:35], v[16:19], v[160:163]
    v_mfma_f32_16x16x32_bf16 v[164:167], v[32:35], v[20:23], v[164:167]
    v_mfma_f32_16x16x32_bf16 v[168:171], v[32:35], v[24:27], v[168:171]
    v_mfma_f32_16x16x32_bf16 v[172:175], v[32:35], v[28:31], v[172:175]
    v_mfma_f32_16x16x32_bf16 v[176:179], v[36:39], v[16:19], v[176:179]
    v_mfma_f32_16x16x32_bf16 v[180:183], v[36:39], v[20:23], v[180:183]
    v_mfma_f32_16x16x32_bf16 v[184:187], v[36:39], v[24:27], v[184:187]
    v_mfma_f32_16x16x32_bf16 v[188:191], v[36:39], v[28:31], v[188:191]
    v_mfma_f32_16x16x32_bf16 v[192:195], v[40:43], v[16:19], v[192:195]
    v_mfma_f32_16x16x32_bf16 v[196:199], v[40:43], v[20:23], v[196:199]
    v_mfma_f32_16x16x32_bf16 v[200:203], v[40:43], v[24:27], v[200:203]
    v_mfma_f32_16x16x32_bf16 v[204:207], v[40:43], v[28:31], v[204:207]
    v_mfma_f32_16x16x32_bf16 v[208:211], v[44:47], v[16:19], v[208:211]
    v_mfma_f32_16x16x32_bf16 v[212:215], v[44:47], v[20:23], v[212:215]
    v_mfma_f32_16x16x32_bf16 v[216:219], v[44:47], v[24:27], v[216:219]
    v_mfma_f32_16x16x32_bf16 v[220:223], v[44:47], v[28:31], v[220:223]
    v_mfma_f32_16x16x32_bf16 v[224:227], v[48:51], v[16:19], v[224:227]
    v_mfma_f32_16x16x32_bf16 v[228:231], v[48:51], v[20:23], v[228:231]
    v_mfma_f32_16x16x32_bf16 v[232:235], v[48:51], v[24:27], v[232:235]
    v_mfma_f32_16x16x32_bf16 v[236:239], v[48:51], v[28:31], v[236:239]
    s_waitcnt vmcnt(18)
    v_mfma_f32_16x16x32_bf16 v[160:163], v[68:71], v[52:55], v[160:163]
    v_mfma_f32_16x16x32_bf16 v[164:167], v[68:71], v[56:59], v[164:167]
    v_mfma_f32_16x16x32_bf16 v[168:171], v[68:71], v[60:63], v[168:171]
    v_mfma_f32_16x16x32_bf16 v[172:175], v[68:71], v[64:67], v[172:175]
    v_mfma_f32_16x16x32_bf16 v[176:179], v[72:75], v[52:55], v[176:179]
    v_mfma_f32_16x16x32_bf16 v[180:183], v[72:75], v[56:59], v[180:183]
    v_mfma_f32_16x16x32_bf16 v[184:187], v[72:75], v[60:63], v[184:187]
    v_mfma_f32_16x16x32_bf16 v[188:191], v[72:75], v[64:67], v[188:191]
    v_mfma_f32_16x16x32_bf16 v[192:195], v[76:79], v[52:55], v[192:195]
    v_mfma_f32_16x16x32_bf16 v[196:199], v[76:79], v[56:59], v[196:199]
    v_mfma_f32_16x16x32_bf16 v[200:203], v[76:79], v[60:63], v[200:203]
    v_mfma_f32_16x16x32_bf16 v[204:207], v[76:79], v[64:67], v[204:207]
    v_mfma_f32_16x16x32_bf16 v[208:211], v[80:83], v[52:55], v[208:211]
    v_mfma_f32_16x16x32_bf16 v[212:215], v[80:83], v[56:59], v[212:215]
    v_mfma_f32_16x16x32_bf16 v[216:219], v[80:83], v[60:63], v[216:219]
    v_mfma_f32_16x16x32_bf16 v[220:223], v[80:83], v[64:67], v[220:223]
    v_mfma_f32_16x16x32_bf16 v[224:227], v[84:87], v[52:55], v[224:227]
    v_mfma_f32_16x16x32_bf16 v[228:231], v[84:87], v[56:59], v[228:231]
    v_mfma_f32_16x16x32_bf16 v[232:235], v[84:87], v[60:63], v[232:235]
    v_mfma_f32_16x16x32_bf16 v[236:239], v[84:87], v[64:67], v[236:239]
    s_waitcnt vmcnt(9)
    v_mfma_f32_16x16x32_bf16 v[160:163], v[104:107], v[88:91], v[160:163]
    v_mfma_f32_16x16x32_bf16 v[164:167], v[104:107], v[92:95], v[164:167]
    v_mfma_f32_16x16x32_bf16 v[168:171], v[104:107], v[96:99], v[168:171]
    v_mfma_f32_16x16x32_bf16 v[172:175], v[104:107], v[100:103], v[172:175]
    v_mfma_f32_16x16x32_bf16 v[176:179], v[108:111], v[88:91], v[176:179]
    v_mfma_f32_16x16x32_bf16 v[180:183], v[108:111], v[92:95], v[180:183]
    v_mfma_f32_16x16x32_bf16 v[184:187], v[108:111], v[96:99], v[184:187]
    v_mfma_f32_16x16x32_bf16 v[188:191], v[108:111], v[100:103], v[188:191]
    v_mfma_f32_16x16x32_bf16 v[192:195], v[112:115], v[88:91], v[192:195]
    v_mfma_f32_16x16x32_bf16 v[196:199], v[112:115], v[92:95], v[196:199]
    v_mfma_f32_16x16x32_bf16 v[200:203], v[112:115], v[96:99], v[200:203]
    v_mfma_f32_16x16x32_bf16 v[204:207], v[112:115], v[100:103], v[204:207]
    v_mfma_f32_16x16x32_bf16 v[208:211], v[116:119], v[88:91], v[208:211]
    v_mfma_f32_16x16x32_bf16 v[212:215], v[116:119], v[92:95], v[212:215]
    v_mfma_f32_16x16x32_bf16 v[216:219], v[116:119], v[96:99], v[216:219]
    v_mfma_f32_16x16x32_bf16 v[220:223], v[116:119], v[100:103], v[220:223]
    v_mfma_f32_16x16x32_bf16 v[224:227], v[120:123], v[88:91], v[224:227]
    v_mfma_f32_16x16x32_bf16 v[228:231], v[120:123], v[92:95], v[228:231]
    v_mfma_f32_16x16x32_bf16 v[232:235], v[120:123], v[96:99], v[232:235]
    v_mfma_f32_16x16x32_bf16 v[236:239], v[120:123], v[100:103], v[236:239]
    s_waitcnt vmcnt(0)
    v_mfma_f32_16x16x32_bf16 v[160:163], v[140:143], v[124:127], v[160:163]
    v_mfma_f32_16x16x32_bf16 v[164:167], v[140:143], v[128:131], v[164:167]
    v_mfma_f32_16x16x32_bf16 v[168:171], v[140:143], v[132:135], v[168:171]
    v_mfma_f32_16x16x32_bf16 v[172:175], v[140:143], v[136:139], v[172:175]
    v_mfma_f32_16x16x32_bf16 v[176:179], v[144:147], v[124:127], v[176:179]
    v_mfma_f32_16x16x32_bf16 v[180:183], v[144:147], v[128:131], v[180:183]
    v_mfma_f32_16x16x32_bf16 v[184:187], v[144:147], v[132:135], v[184:187]
    v_mfma_f32_16x16x32_bf16 v[188:191], v[144:147], v[136:139], v[188:191]
    v_mfma_f32_16x16x32_bf16 v[192:195], v[148:151], v[124:127], v[192:195]
    v_mfma_f32_16x16x32_bf16 v[196:199], v[148:151], v[128:131], v[196:199]
    v_mfma_f32_16x16x32_bf16 v[200:203], v[148:151], v[132:135], v[200:203]
    v_mfma_f32_16x16x32_bf16 v[204:207], v[148:151], v[136:139], v[204:207]
    v_mfma_f32_16x16x32_bf16 v[208:211], v[152:155], v[124:127], v[208:211]
    v_mfma_f32_16x16x32_bf16 v[212:215], v[152:155], v[128:131], v[212:215]
    v_mfma_f32_16x16x32_bf16 v[216:219], v[152:155], v[132:135], v[216:219]
    v_mfma_f32_16x16x32_bf16 v[220:223], v[152:155], v[136:139], v[220:223]
    v_mfma_f32_16x16x32_bf16 v[224:227], v[156:159], v[124:127], v[224:227]
    v_mfma_f32_16x16x32_bf16 v[228:231], v[156:159], v[128:131], v[228:231]
    v_mfma_f32_16x16x32_bf16 v[232:235], v[156:159], v[132:135], v[232:235]
    v_mfma_f32_16x16x32_bf16 v[236:239], v[156:159], v[136:139], v[236:239]
    ds_write_b128 v248, v[160:163] offset:0
    ds_write_b128 v248, v[164:167] offset:5376
    ds_write_b128 v248, v[168:171] offset:10752
    ds_write_b128 v248, v[172:175] offset:16128
    ds_write_b128 v248, v[176:179] offset:64
    ds_write_b128 v248, v[180:183] offset:5440
    ds_write_b128 v248, v[184:187] offset:10816
    ds_write_b128 v248, v[188:191] offset:16192
    ds_write_b128 v248, v[192:195] offset:128
    ds_write_b128 v248, v[196:199] offset:5504
    ds_write_b128 v248, v[200:203] offset:10880
    ds_write_b128 v248, v[204:207] offset:16256
    ds_write_b128 v248, v[208:211] offset:192
    ds_write_b128 v248, v[212:215] offset:5568
    ds_write_b128 v248, v[216:219] offset:10944
    ds_write_b128 v248, v[220:223] offset:16320
    ds_write_b128 v248, v[224:227] offset:256
    ds_write_b128 v248, v[228:231] offset:5632
    ds_write_b128 v248, v[232:235] offset:11008
    ds_write_b128 v248, v[236:239] offset:16384
    v_accvgpr_read_b32 v16, a12
    v_accvgpr_read_b32 v17, a13
    v_accvgpr_read_b32 v18, a14
    v_accvgpr_read_b32 v19, a15
    v_accvgpr_read_b32 v20, a16
    v_accvgpr_read_b32 v21, a17
    v_accvgpr_read_b32 v22, a18
    v_accvgpr_read_b32 v23, a19
    v_accvgpr_read_b32 v24, a20
    v_accvgpr_read_b32 v25, a21
    v_accvgpr_read_b32 v26, a22
    v_accvgpr_read_b32 v27, a23
    v_accvgpr_read_b32 v28, a24
    v_accvgpr_read_b32 v29, a25
    v_accvgpr_read_b32 v30, a26
    v_accvgpr_read_b32 v31, a27
    v_accvgpr_read_b32 v32, a28
    v_accvgpr_read_b32 v33, a29
    v_add_f32 v16, v16, v17
    v_add_f32 v16, v16, v18
    v_add_f32 v16, v16, v19
    v_add_f32 v16, v16, v20
    v_add_f32 v16, v16, v21
    v_add_f32 v16, v16, v22
    v_add_f32 v16, v16, v23
    v_add_f32 v16, v16, v24
    v_add_f32 v16, v16, v25
    v_add_f32 v16, v16, v26
    v_add_f32 v16, v16, v27
    v_add_f32 v16, v16, v28
    v_add_f32 v16, v16, v29
    v_add_f32 v16, v16, v30
    v_add_f32 v16, v16, v31
    v_add_f32 v16, v16, v32
    v_add_f32 v16, v16, v33
    buffer_store_dword v16, v243, s[16:19], s51 offen
    s_lshl_b32 s40, s36, 5
    v_add_u32 v244, s40, v240
    s_lshl_b32 s42, s42, 8
    s_add_u32 s42, s42, s50
    s_lshl_b32 s41, s41, 8
    s_add_u32 s41, s41, s50
    v_mov_b32 v246, 0
    v_mov_b32 v247, 0
    s_waitcnt lgkmcnt(0)
    s_barrier
    ds_read_b128 v[36:39], v244 offset:0
    ds_read_b128 v[40:43], v244 offset:16
    ds_read_b128 v[44:47], v244 offset:21504
    ds_read_b128 v[48:51], v244 offset:21520
    ds_read_b128 v[52:55], v244 offset:43008
    ds_read_b128 v[56:59], v244 offset:43024
    ds_read_b128 v[60:63], v244 offset:64512
    ds_read_b128 v[64:67], v244 offset:64528
    ds_read_b128 v[76:79], v244 offset:128
    ds_read_b128 v[80:83], v244 offset:144
    ds_read_b128 v[84:87], v244 offset:21632
    ds_read_b128 v[88:91], v244 offset:21648
    ds_read_b128 v[92:95], v244 offset:43136
    ds_read_b128 v[96:99], v244 offset:43152
    ds_read_b128 v[100:103], v244 offset:64640
    ds_read_b128 v[104:107], v244 offset:64656
    v_accvgpr_read_b32 v68, a0
    v_accvgpr_read_b32 v69, a1
    v_accvgpr_read_b32 v70, a2
    v_accvgpr_read_b32 v71, a3
    s_waitcnt lgkmcnt(8)
    v_add_f32 v36, v36, v44
    v_add_f32 v52, v52, v60
    v_add_f32 v37, v37, v45
    v_add_f32 v53, v53, v61
    v_add_f32 v38, v38, v46
    v_add_f32 v54, v54, v62
    v_add_f32 v39, v39, v47
    v_add_f32 v55, v55, v63
    v_add_f32 v40, v40, v48
    v_add_f32 v56, v56, v64
    v_add_f32 v41, v41, v49
    v_add_f32 v57, v57, v65
    v_add_f32 v42, v42, v50
    v_add_f32 v58, v58, v66
    v_add_f32 v43, v43, v51
    v_add_f32 v59, v59, v67
    v_add_f32 v36, v36, v52
    v_add_f32 v37, v37, v53
    v_add_f32 v38, v38, v54
    v_add_f32 v39, v39, v55
    v_add_f32 v40, v40, v56
    v_add_f32 v41, v41, v57
    v_add_f32 v42, v42, v58
    v_add_f32 v43, v43, v59
    v_cvt_pk_bf16_f32 v44, v36, v37
    v_cvt_pk_bf16_f32 v45, v38, v39
    v_cvt_pk_bf16_f32 v46, v40, v41
    v_cvt_pk_bf16_f32 v47, v42, v43
    v_lshlrev_b32 v36, 16, v44
    v_and_b32 v37, 0xffff0000, v44
    v_lshlrev_b32 v52, 16, v68
    v_and_b32 v53, 0xffff0000, v68
    v_lshlrev_b32 v38, 16, v45
    v_and_b32 v39, 0xffff0000, v45
    v_lshlrev_b32 v54, 16, v69
    v_and_b32 v55, 0xffff0000, v69
    v_lshlrev_b32 v40, 16, v46
    v_and_b32 v41, 0xffff0000, v46
    v_lshlrev_b32 v56, 16, v70
    v_and_b32 v57, 0xffff0000, v70
    v_lshlrev_b32 v42, 16, v47
    v_and_b32 v43, 0xffff0000, v47
    v_lshlrev_b32 v58, 16, v71
    v_and_b32 v59, 0xffff0000, v71
    v_add_f32 v36, v36, v52
    v_add_f32 v37, v37, v53
    v_add_f32 v38, v38, v54
    v_add_f32 v39, v39, v55
    v_add_f32 v40, v40, v56
    v_add_f32 v41, v41, v57
    v_add_f32 v42, v42, v58
    v_add_f32 v43, v43, v59
    v_cvt_pk_bf16_f32 v44, v36, v37
    v_cvt_pk_bf16_f32 v45, v38, v39
    v_cvt_pk_bf16_f32 v46, v40, v41
    v_cvt_pk_bf16_f32 v47, v42, v43
    buffer_store_dwordx4 v[44:47], v242, s[24:27], s42 offen offset:0
    v_lshlrev_b32 v36, 16, v44
    v_and_b32 v37, 0xffff0000, v44
    v_lshlrev_b32 v38, 16, v45
    v_and_b32 v39, 0xffff0000, v45
    v_lshlrev_b32 v40, 16, v46
    v_and_b32 v41, 0xffff0000, v46
    v_lshlrev_b32 v42, 16, v47
    v_and_b32 v43, 0xffff0000, v47
    v_add_f32 v246, v246, v36
    v_fmac_f32 v247, v36, v36
    v_add_f32 v246, v246, v37
    v_fmac_f32 v247, v37, v37
    v_add_f32 v246, v246, v38
    v_fmac_f32 v247, v38, v38
    v_add_f32 v246, v246, v39
    v_fmac_f32 v247, v39, v39
    v_add_f32 v246, v246, v40
    v_fmac_f32 v247, v40, v40
    v_add_f32 v246, v246, v41
    v_fmac_f32 v247, v41, v41
    v_add_f32 v246, v246, v42
    v_fmac_f32 v247, v42, v42
    v_add_f32 v246, v246, v43
    v_fmac_f32 v247, v43, v43
    v_accvgpr_read_b32 v108, a4
    v_accvgpr_read_b32 v109, a5
    v_accvgpr_read_b32 v110, a6
    v_accvgpr_read_b32 v111, a7
    s_waitcnt lgkmcnt(0)
    v_add_f32 v76, v76, v84
    v_add_f32 v92, v92, v100
    v_add_f32 v77, v77, v85
    v_add_f32 v93, v93, v101
    v_add_f32 v78, v78, v86
    v_add_f32 v94, v94, v102
    v_add_f32 v79, v79, v87
    v_add_f32 v95, v95, v103
    v_add_f32 v80, v80, v88
    v_add_f32 v96, v96, v104
    v_add_f32 v81, v81, v89
    v_add_f32 v97, v97, v105
    v_add_f32 v82, v82, v90
    v_add_f32 v98, v98, v106
    v_add_f32 v83, v83, v91
    v_add_f32 v99, v99, v107
    v_add_f32 v76, v76, v92
    v_add_f32 v77, v77, v93
    v_add_f32 v78, v78, v94
    v_add_f32 v79, v79, v95
    v_add_f32 v80, v80, v96
    v_add_f32 v81, v81, v97
    v_add_f32 v82, v82, v98
    v_add_f32 v83, v83, v99
    v_cvt_pk_bf16_f32 v84, v76, v77
    v_cvt_pk_bf16_f32 v85, v78, v79
    v_cvt_pk_bf16_f32 v86, v80, v81
    v_cvt_pk_bf16_f32 v87, v82, v83
    v_lshlrev_b32 v76, 16, v84
    v_and_b32 v77, 0xffff0000, v84
    v_lshlrev_b32 v92, 16, v108
    v_and_b32 v93, 0xffff0000, v108
    v_lshlrev_b32 v78, 16, v85
    v_and_b32 v79, 0xffff0000, v85
    v_lshlrev_b32 v94, 16, v109
    v_and_b32 v95, 0xffff0000, v109
    v_lshlrev_b32 v80, 16, v86
    v_and_b32 v81, 0xffff0000, v86
    v_lshlrev_b32 v96, 16, v110
    v_and_b32 v97, 0xffff0000, v110
    v_lshlrev_b32 v82, 16, v87
    v_and_b32 v83, 0xffff0000, v87
    v_lshlrev_b32 v98, 16, v111
    v_and_b32 v99, 0xffff0000, v111
    v_add_f32 v76, v76, v92
    v_add_f32 v77, v77, v93
    v_add_f32 v78, v78, v94
    v_add_f32 v79, v79, v95
    v_add_f32 v80, v80, v96
    v_add_f32 v81, v81, v97
    v_add_f32 v82, v82, v98
    v_add_f32 v83, v83, v99
    v_cvt_pk_bf16_f32 v84, v76, v77
    v_cvt_pk_bf16_f32 v85, v78, v79
    v_cvt_pk_bf16_f32 v86, v80, v81
    v_cvt_pk_bf16_f32 v87, v82, v83
    buffer_store_dwordx4 v[84:87], v242, s[24:27], s42 offen offset:1024
    v_lshlrev_b32 v76, 16, v84
    v_and_b32 v77, 0xffff0000, v84
    v_lshlrev_b32 v78, 16, v85
    v_and_b32 v79, 0xffff0000, v85
    v_lshlrev_b32 v80, 16, v86
    v_and_b32 v81, 0xffff0000, v86
    v_lshlrev_b32 v82, 16, v87
    v_and_b32 v83, 0xffff0000, v87
    v_add_f32 v246, v246, v76
    v_fmac_f32 v247, v76, v76
    v_add_f32 v246, v246, v77
    v_fmac_f32 v247, v77, v77
    v_add_f32 v246, v246, v78
    v_fmac_f32 v247, v78, v78
    v_add_f32 v246, v246, v79
    v_fmac_f32 v247, v79, v79
    v_add_f32 v246, v246, v80
    v_fmac_f32 v247, v80, v80
    v_add_f32 v246, v246, v81
    v_fmac_f32 v247, v81, v81
    v_add_f32 v246, v246, v82
    v_fmac_f32 v247, v82, v82
    v_add_f32 v246, v246, v83
    v_fmac_f32 v247, v83, v83
    s_cmp_lg_u32 s36, 0
    s_cbranch_scc1 L_k3_outproj_kernel_nor2_3
    ds_read_b128 v[116:119], v240 offset:256
    ds_read_b128 v[120:123], v240 offset:272
    ds_read_b128 v[124:127], v240 offset:21760
    ds_read_b128 v[128:131], v240 offset:21776
    ds_read_b128 v[132:135], v240 offset:43264
    ds_read_b128 v[136:139], v240 offset:43280
    ds_read_b128 v[140:143], v240 offset:64768
    ds_read_b128 v[144:147], v240 offset:64784
    v_accvgpr_read_b32 v148, a8
    v_accvgpr_read_b32 v149, a9
    v_accvgpr_read_b32 v150, a10
    v_accvgpr_read_b32 v151, a11
    s_waitcnt lgkmcnt(0)
    v_add_f32 v116, v116, v124
    v_add_f32 v132, v132, v140
    v_add_f32 v117, v117, v125
    v_add_f32 v133, v133, v141
    v_add_f32 v118, v118, v126
    v_add_f32 v134, v134, v142
    v_add_f32 v119, v119, v127
    v_add_f32 v135, v135, v143
    v_add_f32 v120, v120, v128
    v_add_f32 v136, v136, v144
    v_add_f32 v121, v121, v129
    v_add_f32 v137, v137, v145
    v_add_f32 v122, v122, v130
    v_add_f32 v138, v138, v146
    v_add_f32 v123, v123, v131
    v_add_f32 v139, v139, v147
    v_add_f32 v116, v116, v132
    v_add_f32 v117, v117, v133
    v_add_f32 v118, v118, v134
    v_add_f32 v119, v119, v135
    v_add_f32 v120, v120, v136
    v_add_f32 v121, v121, v137
    v_add_f32 v122, v122, v138
    v_add_f32 v123, v123, v139
    v_cvt_pk_bf16_f32 v124, v116, v117
    v_cvt_pk_bf16_f32 v125, v118, v119
    v_cvt_pk_bf16_f32 v126, v120, v121
    v_cvt_pk_bf16_f32 v127, v122, v123
    v_lshlrev_b32 v116, 16, v124
    v_and_b32 v117, 0xffff0000, v124
    v_lshlrev_b32 v132, 16, v148
    v_and_b32 v133, 0xffff0000, v148
    v_lshlrev_b32 v118, 16, v125
    v_and_b32 v119, 0xffff0000, v125
    v_lshlrev_b32 v134, 16, v149
    v_and_b32 v135, 0xffff0000, v149
    v_lshlrev_b32 v120, 16, v126
    v_and_b32 v121, 0xffff0000, v126
    v_lshlrev_b32 v136, 16, v150
    v_and_b32 v137, 0xffff0000, v150
    v_lshlrev_b32 v122, 16, v127
    v_and_b32 v123, 0xffff0000, v127
    v_lshlrev_b32 v138, 16, v151
    v_and_b32 v139, 0xffff0000, v151
    v_add_f32 v116, v116, v132
    v_add_f32 v117, v117, v133
    v_add_f32 v118, v118, v134
    v_add_f32 v119, v119, v135
    v_add_f32 v120, v120, v136
    v_add_f32 v121, v121, v137
    v_add_f32 v122, v122, v138
    v_add_f32 v123, v123, v139
    v_cvt_pk_bf16_f32 v124, v116, v117
    v_cvt_pk_bf16_f32 v125, v118, v119
    v_cvt_pk_bf16_f32 v126, v120, v121
    v_cvt_pk_bf16_f32 v127, v122, v123
    buffer_store_dwordx4 v[124:127], v242, s[24:27], s41 offen offset:0
    v_lshlrev_b32 v116, 16, v124
    v_and_b32 v117, 0xffff0000, v124
    v_lshlrev_b32 v118, 16, v125
    v_and_b32 v119, 0xffff0000, v125
    v_lshlrev_b32 v120, 16, v126
    v_and_b32 v121, 0xffff0000, v126
    v_lshlrev_b32 v122, 16, v127
    v_and_b32 v123, 0xffff0000, v127
    v_add_f32 v246, v246, v116
    v_fmac_f32 v247, v116, v116
    v_add_f32 v246, v246, v117
    v_fmac_f32 v247, v117, v117
    v_add_f32 v246, v246, v118
    v_fmac_f32 v247, v118, v118
    v_add_f32 v246, v246, v119
    v_fmac_f32 v247, v119, v119
    v_add_f32 v246, v246, v120
    v_fmac_f32 v247, v120, v120
    v_add_f32 v246, v246, v121
    v_fmac_f32 v247, v121, v121
    v_add_f32 v246, v246, v122
    v_fmac_f32 v247, v122, v122
    v_add_f32 v246, v246, v123
    v_fmac_f32 v247, v123, v123
L_k3_outproj_kernel_nor2_3:
    v_lshlrev_b32 v8, 3, v0
    v_add_u32 v8, 86016, v8
    ds_write_b64 v8, v[246:247]
    s_lshl_b32 s41, s34, 12
    s_lshl_b32 s42, s35, 3
    s_add_u32 s41, s41, s42
    s_add_u32 s41, s41, 4194304
    v_lshlrev_b32 v9, 6, v1
    s_waitcnt lgkmcnt(0)
    s_barrier
    s_cmp_lg_u32 s36, 0
    s_cbranch_scc1 L_k3_outproj_kernel_done_1
    ds_read_b64 v[18:19], v8 offset:512
    ds_read_b64 v[20:21], v8 offset:1024
    ds_read_b64 v[22:23], v8 offset:1536
    s_waitcnt lgkmcnt(0)
    v_add_f32 v246, v246, v18
    v_add_f32 v247, v247, v19
    v_add_f32 v246, v246, v20
    v_add_f32 v247, v247, v21
    v_add_f32 v246, v246, v22
    v_add_f32 v247, v247, v23
    buffer_store_dwordx2 v[246:247], v9, s[24:27], s41 offen
L_k3_outproj_kernel_done_1:
    s_endpgm

.section .rodata,"a"
.p2align 6
.amdhsa_kernel k3_outproj_kernel
  .amdhsa_next_free_vgpr 284
  .amdhsa_next_free_sgpr 102
  .amdhsa_accum_offset 252
  .amdhsa_group_segment_fixed_size 0
  .amdhsa_kernarg_size 104
  .amdhsa_user_sgpr_count 2
  .amdhsa_user_sgpr_kernarg_segment_ptr 1
  .amdhsa_system_sgpr_workgroup_id_x 1
.end_amdhsa_kernel
.text
.globl k4_up_kernel
.p2align 8
.type k4_up_kernel,@function
k4_up_kernel:
    s_cmp_ge_u32 s2, 256
    s_cbranch_scc1 L_k4_up_kernel_done_1
    s_load_dwordx2 s[24:25], s[0:1], 96
    v_lshrrev_b32 v6, 6, v0
    v_and_b32 v1, 63, v0
    v_readfirstlane_b32 s28, v6
    s_and_b32 s27, s2, 7
    s_lshl_b32 s27, s27, 2
    s_lshr_b32 s31, s2, 3
    s_and_b32 s32, s31, 3
    s_add_u32 s27, s27, s32
    s_lshr_b32 s26, s31, 2
    s_and_b32 s29, s28, 3
    s_lshr_b32 s30, s28, 2
    v_lshlrev_b32 v2, 4, v1
    v_lshlrev_b32 v3, 2, v1
    s_lshl_b32 s31, s29, 12
    v_add_u32 v4, s31, v2
    s_mul_i32 s31, s30, 9216
    s_add_u32 s31, s31, 16384
    v_add_u32 v5, s31, v2
    s_lshl_b32 s33, s26, 4
    s_lshl_b32 s31, s28, 1
    s_add_u32 s33, s33, s31
    s_mul_i32 s33, s33, 18432
    s_mul_i32 s34, s27, 18
    s_add_u32 s35, s34, 16
    s_add_u32 s34, s34, s31
    s_mul_i32 s34, s34, 18432
    s_add_u32 s35, s35, s30
    s_mul_i32 s35, s35, 18432
    s_lshl_b32 s32, s29, 8
    s_add_u32 s35, s35, s32
    s_lshl_b32 s36, s28, 11
    s_lshl_b32 s37, s28, 8
    s_add_u32 s37, s37, 32768
    v_add_u32 v6, 17408, v2
    s_waitcnt lgkmcnt(0)
    s_add_u32 s8, s24, 8388608
    s_addc_u32 s9, s25, 0
    s_mov_b32 s10, 2359296
    s_mov_b32 s11, 0x00020000
    s_add_u32 s12, s24, 100663296
    s_addc_u32 s13, s25, 0
    s_mov_b32 s14, 10616832
    s_mov_b32 s15, 0x00020000
    s_add_u32 s16, s24, 67108864
    s_addc_u32 s17, s25, 0
    s_mov_b32 s18, 18874368
    s_mov_b32 s19, 0x00020000
    s_add_u32 s20, s24, 12582912
    s_addc_u32 s21, s25, 0
    s_mov_b32 s22, 1085440
    s_mov_b32 s23, 0x00020000
    s_add_u32 m0, s36, 0
    s_nop 0
    buffer_load_dwordx4 v2, s[8:11], s33 offen lds
    buffer_load_dwordx4 v6, s[8:11], s33 offen offset:1024 lds
    s_add_u32 m0, s36, 16384
    s_add_u32 s33, s33, 1024
    buffer_load_dwordx4 v2, s[12:15], s34 offen lds
    buffer_load_dwordx4 v6, s[12:15], s34 offen offset:1024 lds
    s_add_u32 m0, s37, 0
    s_add_u32 s34, s34, 1024
    buffer_load_dword v3, s[12:15], s35 offen lds
    s_add_u32 s35, s35, 1024
    v_and_b32 v7, 15, v1
    v_lshlrev_b32 v7, 6, v7
    v_lshrrev_b32 v8, 4, v1
    v_lshlrev_b32 v8, 4, v8
    v_add_u32 v7, v7, v8
    s_lshl_b32 s31, s26, 14
    s_lshl_b32 s32, s29, 12
    s_add_u32 s31, s31, s32
    buffer_load_dwordx4 v[64:67], v7, s[20:23], s31 offen offset:0
    buffer_load_dwordx4 v[72:75], v7, s[20:23], s31 offen offset:1024
    buffer_load_dwordx4 v[80:83], v7, s[20:23], s31 offen offset:2048
    buffer_load_dwordx4 v[88:91], v7, s[20:23], s31 offen offset:3072
    s_mul_i32 s31, s27, 18
    s_mul_i32 s32, s30, 9
    s_add_u32 s31, s31, s32
    s_lshl_b32 s31, s31, 6
    s_add_u32 s31, s31, 1048576
    buffer_load_dwordx4 v[28:31], v8, s[20:23], s31 offen offset:0
    buffer_load_dwordx4 v[32:35], v8, s[20:23], s31 offen offset:64
    buffer_load_dwordx4 v[36:39], v8, s[20:23], s31 offen offset:128
    buffer_load_dwordx4 v[40:43], v8, s[20:23], s31 offen offset:192
    buffer_load_dwordx4 v[44:47], v8, s[20:23], s31 offen offset:256
    buffer_load_dwordx4 v[48:51], v8, s[20:23], s31 offen offset:320
    buffer_load_dwordx4 v[52:55], v8, s[20:23], s31 offen offset:384
    buffer_load_dwordx4 v[56:59], v8, s[20:23], s31 offen offset:448
    buffer_load_dwordx4 v[60:63], v8, s[20:23], s31 offen offset:512
    s_lshl_b32 s38, s26, 4
    s_lshl_b32 s31, s29, 2
    s_add_u32 s38, s38, s31
    s_mul_i32 s38, s38, 144
    s_lshl_b32 s31, s27, 1
    s_add_u32 s31, s31, s30
    s_lshr_b32 s39, s31, 2
    s_add_u32 s39, s39, 128
    s_add_u32 s39, s39, s38
    s_lshl_b32 s39, s39, 10
    s_and_b32 s32, s31, 1
    s_lshl_b32 s32, s32, 9
    s_add_u32 s39, s39, s32
    s_bfe_u32 s32, s31, 0x10001
    s_lshl_b32 s32, s32, 3
    s_add_u32 s39, s39, s32
    s_lshl_b32 s31, s31, 1
    s_add_u32 s38, s38, s31
    s_lshl_b32 s38, s38, 10
    s_waitcnt vmcnt(9)
    s_mov_b32 s31, 0x3ae38e39
    s_mov_b32 s32, 0xbfb8aa3b
    v_add_f32 v64, v64, v66
    v_add_f32 v65, v65, v67
    v_mov_b32 v66, v64
    v_mov_b32 v67, v65
    s_nop 0
    v_permlane16_swap_b32 v64, v66
    v_permlane16_swap_b32 v65, v67
    v_add_f32 v64, v64, v66
    v_add_f32 v65, v65, v67
    v_mov_b32 v66, v64
    v_mov_b32 v67, v65
    s_nop 0
    v_permlane32_swap_b32 v64, v66
    v_permlane32_swap_b32 v65, v67
    v_add_f32 v64, v64, v66
    v_add_f32 v65, v65, v67
    v_mul_f32 v64, s31, v64
    v_mul_f32 v65, s31, v65
    v_fma_f32 v65, -v64, v64, v65
    v_max_f32 v65, 0, v65
    v_add_f32 v65, 0x3727c5ac, v65
    v_rcp_f32 v13, v65
    v_rsq_f32 v66, v65
    v_sub_f32 v12, 0, v64
    v_mov_b32 v15, 1.0
    v_mul_f32 v14, s32, v66
    v_add_f32 v72, v72, v74
    v_add_f32 v73, v73, v75
    v_mov_b32 v74, v72
    v_mov_b32 v75, v73
    s_nop 0
    v_permlane16_swap_b32 v72, v74
    v_permlane16_swap_b32 v73, v75
    v_add_f32 v72, v72, v74
    v_add_f32 v73, v73, v75
    v_mov_b32 v74, v72
    v_mov_b32 v75, v73
    s_nop 0
    v_permlane32_swap_b32 v72, v74
    v_permlane32_swap_b32 v73, v75
    v_add_f32 v72, v72, v74
    v_add_f32 v73, v73, v75
    v_mul_f32 v72, s31, v72
    v_mul_f32 v73, s31, v73
    v_fma_f32 v73, -v72, v72, v73
    v_max_f32 v73, 0, v73
    v_add_f32 v73, 0x3727c5ac, v73
    v_rcp_f32 v17, v73
    v_rsq_f32 v74, v73
    v_sub_f32 v16, 0, v72
    v_mov_b32 v19, 1.0
    v_mul_f32 v18, s32, v74
    v_add_f32 v80, v80, v82
    v_add_f32 v81, v81, v83
    v_mov_b32 v82, v80
    v_mov_b32 v83, v81
    s_nop 0
    v_permlane16_swap_b32 v80, v82
    v_permlane16_swap_b32 v81, v83
    v_add_f32 v80, v80, v82
    v_add_f32 v81, v81, v83
    v_mov_b32 v82, v80
    v_mov_b32 v83, v81
    s_nop 0
    v_permlane32_swap_b32 v80, v82
    v_permlane32_swap_b32 v81, v83
    v_add_f32 v80, v80, v82
    v_add_f32 v81, v81, v83
    v_mul_f32 v80, s31, v80
    v_mul_f32 v81, s31, v81
    v_fma_f32 v81, -v80, v80, v81
    v_max_f32 v81, 0, v81
    v_add_f32 v81, 0x3727c5ac, v81
    v_rcp_f32 v21, v81
    v_rsq_f32 v82, v81
    v_sub_f32 v20, 0, v80
    v_mov_b32 v23, 1.0
    v_mul_f32 v22, s32, v82
    v_add_f32 v88, v88, v90
    v_add_f32 v89, v89, v91
    v_mov_b32 v90, v88
    v_mov_b32 v91, v89
    s_nop 0
    v_permlane16_swap_b32 v88, v90
    v_permlane16_swap_b32 v89, v91
    v_add_f32 v88, v88, v90
    v_add_f32 v89, v89, v91
    v_mov_b32 v90, v88
    v_mov_b32 v91, v89
    s_nop 0
    v_permlane32_swap_b32 v88, v90
    v_permlane32_swap_b32 v89, v91
    v_add_f32 v88, v88, v90
    v_add_f32 v89, v89, v91
    v_mul_f32 v88, s31, v88
    v_mul_f32 v89, s31, v89
    v_fma_f32 v89, -v88, v88, v89
    v_max_f32 v89, 0, v89
    v_add_f32 v89, 0x3727c5ac, v89
    v_rcp_f32 v25, v89
    v_rsq_f32 v90, v89
    v_sub_f32 v24, 0, v88
    v_mov_b32 v27, 1.0
    v_mul_f32 v26, s32, v90
    s_barrier
    s_waitcnt lgkmcnt(0)
    v_add_u32 v9, 69632, v4
    v_add_u32 v10, 69632, v5
    ds_read_b128 v[64:67], v4 offset:0
    ds_read_b128 v[68:71], v4 offset:1024
    ds_read_b128 v[72:75], v4 offset:2048
    ds_read_b128 v[76:79], v4 offset:3072
    ds_read_b128 v[96:99], v5 offset:0
    ds_read_b128 v[100:103], v5 offset:1024
    ds_read_b128 v[104:107], v5 offset:2048
    s_waitcnt lgkmcnt(2)
    v_mfma_f32_16x16x32_bf16 v[112:115], v[96:99], v[64:67], 0
    ds_read_b128 v[108:111], v5 offset:3072
    v_mfma_f32_16x16x32_bf16 v[116:119], v[96:99], v[68:71], 0
    v_mfma_f32_16x16x32_bf16 v[120:123], v[96:99], v[72:75], 0
    v_mfma_f32_16x16x32_bf16 v[124:127], v[96:99], v[76:79], 0
    s_add_u32 m0, s36, 34816
    s_nop 0
    buffer_load_dwordx4 v2, s[8:11], s33 offen lds
    buffer_load_dwordx4 v6, s[8:11], s33 offen offset:1024 lds
    s_add_u32 m0, s36, 51200
    s_add_u32 s33, s33, 1024
    buffer_load_dwordx4 v2, s[12:15], s34 offen lds
    buffer_load_dwordx4 v6, s[12:15], s34 offen offset:1024 lds
    s_add_u32 m0, s37, 34816
    s_add_u32 s34, s34, 1024
    buffer_load_dword v3, s[12:15], s35 offen lds
    s_add_u32 s35, s35, 1024
    s_waitcnt lgkmcnt(2)
    v_mfma_f32_16x16x32_bf16 v[128:131], v[100:103], v[64:67], 0
    ds_read_b128 v[96:99], v5 offset:4096
    v_mfma_f32_16x16x32_bf16 v[132:135], v[100:103], v[68:71], 0
    v_mfma_f32_16x16x32_bf16 v[136:139], v[100:103], v[72:75], 0
    v_mfma_f32_16x16x32_bf16 v[140:143], v[100:103], v[76:79], 0
    s_waitcnt lgkmcnt(2)
    v_mfma_f32_16x16x32_bf16 v[144:147], v[104:107], v[64:67], 0
    ds_read_b128 v[100:103], v5 offset:5120
    v_mfma_f32_16x16x32_bf16 v[148:151], v[104:107], v[68:71], 0
    v_mfma_f32_16x16x32_bf16 v[152:155], v[104:107], v[72:75], 0
    v_mfma_f32_16x16x32_bf16 v[156:159], v[104:107], v[76:79], 0
    s_add_u32 m0, s36, 69632
    s_nop 0
    buffer_load_dwordx4 v2, s[8:11], s33 offen lds
    buffer_load_dwordx4 v6, s[8:11], s33 offen offset:1024 lds
    s_add_u32 m0, s36, 86016
    s_add_u32 s33, s33, 1024
    buffer_load_dwordx4 v2, s[12:15], s34 offen lds
    buffer_load_dwordx4 v6, s[12:15], s34 offen offset:1024 lds
    s_add_u32 m0, s37, 69632
    s_add_u32 s34, s34, 1024
    buffer_load_dword v3, s[12:15], s35 offen lds
    s_add_u32 s35, s35, 1024
    s_waitcnt lgkmcnt(2)
    v_mfma_f32_16x16x32_bf16 v[160:163], v[108:111], v[64:67], 0
    ds_read_b128 v[104:107], v5 offset:6144
    v_mfma_f32_16x16x32_bf16 v[164:167], v[108:111], v[68:71], 0
    v_mfma_f32_16x16x32_bf16 v[168:171], v[108:111], v[72:75], 0
    v_mfma_f32_16x16x32_bf16 v[172:175], v[108:111], v[76:79], 0
    s_waitcnt vmcnt(5)
    s_barrier
    s_add_u32 m0, s36, 104448
    s_nop 0
    buffer_load_dwordx4 v2, s[8:11], s33 offen lds
    buffer_load_dwordx4 v6, s[8:11], s33 offen offset:1024 lds
    s_add_u32 m0, s36, 120832
    s_add_u32 s33, s33, 1024
    buffer_load_dwordx4 v2, s[12:15], s34 offen lds
    buffer_load_dwordx4 v6, s[12:15], s34 offen offset:1024 lds
    s_add_u32 m0, s37, 104448
    s_add_u32 s34, s34, 1024
    buffer_load_dword v3, s[12:15], s35 offen lds
    s_add_u32 s35, s35, 1024
    s_waitcnt lgkmcnt(2)
    v_mfma_f32_16x16x32_bf16 v[176:179], v[96:99], v[64:67], 0
    ds_read_b128 v[108:111], v5 offset:7168
    v_mfma_f32_16x16x32_bf16 v[180:183], v[96:99], v[68:71], 0
    v_mfma_f32_16x16x32_bf16 v[184:187], v[96:99], v[72:75], 0
    v_mfma_f32_16x16x32_bf16 v[188:191], v[96:99], v[76:79], 0
    s_waitcnt lgkmcnt(2)
    v_mfma_f32_16x16x32_bf16 v[192:195], v[100:103], v[64:67], 0
    ds_read_b128 v[96:99], v5 offset:8192
    v_mfma_f32_16x16x32_bf16 v[196:199], v[100:103], v[68:71], 0
    v_mfma_f32_16x16x32_bf16 v[200:203], v[100:103], v[72:75], 0
    ds_read_b128 v[80:83], v4 offset:34816
    v_mfma_f32_16x16x32_bf16 v[204:207], v[100:103], v[76:79], 0
    s_waitcnt lgkmcnt(3)
    v_mfma_f32_16x16x32_bf16 v[208:211], v[104:107], v[64:67], 0
    ds_read_b128 v[100:103], v5 offset:34816
    v_mfma_f32_16x16x32_bf16 v[212:215], v[104:107], v[68:71], 0
    v_mfma_f32_16x16x32_bf16 v[216:219], v[104:107], v[72:75], 0
    ds_read_b128 v[84:87], v4 offset:35840
    v_mfma_f32_16x16x32_bf16 v[220:223], v[104:107], v[76:79], 0
    s_waitcnt lgkmcnt(4)
    v_mfma_f32_16x16x32_bf16 v[224:227], v[108:111], v[64:67], 0
    ds_read_b128 v[104:107], v5 offset:35840
    v_mfma_f32_16x16x32_bf16 v[228:231], v[108:111], v[68:71], 0
    v_mfma_f32_16x16x32_bf16 v[232:235], v[108:111], v[72:75], 0
    ds_read_b128 v[88:91], v4 offset:36864
    v_mfma_f32_16x16x32_bf16 v[236:239], v[108:111], v[76:79], 0
    s_waitcnt lgkmcnt(5)
    v_mfma_f32_16x16x32_bf16 v[240:243], v[96:99], v[64:67], 0
    ds_read_b128 v[108:111], v5 offset:36864
    v_mfma_f32_16x16x32_bf16 v[244:247], v[96:99], v[68:71], 0
    v_mfma_f32_16x16x32_bf16 v[248:251], v[96:99], v[72:75], 0
    ds_read_b128 v[92:95], v4 offset:37888
    v_mfma_f32_16x16x32_bf16 v[252:255], v[96:99], v[76:79], 0
    s_waitcnt lgkmcnt(5)
    v_mfma_f32_16x16x32_bf16 v[112:115], v[100:103], v[80:83], v[112:115]
    ds_read_b128 v[96:99], v5 offset:37888
    s_waitcnt lgkmcnt(5)
    v_mfma_f32_16x16x32_bf16 v[116:119], v[100:103], v[84:87], v[116:119]
    s_waitcnt lgkmcnt(3)
    v_mfma_f32_16x16x32_bf16 v[120:123], v[100:103], v[88:91], v[120:123]
    s_waitcnt lgkmcnt(1)
    v_mfma_f32_16x16x32_bf16 v[124:127], v[100:103], v[92:95], v[124:127]
    v_mfma_f32_16x16x32_bf16 v[128:131], v[104:107], v[80:83], v[128:131]
    ds_read_b128 v[100:103], v5 offset:38912
    v_mfma_f32_16x16x32_bf16 v[132:135], v[104:107], v[84:87], v[132:135]
    v_mfma_f32_16x16x32_bf16 v[136:139], v[104:107], v[88:91], v[136:139]
    v_mfma_f32_16x16x32_bf16 v[140:143], v[104:107], v[92:95], v[140:143]
    v_mfma_f32_16x16x32_bf16 v[144:147], v[108:111], v[80:83], v[144:147]
    ds_read_b128 v[104:107], v5 offset:39936
    v_mfma_f32_16x16x32_bf16 v[148:151], v[108:111], v[84:87], v[148:151]
    v_mfma_f32_16x16x32_bf16 v[152:155], v[108:111], v[88:91], v[152:155]
    v_mfma_f32_16x16x32_bf16 v[156:159], v[108:111], v[92:95], v[156:159]
    s_waitcnt lgkmcnt(2)
    v_mfma_f32_16x16x32_bf16 v[160:163], v[96:99], v[80:83], v[160:163]
    ds_read_b128 v[108:111], v5 offset:40960
    v_mfma_f32_16x16x32_bf16 v[164:167], v[96:99], v[84:87], v[164:167]
    v_mfma_f32_16x16x32_bf16 v[168:171], v[96:99], v[88:91], v[168:171]
    v_mfma_f32_16x16x32_bf16 v[172:175], v[96:99], v[92:95], v[172:175]
    s_waitcnt vmcnt(5)
    s_barrier
    s_add_u32 m0, s36, 0
    s_nop 0
    buffer_load_dwordx4 v2, s[8:11], s33 offen lds
    buffer_load_dwordx4 v6, s[8:11], s33 offen offset:1024 lds
    s_add_u32 m0, s36, 16384
    s_add_u32 s33, s33, 1024
    buffer_load_dwordx4 v2, s[12:15], s34 offen lds
    buffer_load_dwordx4 v6, s[12:15], s34 offen offset:1024 lds
    s_add_u32 m0, s37, 0
    s_add_u32 s34, s34, 1024
    buffer_load_dword v3, s[12:15], s35 offen lds
    s_add_u32 s35, s35, 1024
    s_waitcnt lgkmcnt(2)
    v_mfma_f32_16x16x32_bf16 v[176:179], v[100:103], v[80:83], v[176:179]
    ds_read_b128 v[96:99], v5 offset:41984
    v_mfma_f32_16x16x32_bf16 v[180:183], v[100:103], v[84:87], v[180:183]
    v_mfma_f32_16x16x32_bf16 v[184:187], v[100:103], v[88:91], v[184:187]
    v_mfma_f32_16x16x32_bf16 v[188:191], v[100:103], v[92:95], v[188:191]
    s_waitcnt lgkmcnt(2)
    v_mfma_f32_16x16x32_bf16 v[192:195], v[104:107], v[80:83], v[192:195]
    ds_read_b128 v[100:103], v5 offset:43008
    v_mfma_f32_16x16x32_bf16 v[196:199], v[104:107], v[84:87], v[196:199]
    v_mfma_f32_16x16x32_bf16 v[200:203], v[104:107], v[88:91], v[200:203]
    ds_read_b128 v[64:67], v9 offset:0
    v_mfma_f32_16x16x32_bf16 v[204:207], v[104:107], v[92:95], v[204:207]
    s_waitcnt lgkmcnt(3)
    v_mfma_f32_16x16x32_bf16 v[208:211], v[108:111], v[80:83], v[208:211]
    ds_read_b128 v[104:107], v10 offset:0
    v_mfma_f32_16x16x32_bf16 v[212:215], v[108:111], v[84:87], v[212:215]
    v_mfma_f32_16x16x32_bf16 v[216:219], v[108:111], v[88:91], v[216:219]
    ds_read_b128 v[68:71], v9 offset:1024
    v_mfma_f32_16x16x32_bf16 v[220:223], v[108:111], v[92:95], v[220:223]
    s_waitcnt lgkmcnt(4)
    v_mfma_f32_16x16x32_bf16 v[224:227], v[96:99], v[80:83], v[224:227]
    ds_read_b128 v[108:111], v10 offset:1024
    v_mfma_f32_16x16x32_bf16 v[228:231], v[96:99], v[84:87], v[228:231]
    v_mfma_f32_16x16x32_bf16 v[232:235], v[96:99], v[88:91], v[232:235]
    ds_read_b128 v[72:75], v9 offset:2048
    v_mfma_f32_16x16x32_bf16 v[236:239], v[96:99], v[92:95], v[236:239]
    s_waitcnt lgkmcnt(5)
    v_mfma_f32_16x16x32_bf16 v[240:243], v[100:103], v[80:83], v[240:243]
    ds_read_b128 v[96:99], v10 offset:2048
    v_mfma_f32_16x16x32_bf16 v[244:247], v[100:103], v[84:87], v[244:247]
    v_mfma_f32_16x16x32_bf16 v[248:251], v[100:103], v[88:91], v[248:251]
    ds_read_b128 v[76:79], v9 offset:3072
    v_mfma_f32_16x16x32_bf16 v[252:255], v[100:103], v[92:95], v[252:255]
    s_waitcnt lgkmcnt(5)
    v_mfma_f32_16x16x32_bf16 v[112:115], v[104:107], v[64:67], v[112:115]
    ds_read_b128 v[100:103], v10 offset:3072
    s_waitcnt lgkmcnt(5)
    v_mfma_f32_16x16x32_bf16 v[116:119], v[104:107], v[68:71], v[116:119]
    s_waitcnt lgkmcnt(3)
    v_mfma_f32_16x16x32_bf16 v[120:123], v[104:107], v[72:75], v[120:123]
    s_waitcnt lgkmcnt(1)
    v_mfma_f32_16x16x32_bf16 v[124:127], v[104:107], v[76:79], v[124:127]
    v_mfma_f32_16x16x32_bf16 v[128:131], v[108:111], v[64:67], v[128:131]
    ds_read_b128 v[104:107], v10 offset:4096
    v_mfma_f32_16x16x32_bf16 v[132:135], v[108:111], v[68:71], v[132:135]
    v_mfma_f32_16x16x32_bf16 v[136:139], v[108:111], v[72:75], v[136:139]
    v_mfma_f32_16x16x32_bf16 v[140:143], v[108:111], v[76:79], v[140:143]
    v_mfma_f32_16x16x32_bf16 v[144:147], v[96:99], v[64:67], v[144:147]
    ds_read_b128 v[108:111], v10 offset:5120
    v_mfma_f32_16x16x32_bf16 v[148:151], v[96:99], v[68:71], v[148:151]
    v_mfma_f32_16x16x32_bf16 v[152:155], v[96:99], v[72:75], v[152:155]
    v_mfma_f32_16x16x32_bf16 v[156:159], v[96:99], v[76:79], v[156:159]
    s_waitcnt lgkmcnt(2)
    v_mfma_f32_16x16x32_bf16 v[160:163], v[100:103], v[64:67], v[160:163]
    ds_read_b128 v[96:99], v10 offset:6144
    v_mfma_f32_16x16x32_bf16 v[164:167], v[100:103], v[68:71], v[164:167]
    v_mfma_f32_16x16x32_bf16 v[168:171], v[100:103], v[72:75], v[168:171]
    v_mfma_f32_16x16x32_bf16 v[172:175], v[100:103], v[76:79], v[172:175]
    s_waitcnt vmcnt(5)
    s_barrier
    s_add_u32 m0, s36, 34816
    s_nop 0
    buffer_load_dwordx4 v2, s[8:11], s33 offen lds
    buffer_load_dwordx4 v6, s[8:11], s33 offen offset:1024 lds
    s_add_u32 m0, s36, 51200
    s_add_u32 s33, s33, 1024
    buffer_load_dwordx4 v2, s[12:15], s34 offen lds
    buffer_load_dwordx4 v6, s[12:15], s34 offen offset:1024 lds
    s_add_u32 m0, s37, 34816
    s_add_u32 s34, s34, 1024
    buffer_load_dword v3, s[12:15], s35 offen lds
    s_add_u32 s35, s35, 1024
    s_waitcnt lgkmcnt(2)
    v_mfma_f32_16x16x32_bf16 v[176:179], v[104:107], v[64:67], v[176:179]
    ds_read_b128 v[100:103], v10 offset:7168
    v_mfma_f32_16x16x32_bf16 v[180:183], v[104:107], v[68:71], v[180:183]
    v_mfma_f32_16x16x32_bf16 v[184:187], v[104:107], v[72:75], v[184:187]
    v_mfma_f32_16x16x32_bf16 v[188:191], v[104:107], v[76:79], v[188:191]
    s_waitcnt lgkmcnt(2)
    v_mfma_f32_16x16x32_bf16 v[192:195], v[108:111], v[64:67], v[192:195]
    ds_read_b128 v[104:107], v10 offset:8192
    v_mfma_f32_16x16x32_bf16 v[196:199], v[108:111], v[68:71], v[196:199]
    v_mfma_f32_16x16x32_bf16 v[200:203], v[108:111], v[72:75], v[200:203]
    ds_read_b128 v[80:83], v9 offset:34816
    v_mfma_f32_16x16x32_bf16 v[204:207], v[108:111], v[76:79], v[204:207]
    s_waitcnt lgkmcnt(3)
    v_mfma_f32_16x16x32_bf16 v[208:211], v[96:99], v[64:67], v[208:211]
    ds_read_b128 v[108:111], v10 offset:34816
    v_mfma_f32_16x16x32_bf16 v[212:215], v[96:99], v[68:71], v[212:215]
    v_mfma_f32_16x16x32_bf16 v[216:219], v[96:99], v[72:75], v[216:219]
    ds_read_b128 v[84:87], v9 offset:35840
    v_mfma_f32_16x16x32_bf16 v[220:223], v[96:99], v[76:79], v[220:223]
    s_waitcnt lgkmcnt(4)
    v_mfma_f32_16x16x32_bf16 v[224:227], v[100:103], v[64:67], v[224:227]
    ds_read_b128 v[96:99], v10 offset:35840
    v_mfma_f32_16x16x32_bf16 v[228:231], v[100:103], v[68:71], v[228:231]
    v_mfma_f32_16x16x32_bf16 v[232:235], v[100:103], v[72:75], v[232:235]
    ds_read_b128 v[88:91], v9 offset:36864
    v_mfma_f32_16x16x32_bf16 v[236:239], v[100:103], v[76:79], v[236:239]
    s_waitcnt lgkmcnt(5)
    v_mfma_f32_16x16x32_bf16 v[240:243], v[104:107], v[64:67], v[240:243]
    ds_read_b128 v[100:103], v10 offset:36864
    v_mfma_f32_16x16x32_bf16 v[244:247], v[104:107], v[68:71], v[244:247]
    v_mfma_f32_16x16x32_bf16 v[248:251], v[104:107], v[72:75], v[248:251]
    ds_read_b128 v[92:95], v9 offset:37888
    v_mfma_f32_16x16x32_bf16 v[252:255], v[104:107], v[76:79], v[252:255]
    s_waitcnt lgkmcnt(5)
    v_mfma_f32_16x16x32_bf16 v[112:115], v[108:111], v[80:83], v[112:115]
    ds_read_b128 v[104:107], v10 offset:37888
    s_waitcnt lgkmcnt(5)
    v_mfma_f32_16x16x32_bf16 v[116:119], v[108:111], v[84:87], v[116:119]
    s_waitcnt lgkmcnt(3)
    v_mfma_f32_16x16x32_bf16 v[120:123], v[108:111], v[88:91], v[120:123]
    s_waitcnt lgkmcnt(1)
    v_mfma_f32_16x16x32_bf16 v[124:127], v[108:111], v[92:95], v[124:127]
    v_mfma_f32_16x16x32_bf16 v[128:131], v[96:99], v[80:83], v[128:131]
    ds_read_b128 v[108:111], v10 offset:38912
    v_mfma_f32_16x16x32_bf16 v[132:135], v[96:99], v[84:87], v[132:135]
    v_mfma_f32_16x16x32_bf16 v[136:139], v[96:99], v[88:91], v[136:139]
    v_mfma_f32_16x16x32_bf16 v[140:143], v[96:99], v[92:95], v[140:143]
    v_mfma_f32_16x16x32_bf16 v[144:147], v[100:103], v[80:83], v[144:147]
    ds_read_b128 v[96:99], v10 offset:39936
    v_mfma_f32_16x16x32_bf16 v[148:151], v[100:103], v[84:87], v[148:151]
    v_mfma_f32_16x16x32_bf16 v[152:155], v[100:103], v[88:91], v[152:155]
    v_mfma_f32_16x16x32_bf16 v[156:159], v[100:103], v[92:95], v[156:159]
    s_waitcnt lgkmcnt(2)
    v_mfma_f32_16x16x32_bf16 v[160:163], v[104:107], v[80:83], v[160:163]
    ds_read_b128 v[100:103], v10 offset:40960
    v_mfma_f32_16x16x32_bf16 v[164:167], v[104:107], v[84:87], v[164:167]
    v_mfma_f32_16x16x32_bf16 v[168:171], v[104:107], v[88:91], v[168:171]
    v_mfma_f32_16x16x32_bf16 v[172:175], v[104:107], v[92:95], v[172:175]
    s_waitcnt vmcnt(5)
    s_barrier
    s_add_u32 m0, s36, 69632
    s_nop 0
    buffer_load_dwordx4 v2, s[8:11], s33 offen lds
    buffer_load_dwordx4 v6, s[8:11], s33 offen offset:1024 lds
    s_add_u32 m0, s36, 86016
    s_add_u32 s33, s33, 1024
    buffer_load_dwordx4 v2, s[12:15], s34 offen lds
    buffer_load_dwordx4 v6, s[12:15], s34 offen offset:1024 lds
    s_add_u32 m0, s37, 69632
    s_add_u32 s34, s34, 1024
    buffer_load_dword v3, s[12:15], s35 offen lds
    s_add_u32 s35, s35, 1024
    s_waitcnt lgkmcnt(2)
    v_mfma_f32_16x16x32_bf16 v[176:179], v[108:111], v[80:83], v[176:179]
    ds_read_b128 v[104:107], v10 offset:41984
    v_mfma_f32_16x16x32_bf16 v[180:183], v[108:111], v[84:87], v[180:183]
    v_mfma_f32_16x16x32_bf16 v[184:187], v[108:111], v[88:91], v[184:187]
    v_mfma_f32_16x16x32_bf16 v[188:191], v[108:111], v[92:95], v[188:191]
    s_waitcnt lgkmcnt(2)
    v_mfma_f32_16x16x32_bf16 v[192:195], v[96:99], v[80:83], v[192:195]
    ds_read_b128 v[108:111], v10 offset:43008
    v_mfma_f32_16x16x32_bf16 v[196:199], v[96:99], v[84:87], v[196:199]
    v_mfma_f32_16x16x32_bf16 v[200:203], v[96:99], v[88:91], v[200:203]
    ds_read_b128 v[64:67], v4 offset:0
    v_mfma_f32_16x16x32_bf16 v[204:207], v[96:99], v[92:95], v[204:207]
    s_waitcnt lgkmcnt(3)
    v_mfma_f32_16x16x32_bf16 v[208:211], v[100:103], v[80:83], v[208:211]
    ds_read_b128 v[96:99], v5 offset:0
    v_mfma_f32_16x16x32_bf16 v[212:215], v[100:103], v[84:87], v[212:215]
    v_mfma_f32_16x16x32_bf16 v[216:219], v[100:103], v[88:91], v[216:219]
    ds_read_b128 v[68:71], v4 offset:1024
    v_mfma_f32_16x16x32_bf16 v[220:223], v[100:103], v[92:95], v[220:223]
    s_waitcnt lgkmcnt(4)
    v_mfma_f32_16x16x32_bf16 v[224:227], v[104:107], v[80:83], v[224:227]
    ds_read_b128 v[100:103], v5 offset:1024
    v_mfma_f32_16x16x32_bf16 v[228:231], v[104:107], v[84:87], v[228:231]
    v_mfma_f32_16x16x32_bf16 v[232:235], v[104:107], v[88:91], v[232:235]
    ds_read_b128 v[72:75], v4 offset:2048
    v_mfma_f32_16x16x32_bf16 v[236:239], v[104:107], v[92:95], v[236:239]
    s_waitcnt lgkmcnt(5)
    v_mfma_f32_16x16x32_bf16 v[240:243], v[108:111], v[80:83], v[240:243]
    ds_read_b128 v[104:107], v5 offset:2048
    v_mfma_f32_16x16x32_bf16 v[244:247], v[108:111], v[84:87], v[244:247]
    v_mfma_f32_16x16x32_bf16 v[248:251], v[108:111], v[88:91], v[248:251]
    ds_read_b128 v[76:79], v4 offset:3072
    v_mfma_f32_16x16x32_bf16 v[252:255], v[108:111], v[92:95], v[252:255]
    s_waitcnt lgkmcnt(5)
    v_mfma_f32_16x16x32_bf16 v[112:115], v[96:99], v[64:67], v[112:115]
    ds_read_b128 v[108:111], v5 offset:3072
    s_waitcnt lgkmcnt(5)
    v_mfma_f32_16x16x32_bf16 v[116:119], v[96:99], v[68:71], v[116:119]
    s_waitcnt lgkmcnt(3)
    v_mfma_f32_16x16x32_bf16 v[120:123], v[96:99], v[72:75], v[120:123]
    s_waitcnt lgkmcnt(1)
    v_mfma_f32_16x16x32_bf16 v[124:127], v[96:99], v[76:79], v[124:127]
    v_mfma_f32_16x16x32_bf16 v[128:131], v[100:103], v[64:67], v[128:131]
    ds_read_b128 v[96:99], v5 offset:4096
    v_mfma_f32_16x16x32_bf16 v[132:135], v[100:103], v[68:71], v[132:135]
    v_mfma_f32_16x16x32_bf16 v[136:139], v[100:103], v[72:75], v[136:139]
    v_mfma_f32_16x16x32_bf16 v[140:143], v[100:103], v[76:79], v[140:143]
    v_mfma_f32_16x16x32_bf16 v[144:147], v[104:107], v[64:67], v[144:147]
    ds_read_b128 v[100:103], v5 offset:5120
    v_mfma_f32_16x16x32_bf16 v[148:151], v[104:107], v[68:71], v[148:151]
    v_mfma_f32_16x16x32_bf16 v[152:155], v[104:107], v[72:75], v[152:155]
    v_mfma_f32_16x16x32_bf16 v[156:159], v[104:107], v[76:79], v[156:159]
    s_waitcnt lgkmcnt(2)
    v_mfma_f32_16x16x32_bf16 v[160:163], v[108:111], v[64:67], v[160:163]
    ds_read_b128 v[104:107], v5 offset:6144
    v_mfma_f32_16x16x32_bf16 v[164:167], v[108:111], v[68:71], v[164:167]
    v_mfma_f32_16x16x32_bf16 v[168:171], v[108:111], v[72:75], v[168:171]
    v_mfma_f32_16x16x32_bf16 v[172:175], v[108:111], v[76:79], v[172:175]
    s_waitcnt vmcnt(5)
    s_barrier
    s_add_u32 m0, s36, 104448
    s_nop 0
    buffer_load_dwordx4 v2, s[8:11], s33 offen lds
    buffer_load_dwordx4 v6, s[8:11], s33 offen offset:1024 lds
    s_add_u32 m0, s36, 120832
    s_add_u32 s33, s33, 1024
    buffer_load_dwordx4 v2, s[12:15], s34 offen lds
    buffer_load_dwordx4 v6, s[12:15], s34 offen offset:1024 lds
    s_add_u32 m0, s37, 104448
    s_add_u32 s34, s34, 1024
    buffer_load_dword v3, s[12:15], s35 offen lds
    s_add_u32 s35, s35, 1024
    s_waitcnt lgkmcnt(2)
    v_mfma_f32_16x16x32_bf16 v[176:179], v[96:99], v[64:67], v[176:179]
    ds_read_b128 v[108:111], v5 offset:7168
    v_mfma_f32_16x16x32_bf16 v[180:183], v[96:99], v[68:71], v[180:183]
    v_mfma_f32_16x16x32_bf16 v[184:187], v[96:99], v[72:75], v[184:187]
    v_mfma_f32_16x16x32_bf16 v[188:191], v[96:99], v[76:79], v[188:191]
    s_waitcnt lgkmcnt(2)
    v_mfma_f32_16x16x32_bf16 v[192:195], v[100:103], v[64:67], v[192:195]
    ds_read_b128 v[96:99], v5 offset:8192
    v_mfma_f32_16x16x32_bf16 v[196:199], v[100:103], v[68:71], v[196:199]
    v_mfma_f32_16x16x32_bf16 v[200:203], v[100:103], v[72:75], v[200:203]
    ds_read_b128 v[80:83], v4 offset:34816
    v_mfma_f32_16x16x32_bf16 v[204:207], v[100:103], v[76:79], v[204:207]
    s_waitcnt lgkmcnt(3)
    v_mfma_f32_16x16x32_bf16 v[208:211], v[104:107], v[64:67], v[208:211]
    ds_read_b128 v[100:103], v5 offset:34816
    v_mfma_f32_16x16x32_bf16 v[212:215], v[104:107], v[68:71], v[212:215]
    v_mfma_f32_16x16x32_bf16 v[216:219], v[104:107], v[72:75], v[216:219]
    ds_read_b128 v[84:87], v4 offset:35840
    v_mfma_f32_16x16x32_bf16 v[220:223], v[104:107], v[76:79], v[220:223]
    s_waitcnt lgkmcnt(4)
    v_mfma_f32_16x16x32_bf16 v[224:227], v[108:111], v[64:67], v[224:227]
    ds_read_b128 v[104:107], v5 offset:35840
    v_mfma_f32_16x16x32_bf16 v[228:231], v[108:111], v[68:71], v[228:231]
    v_mfma_f32_16x16x32_bf16 v[232:235], v[108:111], v[72:75], v[232:235]
    ds_read_b128 v[88:91], v4 offset:36864
    v_mfma_f32_16x16x32_bf16 v[236:239], v[108:111], v[76:79], v[236:239]
    s_waitcnt lgkmcnt(5)
    v_mfma_f32_16x16x32_bf16 v[240:243], v[96:99], v[64:67], v[240:243]
    ds_read_b128 v[108:111], v5 offset:36864
    v_mfma_f32_16x16x32_bf16 v[244:247], v[96:99], v[68:71], v[244:247]
    v_mfma_f32_16x16x32_bf16 v[248:251], v[96:99], v[72:75], v[248:251]
    ds_read_b128 v[92:95], v4 offset:37888
    v_mfma_f32_16x16x32_bf16 v[252:255], v[96:99], v[76:79], v[252:255]
    s_waitcnt lgkmcnt(5)
    v_mfma_f32_16x16x32_bf16 v[112:115], v[100:103], v[80:83], v[112:115]
    ds_read_b128 v[96:99], v5 offset:37888
    s_waitcnt lgkmcnt(5)
    v_mfma_f32_16x16x32_bf16 v[116:119], v[100:103], v[84:87], v[116:119]
    s_waitcnt lgkmcnt(3)
    v_mfma_f32_16x16x32_bf16 v[120:123], v[100:103], v[88:91], v[120:123]
    s_waitcnt lgkmcnt(1)
    v_mfma_f32_16x16x32_bf16 v[124:127], v[100:103], v[92:95], v[124:127]
    v_mfma_f32_16x16x32_bf16 v[128:131], v[104:107], v[80:83], v[128:131]
    ds_read_b128 v[100:103], v5 offset:38912
    v_mfma_f32_16x16x32_bf16 v[132:135], v[104:107], v[84:87], v[132:135]
    v_mfma_f32_16x16x32_bf16 v[136:139], v[104:107], v[88:91], v[136:139]
    v_mfma_f32_16x16x32_bf16 v[140:143], v[104:107], v[92:95], v[140:143]
    v_mfma_f32_16x16x32_bf16 v[144:147], v[108:111], v[80:83], v[144:147]
    ds_read_b128 v[104:107], v5 offset:39936
    v_mfma_f32_16x16x32_bf16 v[148:151], v[108:111], v[84:87], v[148:151]
    v_mfma_f32_16x16x32_bf16 v[152:155], v[108:111], v[88:91], v[152:155]
    v_mfma_f32_16x16x32_bf16 v[156:159], v[108:111], v[92:95], v[156:159]
    s_waitcnt lgkmcnt(2)
    v_mfma_f32_16x16x32_bf16 v[160:163], v[96:99], v[80:83], v[160:163]
    ds_read_b128 v[108:111], v5 offset:40960
    v_mfma_f32_16x16x32_bf16 v[164:167], v[96:99], v[84:87], v[164:167]
    v_mfma_f32_16x16x32_bf16 v[168:171], v[96:99], v[88:91], v[168:171]
    v_mfma_f32_16x16x32_bf16 v[172:175], v[96:99], v[92:95], v[172:175]
    s_waitcnt vmcnt(5)
    s_barrier
    s_add_u32 m0, s36, 0
    s_nop 0
    buffer_load_dwordx4 v2, s[8:11], s33 offen lds
    buffer_load_dwordx4 v6, s[8:11], s33 offen offset:1024 lds
    s_add_u32 m0, s36, 16384
    s_add_u32 s33, s33, 1024
    buffer_load_dwordx4 v2, s[12:15], s34 offen lds
    buffer_load_dwordx4 v6, s[12:15], s34 offen offset:1024 lds
    s_add_u32 m0, s37, 0
    s_add_u32 s34, s34, 1024
    buffer_load_dword v3, s[12:15], s35 offen lds
    s_add_u32 s35, s35, 1024
    s_waitcnt lgkmcnt(2)
    v_mfma_f32_16x16x32_bf16 v[176:179], v[100:103], v[80:83], v[176:179]
    ds_read_b128 v[96:99], v5 offset:41984
    v_mfma_f32_16x16x32_bf16 v[180:183], v[100:103], v[84:87], v[180:183]
    v_mfma_f32_16x16x32_bf16 v[184:187], v[100:103], v[88:91], v[184:187]
    v_mfma_f32_16x16x32_bf16 v[188:191], v[100:103], v[92:95], v[188:191]
    s_waitcnt lgkmcnt(2)
    v_mfma_f32_16x16x32_bf16 v[192:195], v[104:107], v[80:83], v[192:195]
    ds_read_b128 v[100:103], v5 offset:43008
    v_mfma_f32_16x16x32_bf16 v[196:199], v[104:107], v[84:87], v[196:199]
    v_mfma_f32_16x16x32_bf16 v[200:203], v[104:107], v[88:91], v[200:203]
    ds_read_b128 v[64:67], v9 offset:0
    v_mfma_f32_16x16x32_bf16 v[204:207], v[104:107], v[92:95], v[204:207]
    s_waitcnt lgkmcnt(3)
    v_mfma_f32_16x16x32_bf16 v[208:211], v[108:111], v[80:83], v[208:211]
    ds_read_b128 v[104:107], v10 offset:0
    v_mfma_f32_16x16x32_bf16 v[212:215], v[108:111], v[84:87], v[212:215]
    v_mfma_f32_16x16x32_bf16 v[216:219], v[108:111], v[88:91], v[216:219]
    ds_read_b128 v[68:71], v9 offset:1024
    v_mfma_f32_16x16x32_bf16 v[220:223], v[108:111], v[92:95], v[220:223]
    s_waitcnt lgkmcnt(4)
    v_mfma_f32_16x16x32_bf16 v[224:227], v[96:99], v[80:83], v[224:227]
    ds_read_b128 v[108:111], v10 offset:1024
    v_mfma_f32_16x16x32_bf16 v[228:231], v[96:99], v[84:87], v[228:231]
    v_mfma_f32_16x16x32_bf16 v[232:235], v[96:99], v[88:91], v[232:235]
    ds_read_b128 v[72:75], v9 offset:2048
    v_mfma_f32_16x16x32_bf16 v[236:239], v[96:99], v[92:95], v[236:239]
    s_waitcnt lgkmcnt(5)
    v_mfma_f32_16x16x32_bf16 v[240:243], v[100:103], v[80:83], v[240:243]
    ds_read_b128 v[96:99], v10 offset:2048
    v_mfma_f32_16x16x32_bf16 v[244:247], v[100:103], v[84:87], v[244:247]
    v_mfma_f32_16x16x32_bf16 v[248:251], v[100:103], v[88:91], v[248:251]
    ds_read_b128 v[76:79], v9 offset:3072
    v_mfma_f32_16x16x32_bf16 v[252:255], v[100:103], v[92:95], v[252:255]
    s_waitcnt lgkmcnt(5)
    v_mfma_f32_16x16x32_bf16 v[112:115], v[104:107], v[64:67], v[112:115]
    ds_read_b128 v[100:103], v10 offset:3072
    s_waitcnt lgkmcnt(5)
    v_mfma_f32_16x16x32_bf16 v[116:119], v[104:107], v[68:71], v[116:119]
    s_waitcnt lgkmcnt(3)
    v_mfma_f32_16x16x32_bf16 v[120:123], v[104:107], v[72:75], v[120:123]
    s_waitcnt lgkmcnt(1)
    v_mfma_f32_16x16x32_bf16 v[124:127], v[104:107], v[76:79], v[124:127]
    v_mfma_f32_16x16x32_bf16 v[128:131], v[108:111], v[64:67], v[128:131]
    ds_read_b128 v[104:107], v10 offset:4096
    v_mfma_f32_16x16x32_bf16 v[132:135], v[108:111], v[68:71], v[132:135]
    v_mfma_f32_16x16x32_bf16 v[136:139], v[108:111], v[72:75], v[136:139]
    v_mfma_f32_16x16x32_bf16 v[140:143], v[108:111], v[76:79], v[140:143]
    v_mfma_f32_16x16x32_bf16 v[144:147], v[96:99], v[64:67], v[144:147]
    ds_read_b128 v[108:111], v10 offset:5120
    v_mfma_f32_16x16x32_bf16 v[148:151], v[96:99], v[68:71], v[148:151]
    v_mfma_f32_16x16x32_bf16 v[152:155], v[96:99], v[72:75], v[152:155]
    v_mfma_f32_16x16x32_bf16 v[156:159], v[96:99], v[76:79], v[156:159]
    s_waitcnt lgkmcnt(2)
    v_mfma_f32_16x16x32_bf16 v[160:163], v[100:103], v[64:67], v[160:163]
    ds_read_b128 v[96:99], v10 offset:6144
    v_mfma_f32_16x16x32_bf16 v[164:167], v[100:103], v[68:71], v[164:167]
    v_mfma_f32_16x16x32_bf16 v[168:171], v[100:103], v[72:75], v[168:171]
    v_mfma_f32_16x16x32_bf16 v[172:175], v[100:103], v[76:79], v[172:175]
    s_waitcnt vmcnt(5)
    s_barrier
    s_add_u32 m0, s36, 34816
    s_nop 0
    buffer_load_dwordx4 v2, s[8:11], s33 offen lds
    buffer_load_dwordx4 v6, s[8:11], s33 offen offset:1024 lds
    s_add_u32 m0, s36, 51200
    s_add_u32 s33, s33, 1024
    buffer_load_dwordx4 v2, s[12:15], s34 offen lds
    buffer_load_dwordx4 v6, s[12:15], s34 offen offset:1024 lds
    s_add_u32 m0, s37, 34816
    s_add_u32 s34, s34, 1024
    buffer_load_dword v3, s[12:15], s35 offen lds
    s_add_u32 s35, s35, 1024
    s_waitcnt lgkmcnt(2)
    v_mfma_f32_16x16x32_bf16 v[176:179], v[104:107], v[64:67], v[176:179]
    ds_read_b128 v[100:103], v10 offset:7168
    v_mfma_f32_16x16x32_bf16 v[180:183], v[104:107], v[68:71], v[180:183]
    v_mfma_f32_16x16x32_bf16 v[184:187], v[104:107], v[72:75], v[184:187]
    v_mfma_f32_16x16x32_bf16 v[188:191], v[104:107], v[76:79], v[188:191]
    s_waitcnt lgkmcnt(2)
    v_mfma_f32_16x16x32_bf16 v[192:195], v[108:111], v[64:67], v[192:195]
    ds_read_b128 v[104:107], v10 offset:8192
    v_mfma_f32_16x16x32_bf16 v[196:199], v[108:111], v[68:71], v[196:199]
    v_mfma_f32_16x16x32_bf16 v[200:203], v[108:111], v[72:75], v[200:203]
    ds_read_b128 v[80:83], v9 offset:34816
    v_mfma_f32_16x16x32_bf16 v[204:207], v[108:111], v[76:79], v[204:207]
    s_waitcnt lgkmcnt(3)
    v_mfma_f32_16x16x32_bf16 v[208:211], v[96:99], v[64:67], v[208:211]
    ds_read_b128 v[108:111], v10 offset:34816
    v_mfma_f32_16x16x32_bf16 v[212:215], v[96:99], v[68:71], v[212:215]
    v_mfma_f32_16x16x32_bf16 v[216:219], v[96:99], v[72:75], v[216:219]
    ds_read_b128 v[84:87], v9 offset:35840
    v_mfma_f32_16x16x32_bf16 v[220:223], v[96:99], v[76:79], v[220:223]
    s_waitcnt lgkmcnt(4)
    v_mfma_f32_16x16x32_bf16 v[224:227], v[100:103], v[64:67], v[224:227]
    ds_read_b128 v[96:99], v10 offset:35840
    v_mfma_f32_16x16x32_bf16 v[228:231], v[100:103], v[68:71], v[228:231]
    v_mfma_f32_16x16x32_bf16 v[232:235], v[100:103], v[72:75], v[232:235]
    ds_read_b128 v[88:91], v9 offset:36864
    v_mfma_f32_16x16x32_bf16 v[236:239], v[100:103], v[76:79], v[236:239]
    s_waitcnt lgkmcnt(5)
    v_mfma_f32_16x16x32_bf16 v[240:243], v[104:107], v[64:67], v[240:243]
    ds_read_b128 v[100:103], v10 offset:36864
    v_mfma_f32_16x16x32_bf16 v[244:247], v[104:107], v[68:71], v[244:247]
    v_mfma_f32_16x16x32_bf16 v[248:251], v[104:107], v[72:75], v[248:251]
    ds_read_b128 v[92:95], v9 offset:37888
    v_mfma_f32_16x16x32_bf16 v[252:255], v[104:107], v[76:79], v[252:255]
    s_waitcnt lgkmcnt(5)
    v_mfma_f32_16x16x32_bf16 v[112:115], v[108:111], v[80:83], v[112:115]
    ds_read_b128 v[104:107], v10 offset:37888
    s_waitcnt lgkmcnt(5)
    v_mfma_f32_16x16x32_bf16 v[116:119], v[108:111], v[84:87], v[116:119]
    s_waitcnt lgkmcnt(3)
    v_mfma_f32_16x16x32_bf16 v[120:123], v[108:111], v[88:91], v[120:123]
    s_waitcnt lgkmcnt(1)
    v_mfma_f32_16x16x32_bf16 v[124:127], v[108:111], v[92:95], v[124:127]
    v_mfma_f32_16x16x32_bf16 v[128:131], v[96:99], v[80:83], v[128:131]
    ds_read_b128 v[108:111], v10 offset:38912
    v_mfma_f32_16x16x32_bf16 v[132:135], v[96:99], v[84:87], v[132:135]
    v_mfma_f32_16x16x32_bf16 v[136:139], v[96:99], v[88:91], v[136:139]
    v_mfma_f32_16x16x32_bf16 v[140:143], v[96:99], v[92:95], v[140:143]
    v_mfma_f32_16x16x32_bf16 v[144:147], v[100:103], v[80:83], v[144:147]
    ds_read_b128 v[96:99], v10 offset:39936
    v_mfma_f32_16x16x32_bf16 v[148:151], v[100:103], v[84:87], v[148:151]
    v_mfma_f32_16x16x32_bf16 v[152:155], v[100:103], v[88:91], v[152:155]
    v_mfma_f32_16x16x32_bf16 v[156:159], v[100:103], v[92:95], v[156:159]
    s_waitcnt lgkmcnt(2)
    v_mfma_f32_16x16x32_bf16 v[160:163], v[104:107], v[80:83], v[160:163]
    ds_read_b128 v[100:103], v10 offset:40960
    v_mfma_f32_16x16x32_bf16 v[164:167], v[104:107], v[84:87], v[164:167]
    v_mfma_f32_16x16x32_bf16 v[168:171], v[104:107], v[88:91], v[168:171]
    v_mfma_f32_16x16x32_bf16 v[172:175], v[104:107], v[92:95], v[172:175]
    s_waitcnt vmcnt(5)
    s_barrier
    s_add_u32 m0, s36, 69632
    s_nop 0
    buffer_load_dwordx4 v2, s[8:11], s33 offen lds
    buffer_load_dwordx4 v6, s[8:11], s33 offen offset:1024 lds
    s_add_u32 m0, s36, 86016
    s_add_u32 s33, s33, 1024
    buffer_load_dwordx4 v2, s[12:15], s34 offen lds
    buffer_load_dwordx4 v6, s[12:15], s34 offen offset:1024 lds
    s_add_u32 m0, s37, 69632
    s_add_u32 s34, s34, 1024
    buffer_load_dword v3, s[12:15], s35 offen lds
    s_add_u32 s35, s35, 1024
    s_waitcnt lgkmcnt(2)
    v_mfma_f32_16x16x32_bf16 v[176:179], v[108:111], v[80:83], v[176:179]
    ds_read_b128 v[104:107], v10 offset:41984
    v_mfma_f32_16x16x32_bf16 v[180:183], v[108:111], v[84:87], v[180:183]
    v_mfma_f32_16x16x32_bf16 v[184:187], v[108:111], v[88:91], v[184:187]
    v_mfma_f32_16x16x32_bf16 v[188:191], v[108:111], v[92:95], v[188:191]
    s_waitcnt lgkmcnt(2)
    v_mfma_f32_16x16x32_bf16 v[192:195], v[96:99], v[80:83], v[192:195]
    ds_read_b128 v[108:111], v10 offset:43008
    v_mfma_f32_16x16x32_bf16 v[196:199], v[96:99], v[84:87], v[196:199]
    v_mfma_f32_16x16x32_bf16 v[200:203], v[96:99], v[88:91], v[200:203]
    ds_read_b128 v[64:67], v4 offset:0
    v_mfma_f32_16x16x32_bf16 v[204:207], v[96:99], v[92:95], v[204:207]
    s_waitcnt lgkmcnt(3)
    v_mfma_f32_16x16x32_bf16 v[208:211], v[100:103], v[80:83], v[208:211]
    ds_read_b128 v[96:99], v5 offset:0
    v_mfma_f32_16x16x32_bf16 v[212:215], v[100:103], v[84:87], v[212:215]
    v_mfma_f32_16x16x32_bf16 v[216:219], v[100:103], v[88:91], v[216:219]
    ds_read_b128 v[68:71], v4 offset:1024
    v_mfma_f32_16x16x32_bf16 v[220:223], v[100:103], v[92:95], v[220:223]
    s_waitcnt lgkmcnt(4)
    v_mfma_f32_16x16x32_bf16 v[224:227], v[104:107], v[80:83], v[224:227]
    ds_read_b128 v[100:103], v5 offset:1024
    v_mfma_f32_16x16x32_bf16 v[228:231], v[104:107], v[84:87], v[228:231]
    v_mfma_f32_16x16x32_bf16 v[232:235], v[104:107], v[88:91], v[232:235]
    ds_read_b128 v[72:75], v4 offset:2048
    v_mfma_f32_16x16x32_bf16 v[236:239], v[104:107], v[92:95], v[236:239]
    s_waitcnt lgkmcnt(5)
    v_mfma_f32_16x16x32_bf16 v[240:243], v[108:111], v[80:83], v[240:243]
    ds_read_b128 v[104:107], v5 offset:2048
    v_mfma_f32_16x16x32_bf16 v[244:247], v[108:111], v[84:87], v[244:247]
    v_mfma_f32_16x16x32_bf16 v[248:251], v[108:111], v[88:91], v[248:251]
    ds_read_b128 v[76:79], v4 offset:3072
    v_mfma_f32_16x16x32_bf16 v[252:255], v[108:111], v[92:95], v[252:255]
    s_waitcnt lgkmcnt(5)
    v_mfma_f32_16x16x32_bf16 v[112:115], v[96:99], v[64:67], v[112:115]
    ds_read_b128 v[108:111], v5 offset:3072
    s_waitcnt lgkmcnt(5)
    v_mfma_f32_16x16x32_bf16 v[116:119], v[96:99], v[68:71], v[116:119]
    s_waitcnt lgkmcnt(3)
    v_mfma_f32_16x16x32_bf16 v[120:123], v[96:99], v[72:75], v[120:123]
    s_waitcnt lgkmcnt(1)
    v_mfma_f32_16x16x32_bf16 v[124:127], v[96:99], v[76:79], v[124:127]
    v_mfma_f32_16x16x32_bf16 v[128:131], v[100:103], v[64:67], v[128:131]
    ds_read_b128 v[96:99], v5 offset:4096
    v_mfma_f32_16x16x32_bf16 v[132:135], v[100:103], v[68:71], v[132:135]
    v_mfma_f32_16x16x32_bf16 v[136:139], v[100:103], v[72:75], v[136:139]
    v_mfma_f32_16x16x32_bf16 v[140:143], v[100:103], v[76:79], v[140:143]
    v_mfma_f32_16x16x32_bf16 v[144:147], v[104:107], v[64:67], v[144:147]
    ds_read_b128 v[100:103], v5 offset:5120
    v_mfma_f32_16x16x32_bf16 v[148:151], v[104:107], v[68:71], v[148:151]
    v_mfma_f32_16x16x32_bf16 v[152:155], v[104:107], v[72:75], v[152:155]
    v_mfma_f32_16x16x32_bf16 v[156:159], v[104:107], v[76:79], v[156:159]
    s_waitcnt lgkmcnt(2)
    v_mfma_f32_16x16x32_bf16 v[160:163], v[108:111], v[64:67], v[160:163]
    ds_read_b128 v[104:107], v5 offset:6144
    v_mfma_f32_16x16x32_bf16 v[164:167], v[108:111], v[68:71], v[164:167]
    v_mfma_f32_16x16x32_bf16 v[168:171], v[108:111], v[72:75], v[168:171]
    v_mfma_f32_16x16x32_bf16 v[172:175], v[108:111], v[76:79], v[172:175]
    s_waitcnt vmcnt(5)
    s_barrier
    s_add_u32 m0, s36, 104448
    s_nop 0
    buffer_load_dwordx4 v2, s[8:11], s33 offen lds
    buffer_load_dwordx4 v6, s[8:11], s33 offen offset:1024 lds
    s_add_u32 m0, s36, 120832
    s_add_u32 s33, s33, 1024
    buffer_load_dwordx4 v2, s[12:15], s34 offen lds
    buffer_load_dwordx4 v6, s[12:15], s34 offen offset:1024 lds
    s_add_u32 m0, s37, 104448
    s_add_u32 s34, s34, 1024
    buffer_load_dword v3, s[12:15], s35 offen lds
    s_add_u32 s35, s35, 1024
    s_waitcnt lgkmcnt(2)
    v_mfma_f32_16x16x32_bf16 v[176:179], v[96:99], v[64:67], v[176:179]
    ds_read_b128 v[108:111], v5 offset:7168
    v_mfma_f32_16x16x32_bf16 v[180:183], v[96:99], v[68:71], v[180:183]
    v_mfma_f32_16x16x32_bf16 v[184:187], v[96:99], v[72:75], v[184:187]
    v_mfma_f32_16x16x32_bf16 v[188:191], v[96:99], v[76:79], v[188:191]
    s_waitcnt lgkmcnt(2)
    v_mfma_f32_16x16x32_bf16 v[192:195], v[100:103], v[64:67], v[192:195]
    ds_read_b128 v[96:99], v5 offset:8192
    v_mfma_f32_16x16x32_bf16 v[196:199], v[100:103], v[68:71], v[196:199]
    v_mfma_f32_16x16x32_bf16 v[200:203], v[100:103], v[72:75], v[200:203]
    ds_read_b128 v[80:83], v4 offset:34816
    v_mfma_f32_16x16x32_bf16 v[204:207], v[100:103], v[76:79], v[204:207]
    s_waitcnt lgkmcnt(3)
    v_mfma_f32_16x16x32_bf16 v[208:211], v[104:107], v[64:67], v[208:211]
    ds_read_b128 v[100:103], v5 offset:34816
    v_mfma_f32_16x16x32_bf16 v[212:215], v[104:107], v[68:71], v[212:215]
    v_mfma_f32_16x16x32_bf16 v[216:219], v[104:107], v[72:75], v[216:219]
    ds_read_b128 v[84:87], v4 offset:35840
    v_mfma_f32_16x16x32_bf16 v[220:223], v[104:107], v[76:79], v[220:223]
    s_waitcnt lgkmcnt(4)
    v_mfma_f32_16x16x32_bf16 v[224:227], v[108:111], v[64:67], v[224:227]
    ds_read_b128 v[104:107], v5 offset:35840
    v_mfma_f32_16x16x32_bf16 v[228:231], v[108:111], v[68:71], v[228:231]
    v_mfma_f32_16x16x32_bf16 v[232:235], v[108:111], v[72:75], v[232:235]
    ds_read_b128 v[88:91], v4 offset:36864
    v_mfma_f32_16x16x32_bf16 v[236:239], v[108:111], v[76:79], v[236:239]
    s_waitcnt lgkmcnt(5)
    v_mfma_f32_16x16x32_bf16 v[240:243], v[96:99], v[64:67], v[240:243]
    ds_read_b128 v[108:111], v5 offset:36864
    v_mfma_f32_16x16x32_bf16 v[244:247], v[96:99], v[68:71], v[244:247]
    v_mfma_f32_16x16x32_bf16 v[248:251], v[96:99], v[72:75], v[248:251]
    ds_read_b128 v[92:95], v4 offset:37888
    v_mfma_f32_16x16x32_bf16 v[252:255], v[96:99], v[76:79], v[252:255]
    s_waitcnt lgkmcnt(5)
    v_mfma_f32_16x16x32_bf16 v[112:115], v[100:103], v[80:83], v[112:115]
    ds_read_b128 v[96:99], v5 offset:37888
    s_waitcnt lgkmcnt(5)
    v_mfma_f32_16x16x32_bf16 v[116:119], v[100:103], v[84:87], v[116:119]
    s_waitcnt lgkmcnt(3)
    v_mfma_f32_16x16x32_bf16 v[120:123], v[100:103], v[88:91], v[120:123]
    s_waitcnt lgkmcnt(1)
    v_mfma_f32_16x16x32_bf16 v[124:127], v[100:103], v[92:95], v[124:127]
    v_mfma_f32_16x16x32_bf16 v[128:131], v[104:107], v[80:83], v[128:131]
    ds_read_b128 v[100:103], v5 offset:38912
    v_mfma_f32_16x16x32_bf16 v[132:135], v[104:107], v[84:87], v[132:135]
    v_mfma_f32_16x16x32_bf16 v[136:139], v[104:107], v[88:91], v[136:139]
    v_mfma_f32_16x16x32_bf16 v[140:143], v[104:107], v[92:95], v[140:143]
    v_mfma_f32_16x16x32_bf16 v[144:147], v[108:111], v[80:83], v[144:147]
    ds_read_b128 v[104:107], v5 offset:39936
    v_mfma_f32_16x16x32_bf16 v[148:151], v[108:111], v[84:87], v[148:151]
    v_mfma_f32_16x16x32_bf16 v[152:155], v[108:111], v[88:91], v[152:155]
    v_mfma_f32_16x16x32_bf16 v[156:159], v[108:111], v[92:95], v[156:159]
    s_waitcnt lgkmcnt(2)
    v_mfma_f32_16x16x32_bf16 v[160:163], v[96:99], v[80:83], v[160:163]
    ds_read_b128 v[108:111], v5 offset:40960
    v_mfma_f32_16x16x32_bf16 v[164:167], v[96:99], v[84:87], v[164:167]
    v_mfma_f32_16x16x32_bf16 v[168:171], v[96:99], v[88:91], v[168:171]
    v_mfma_f32_16x16x32_bf16 v[172:175], v[96:99], v[92:95], v[172:175]
    s_waitcnt vmcnt(5)
    s_barrier
    s_add_u32 m0, s36, 0
    s_nop 0
    buffer_load_dwordx4 v2, s[8:11], s33 offen lds
    buffer_load_dwordx4 v6, s[8:11], s33 offen offset:1024 lds
    s_add_u32 m0, s36, 16384
    s_add_u32 s33, s33, 1024
    buffer_load_dwordx4 v2, s[12:15], s34 offen lds
    buffer_load_dwordx4 v6, s[12:15], s34 offen offset:1024 lds
    s_add_u32 m0, s37, 0
    s_add_u32 s34, s34, 1024
    buffer_load_dword v3, s[12:15], s35 offen lds
    s_add_u32 s35, s35, 1024
    s_waitcnt lgkmcnt(2)
    v_mfma_f32_16x16x32_bf16 v[176:179], v[100:103], v[80:83], v[176:179]
    ds_read_b128 v[96:99], v5 offset:41984
    v_mfma_f32_16x16x32_bf16 v[180:183], v[100:103], v[84:87], v[180:183]
    v_mfma_f32_16x16x32_bf16 v[184:187], v[100:103], v[88:91], v[184:187]
    v_mfma_f32_16x16x32_bf16 v[188:191], v[100:103], v[92:95], v[188:191]
    s_waitcnt lgkmcnt(2)
    v_mfma_f32_16x16x32_bf16 v[192:195], v[104:107], v[80:83], v[192:195]
    ds_read_b128 v[100:103], v5 offset:43008
    v_mfma_f32_16x16x32_bf16 v[196:199], v[104:107], v[84:87], v[196:199]
    v_mfma_f32_16x16x32_bf16 v[200:203], v[104:107], v[88:91], v[200:203]
    ds_read_b128 v[64:67], v9 offset:0
    v_mfma_f32_16x16x32_bf16 v[204:207], v[104:107], v[92:95], v[204:207]
    s_waitcnt lgkmcnt(3)
    v_mfma_f32_16x16x32_bf16 v[208:211], v[108:111], v[80:83], v[208:211]
    ds_read_b128 v[104:107], v10 offset:0
    v_mfma_f32_16x16x32_bf16 v[212:215], v[108:111], v[84:87], v[212:215]
    v_mfma_f32_16x16x32_bf16 v[216:219], v[108:111], v[88:91], v[216:219]
    ds_read_b128 v[68:71], v9 offset:1024
    v_mfma_f32_16x16x32_bf16 v[220:223], v[108:111], v[92:95], v[220:223]
    s_waitcnt lgkmcnt(4)
    v_mfma_f32_16x16x32_bf16 v[224:227], v[96:99], v[80:83], v[224:227]
    ds_read_b128 v[108:111], v10 offset:1024
    v_mfma_f32_16x16x32_bf16 v[228:231], v[96:99], v[84:87], v[228:231]
    v_mfma_f32_16x16x32_bf16 v[232:235], v[96:99], v[88:91], v[232:235]
    ds_read_b128 v[72:75], v9 offset:2048
    v_mfma_f32_16x16x32_bf16 v[236:239], v[96:99], v[92:95], v[236:239]
    s_waitcnt lgkmcnt(5)
    v_mfma_f32_16x16x32_bf16 v[240:243], v[100:103], v[80:83], v[240:243]
    ds_read_b128 v[96:99], v10 offset:2048
    v_mfma_f32_16x16x32_bf16 v[244:247], v[100:103], v[84:87], v[244:247]
    v_mfma_f32_16x16x32_bf16 v[248:251], v[100:103], v[88:91], v[248:251]
    ds_read_b128 v[76:79], v9 offset:3072
    v_mfma_f32_16x16x32_bf16 v[252:255], v[100:103], v[92:95], v[252:255]
    s_waitcnt lgkmcnt(5)
    v_mfma_f32_16x16x32_bf16 v[112:115], v[104:107], v[64:67], v[112:115]
    ds_read_b128 v[100:103], v10 offset:3072
    s_waitcnt lgkmcnt(5)
    v_mfma_f32_16x16x32_bf16 v[116:119], v[104:107], v[68:71], v[116:119]
    s_waitcnt lgkmcnt(3)
    v_mfma_f32_16x16x32_bf16 v[120:123], v[104:107], v[72:75], v[120:123]
    s_waitcnt lgkmcnt(1)
    v_mfma_f32_16x16x32_bf16 v[124:127], v[104:107], v[76:79], v[124:127]
    v_mfma_f32_16x16x32_bf16 v[128:131], v[108:111], v[64:67], v[128:131]
    ds_read_b128 v[104:107], v10 offset:4096
    v_mfma_f32_16x16x32_bf16 v[132:135], v[108:111], v[68:71], v[132:135]
    v_mfma_f32_16x16x32_bf16 v[136:139], v[108:111], v[72:75], v[136:139]
    v_mfma_f32_16x16x32_bf16 v[140:143], v[108:111], v[76:79], v[140:143]
    v_mfma_f32_16x16x32_bf16 v[144:147], v[96:99], v[64:67], v[144:147]
    ds_read_b128 v[108:111], v10 offset:5120
    v_mfma_f32_16x16x32_bf16 v[148:151], v[96:99], v[68:71], v[148:151]
    v_mfma_f32_16x16x32_bf16 v[152:155], v[96:99], v[72:75], v[152:155]
    v_mfma_f32_16x16x32_bf16 v[156:159], v[96:99], v[76:79], v[156:159]
    s_waitcnt lgkmcnt(2)
    v_mfma_f32_16x16x32_bf16 v[160:163], v[100:103], v[64:67], v[160:163]
    ds_read_b128 v[96:99], v10 offset:6144
    v_mfma_f32_16x16x32_bf16 v[164:167], v[100:103], v[68:71], v[164:167]
    v_mfma_f32_16x16x32_bf16 v[168:171], v[100:103], v[72:75], v[168:171]
    v_mfma_f32_16x16x32_bf16 v[172:175], v[100:103], v[76:79], v[172:175]
    s_waitcnt vmcnt(5)
    s_barrier
    s_add_u32 m0, s36, 34816
    s_nop 0
    buffer_load_dwordx4 v2, s[8:11], s33 offen lds
    buffer_load_dwordx4 v6, s[8:11], s33 offen offset:1024 lds
    s_add_u32 m0, s36, 51200
    s_add_u32 s33, s33, 1024
    buffer_load_dwordx4 v2, s[12:15], s34 offen lds
    buffer_load_dwordx4 v6, s[12:15], s34 offen offset:1024 lds
    s_add_u32 m0, s37, 34816
    s_add_u32 s34, s34, 1024
    buffer_load_dword v3, s[12:15], s35 offen lds
    s_add_u32 s35, s35, 1024
    s_waitcnt lgkmcnt(2)
    v_mfma_f32_16x16x32_bf16 v[176:179], v[104:107], v[64:67], v[176:179]
    ds_read_b128 v[100:103], v10 offset:7168
    v_mfma_f32_16x16x32_bf16 v[180:183], v[104:107], v[68:71], v[180:183]
    v_mfma_f32_16x16x32_bf16 v[184:187], v[104:107], v[72:75], v[184:187]
    v_mfma_f32_16x16x32_bf16 v[188:191], v[104:107], v[76:79], v[188:191]
    s_waitcnt lgkmcnt(2)
    v_mfma_f32_16x16x32_bf16 v[192:195], v[108:111], v[64:67], v[192:195]
    ds_read_b128 v[104:107], v10 offset:8192
    v_mfma_f32_16x16x32_bf16 v[196:199], v[108:111], v[68:71], v[196:199]
    v_mfma_f32_16x16x32_bf16 v[200:203], v[108:111], v[72:75], v[200:203]
    ds_read_b128 v[80:83], v9 offset:34816
    v_mfma_f32_16x16x32_bf16 v[204:207], v[108:111], v[76:79], v[204:207]
    s_waitcnt lgkmcnt(3)
    v_mfma_f32_16x16x32_bf16 v[208:211], v[96:99], v[64:67], v[208:211]
    ds_read_b128 v[108:111], v10 offset:34816
    v_mfma_f32_16x16x32_bf16 v[212:215], v[96:99], v[68:71], v[212:215]
    v_mfma_f32_16x16x32_bf16 v[216:219], v[96:99], v[72:75], v[216:219]
    ds_read_b128 v[84:87], v9 offset:35840
    v_mfma_f32_16x16x32_bf16 v[220:223], v[96:99], v[76:79], v[220:223]
    s_waitcnt lgkmcnt(4)
    v_mfma_f32_16x16x32_bf16 v[224:227], v[100:103], v[64:67], v[224:227]
    ds_read_b128 v[96:99], v10 offset:35840
    v_mfma_f32_16x16x32_bf16 v[228:231], v[100:103], v[68:71], v[228:231]
    v_mfma_f32_16x16x32_bf16 v[232:235], v[100:103], v[72:75], v[232:235]
    ds_read_b128 v[88:91], v9 offset:36864
    v_mfma_f32_16x16x32_bf16 v[236:239], v[100:103], v[76:79], v[236:239]
    s_waitcnt lgkmcnt(5)
    v_mfma_f32_16x16x32_bf16 v[240:243], v[104:107], v[64:67], v[240:243]
    ds_read_b128 v[100:103], v10 offset:36864
    v_mfma_f32_16x16x32_bf16 v[244:247], v[104:107], v[68:71], v[244:247]
    v_mfma_f32_16x16x32_bf16 v[248:251], v[104:107], v[72:75], v[248:251]
    ds_read_b128 v[92:95], v9 offset:37888
    v_mfma_f32_16x16x32_bf16 v[252:255], v[104:107], v[76:79], v[252:255]
    s_waitcnt lgkmcnt(5)
    v_mfma_f32_16x16x32_bf16 v[112:115], v[108:111], v[80:83], v[112:115]
    ds_read_b128 v[104:107], v10 offset:37888
    s_waitcnt lgkmcnt(5)
    v_mfma_f32_16x16x32_bf16 v[116:119], v[108:111], v[84:87], v[116:119]
    s_waitcnt lgkmcnt(3)
    v_mfma_f32_16x16x32_bf16 v[120:123], v[108:111], v[88:91], v[120:123]
    s_waitcnt lgkmcnt(1)
    v_mfma_f32_16x16x32_bf16 v[124:127], v[108:111], v[92:95], v[124:127]
    v_mfma_f32_16x16x32_bf16 v[128:131], v[96:99], v[80:83], v[128:131]
    ds_read_b128 v[108:111], v10 offset:38912
    v_mfma_f32_16x16x32_bf16 v[132:135], v[96:99], v[84:87], v[132:135]
    v_mfma_f32_16x16x32_bf16 v[136:139], v[96:99], v[88:91], v[136:139]
    v_mfma_f32_16x16x32_bf16 v[140:143], v[96:99], v[92:95], v[140:143]
    v_mfma_f32_16x16x32_bf16 v[144:147], v[100:103], v[80:83], v[144:147]
    ds_read_b128 v[96:99], v10 offset:39936
    v_mfma_f32_16x16x32_bf16 v[148:151], v[100:103], v[84:87], v[148:151]
    v_mfma_f32_16x16x32_bf16 v[152:155], v[100:103], v[88:91], v[152:155]
    v_mfma_f32_16x16x32_bf16 v[156:159], v[100:103], v[92:95], v[156:159]
    s_waitcnt lgkmcnt(2)
    v_mfma_f32_16x16x32_bf16 v[160:163], v[104:107], v[80:83], v[160:163]
    ds_read_b128 v[100:103], v10 offset:40960
    v_mfma_f32_16x16x32_bf16 v[164:167], v[104:107], v[84:87], v[164:167]
    v_mfma_f32_16x16x32_bf16 v[168:171], v[104:107], v[88:91], v[168:171]
    v_mfma_f32_16x16x32_bf16 v[172:175], v[104:107], v[92:95], v[172:175]
    s_waitcnt vmcnt(5)
    s_barrier
    s_add_u32 m0, s36, 69632
    s_nop 0
    buffer_load_dwordx4 v2, s[8:11], s33 offen lds
    buffer_load_dwordx4 v6, s[8:11], s33 offen offset:1024 lds
    s_add_u32 m0, s36, 86016
    s_add_u32 s33, s33, 1024
    buffer_load_dwordx4 v2, s[12:15], s34 offen lds
    buffer_load_dwordx4 v6, s[12:15], s34 offen offset:1024 lds
    s_add_u32 m0, s37, 69632
    s_add_u32 s34, s34, 1024
    buffer_load_dword v3, s[12:15], s35 offen lds
    s_add_u32 s35, s35, 1024
    s_waitcnt lgkmcnt(2)
    v_mfma_f32_16x16x32_bf16 v[176:179], v[108:111], v[80:83], v[176:179]
    ds_read_b128 v[104:107], v10 offset:41984
    v_mfma_f32_16x16x32_bf16 v[180:183], v[108:111], v[84:87], v[180:183]
    v_mfma_f32_16x16x32_bf16 v[184:187], v[108:111], v[88:91], v[184:187]
    v_mfma_f32_16x16x32_bf16 v[188:191], v[108:111], v[92:95], v[188:191]
    s_waitcnt lgkmcnt(2)
    v_mfma_f32_16x16x32_bf16 v[192:195], v[96:99], v[80:83], v[192:195]
    ds_read_b128 v[108:111], v10 offset:43008
    v_mfma_f32_16x16x32_bf16 v[196:199], v[96:99], v[84:87], v[196:199]
    v_mfma_f32_16x16x32_bf16 v[200:203], v[96:99], v[88:91], v[200:203]
    ds_read_b128 v[64:67], v4 offset:0
    v_mfma_f32_16x16x32_bf16 v[204:207], v[96:99], v[92:95], v[204:207]
    s_waitcnt lgkmcnt(3)
    v_mfma_f32_16x16x32_bf16 v[208:211], v[100:103], v[80:83], v[208:211]
    ds_read_b128 v[96:99], v5 offset:0
    v_mfma_f32_16x16x32_bf16 v[212:215], v[100:103], v[84:87], v[212:215]
    v_mfma_f32_16x16x32_bf16 v[216:219], v[100:103], v[88:91], v[216:219]
    ds_read_b128 v[68:71], v4 offset:1024
    v_mfma_f32_16x16x32_bf16 v[220:223], v[100:103], v[92:95], v[220:223]
    s_waitcnt lgkmcnt(4)
    v_mfma_f32_16x16x32_bf16 v[224:227], v[104:107], v[80:83], v[224:227]
    ds_read_b128 v[100:103], v5 offset:1024
    v_mfma_f32_16x16x32_bf16 v[228:231], v[104:107], v[84:87], v[228:231]
    v_mfma_f32_16x16x32_bf16 v[232:235], v[104:107], v[88:91], v[232:235]
    ds_read_b128 v[72:75], v4 offset:2048
    v_mfma_f32_16x16x32_bf16 v[236:239], v[104:107], v[92:95], v[236:239]
    s_waitcnt lgkmcnt(5)
    v_mfma_f32_16x16x32_bf16 v[240:243], v[108:111], v[80:83], v[240:243]
    ds_read_b128 v[104:107], v5 offset:2048
    v_mfma_f32_16x16x32_bf16 v[244:247], v[108:111], v[84:87], v[244:247]
    v_mfma_f32_16x16x32_bf16 v[248:251], v[108:111], v[88:91], v[248:251]
    ds_read_b128 v[76:79], v4 offset:3072
    v_mfma_f32_16x16x32_bf16 v[252:255], v[108:111], v[92:95], v[252:255]
    s_waitcnt lgkmcnt(5)
    v_mfma_f32_16x16x32_bf16 v[112:115], v[96:99], v[64:67], v[112:115]
    ds_read_b128 v[108:111], v5 offset:3072
    s_waitcnt lgkmcnt(5)
    v_mfma_f32_16x16x32_bf16 v[116:119], v[96:99], v[68:71], v[116:119]
    s_waitcnt lgkmcnt(3)
    v_mfma_f32_16x16x32_bf16 v[120:123], v[96:99], v[72:75], v[120:123]
    s_waitcnt lgkmcnt(1)
    v_mfma_f32_16x16x32_bf16 v[124:127], v[96:99], v[76:79], v[124:127]
    v_mfma_f32_16x16x32_bf16 v[128:131], v[100:103], v[64:67], v[128:131]
    ds_read_b128 v[96:99], v5 offset:4096
    v_mfma_f32_16x16x32_bf16 v[132:135], v[100:103], v[68:71], v[132:135]
    v_mfma_f32_16x16x32_bf16 v[136:139], v[100:103], v[72:75], v[136:139]
    v_mfma_f32_16x16x32_bf16 v[140:143], v[100:103], v[76:79], v[140:143]
    v_mfma_f32_16x16x32_bf16 v[144:147], v[104:107], v[64:67], v[144:147]
    ds_read_b128 v[100:103], v5 offset:5120
    v_mfma_f32_16x16x32_bf16 v[148:151], v[104:107], v[68:71], v[148:151]
    v_mfma_f32_16x16x32_bf16 v[152:155], v[104:107], v[72:75], v[152:155]
    v_mfma_f32_16x16x32_bf16 v[156:159], v[104:107], v[76:79], v[156:159]
    s_waitcnt lgkmcnt(2)
    v_mfma_f32_16x16x32_bf16 v[160:163], v[108:111], v[64:67], v[160:163]
    ds_read_b128 v[104:107], v5 offset:6144
    v_mfma_f32_16x16x32_bf16 v[164:167], v[108:111], v[68:71], v[164:167]
    v_mfma_f32_16x16x32_bf16 v[168:171], v[108:111], v[72:75], v[168:171]
    v_mfma_f32_16x16x32_bf16 v[172:175], v[108:111], v[76:79], v[172:175]
    s_waitcnt vmcnt(5)
    s_barrier
    s_add_u32 m0, s36, 104448
    s_nop 0
    buffer_load_dwordx4 v2, s[8:11], s33 offen lds
    buffer_load_dwordx4 v6, s[8:11], s33 offen offset:1024 lds
    s_add_u32 m0, s36, 120832
    s_add_u32 s33, s33, 1024
    buffer_load_dwordx4 v2, s[12:15], s34 offen lds
    buffer_load_dwordx4 v6, s[12:15], s34 offen offset:1024 lds
    s_add_u32 m0, s37, 104448
    s_add_u32 s34, s34, 1024
    buffer_load_dword v3, s[12:15], s35 offen lds
    s_add_u32 s35, s35, 1024
    s_waitcnt lgkmcnt(2)
    v_mfma_f32_16x16x32_bf16 v[176:179], v[96:99], v[64:67], v[176:179]
    ds_read_b128 v[108:111], v5 offset:7168
    v_mfma_f32_16x16x32_bf16 v[180:183], v[96:99], v[68:71], v[180:183]
    v_mfma_f32_16x16x32_bf16 v[184:187], v[96:99], v[72:75], v[184:187]
    v_mfma_f32_16x16x32_bf16 v[188:191], v[96:99], v[76:79], v[188:191]
    s_waitcnt lgkmcnt(2)
    v_mfma_f32_16x16x32_bf16 v[192:195], v[100:103], v[64:67], v[192:195]
    ds_read_b128 v[96:99], v5 offset:8192
    v_mfma_f32_16x16x32_bf16 v[196:199], v[100:103], v[68:71], v[196:199]
    v_mfma_f32_16x16x32_bf16 v[200:203], v[100:103], v[72:75], v[200:203]
    ds_read_b128 v[80:83], v4 offset:34816
    v_mfma_f32_16x16x32_bf16 v[204:207], v[100:103], v[76:79], v[204:207]
    s_waitcnt lgkmcnt(3)
    v_mfma_f32_16x16x32_bf16 v[208:211], v[104:107], v[64:67], v[208:211]
    ds_read_b128 v[100:103], v5 offset:34816
    v_mfma_f32_16x16x32_bf16 v[212:215], v[104:107], v[68:71], v[212:215]
    v_mfma_f32_16x16x32_bf16 v[216:219], v[104:107], v[72:75], v[216:219]
    ds_read_b128 v[84:87], v4 offset:35840
    v_mfma_f32_16x16x32_bf16 v[220:223], v[104:107], v[76:79], v[220:223]
    s_waitcnt lgkmcnt(4)
    v_mfma_f32_16x16x32_bf16 v[224:227], v[108:111], v[64:67], v[224:227]
    ds_read_b128 v[104:107], v5 offset:35840
    v_mfma_f32_16x16x32_bf16 v[228:231], v[108:111], v[68:71], v[228:231]
    v_mfma_f32_16x16x32_bf16 v[232:235], v[108:111], v[72:75], v[232:235]
    ds_read_b128 v[88:91], v4 offset:36864
    v_mfma_f32_16x16x32_bf16 v[236:239], v[108:111], v[76:79], v[236:239]
    s_waitcnt lgkmcnt(5)
    v_mfma_f32_16x16x32_bf16 v[240:243], v[96:99], v[64:67], v[240:243]
    ds_read_b128 v[108:111], v5 offset:36864
    v_mfma_f32_16x16x32_bf16 v[244:247], v[96:99], v[68:71], v[244:247]
    v_mfma_f32_16x16x32_bf16 v[248:251], v[96:99], v[72:75], v[248:251]
    ds_read_b128 v[92:95], v4 offset:37888
    v_mfma_f32_16x16x32_bf16 v[252:255], v[96:99], v[76:79], v[252:255]
    s_waitcnt lgkmcnt(5)
    v_mfma_f32_16x16x32_bf16 v[112:115], v[100:103], v[80:83], v[112:115]
    ds_read_b128 v[96:99], v5 offset:37888
    s_waitcnt lgkmcnt(5)
    v_mfma_f32_16x16x32_bf16 v[116:119], v[100:103], v[84:87], v[116:119]
    s_waitcnt lgkmcnt(3)
    v_mfma_f32_16x16x32_bf16 v[120:123], v[100:103], v[88:91], v[120:123]
    s_waitcnt lgkmcnt(1)
    v_mfma_f32_16x16x32_bf16 v[124:127], v[100:103], v[92:95], v[124:127]
    v_mfma_f32_16x16x32_bf16 v[128:131], v[104:107], v[80:83], v[128:131]
    ds_read_b128 v[100:103], v5 offset:38912
    v_mfma_f32_16x16x32_bf16 v[132:135], v[104:107], v[84:87], v[132:135]
    v_mfma_f32_16x16x32_bf16 v[136:139], v[104:107], v[88:91], v[136:139]
    v_mfma_f32_16x16x32_bf16 v[140:143], v[104:107], v[92:95], v[140:143]
    v_mfma_f32_16x16x32_bf16 v[144:147], v[108:111], v[80:83], v[144:147]
    ds_read_b128 v[104:107], v5 offset:39936
    v_mfma_f32_16x16x32_bf16 v[148:151], v[108:111], v[84:87], v[148:151]
    v_mfma_f32_16x16x32_bf16 v[152:155], v[108:111], v[88:91], v[152:155]
    v_mfma_f32_16x16x32_bf16 v[156:159], v[108:111], v[92:95], v[156:159]
    s_waitcnt lgkmcnt(2)
    v_mfma_f32_16x16x32_bf16 v[160:163], v[96:99], v[80:83], v[160:163]
    ds_read_b128 v[108:111], v5 offset:40960
    v_mfma_f32_16x16x32_bf16 v[164:167], v[96:99], v[84:87], v[164:167]
    v_mfma_f32_16x16x32_bf16 v[168:171], v[96:99], v[88:91], v[168:171]
    v_mfma_f32_16x16x32_bf16 v[172:175], v[96:99], v[92:95], v[172:175]
    s_waitcnt vmcnt(5)
    s_barrier
    s_add_u32 m0, s36, 0
    s_nop 0
    buffer_load_dwordx4 v2, s[8:11], s33 offen lds
    buffer_load_dwordx4 v6, s[8:11], s33 offen offset:1024 lds
    s_add_u32 m0, s36, 16384
    s_add_u32 s33, s33, 1024
    buffer_load_dwordx4 v2, s[12:15], s34 offen lds
    buffer_load_dwordx4 v6, s[12:15], s34 offen offset:1024 lds
    s_add_u32 m0, s37, 0
    s_add_u32 s34, s34, 1024
    buffer_load_dword v3, s[12:15], s35 offen lds
    s_add_u32 s35, s35, 1024
    s_waitcnt lgkmcnt(2)
    v_mfma_f32_16x16x32_bf16 v[176:179], v[100:103], v[80:83], v[176:179]
    ds_read_b128 v[96:99], v5 offset:41984
    v_mfma_f32_16x16x32_bf16 v[180:183], v[100:103], v[84:87], v[180:183]
    v_mfma_f32_16x16x32_bf16 v[184:187], v[100:103], v[88:91], v[184:187]
    v_mfma_f32_16x16x32_bf16 v[188:191], v[100:103], v[92:95], v[188:191]
    s_waitcnt lgkmcnt(2)
    v_mfma_f32_16x16x32_bf16 v[192:195], v[104:107], v[80:83], v[192:195]
    ds_read_b128 v[100:103], v5 offset:43008
    v_mfma_f32_16x16x32_bf16 v[196:199], v[104:107], v[84:87], v[196:199]
    v_mfma_f32_16x16x32_bf16 v[200:203], v[104:107], v[88:91], v[200:203]
    ds_read_b128 v[64:67], v9 offset:0
    v_mfma_f32_16x16x32_bf16 v[204:207], v[104:107], v[92:95], v[204:207]
    s_waitcnt lgkmcnt(3)
    v_mfma_f32_16x16x32_bf16 v[208:211], v[108:111], v[80:83], v[208:211]
    ds_read_b128 v[104:107], v10 offset:0
    v_mfma_f32_16x16x32_bf16 v[212:215], v[108:111], v[84:87], v[212:215]
    v_mfma_f32_16x16x32_bf16 v[216:219], v[108:111], v[88:91], v[216:219]
    ds_read_b128 v[68:71], v9 offset:1024
    v_mfma_f32_16x16x32_bf16 v[220:223], v[108:111], v[92:95], v[220:223]
    s_waitcnt lgkmcnt(4)
    v_mfma_f32_16x16x32_bf16 v[224:227], v[96:99], v[80:83], v[224:227]
    ds_read_b128 v[108:111], v10 offset:1024
    v_mfma_f32_16x16x32_bf16 v[228:231], v[96:99], v[84:87], v[228:231]
    v_mfma_f32_16x16x32_bf16 v[232:235], v[96:99], v[88:91], v[232:235]
    ds_read_b128 v[72:75], v9 offset:2048
    v_mfma_f32_16x16x32_bf16 v[236:239], v[96:99], v[92:95], v[236:239]
    s_waitcnt lgkmcnt(5)
    v_mfma_f32_16x16x32_bf16 v[240:243], v[100:103], v[80:83], v[240:243]
    ds_read_b128 v[96:99], v10 offset:2048
    v_mfma_f32_16x16x32_bf16 v[244:247], v[100:103], v[84:87], v[244:247]
    v_mfma_f32_16x16x32_bf16 v[248:251], v[100:103], v[88:91], v[248:251]
    ds_read_b128 v[76:79], v9 offset:3072
    v_mfma_f32_16x16x32_bf16 v[252:255], v[100:103], v[92:95], v[252:255]
    s_waitcnt lgkmcnt(5)
    v_mfma_f32_16x16x32_bf16 v[112:115], v[104:107], v[64:67], v[112:115]
    ds_read_b128 v[100:103], v10 offset:3072
    s_waitcnt lgkmcnt(5)
    v_mfma_f32_16x16x32_bf16 v[116:119], v[104:107], v[68:71], v[116:119]
    s_waitcnt lgkmcnt(3)
    v_mfma_f32_16x16x32_bf16 v[120:123], v[104:107], v[72:75], v[120:123]
    s_waitcnt lgkmcnt(1)
    v_mfma_f32_16x16x32_bf16 v[124:127], v[104:107], v[76:79], v[124:127]
    v_mfma_f32_16x16x32_bf16 v[128:131], v[108:111], v[64:67], v[128:131]
    ds_read_b128 v[104:107], v10 offset:4096
    v_mfma_f32_16x16x32_bf16 v[132:135], v[108:111], v[68:71], v[132:135]
    v_mfma_f32_16x16x32_bf16 v[136:139], v[108:111], v[72:75], v[136:139]
    v_mfma_f32_16x16x32_bf16 v[140:143], v[108:111], v[76:79], v[140:143]
    v_mfma_f32_16x16x32_bf16 v[144:147], v[96:99], v[64:67], v[144:147]
    ds_read_b128 v[108:111], v10 offset:5120
    v_mfma_f32_16x16x32_bf16 v[148:151], v[96:99], v[68:71], v[148:151]
    v_mfma_f32_16x16x32_bf16 v[152:155], v[96:99], v[72:75], v[152:155]
    v_mfma_f32_16x16x32_bf16 v[156:159], v[96:99], v[76:79], v[156:159]
    s_waitcnt lgkmcnt(2)
    v_mfma_f32_16x16x32_bf16 v[160:163], v[100:103], v[64:67], v[160:163]
    ds_read_b128 v[96:99], v10 offset:6144
    v_mfma_f32_16x16x32_bf16 v[164:167], v[100:103], v[68:71], v[164:167]
    v_mfma_f32_16x16x32_bf16 v[168:171], v[100:103], v[72:75], v[168:171]
    v_mfma_f32_16x16x32_bf16 v[172:175], v[100:103], v[76:79], v[172:175]
    s_waitcnt vmcnt(5)
    s_barrier
    s_add_u32 m0, s36, 34816
    s_nop 0
    buffer_load_dwordx4 v2, s[8:11], s33 offen lds
    buffer_load_dwordx4 v6, s[8:11], s33 offen offset:1024 lds
    s_add_u32 m0, s36, 51200
    s_add_u32 s33, s33, 1024
    buffer_load_dwordx4 v2, s[12:15], s34 offen lds
    buffer_load_dwordx4 v6, s[12:15], s34 offen offset:1024 lds
    s_add_u32 m0, s37, 34816
    s_add_u32 s34, s34, 1024
    buffer_load_dword v3, s[12:15], s35 offen lds
    s_add_u32 s35, s35, 1024
    s_waitcnt lgkmcnt(2)
    v_mfma_f32_16x16x32_bf16 v[176:179], v[104:107], v[64:67], v[176:179]
    ds_read_b128 v[100:103], v10 offset:7168
    v_mfma_f32_16x16x32_bf16 v[180:183], v[104:107], v[68:71], v[180:183]
    v_mfma_f32_16x16x32_bf16 v[184:187], v[104:107], v[72:75], v[184:187]
    v_mfma_f32_16x16x32_bf16 v[188:191], v[104:107], v[76:79], v[188:191]
    s_waitcnt lgkmcnt(2)
    v_mfma_f32_16x16x32_bf16 v[192:195], v[108:111], v[64:67], v[192:195]
    ds_read_b128 v[104:107], v10 offset:8192
    v_mfma_f32_16x16x32_bf16 v[196:199], v[108:111], v[68:71], v[196:199]
    v_mfma_f32_16x16x32_bf16 v[200:203], v[108:111], v[72:75], v[200:203]
    ds_read_b128 v[80:83], v9 offset:34816
    v_mfma_f32_16x16x32_bf16 v[204:207], v[108:111], v[76:79], v[204:207]
    s_waitcnt lgkmcnt(3)
    v_mfma_f32_16x16x32_bf16 v[208:211], v[96:99], v[64:67], v[208:211]
    ds_read_b128 v[108:111], v10 offset:34816
    v_mfma_f32_16x16x32_bf16 v[212:215], v[96:99], v[68:71], v[212:215]
    v_mfma_f32_16x16x32_bf16 v[216:219], v[96:99], v[72:75], v[216:219]
    ds_read_b128 v[84:87], v9 offset:35840
    v_mfma_f32_16x16x32_bf16 v[220:223], v[96:99], v[76:79], v[220:223]
    s_waitcnt lgkmcnt(4)
    v_mfma_f32_16x16x32_bf16 v[224:227], v[100:103], v[64:67], v[224:227]
    ds_read_b128 v[96:99], v10 offset:35840
    v_mfma_f32_16x16x32_bf16 v[228:231], v[100:103], v[68:71], v[228:231]
    v_mfma_f32_16x16x32_bf16 v[232:235], v[100:103], v[72:75], v[232:235]
    ds_read_b128 v[88:91], v9 offset:36864
    v_mfma_f32_16x16x32_bf16 v[236:239], v[100:103], v[76:79], v[236:239]
    s_waitcnt lgkmcnt(5)
    v_mfma_f32_16x16x32_bf16 v[240:243], v[104:107], v[64:67], v[240:243]
    ds_read_b128 v[100:103], v10 offset:36864
    v_mfma_f32_16x16x32_bf16 v[244:247], v[104:107], v[68:71], v[244:247]
    v_mfma_f32_16x16x32_bf16 v[248:251], v[104:107], v[72:75], v[248:251]
    ds_read_b128 v[92:95], v9 offset:37888
    v_mfma_f32_16x16x32_bf16 v[252:255], v[104:107], v[76:79], v[252:255]
    s_waitcnt lgkmcnt(5)
    v_mfma_f32_16x16x32_bf16 v[112:115], v[108:111], v[80:83], v[112:115]
    ds_read_b128 v[104:107], v10 offset:37888
    s_waitcnt lgkmcnt(5)
    v_mfma_f32_16x16x32_bf16 v[116:119], v[108:111], v[84:87], v[116:119]
    s_waitcnt lgkmcnt(3)
    v_mfma_f32_16x16x32_bf16 v[120:123], v[108:111], v[88:91], v[120:123]
    s_waitcnt lgkmcnt(1)
    v_mfma_f32_16x16x32_bf16 v[124:127], v[108:111], v[92:95], v[124:127]
    v_mfma_f32_16x16x32_bf16 v[128:131], v[96:99], v[80:83], v[128:131]
    ds_read_b128 v[108:111], v10 offset:38912
    v_mfma_f32_16x16x32_bf16 v[132:135], v[96:99], v[84:87], v[132:135]
    v_mfma_f32_16x16x32_bf16 v[136:139], v[96:99], v[88:91], v[136:139]
    v_mfma_f32_16x16x32_bf16 v[140:143], v[96:99], v[92:95], v[140:143]
    v_mfma_f32_16x16x32_bf16 v[144:147], v[100:103], v[80:83], v[144:147]
    ds_read_b128 v[96:99], v10 offset:39936
    v_mfma_f32_16x16x32_bf16 v[148:151], v[100:103], v[84:87], v[148:151]
    v_mfma_f32_16x16x32_bf16 v[152:155], v[100:103], v[88:91], v[152:155]
    v_mfma_f32_16x16x32_bf16 v[156:159], v[100:103], v[92:95], v[156:159]
    s_waitcnt lgkmcnt(2)
    v_mfma_f32_16x16x32_bf16 v[160:163], v[104:107], v[80:83], v[160:163]
    ds_read_b128 v[100:103], v10 offset:40960
    v_mfma_f32_16x16x32_bf16 v[164:167], v[104:107], v[84:87], v[164:167]
    v_mfma_f32_16x16x32_bf16 v[168:171], v[104:107], v[88:91], v[168:171]
    v_mfma_f32_16x16x32_bf16 v[172:175], v[104:107], v[92:95], v[172:175]
    s_waitcnt vmcnt(5)
    s_barrier
    s_waitcnt lgkmcnt(2)
    v_mfma_f32_16x16x32_bf16 v[176:179], v[108:111], v[80:83], v[176:179]
    ds_read_b128 v[104:107], v10 offset:41984
    v_mfma_f32_16x16x32_bf16 v[180:183], v[108:111], v[84:87], v[180:183]
    v_mfma_f32_16x16x32_bf16 v[184:187], v[108:111], v[88:91], v[184:187]
    v_mfma_f32_16x16x32_bf16 v[188:191], v[108:111], v[92:95], v[188:191]
    s_waitcnt lgkmcnt(2)
    v_mfma_f32_16x16x32_bf16 v[192:195], v[96:99], v[80:83], v[192:195]
    ds_read_b128 v[108:111], v10 offset:43008
    v_mfma_f32_16x16x32_bf16 v[196:199], v[96:99], v[84:87], v[196:199]
    v_mfma_f32_16x16x32_bf16 v[200:203], v[96:99], v[88:91], v[200:203]
    ds_read_b128 v[64:67], v4 offset:0
    v_mfma_f32_16x16x32_bf16 v[204:207], v[96:99], v[92:95], v[204:207]
    s_waitcnt lgkmcnt(3)
    v_mfma_f32_16x16x32_bf16 v[208:211], v[100:103], v[80:83], v[208:211]
    ds_read_b128 v[96:99], v5 offset:0
    v_mfma_f32_16x16x32_bf16 v[212:215], v[100:103], v[84:87], v[212:215]
    v_mfma_f32_16x16x32_bf16 v[216:219], v[100:103], v[88:91], v[216:219]
    ds_read_b128 v[68:71], v4 offset:1024
    v_mfma_f32_16x16x32_bf16 v[220:223], v[100:103], v[92:95], v[220:223]
    s_waitcnt lgkmcnt(4)
    v_mfma_f32_16x16x32_bf16 v[224:227], v[104:107], v[80:83], v[224:227]
    ds_read_b128 v[100:103], v5 offset:1024
    v_mfma_f32_16x16x32_bf16 v[228:231], v[104:107], v[84:87], v[228:231]
    v_mfma_f32_16x16x32_bf16 v[232:235], v[104:107], v[88:91], v[232:235]
    ds_read_b128 v[72:75], v4 offset:2048
    v_mfma_f32_16x16x32_bf16 v[236:239], v[104:107], v[92:95], v[236:239]
    s_waitcnt lgkmcnt(5)
    v_mfma_f32_16x16x32_bf16 v[240:243], v[108:111], v[80:83], v[240:243]
    ds_read_b128 v[104:107], v5 offset:2048
    v_mfma_f32_16x16x32_bf16 v[244:247], v[108:111], v[84:87], v[244:247]
    v_mfma_f32_16x16x32_bf16 v[248:251], v[108:111], v[88:91], v[248:251]
    ds_read_b128 v[76:79], v4 offset:3072
    v_mfma_f32_16x16x32_bf16 v[252:255], v[108:111], v[92:95], v[252:255]
    s_waitcnt lgkmcnt(5)
    v_mfma_f32_16x16x32_bf16 v[112:115], v[96:99], v[64:67], v[112:115]
    ds_read_b128 v[108:111], v5 offset:3072
    s_waitcnt lgkmcnt(5)
    v_mfma_f32_16x16x32_bf16 v[116:119], v[96:99], v[68:71], v[116:119]
    s_waitcnt lgkmcnt(3)
    v_mfma_f32_16x16x32_bf16 v[120:123], v[96:99], v[72:75], v[120:123]
    s_waitcnt lgkmcnt(1)
    v_mfma_f32_16x16x32_bf16 v[124:127], v[96:99], v[76:79], v[124:127]
    v_mfma_f32_16x16x32_bf16 v[128:131], v[100:103], v[64:67], v[128:131]
    ds_read_b128 v[96:99], v5 offset:4096
    v_mfma_f32_16x16x32_bf16 v[132:135], v[100:103], v[68:71], v[132:135]
    v_mfma_f32_16x16x32_bf16 v[136:139], v[100:103], v[72:75], v[136:139]
    v_mfma_f32_16x16x32_bf16 v[140:143], v[100:103], v[76:79], v[140:143]
    v_mfma_f32_16x16x32_bf16 v[144:147], v[104:107], v[64:67], v[144:147]
    ds_read_b128 v[100:103], v5 offset:5120
    v_mfma_f32_16x16x32_bf16 v[148:151], v[104:107], v[68:71], v[148:151]
    v_mfma_f32_16x16x32_bf16 v[152:155], v[104:107], v[72:75], v[152:155]
    v_mfma_f32_16x16x32_bf16 v[156:159], v[104:107], v[76:79], v[156:159]
    s_waitcnt lgkmcnt(2)
    v_mfma_f32_16x16x32_bf16 v[160:163], v[108:111], v[64:67], v[160:163]
    ds_read_b128 v[104:107], v5 offset:6144
    v_mfma_f32_16x16x32_bf16 v[164:167], v[108:111], v[68:71], v[164:167]
    v_mfma_f32_16x16x32_bf16 v[168:171], v[108:111], v[72:75], v[168:171]
    v_mfma_f32_16x16x32_bf16 v[172:175], v[108:111], v[76:79], v[172:175]
    s_waitcnt vmcnt(0)
    s_barrier
    s_waitcnt lgkmcnt(2)
    v_mfma_f32_16x16x32_bf16 v[176:179], v[96:99], v[64:67], v[176:179]
    ds_read_b128 v[108:111], v5 offset:7168
    v_mfma_f32_16x16x32_bf16 v[180:183], v[96:99], v[68:71], v[180:183]
    v_mfma_f32_16x16x32_bf16 v[184:187], v[96:99], v[72:75], v[184:187]
    v_mfma_f32_16x16x32_bf16 v[188:191], v[96:99], v[76:79], v[188:191]
    s_waitcnt lgkmcnt(2)
    v_mfma_f32_16x16x32_bf16 v[192:195], v[100:103], v[64:67], v[192:195]
    ds_read_b128 v[96:99], v5 offset:8192
    v_mfma_f32_16x16x32_bf16 v[196:199], v[100:103], v[68:71], v[196:199]
    v_mfma_f32_16x16x32_bf16 v[200:203], v[100:103], v[72:75], v[200:203]
    ds_read_b128 v[80:83], v4 offset:34816
    v_mfma_f32_16x16x32_bf16 v[204:207], v[100:103], v[76:79], v[204:207]
    s_waitcnt lgkmcnt(3)
    v_mfma_f32_16x16x32_bf16 v[208:211], v[104:107], v[64:67], v[208:211]
    ds_read_b128 v[100:103], v5 offset:34816
    v_mfma_f32_16x16x32_bf16 v[212:215], v[104:107], v[68:71], v[212:215]
    v_mfma_f32_16x16x32_bf16 v[216:219], v[104:107], v[72:75], v[216:219]
    ds_read_b128 v[84:87], v4 offset:35840
    v_mfma_f32_16x16x32_bf16 v[220:223], v[104:107], v[76:79], v[220:223]
    s_waitcnt lgkmcnt(4)
    v_mfma_f32_16x16x32_bf16 v[224:227], v[108:111], v[64:67], v[224:227]
    ds_read_b128 v[104:107], v5 offset:35840
    v_mfma_f32_16x16x32_bf16 v[228:231], v[108:111], v[68:71], v[228:231]
    v_mfma_f32_16x16x32_bf16 v[232:235], v[108:111], v[72:75], v[232:235]
    ds_read_b128 v[88:91], v4 offset:36864
    v_mfma_f32_16x16x32_bf16 v[236:239], v[108:111], v[76:79], v[236:239]
    s_waitcnt lgkmcnt(5)
    v_mfma_f32_16x16x32_bf16 v[240:243], v[96:99], v[64:67], v[240:243]
    ds_read_b128 v[108:111], v5 offset:36864
    v_mfma_f32_16x16x32_bf16 v[244:247], v[96:99], v[68:71], v[244:247]
    v_mfma_f32_16x16x32_bf16 v[248:251], v[96:99], v[72:75], v[248:251]
    ds_read_b128 v[92:95], v4 offset:37888
    v_mfma_f32_16x16x32_bf16 v[252:255], v[96:99], v[76:79], v[252:255]
    s_waitcnt lgkmcnt(5)
    v_mfma_f32_16x16x32_bf16 v[112:115], v[100:103], v[80:83], v[112:115]
    ds_read_b128 v[96:99], v5 offset:37888
    s_waitcnt lgkmcnt(5)
    v_mfma_f32_16x16x32_bf16 v[116:119], v[100:103], v[84:87], v[116:119]
    s_waitcnt lgkmcnt(3)
    v_mfma_f32_16x16x32_bf16 v[120:123], v[100:103], v[88:91], v[120:123]
    s_waitcnt lgkmcnt(1)
    v_mfma_f32_16x16x32_bf16 v[124:127], v[100:103], v[92:95], v[124:127]
    v_mfma_f32_16x16x32_bf16 v[128:131], v[104:107], v[80:83], v[128:131]
    ds_read_b128 v[100:103], v5 offset:38912
    v_mfma_f32_16x16x32_bf16 v[132:135], v[104:107], v[84:87], v[132:135]
    v_mfma_f32_16x16x32_bf16 v[136:139], v[104:107], v[88:91], v[136:139]
    v_mfma_f32_16x16x32_bf16 v[140:143], v[104:107], v[92:95], v[140:143]
    v_mfma_f32_16x16x32_bf16 v[144:147], v[108:111], v[80:83], v[144:147]
    ds_read_b128 v[104:107], v5 offset:39936
    v_mfma_f32_16x16x32_bf16 v[148:151], v[108:111], v[84:87], v[148:151]
    v_mfma_f32_16x16x32_bf16 v[152:155], v[108:111], v[88:91], v[152:155]
    v_mfma_f32_16x16x32_bf16 v[156:159], v[108:111], v[92:95], v[156:159]
    s_waitcnt lgkmcnt(2)
    v_mfma_f32_16x16x32_bf16 v[160:163], v[96:99], v[80:83], v[160:163]
    ds_read_b128 v[108:111], v5 offset:40960
    v_mfma_f32_16x16x32_bf16 v[164:167], v[96:99], v[84:87], v[164:167]
    v_mfma_f32_16x16x32_bf16 v[168:171], v[96:99], v[88:91], v[168:171]
    v_mfma_f32_16x16x32_bf16 v[172:175], v[96:99], v[92:95], v[172:175]
    s_waitcnt lgkmcnt(2)
    v_mfma_f32_16x16x32_bf16 v[176:179], v[100:103], v[80:83], v[176:179]
    ds_read_b128 v[96:99], v5 offset:41984
    v_mfma_f32_16x16x32_bf16 v[180:183], v[100:103], v[84:87], v[180:183]
    v_mfma_f32_16x16x32_bf16 v[184:187], v[100:103], v[88:91], v[184:187]
    v_mfma_f32_16x16x32_bf16 v[188:191], v[100:103], v[92:95], v[188:191]
    s_waitcnt lgkmcnt(2)
    v_mfma_f32_16x16x32_bf16 v[192:195], v[104:107], v[80:83], v[192:195]
    ds_read_b128 v[100:103], v5 offset:43008
    v_mfma_f32_16x16x32_bf16 v[196:199], v[104:107], v[84:87], v[196:199]
    v_mfma_f32_16x16x32_bf16 v[200:203], v[104:107], v[88:91], v[200:203]
    v_mfma_f32_16x16x32_bf16 v[204:207], v[104:107], v[92:95], v[204:207]
    s_waitcnt lgkmcnt(2)
    v_mfma_f32_16x16x32_bf16 v[208:211], v[108:111], v[80:83], v[208:211]
    v_mfma_f32_16x16x32_bf16 v[212:215], v[108:111], v[84:87], v[212:215]
    v_mfma_f32_16x16x32_bf16 v[216:219], v[108:111], v[88:91], v[216:219]
    v_mfma_f32_16x16x32_bf16 v[220:223], v[108:111], v[92:95], v[220:223]
    s_waitcnt lgkmcnt(1)
    v_mfma_f32_16x16x32_bf16 v[224:227], v[96:99], v[80:83], v[224:227]
    v_mfma_f32_16x16x32_bf16 v[228:231], v[96:99], v[84:87], v[228:231]
    v_mfma_f32_16x16x32_bf16 v[232:235], v[96:99], v[88:91], v[232:235]
    v_mfma_f32_16x16x32_bf16 v[236:239], v[96:99], v[92:95], v[236:239]
    s_waitcnt lgkmcnt(0)
    v_mfma_f32_16x16x32_bf16 v[240:243], v[100:103], v[80:83], v[240:243]
    v_mfma_f32_16x16x32_bf16 v[244:247], v[100:103], v[84:87], v[244:247]
    v_mfma_f32_16x16x32_bf16 v[248:251], v[100:103], v[88:91], v[248:251]
    v_mfma_f32_16x16x32_bf16 v[252:255], v[100:103], v[92:95], v[252:255]
    v_cmp_gt_u32 vcc, 32, v1
    v_mov_b32 v7, 0x7f000000
    s_nop 0
    v_cndmask_b32 v7, v7, v2, vcc
    v_pk_fma_f32 v[112:113], v[12:13], v[28:29], v[112:113] op_sel:[0,0,0] op_sel_hi:[0,1,1]
    v_pk_fma_f32 v[176:177], v[12:13], v[44:45], v[176:177] op_sel:[0,0,0] op_sel_hi:[0,1,1]
    v_pk_fma_f32 v[114:115], v[12:13], v[30:31], v[114:115] op_sel:[0,0,0] op_sel_hi:[0,1,1]
    v_pk_fma_f32 v[178:179], v[12:13], v[46:47], v[178:179] op_sel:[0,0,0] op_sel_hi:[0,1,1]
    v_pk_mul_f32 v[64:65], v[14:15], v[112:113] op_sel:[0,0] op_sel_hi:[0,1]
    v_pk_mul_f32 v[66:67], v[14:15], v[114:115] op_sel:[0,0] op_sel_hi:[0,1]
    v_exp_f32 v64, v64
    v_exp_f32 v65, v65
    v_exp_f32 v66, v66
    v_exp_f32 v67, v67
    v_pk_mul_f32 v[112:113], v[112:113], v[176:177]
    v_pk_mul_f32 v[114:115], v[114:115], v[178:179]
    v_pk_add_f32 v[64:65], v[14:15], v[64:65] op_sel:[1,0] op_sel_hi:[1,1]
    v_pk_add_f32 v[66:67], v[14:15], v[66:67] op_sel:[1,0] op_sel_hi:[1,1]
    v_rcp_f32 v64, v64
    v_rcp_f32 v65, v65
    v_rcp_f32 v66, v66
    v_rcp_f32 v67, v67
    v_pk_mul_f32 v[112:113], v[12:13], v[112:113] op_sel:[1,0] op_sel_hi:[1,1]
    v_pk_mul_f32 v[114:115], v[12:13], v[114:115] op_sel:[1,0] op_sel_hi:[1,1]
    v_pk_mul_f32 v[112:113], v[112:113], v[64:65]
    v_pk_mul_f32 v[114:115], v[114:115], v[66:67]
    v_cvt_pk_bf16_f32 v80, v112, v113
    v_cvt_pk_bf16_f32 v81, v114, v115
    v_pk_fma_f32 v[128:129], v[12:13], v[32:33], v[128:129] op_sel:[0,0,0] op_sel_hi:[0,1,1]
    v_pk_fma_f32 v[192:193], v[12:13], v[48:49], v[192:193] op_sel:[0,0,0] op_sel_hi:[0,1,1]
    v_pk_fma_f32 v[130:131], v[12:13], v[34:35], v[130:131] op_sel:[0,0,0] op_sel_hi:[0,1,1]
    v_pk_fma_f32 v[194:195], v[12:13], v[50:51], v[194:195] op_sel:[0,0,0] op_sel_hi:[0,1,1]
    v_pk_mul_f32 v[68:69], v[14:15], v[128:129] op_sel:[0,0] op_sel_hi:[0,1]
    v_pk_mul_f32 v[70:71], v[14:15], v[130:131] op_sel:[0,0] op_sel_hi:[0,1]
    v_exp_f32 v68, v68
    v_exp_f32 v69, v69
    v_exp_f32 v70, v70
    v_exp_f32 v71, v71
    v_pk_mul_f32 v[128:129], v[128:129], v[192:193]
    v_pk_mul_f32 v[130:131], v[130:131], v[194:195]
    v_pk_add_f32 v[68:69], v[14:15], v[68:69] op_sel:[1,0] op_sel_hi:[1,1]
    v_pk_add_f32 v[70:71], v[14:15], v[70:71] op_sel:[1,0] op_sel_hi:[1,1]
    v_rcp_f32 v68, v68
    v_rcp_f32 v69, v69
    v_rcp_f32 v70, v70
    v_rcp_f32 v71, v71
    v_pk_mul_f32 v[128:129], v[12:13], v[128:129] op_sel:[1,0] op_sel_hi:[1,1]
    v_pk_mul_f32 v[130:131], v[12:13], v[130:131] op_sel:[1,0] op_sel_hi:[1,1]
    v_pk_mul_f32 v[128:129], v[128:129], v[68:69]
    v_pk_mul_f32 v[130:131], v[130:131], v[70:71]
    v_cvt_pk_bf16_f32 v82, v128, v129
    v_cvt_pk_bf16_f32 v83, v130, v131
    buffer_store_dwordx4 v[80:83], v2, s[16:19], s38 offen offset:0 sc1
    v_pk_fma_f32 v[144:145], v[12:13], v[36:37], v[144:145] op_sel:[0,0,0] op_sel_hi:[0,1,1]
    v_pk_fma_f32 v[208:209], v[12:13], v[52:53], v[208:209] op_sel:[0,0,0] op_sel_hi:[0,1,1]
    v_pk_fma_f32 v[146:147], v[12:13], v[38:39], v[146:147] op_sel:[0,0,0] op_sel_hi:[0,1,1]
    v_pk_fma_f32 v[210:211], v[12:13], v[54:55], v[210:211] op_sel:[0,0,0] op_sel_hi:[0,1,1]
    v_pk_mul_f32 v[72:73], v[14:15], v[144:145] op_sel:[0,0] op_sel_hi:[0,1]
    v_pk_mul_f32 v[74:75], v[14:15], v[146:147] op_sel:[0,0] op_sel_hi:[0,1]
    v_exp_f32 v72, v72
    v_exp_f32 v73, v73
    v_exp_f32 v74, v74
    v_exp_f32 v75, v75
    v_pk_mul_f32 v[144:145], v[144:145], v[208:209]
    v_pk_mul_f32 v[146:147], v[146:147], v[210:211]
    v_pk_add_f32 v[72:73], v[14:15], v[72:73] op_sel:[1,0] op_sel_hi:[1,1]
    v_pk_add_f32 v[74:75], v[14:15], v[74:75] op_sel:[1,0] op_sel_hi:[1,1]
    v_rcp_f32 v72, v72
    v_rcp_f32 v73, v73
    v_rcp_f32 v74, v74
    v_rcp_f32 v75, v75
    v_pk_mul_f32 v[144:145], v[12:13], v[144:145] op_sel:[1,0] op_sel_hi:[1,1]
    v_pk_mul_f32 v[146:147], v[12:13], v[146:147] op_sel:[1,0] op_sel_hi:[1,1]
    v_pk_mul_f32 v[144:145], v[144:145], v[72:73]
    v_pk_mul_f32 v[146:147], v[146:147], v[74:75]
    v_cvt_pk_bf16_f32 v84, v144, v145
    v_cvt_pk_bf16_f32 v85, v146, v147
    v_pk_fma_f32 v[160:161], v[12:13], v[40:41], v[160:161] op_sel:[0,0,0] op_sel_hi:[0,1,1]
    v_pk_fma_f32 v[224:225], v[12:13], v[56:57], v[224:225] op_sel:[0,0,0] op_sel_hi:[0,1,1]
    v_pk_fma_f32 v[162:163], v[12:13], v[42:43], v[162:163] op_sel:[0,0,0] op_sel_hi:[0,1,1]
    v_pk_fma_f32 v[226:227], v[12:13], v[58:59], v[226:227] op_sel:[0,0,0] op_sel_hi:[0,1,1]
    v_pk_mul_f32 v[64:65], v[14:15], v[160:161] op_sel:[0,0] op_sel_hi:[0,1]
    v_pk_mul_f32 v[66:67], v[14:15], v[162:163] op_sel:[0,0] op_sel_hi:[0,1]
    v_exp_f32 v64, v64
    v_exp_f32 v65, v65
    v_exp_f32 v66, v66
    v_exp_f32 v67, v67
    v_pk_mul_f32 v[160:161], v[160:161], v[224:225]
    v_pk_mul_f32 v[162:163], v[162:163], v[226:227]
    v_pk_add_f32 v[64:65], v[14:15], v[64:65] op_sel:[1,0] op_sel_hi:[1,1]
    v_pk_add_f32 v[66:67], v[14:15], v[66:67] op_sel:[1,0] op_sel_hi:[1,1]
    v_rcp_f32 v64, v64
    v_rcp_f32 v65, v65
    v_rcp_f32 v66, v66
    v_rcp_f32 v67, v67
    v_pk_mul_f32 v[160:161], v[12:13], v[160:161] op_sel:[1,0] op_sel_hi:[1,1]
    v_pk_mul_f32 v[162:163], v[12:13], v[162:163] op_sel:[1,0] op_sel_hi:[1,1]
    v_pk_mul_f32 v[160:161], v[160:161], v[64:65]
    v_pk_mul_f32 v[162:163], v[162:163], v[66:67]
    v_cvt_pk_bf16_f32 v86, v160, v161
    v_cvt_pk_bf16_f32 v87, v162, v163
    buffer_store_dwordx4 v[84:87], v2, s[16:19], s38 offen offset:1024 sc1
    v_pk_fma_f32 v[240:241], v[12:13], v[60:61], v[240:241] op_sel:[0,0,0] op_sel_hi:[0,1,1]
    v_pk_fma_f32 v[242:243], v[12:13], v[62:63], v[242:243] op_sel:[0,0,0] op_sel_hi:[0,1,1]
    v_mov_b32 v76, v240
    v_mov_b32 v77, v241
    v_mov_b32 v78, v242
    v_mov_b32 v79, v243
    v_permlane32_swap_b32 v240, v76
    v_permlane32_swap_b32 v241, v77
    v_permlane32_swap_b32 v242, v78
    v_permlane32_swap_b32 v243, v79
    v_pk_mul_f32 v[68:69], v[14:15], v[240:241] op_sel:[0,0] op_sel_hi:[0,1]
    v_pk_mul_f32 v[70:71], v[14:15], v[242:243] op_sel:[0,0] op_sel_hi:[0,1]
    v_exp_f32 v68, v68
    v_exp_f32 v69, v69
    v_exp_f32 v70, v70
    v_exp_f32 v71, v71
    v_pk_mul_f32 v[240:241], v[240:241], v[76:77]
    v_pk_mul_f32 v[242:243], v[242:243], v[78:79]
    v_pk_add_f32 v[68:69], v[14:15], v[68:69] op_sel:[1,0] op_sel_hi:[1,1]
    v_pk_add_f32 v[70:71], v[14:15], v[70:71] op_sel:[1,0] op_sel_hi:[1,1]
    v_rcp_f32 v68, v68
    v_rcp_f32 v69, v69
    v_rcp_f32 v70, v70
    v_rcp_f32 v71, v71
    v_pk_mul_f32 v[240:241], v[12:13], v[240:241] op_sel:[1,0] op_sel_hi:[1,1]
    v_pk_mul_f32 v[242:243], v[12:13], v[242:243] op_sel:[1,0] op_sel_hi:[1,1]
    v_pk_mul_f32 v[240:241], v[240:241], v[68:69]
    v_pk_mul_f32 v[242:243], v[242:243], v[70:71]
    v_cvt_pk_bf16_f32 v88, v240, v241
    v_cvt_pk_bf16_f32 v89, v242, v243
    buffer_store_dwordx2 v[88:89], v7, s[16:19], s39 offen
    s_add_u32 s38, s38, 147456
    s_add_u32 s39, s39, 147456
    v_pk_fma_f32 v[116:117], v[16:17], v[28:29], v[116:117] op_sel:[0,0,0] op_sel_hi:[0,1,1]
    v_pk_fma_f32 v[180:181], v[16:17], v[44:45], v[180:181] op_sel:[0,0,0] op_sel_hi:[0,1,1]
    v_pk_fma_f32 v[118:119], v[16:17], v[30:31], v[118:119] op_sel:[0,0,0] op_sel_hi:[0,1,1]
    v_pk_fma_f32 v[182:183], v[16:17], v[46:47], v[182:183] op_sel:[0,0,0] op_sel_hi:[0,1,1]
    v_pk_mul_f32 v[72:73], v[18:19], v[116:117] op_sel:[0,0] op_sel_hi:[0,1]
    v_pk_mul_f32 v[74:75], v[18:19], v[118:119] op_sel:[0,0] op_sel_hi:[0,1]
    v_exp_f32 v72, v72
    v_exp_f32 v73, v73
    v_exp_f32 v74, v74
    v_exp_f32 v75, v75
    v_pk_mul_f32 v[116:117], v[116:117], v[180:181]
    v_pk_mul_f32 v[118:119], v[118:119], v[182:183]
    v_pk_add_f32 v[72:73], v[18:19], v[72:73] op_sel:[1,0] op_sel_hi:[1,1]
    v_pk_add_f32 v[74:75], v[18:19], v[74:75] op_sel:[1,0] op_sel_hi:[1,1]
    v_rcp_f32 v72, v72
    v_rcp_f32 v73, v73
    v_rcp_f32 v74, v74
    v_rcp_f32 v75, v75
    v_pk_mul_f32 v[116:117], v[16:17], v[116:117] op_sel:[1,0] op_sel_hi:[1,1]
    v_pk_mul_f32 v[118:119], v[16:17], v[118:119] op_sel:[1,0] op_sel_hi:[1,1]
    v_pk_mul_f32 v[116:117], v[116:117], v[72:73]
    v_pk_mul_f32 v[118:119], v[118:119], v[74:75]
    v_cvt_pk_bf16_f32 v92, v116, v117
    v_cvt_pk_bf16_f32 v93, v118, v119
    v_pk_fma_f32 v[132:133], v[16:17], v[32:33], v[132:133] op_sel:[0,0,0] op_sel_hi:[0,1,1]
    v_pk_fma_f32 v[196:197], v[16:17], v[48:49], v[196:197] op_sel:[0,0,0] op_sel_hi:[0,1,1]
    v_pk_fma_f32 v[134:135], v[16:17], v[34:35], v[134:135] op_sel:[0,0,0] op_sel_hi:[0,1,1]
    v_pk_fma_f32 v[198:199], v[16:17], v[50:51], v[198:199] op_sel:[0,0,0] op_sel_hi:[0,1,1]
    v_pk_mul_f32 v[64:65], v[18:19], v[132:133] op_sel:[0,0] op_sel_hi:[0,1]
    v_pk_mul_f32 v[66:67], v[18:19], v[134:135] op_sel:[0,0] op_sel_hi:[0,1]
    v_exp_f32 v64, v64
    v_exp_f32 v65, v65
    v_exp_f32 v66, v66
    v_exp_f32 v67, v67
    v_pk_mul_f32 v[132:133], v[132:133], v[196:197]
    v_pk_mul_f32 v[134:135], v[134:135], v[198:199]
    v_pk_add_f32 v[64:65], v[18:19], v[64:65] op_sel:[1,0] op_sel_hi:[1,1]
    v_pk_add_f32 v[66:67], v[18:19], v[66:67] op_sel:[1,0] op_sel_hi:[1,1]
    v_rcp_f32 v64, v64
    v_rcp_f32 v65, v65
    v_rcp_f32 v66, v66
    v_rcp_f32 v67, v67
    v_pk_mul_f32 v[132:133], v[16:17], v[132:133] op_sel:[1,0] op_sel_hi:[1,1]
    v_pk_mul_f32 v[134:135], v[16:17], v[134:135] op_sel:[1,0] op_sel_hi:[1,1]
    v_pk_mul_f32 v[132:133], v[132:133], v[64:65]
    v_pk_mul_f32 v[134:135], v[134:135], v[66:67]
    v_cvt_pk_bf16_f32 v94, v132, v133
    v_cvt_pk_bf16_f32 v95, v134, v135
    buffer_store_dwordx4 v[92:95], v2, s[16:19], s38 offen offset:0 sc1
    v_pk_fma_f32 v[148:149], v[16:17], v[36:37], v[148:149] op_sel:[0,0,0] op_sel_hi:[0,1,1]
    v_pk_fma_f32 v[212:213], v[16:17], v[52:53], v[212:213] op_sel:[0,0,0] op_sel_hi:[0,1,1]
    v_pk_fma_f32 v[150:151], v[16:17], v[38:39], v[150:151] op_sel:[0,0,0] op_sel_hi:[0,1,1]
    v_pk_fma_f32 v[214:215], v[16:17], v[54:55], v[214:215] op_sel:[0,0,0] op_sel_hi:[0,1,1]
    v_pk_mul_f32 v[68:69], v[18:19], v[148:149] op_sel:[0,0] op_sel_hi:[0,1]
    v_pk_mul_f32 v[70:71], v[18:19], v[150:151] op_sel:[0,0] op_sel_hi:[0,1]
    v_exp_f32 v68, v68
    v_exp_f32 v69, v69
    v_exp_f32 v70, v70
    v_exp_f32 v71, v71
    v_pk_mul_f32 v[148:149], v[148:149], v[212:213]
    v_pk_mul_f32 v[150:151], v[150:151], v[214:215]
    v_pk_add_f32 v[68:69], v[18:19], v[68:69] op_sel:[1,0] op_sel_hi:[1,1]
    v_pk_add_f32 v[70:71], v[18:19], v[70:71] op_sel:[1,0] op_sel_hi:[1,1]
    v_rcp_f32 v68, v68
    v_rcp_f32 v69, v69
    v_rcp_f32 v70, v70
    v_rcp_f32 v71, v71
    v_pk_mul_f32 v[148:149], v[16:17], v[148:149] op_sel:[1,0] op_sel_hi:[1,1]
    v_pk_mul_f32 v[150:151], v[16:17], v[150:151] op_sel:[1,0] op_sel_hi:[1,1]
    v_pk_mul_f32 v[148:149], v[148:149], v[68:69]
    v_pk_mul_f32 v[150:151], v[150:151], v[70:71]
    v_cvt_pk_bf16_f32 v96, v148, v149
    v_cvt_pk_bf16_f32 v97, v150, v151
    v_pk_fma_f32 v[164:165], v[16:17], v[40:41], v[164:165] op_sel:[0,0,0] op_sel_hi:[0,1,1]
    v_pk_fma_f32 v[228:229], v[16:17], v[56:57], v[228:229] op_sel:[0,0,0] op_sel_hi:[0,1,1]
    v_pk_fma_f32 v[166:167], v[16:17], v[42:43], v[166:167] op_sel:[0,0,0] op_sel_hi:[0,1,1]
    v_pk_fma_f32 v[230:231], v[16:17], v[58:59], v[230:231] op_sel:[0,0,0] op_sel_hi:[0,1,1]
    v_pk_mul_f32 v[72:73], v[18:19], v[164:165] op_sel:[0,0] op_sel_hi:[0,1]
    v_pk_mul_f32 v[74:75], v[18:19], v[166:167] op_sel:[0,0] op_sel_hi:[0,1]
    v_exp_f32 v72, v72
    v_exp_f32 v73, v73
    v_exp_f32 v74, v74
    v_exp_f32 v75, v75
    v_pk_mul_f32 v[164:165], v[164:165], v[228:229]
    v_pk_mul_f32 v[166:167], v[166:167], v[230:231]
    v_pk_add_f32 v[72:73], v[18:19], v[72:73] op_sel:[1,0] op_sel_hi:[1,1]
    v_pk_add_f32 v[74:75], v[18:19], v[74:75] op_sel:[1,0] op_sel_hi:[1,1]
    v_rcp_f32 v72, v72
    v_rcp_f32 v73, v73
    v_rcp_f32 v74, v74
    v_rcp_f32 v75, v75
    v_pk_mul_f32 v[164:165], v[16:17], v[164:165] op_sel:[1,0] op_sel_hi:[1,1]
    v_pk_mul_f32 v[166:167], v[16:17], v[166:167] op_sel:[1,0] op_sel_hi:[1,1]
    v_pk_mul_f32 v[164:165], v[164:165], v[72:73]
    v_pk_mul_f32 v[166:167], v[166:167], v[74:75]
    v_cvt_pk_bf16_f32 v98, v164, v165
    v_cvt_pk_bf16_f32 v99, v166, v167
    buffer_store_dwordx4 v[96:99], v2, s[16:19], s38 offen offset:1024 sc1
    v_pk_fma_f32 v[244:245], v[16:17], v[60:61], v[244:245] op_sel:[0,0,0] op_sel_hi:[0,1,1]
    v_pk_fma_f32 v[246:247], v[16:17], v[62:63], v[246:247] op_sel:[0,0,0] op_sel_hi:[0,1,1]
    v_mov_b32 v76, v244
    v_mov_b32 v77, v245
    v_mov_b32 v78, v246
    v_mov_b32 v79, v247
    v_permlane32_swap_b32 v244, v76
    v_permlane32_swap_b32 v245, v77
    v_permlane32_swap_b32 v246, v78
    v_permlane32_swap_b32 v247, v79
    v_pk_mul_f32 v[64:65], v[18:19], v[244:245] op_sel:[0,0] op_sel_hi:[0,1]
    v_pk_mul_f32 v[66:67], v[18:19], v[246:247] op_sel:[0,0] op_sel_hi:[0,1]
    v_exp_f32 v64, v64
    v_exp_f32 v65, v65
    v_exp_f32 v66, v66
    v_exp_f32 v67, v67
    v_pk_mul_f32 v[244:245], v[244:245], v[76:77]
    v_pk_mul_f32 v[246:247], v[246:247], v[78:79]
    v_pk_add_f32 v[64:65], v[18:19], v[64:65] op_sel:[1,0] op_sel_hi:[1,1]
    v_pk_add_f32 v[66:67], v[18:19], v[66:67] op_sel:[1,0] op_sel_hi:[1,1]
    v_rcp_f32 v64, v64
    v_rcp_f32 v65, v65
    v_rcp_f32 v66, v66
    v_rcp_f32 v67, v67
    v_pk_mul_f32 v[244:245], v[16:17], v[244:245] op_sel:[1,0] op_sel_hi:[1,1]
    v_pk_mul_f32 v[246:247], v[16:17], v[246:247] op_sel:[1,0] op_sel_hi:[1,1]
    v_pk_mul_f32 v[244:245], v[244:245], v[64:65]
    v_pk_mul_f32 v[246:247], v[246:247], v[66:67]
    v_cvt_pk_bf16_f32 v100, v244, v245
    v_cvt_pk_bf16_f32 v101, v246, v247
    buffer_store_dwordx2 v[100:101], v7, s[16:19], s39 offen
    s_add_u32 s38, s38, 147456
    s_add_u32 s39, s39, 147456
    v_pk_fma_f32 v[120:121], v[20:21], v[28:29], v[120:121] op_sel:[0,0,0] op_sel_hi:[0,1,1]
    v_pk_fma_f32 v[184:185], v[20:21], v[44:45], v[184:185] op_sel:[0,0,0] op_sel_hi:[0,1,1]
    v_pk_fma_f32 v[122:123], v[20:21], v[30:31], v[122:123] op_sel:[0,0,0] op_sel_hi:[0,1,1]
    v_pk_fma_f32 v[186:187], v[20:21], v[46:47], v[186:187] op_sel:[0,0,0] op_sel_hi:[0,1,1]
    v_pk_mul_f32 v[68:69], v[22:23], v[120:121] op_sel:[0,0] op_sel_hi:[0,1]
    v_pk_mul_f32 v[70:71], v[22:23], v[122:123] op_sel:[0,0] op_sel_hi:[0,1]
    v_exp_f32 v68, v68
    v_exp_f32 v69, v69
    v_exp_f32 v70, v70
    v_exp_f32 v71, v71
    v_pk_mul_f32 v[120:121], v[120:121], v[184:185]
    v_pk_mul_f32 v[122:123], v[122:123], v[186:187]
    v_pk_add_f32 v[68:69], v[22:23], v[68:69] op_sel:[1,0] op_sel_hi:[1,1]
    v_pk_add_f32 v[70:71], v[22:23], v[70:71] op_sel:[1,0] op_sel_hi:[1,1]
    v_rcp_f32 v68, v68
    v_rcp_f32 v69, v69
    v_rcp_f32 v70, v70
    v_rcp_f32 v71, v71
    v_pk_mul_f32 v[120:121], v[20:21], v[120:121] op_sel:[1,0] op_sel_hi:[1,1]
    v_pk_mul_f32 v[122:123], v[20:21], v[122:123] op_sel:[1,0] op_sel_hi:[1,1]
    v_pk_mul_f32 v[120:121], v[120:121], v[68:69]
    v_pk_mul_f32 v[122:123], v[122:123], v[70:71]
    v_cvt_pk_bf16_f32 v80, v120, v121
    v_cvt_pk_bf16_f32 v81, v122, v123
    v_pk_fma_f32 v[136:137], v[20:21], v[32:33], v[136:137] op_sel:[0,0,0] op_sel_hi:[0,1,1]
    v_pk_fma_f32 v[200:201], v[20:21], v[48:49], v[200:201] op_sel:[0,0,0] op_sel_hi:[0,1,1]
    v_pk_fma_f32 v[138:139], v[20:21], v[34:35], v[138:139] op_sel:[0,0,0] op_sel_hi:[0,1,1]
    v_pk_fma_f32 v[202:203], v[20:21], v[50:51], v[202:203] op_sel:[0,0,0] op_sel_hi:[0,1,1]
    v_pk_mul_f32 v[72:73], v[22:23], v[136:137] op_sel:[0,0] op_sel_hi:[0,1]
    v_pk_mul_f32 v[74:75], v[22:23], v[138:139] op_sel:[0,0] op_sel_hi:[0,1]
    v_exp_f32 v72, v72
    v_exp_f32 v73, v73
    v_exp_f32 v74, v74
    v_exp_f32 v75, v75
    v_pk_mul_f32 v[136:137], v[136:137], v[200:201]
    v_pk_mul_f32 v[138:139], v[138:139], v[202:203]
    v_pk_add_f32 v[72:73], v[22:23], v[72:73] op_sel:[1,0] op_sel_hi:[1,1]
    v_pk_add_f32 v[74:75], v[22:23], v[74:75] op_sel:[1,0] op_sel_hi:[1,1]
    v_rcp_f32 v72, v72
    v_rcp_f32 v73, v73
    v_rcp_f32 v74, v74
    v_rcp_f32 v75, v75
    v_pk_mul_f32 v[136:137], v[20:21], v[136:137] op_sel:[1,0] op_sel_hi:[1,1]
    v_pk_mul_f32 v[138:139], v[20:21], v[138:139] op_sel:[1,0] op_sel_hi:[1,1]
    v_pk_mul_f32 v[136:137], v[136:137], v[72:73]
    v_pk_mul_f32 v[138:139], v[138:139], v[74:75]
    v_cvt_pk_bf16_f32 v82, v136, v137
    v_cvt_pk_bf16_f32 v83, v138, v139
    buffer_store_dwordx4 v[80:83], v2, s[16:19], s38 offen offset:0 sc1
    v_pk_fma_f32 v[152:153], v[20:21], v[36:37], v[152:153] op_sel:[0,0,0] op_sel_hi:[0,1,1]
    v_pk_fma_f32 v[216:217], v[20:21], v[52:53], v[216:217] op_sel:[0,0,0] op_sel_hi:[0,1,1]
    v_pk_fma_f32 v[154:155], v[20:21], v[38:39], v[154:155] op_sel:[0,0,0] op_sel_hi:[0,1,1]
    v_pk_fma_f32 v[218:219], v[20:21], v[54:55], v[218:219] op_sel:[0,0,0] op_sel_hi:[0,1,1]
    v_pk_mul_f32 v[64:65], v[22:23], v[152:153] op_sel:[0,0] op_sel_hi:[0,1]
    v_pk_mul_f32 v[66:67], v[22:23], v[154:155] op_sel:[0,0] op_sel_hi:[0,1]
    v_exp_f32 v64, v64
    v_exp_f32 v65, v65
    v_exp_f32 v66, v66
    v_exp_f32 v67, v67
    v_pk_mul_f32 v[152:153], v[152:153], v[216:217]
    v_pk_mul_f32 v[154:155], v[154:155], v[218:219]
    v_pk_add_f32 v[64:65], v[22:23], v[64:65] op_sel:[1,0] op_sel_hi:[1,1]
    v_pk_add_f32 v[66:67], v[22:23], v[66:67] op_sel:[1,0] op_sel_hi:[1,1]
    v_rcp_f32 v64, v64
    v_rcp_f32 v65, v65
    v_rcp_f32 v66, v66
    v_rcp_f32 v67, v67
    v_pk_mul_f32 v[152:153], v[20:21], v[152:153] op_sel:[1,0] op_sel_hi:[1,1]
    v_pk_mul_f32 v[154:155], v[20:21], v[154:155] op_sel:[1,0] op_sel_hi:[1,1]
    v_pk_mul_f32 v[152:153], v[152:153], v[64:65]
    v_pk_mul_f32 v[154:155], v[154:155], v[66:67]
    v_cvt_pk_bf16_f32 v84, v152, v153
    v_cvt_pk_bf16_f32 v85, v154, v155
    v_pk_fma_f32 v[168:169], v[20:21], v[40:41], v[168:169] op_sel:[0,0,0] op_sel_hi:[0,1,1]
    v_pk_fma_f32 v[232:233], v[20:21], v[56:57], v[232:233] op_sel:[0,0,0] op_sel_hi:[0,1,1]
    v_pk_fma_f32 v[170:171], v[20:21], v[42:43], v[170:171] op_sel:[0,0,0] op_sel_hi:[0,1,1]
    v_pk_fma_f32 v[234:235], v[20:21], v[58:59], v[234:235] op_sel:[0,0,0] op_sel_hi:[0,1,1]
    v_pk_mul_f32 v[68:69], v[22:23], v[168:169] op_sel:[0,0] op_sel_hi:[0,1]
    v_pk_mul_f32 v[70:71], v[22:23], v[170:171] op_sel:[0,0] op_sel_hi:[0,1]
    v_exp_f32 v68, v68
    v_exp_f32 v69, v69
    v_exp_f32 v70, v70
    v_exp_f32 v71, v71
    v_pk_mul_f32 v[168:169], v[168:169], v[232:233]
    v_pk_mul_f32 v[170:171], v[170:171], v[234:235]
    v_pk_add_f32 v[68:69], v[22:23], v[68:69] op_sel:[1,0] op_sel_hi:[1,1]
    v_pk_add_f32 v[70:71], v[22:23], v[70:71] op_sel:[1,0] op_sel_hi:[1,1]
    v_rcp_f32 v68, v68
    v_rcp_f32 v69, v69
    v_rcp_f32 v70, v70
    v_rcp_f32 v71, v71
    v_pk_mul_f32 v[168:169], v[20:21], v[168:169] op_sel:[1,0] op_sel_hi:[1,1]
    v_pk_mul_f32 v[170:171], v[20:21], v[170:171] op_sel:[1,0] op_sel_hi:[1,1]
    v_pk_mul_f32 v[168:169], v[168:169], v[68:69]
    v_pk_mul_f32 v[170:171], v[170:171], v[70:71]
    v_cvt_pk_bf16_f32 v86, v168, v169
    v_cvt_pk_bf16_f32 v87, v170, v171
    buffer_store_dwordx4 v[84:87], v2, s[16:19], s38 offen offset:1024 sc1
    v_pk_fma_f32 v[248:249], v[20:21], v[60:61], v[248:249] op_sel:[0,0,0] op_sel_hi:[0,1,1]
    v_pk_fma_f32 v[250:251], v[20:21], v[62:63], v[250:251] op_sel:[0,0,0] op_sel_hi:[0,1,1]
    v_mov_b32 v76, v248
    v_mov_b32 v77, v249
    v_mov_b32 v78, v250
    v_mov_b32 v79, v251
    v_permlane32_swap_b32 v248, v76
    v_permlane32_swap_b32 v249, v77
    v_permlane32_swap_b32 v250, v78
    v_permlane32_swap_b32 v251, v79
    v_pk_mul_f32 v[72:73], v[22:23], v[248:249] op_sel:[0,0] op_sel_hi:[0,1]
    v_pk_mul_f32 v[74:75], v[22:23], v[250:251] op_sel:[0,0] op_sel_hi:[0,1]
    v_exp_f32 v72, v72
    v_exp_f32 v73, v73
    v_exp_f32 v74, v74
    v_exp_f32 v75, v75
    v_pk_mul_f32 v[248:249], v[248:249], v[76:77]
    v_pk_mul_f32 v[250:251], v[250:251], v[78:79]
    v_pk_add_f32 v[72:73], v[22:23], v[72:73] op_sel:[1,0] op_sel_hi:[1,1]
    v_pk_add_f32 v[74:75], v[22:23], v[74:75] op_sel:[1,0] op_sel_hi:[1,1]
    v_rcp_f32 v72, v72
    v_rcp_f32 v73, v73
    v_rcp_f32 v74, v74
    v_rcp_f32 v75, v75
    v_pk_mul_f32 v[248:249], v[20:21], v[248:249] op_sel:[1,0] op_sel_hi:[1,1]
    v_pk_mul_f32 v[250:251], v[20:21], v[250:251] op_sel:[1,0] op_sel_hi:[1,1]
    v_pk_mul_f32 v[248:249], v[248:249], v[72:73]
    v_pk_mul_f32 v[250:251], v[250:251], v[74:75]
    v_cvt_pk_bf16_f32 v88, v248, v249
    v_cvt_pk_bf16_f32 v89, v250, v251
    buffer_store_dwordx2 v[88:89], v7, s[16:19], s39 offen
    s_add_u32 s38, s38, 147456
    s_add_u32 s39, s39, 147456
    v_pk_fma_f32 v[124:125], v[24:25], v[28:29], v[124:125] op_sel:[0,0,0] op_sel_hi:[0,1,1]
    v_pk_fma_f32 v[188:189], v[24:25], v[44:45], v[188:189] op_sel:[0,0,0] op_sel_hi:[0,1,1]
    v_pk_fma_f32 v[126:127], v[24:25], v[30:31], v[126:127] op_sel:[0,0,0] op_sel_hi:[0,1,1]
    v_pk_fma_f32 v[190:191], v[24:25], v[46:47], v[190:191] op_sel:[0,0,0] op_sel_hi:[0,1,1]
    v_pk_mul_f32 v[64:65], v[26:27], v[124:125] op_sel:[0,0] op_sel_hi:[0,1]
    v_pk_mul_f32 v[66:67], v[26:27], v[126:127] op_sel:[0,0] op_sel_hi:[0,1]
    v_exp_f32 v64, v64
    v_exp_f32 v65, v65
    v_exp_f32 v66, v66
    v_exp_f32 v67, v67
    v_pk_mul_f32 v[124:125], v[124:125], v[188:189]
    v_pk_mul_f32 v[126:127], v[126:127], v[190:191]
    v_pk_add_f32 v[64:65], v[26:27], v[64:65] op_sel:[1,0] op_sel_hi:[1,1]
    v_pk_add_f32 v[66:67], v[26:27], v[66:67] op_sel:[1,0] op_sel_hi:[1,1]
    v_rcp_f32 v64, v64
    v_rcp_f32 v65, v65
    v_rcp_f32 v66, v66
    v_rcp_f32 v67, v67
    v_pk_mul_f32 v[124:125], v[24:25], v[124:125] op_sel:[1,0] op_sel_hi:[1,1]
    v_pk_mul_f32 v[126:127], v[24:25], v[126:127] op_sel:[1,0] op_sel_hi:[1,1]
    v_pk_mul_f32 v[124:125], v[124:125], v[64:65]
    v_pk_mul_f32 v[126:127], v[126:127], v[66:67]
    v_cvt_pk_bf16_f32 v92, v124, v125
    v_cvt_pk_bf16_f32 v93, v126, v127
    v_pk_fma_f32 v[140:141], v[24:25], v[32:33], v[140:141] op_sel:[0,0,0] op_sel_hi:[0,1,1]
    v_pk_fma_f32 v[204:205], v[24:25], v[48:49], v[204:205] op_sel:[0,0,0] op_sel_hi:[0,1,1]
    v_pk_fma_f32 v[142:143], v[24:25], v[34:35], v[142:143] op_sel:[0,0,0] op_sel_hi:[0,1,1]
    v_pk_fma_f32 v[206:207], v[24:25], v[50:51], v[206:207] op_sel:[0,0,0] op_sel_hi:[0,1,1]
    v_pk_mul_f32 v[68:69], v[26:27], v[140:141] op_sel:[0,0] op_sel_hi:[0,1]
    v_pk_mul_f32 v[70:71], v[26:27], v[142:143] op_sel:[0,0] op_sel_hi:[0,1]
    v_exp_f32 v68, v68
    v_exp_f32 v69, v69
    v_exp_f32 v70, v70
    v_exp_f32 v71, v71
    v_pk_mul_f32 v[140:141], v[140:141], v[204:205]
    v_pk_mul_f32 v[142:143], v[142:143], v[206:207]
    v_pk_add_f32 v[68:69], v[26:27], v[68:69] op_sel:[1,0] op_sel_hi:[1,1]
    v_pk_add_f32 v[70:71], v[26:27], v[70:71] op_sel:[1,0] op_sel_hi:[1,1]
    v_rcp_f32 v68, v68
    v_rcp_f32 v69, v69
    v_rcp_f32 v70, v70
    v_rcp_f32 v71, v71
    v_pk_mul_f32 v[140:141], v[24:25], v[140:141] op_sel:[1,0] op_sel_hi:[1,1]
    v_pk_mul_f32 v[142:143], v[24:25], v[142:143] op_sel:[1,0] op_sel_hi:[1,1]
    v_pk_mul_f32 v[140:141], v[140:141], v[68:69]
    v_pk_mul_f32 v[142:143], v[142:143], v[70:71]
    v_cvt_pk_bf16_f32 v94, v140, v141
    v_cvt_pk_bf16_f32 v95, v142, v143
    buffer_store_dwordx4 v[92:95], v2, s[16:19], s38 offen offset:0 sc1
    v_pk_fma_f32 v[156:157], v[24:25], v[36:37], v[156:157] op_sel:[0,0,0] op_sel_hi:[0,1,1]
    v_pk_fma_f32 v[220:221], v[24:25], v[52:53], v[220:221] op_sel:[0,0,0] op_sel_hi:[0,1,1]
    v_pk_fma_f32 v[158:159], v[24:25], v[38:39], v[158:159] op_sel:[0,0,0] op_sel_hi:[0,1,1]
    v_pk_fma_f32 v[222:223], v[24:25], v[54:55], v[222:223] op_sel:[0,0,0] op_sel_hi:[0,1,1]
    v_pk_mul_f32 v[72:73], v[26:27], v[156:157] op_sel:[0,0] op_sel_hi:[0,1]
    v_pk_mul_f32 v[74:75], v[26:27], v[158:159] op_sel:[0,0] op_sel_hi:[0,1]
    v_exp_f32 v72, v72
    v_exp_f32 v73, v73
    v_exp_f32 v74, v74
    v_exp_f32 v75, v75
    v_pk_mul_f32 v[156:157], v[156:157], v[220:221]
    v_pk_mul_f32 v[158:159], v[158:159], v[222:223]
    v_pk_add_f32 v[72:73], v[26:27], v[72:73] op_sel:[1,0] op_sel_hi:[1,1]
    v_pk_add_f32 v[74:75], v[26:27], v[74:75] op_sel:[1,0] op_sel_hi:[1,1]
    v_rcp_f32 v72, v72
    v_rcp_f32 v73, v73
    v_rcp_f32 v74, v74
    v_rcp_f32 v75, v75
    v_pk_mul_f32 v[156:157], v[24:25], v[156:157] op_sel:[1,0] op_sel_hi:[1,1]
    v_pk_mul_f32 v[158:159], v[24:25], v[158:159] op_sel:[1,0] op_sel_hi:[1,1]
    v_pk_mul_f32 v[156:157], v[156:157], v[72:73]
    v_pk_mul_f32 v[158:159], v[158:159], v[74:75]
    v_cvt_pk_bf16_f32 v96, v156, v157
    v_cvt_pk_bf16_f32 v97, v158, v159
    v_pk_fma_f32 v[172:173], v[24:25], v[40:41], v[172:173] op_sel:[0,0,0] op_sel_hi:[0,1,1]
    v_pk_fma_f32 v[236:237], v[24:25], v[56:57], v[236:237] op_sel:[0,0,0] op_sel_hi:[0,1,1]
    v_pk_fma_f32 v[174:175], v[24:25], v[42:43], v[174:175] op_sel:[0,0,0] op_sel_hi:[0,1,1]
    v_pk_fma_f32 v[238:239], v[24:25], v[58:59], v[238:239] op_sel:[0,0,0] op_sel_hi:[0,1,1]
    v_pk_mul_f32 v[64:65], v[26:27], v[172:173] op_sel:[0,0] op_sel_hi:[0,1]
    v_pk_mul_f32 v[66:67], v[26:27], v[174:175] op_sel:[0,0] op_sel_hi:[0,1]
    v_exp_f32 v64, v64
    v_exp_f32 v65, v65
    v_exp_f32 v66, v66
    v_exp_f32 v67, v67
    v_pk_mul_f32 v[172:173], v[172:173], v[236:237]
    v_pk_mul_f32 v[174:175], v[174:175], v[238:239]
    v_pk_add_f32 v[64:65], v[26:27], v[64:65] op_sel:[1,0] op_sel_hi:[1,1]
    v_pk_add_f32 v[66:67], v[26:27], v[66:67] op_sel:[1,0] op_sel_hi:[1,1]
    v_rcp_f32 v64, v64
    v_rcp_f32 v65, v65
    v_rcp_f32 v66, v66
    v_rcp_f32 v67, v67
    v_pk_mul_f32 v[172:173], v[24:25], v[172:173] op_sel:[1,0] op_sel_hi:[1,1]
    v_pk_mul_f32 v[174:175], v[24:25], v[174:175] op_sel:[1,0] op_sel_hi:[1,1]
    v_pk_mul_f32 v[172:173], v[172:173], v[64:65]
    v_pk_mul_f32 v[174:175], v[174:175], v[66:67]
    v_cvt_pk_bf16_f32 v98, v172, v173
    v_cvt_pk_bf16_f32 v99, v174, v175
    buffer_store_dwordx4 v[96:99], v2, s[16:19], s38 offen offset:1024 sc1
    v_pk_fma_f32 v[252:253], v[24:25], v[60:61], v[252:253] op_sel:[0,0,0] op_sel_hi:[0,1,1]
    v_pk_fma_f32 v[254:255], v[24:25], v[62:63], v[254:255] op_sel:[0,0,0] op_sel_hi:[0,1,1]
    v_mov_b32 v76, v252
    v_mov_b32 v77, v253
    v_mov_b32 v78, v254
    v_mov_b32 v79, v255
    v_permlane32_swap_b32 v252, v76
    v_permlane32_swap_b32 v253, v77
    v_permlane32_swap_b32 v254, v78
    v_permlane32_swap_b32 v255, v79
    v_pk_mul_f32 v[68:69], v[26:27], v[252:253] op_sel:[0,0] op_sel_hi:[0,1]
    v_pk_mul_f32 v[70:71], v[26:27], v[254:255] op_sel:[0,0] op_sel_hi:[0,1]
    v_exp_f32 v68, v68
    v_exp_f32 v69, v69
    v_exp_f32 v70, v70
    v_exp_f32 v71, v71
    v_pk_mul_f32 v[252:253], v[252:253], v[76:77]
    v_pk_mul_f32 v[254:255], v[254:255], v[78:79]
    v_pk_add_f32 v[68:69], v[26:27], v[68:69] op_sel:[1,0] op_sel_hi:[1,1]
    v_pk_add_f32 v[70:71], v[26:27], v[70:71] op_sel:[1,0] op_sel_hi:[1,1]
    v_rcp_f32 v68, v68
    v_rcp_f32 v69, v69
    v_rcp_f32 v70, v70
    v_rcp_f32 v71, v71
    v_pk_mul_f32 v[252:253], v[24:25], v[252:253] op_sel:[1,0] op_sel_hi:[1,1]
    v_pk_mul_f32 v[254:255], v[24:25], v[254:255] op_sel:[1,0] op_sel_hi:[1,1]
    v_pk_mul_f32 v[252:253], v[252:253], v[68:69]
    v_pk_mul_f32 v[254:255], v[254:255], v[70:71]
    v_cvt_pk_bf16_f32 v100, v252, v253
    v_cvt_pk_bf16_f32 v101, v254, v255
    buffer_store_dwordx2 v[100:101], v7, s[16:19], s39 offen
L_k4_up_kernel_done_1:
    s_endpgm

.section .rodata,"a"
.p2align 6
.amdhsa_kernel k4_up_kernel
  .amdhsa_next_free_vgpr 256
  .amdhsa_next_free_sgpr 102
  .amdhsa_accum_offset 256
  .amdhsa_group_segment_fixed_size 0
  .amdhsa_kernarg_size 104
  .amdhsa_user_sgpr_count 2
  .amdhsa_user_sgpr_kernarg_segment_ptr 1
  .amdhsa_system_sgpr_workgroup_id_x 1
.end_amdhsa_kernel
.text
.globl k5_down_kernel
.p2align 8
.type k5_down_kernel,@function
k5_down_kernel:
    s_cmp_ge_u32 s2, 256
    s_cbranch_scc1 L_k5_down_kernel_done_1
    s_load_dwordx2 s[28:29], s[0:1], 96
    s_load_dwordx2 s[30:31], s[0:1], 96
    s_load_dwordx2 s[32:33], s[0:1], 80
    v_lshrrev_b32 v8, 6, v0
    v_and_b32 v1, 63, v0
    v_readfirstlane_b32 s36, v8
    s_and_b32 s41, s2, 7
    s_lshr_b32 s34, s41, 0
    s_lshl_b32 s34, s34, 2
    s_and_b32 s35, s41, 0
    s_lshl_b32 s35, s35, 3
    s_lshr_b32 s41, s2, 3
    s_and_b32 s42, s41, 3
    s_add_u32 s34, s34, s42
    s_lshr_b32 s41, s41, 2
    s_add_u32 s35, s35, s41
    v_lshlrev_b32 v2, 4, v1
    v_add_u32 v3, 147456, v2
    v_add_u32 v4, 294912, v2
    v_add_u32 v5, 442368, v2
    v_mov_b32 v6, v2
    v_lshrrev_b32 v8, 4, v1
    v_and_b32 v9, 15, v1
    v_lshl_add_u32 v8, v8, 3, v9
    v_lshlrev_b32 v8, 4, v8
    v_add_u32 v8, 4096, v8
    v_cmp_gt_u32 vcc, 8, v9
    v_mov_b32 v10, 0x7f000000
    s_nop 0
    v_cndmask_b32 v7, v10, v8, vcc
    s_mul_i32 s39, s36, 21504
    s_waitcnt lgkmcnt(0)
    s_add_u32 s8, s28, 67108864
    s_addc_u32 s9, s29, 0
    s_mov_b32 s10, 18874368
    s_mov_b32 s11, 0x00020000
    s_add_u32 s12, s28, 94371840
    s_addc_u32 s13, s29, 0
    s_mov_b32 s14, 5308416
    s_mov_b32 s15, 0x00020000
    s_mul_i32 s37, s34, 576
    s_add_u32 s37, s37, s36
    s_lshl_b32 s37, s37, 10
    s_mul_i32 s38, s35, 144
    s_add_u32 s38, s38, s36
    s_mul_i32 s38, s38, 4608
    buffer_load_dwordx4 v[16:19], v2, s[8:11], s37 offen
    buffer_load_dwordx4 v[20:23], v3, s[8:11], s37 offen
    buffer_load_dwordx4 v[24:27], v4, s[8:11], s37 offen
    buffer_load_dwordx4 v[28:31], v5, s[8:11], s37 offen
    buffer_load_dwordx4 v[32:35], v6, s[12:15], s38 offen offset:0
    buffer_load_dwordx4 v[36:39], v6, s[12:15], s38 offen offset:1024
    buffer_load_dwordx4 v[40:43], v6, s[12:15], s38 offen offset:2048
    buffer_load_dwordx4 v[44:47], v6, s[12:15], s38 offen offset:3072
    buffer_load_dwordx4 v[48:51], v7, s[12:15], s38 offen
    s_add_u32 s37, s37, 4096
    s_add_u32 s38, s38, 18432
    buffer_load_dwordx4 v[52:55], v2, s[8:11], s37 offen
    buffer_load_dwordx4 v[56:59], v3, s[8:11], s37 offen
    buffer_load_dwordx4 v[60:63], v4, s[8:11], s37 offen
    buffer_load_dwordx4 v[64:67], v5, s[8:11], s37 offen
    buffer_load_dwordx4 v[68:71], v6, s[12:15], s38 offen offset:0
    buffer_load_dwordx4 v[72:75], v6, s[12:15], s38 offen offset:1024
    buffer_load_dwordx4 v[76:79], v6, s[12:15], s38 offen offset:2048
    buffer_load_dwordx4 v[80:83], v6, s[12:15], s38 offen offset:3072
    buffer_load_dwordx4 v[84:87], v7, s[12:15], s38 offen
    s_add_u32 s37, s37, 4096
    s_add_u32 s38, s38, 18432
    buffer_load_dwordx4 v[88:91], v2, s[8:11], s37 offen
    buffer_load_dwordx4 v[92:95], v3, s[8:11], s37 offen
    buffer_load_dwordx4 v[96:99], v4, s[8:11], s37 offen
    buffer_load_dwordx4 v[100:103], v5, s[8:11], s37 offen
    buffer_load_dwordx4 v[104:107], v6, s[12:15], s38 offen offset:0
    buffer_load_dwordx4 v[108:111], v6, s[12:15], s38 offen offset:1024
    buffer_load_dwordx4 v[112:115], v6, s[12:15], s38 offen offset:2048
    buffer_load_dwordx4 v[116:119], v6, s[12:15], s38 offen offset:3072
    buffer_load_dwordx4 v[120:123], v7, s[12:15], s38 offen
    s_add_u32 s37, s37, 4096
    s_add_u32 s38, s38, 18432
    s_mov_b32 s20, s32
    s_mov_b32 s21, s33
    s_mov_b32 s22, 2359296
    s_mov_b32 s23, 0x00020000
    s_add_u32 s24, s28, 8388608
    s_addc_u32 s25, s29, 0
    s_mov_b32 s26, 4325376
    s_mov_b32 s27, 0x00020000
    s_lshl_b32 s49, s34, 6
    s_mul_i32 s49, s49, 1152
    s_mul_i32 s50, s34, 73728
    s_lshl_b32 s42, s35, 3
    s_add_u32 s41, s35, 64
    v_add_u32 v8, 0, v0
    v_mul_u32_u24 v9, 1821, v8
    v_lshrrev_b32 v9, 14, v9
    v_mul_u32_u24 v10, 9, v9
    v_sub_u32 v10, v8, v10
    v_mul_u32_u24 v240, 336, v9
    v_lshl_add_u32 v240, v10, 5, v240
    v_cmp_eq_u32 vcc, 8, v10
    v_add_u32 v10, s42, v10
    v_mov_b32 v243, s41
    v_cndmask_b32 v10, v10, v243, vcc
    v_mul_u32_u24 v243, 1152, v9
    v_lshl_add_u32 v243, v10, 4, v243
    v_lshrrev_b32 v11, 4, v9
    v_mul_u32_u24 v11, 18432, v11
    v_lshl_add_u32 v11, v10, 8, v11
    v_and_b32 v9, 15, v9
    v_lshl_add_u32 v11, v9, 4, v11
    buffer_load_dwordx4 a[0:3], v11, s[24:27], s50 offen
    v_add_u32 v8, 256, v0
    v_mul_u32_u24 v9, 1821, v8
    v_lshrrev_b32 v9, 14, v9
    v_mul_u32_u24 v10, 9, v9
    v_sub_u32 v10, v8, v10
    v_mul_u32_u24 v241, 336, v9
    v_lshl_add_u32 v241, v10, 5, v241
    v_cmp_eq_u32 vcc, 8, v10
    v_add_u32 v10, s42, v10
    v_mov_b32 v244, s41
    v_cndmask_b32 v10, v10, v244, vcc
    v_mul_u32_u24 v244, 1152, v9
    v_lshl_add_u32 v244, v10, 4, v244
    v_lshrrev_b32 v11, 4, v9
    v_mul_u32_u24 v11, 18432, v11
    v_lshl_add_u32 v11, v10, 8, v11
    v_and_b32 v9, 15, v9
    v_lshl_add_u32 v11, v9, 4, v11
    buffer_load_dwordx4 a[4:7], v11, s[24:27], s50 offen
    v_add_u32 v8, 512, v0
    v_mul_u32_u24 v9, 1821, v8
    v_lshrrev_b32 v9, 14, v9
    v_mul_u32_u24 v10, 9, v9
    v_sub_u32 v10, v8, v10
    v_mul_u32_u24 v242, 336, v9
    v_lshl_add_u32 v242, v10, 5, v242
    v_cmp_eq_u32 vcc, 8, v10
    v_add_u32 v10, s42, v10
    v_mov_b32 v245, s41
    v_cndmask_b32 v10, v10, v245, vcc
    v_mul_u32_u24 v245, 1152, v9
    v_lshl_add_u32 v245, v10, 4, v245
    v_lshrrev_b32 v11, 4, v9
    v_mul_u32_u24 v11, 18432, v11
    v_lshl_add_u32 v11, v10, 8, v11
    v_and_b32 v9, 15, v9
    v_lshl_add_u32 v11, v9, 4, v11
    v_cmp_gt_u32 vcc, 576, v8
    v_mov_b32 v9, 0x7f000000
    s_nop 0
    v_cndmask_b32 v245, v9, v245, vcc
    v_cndmask_b32 v242, 0, v242, vcc
    v_cndmask_b32 v11, v9, v11, vcc
    buffer_load_dwordx4 a[8:11], v11, s[24:27], s50 offen
    v_and_b32 v8, 15, v1
    v_mul_u32_u24 v8, 336, v8
    v_lshrrev_b32 v9, 4, v1
    v_lshl_add_u32 v8, v9, 4, v8
    v_add_u32 v248, s39, v8
    v_mov_b32 v160, 0
    v_mov_b32 v161, 0
    v_mov_b32 v162, 0
    v_mov_b32 v163, 0
    v_mov_b32 v164, 0
    v_mov_b32 v165, 0
    v_mov_b32 v166, 0
    v_mov_b32 v167, 0
    v_mov_b32 v168, 0
    v_mov_b32 v169, 0
    v_mov_b32 v170, 0
    v_mov_b32 v171, 0
    v_mov_b32 v172, 0
    v_mov_b32 v173, 0
    v_mov_b32 v174, 0
    v_mov_b32 v175, 0
    v_mov_b32 v176, 0
    v_mov_b32 v177, 0
    v_mov_b32 v178, 0
    v_mov_b32 v179, 0
    v_mov_b32 v180, 0
    v_mov_b32 v181, 0
    v_mov_b32 v182, 0
    v_mov_b32 v183, 0
    v_mov_b32 v184, 0
    v_mov_b32 v185, 0
    v_mov_b32 v186, 0
    v_mov_b32 v187, 0
    v_mov_b32 v188, 0
    v_mov_b32 v189, 0
    v_mov_b32 v190, 0
    v_mov_b32 v191, 0
    v_mov_b32 v192, 0
    v_mov_b32 v193, 0
    v_mov_b32 v194, 0
    v_mov_b32 v195, 0
    v_mov_b32 v196, 0
    v_mov_b32 v197, 0
    v_mov_b32 v198, 0
    v_mov_b32 v199, 0
    v_mov_b32 v200, 0
    v_mov_b32 v201, 0
    v_mov_b32 v202, 0
    v_mov_b32 v203, 0
    v_mov_b32 v204, 0
    v_mov_b32 v205, 0
    v_mov_b32 v206, 0
    v_mov_b32 v207, 0
    v_mov_b32 v208, 0
    v_mov_b32 v209, 0
    v_mov_b32 v210, 0
    v_mov_b32 v211, 0
    v_mov_b32 v212, 0
    v_mov_b32 v213, 0
    v_mov_b32 v214, 0
    v_mov_b32 v215, 0
    v_mov_b32 v216, 0
    v_mov_b32 v217, 0
    v_mov_b32 v218, 0
    v_mov_b32 v219, 0
    v_mov_b32 v220, 0
    v_mov_b32 v221, 0
    v_mov_b32 v222, 0
    v_mov_b32 v223, 0
    v_mov_b32 v224, 0
    v_mov_b32 v225, 0
    v_mov_b32 v226, 0
    v_mov_b32 v227, 0
    v_mov_b32 v228, 0
    v_mov_b32 v229, 0
    v_mov_b32 v230, 0
    v_mov_b32 v231, 0
    v_mov_b32 v232, 0
    v_mov_b32 v233, 0
    v_mov_b32 v234, 0
    v_mov_b32 v235, 0
    v_mov_b32 v236, 0
    v_mov_b32 v237, 0
    v_mov_b32 v238, 0
    v_mov_b32 v239, 0
    s_mov_b32 s40, 8
L_k5_down_kernel_loop_2:
    buffer_load_dwordx4 v[124:127], v2, s[8:11], s37 offen
    buffer_load_dwordx4 v[128:131], v3, s[8:11], s37 offen
    buffer_load_dwordx4 v[132:135], v4, s[8:11], s37 offen
    buffer_load_dwordx4 v[136:139], v5, s[8:11], s37 offen
    buffer_load_dwordx4 v[140:143], v6, s[12:15], s38 offen offset:0
    buffer_load_dwordx4 v[144:147], v6, s[12:15], s38 offen offset:1024
    buffer_load_dwordx4 v[148:151], v6, s[12:15], s38 offen offset:2048
    buffer_load_dwordx4 v[152:155], v6, s[12:15], s38 offen offset:3072
    buffer_load_dwordx4 v[156:159], v7, s[12:15], s38 offen
    s_add_u32 s37, s37, 4096
    s_add_u32 s38, s38, 18432
    s_waitcnt vmcnt(27)
    v_mfma_f32_16x16x32_bf16 v[160:163], v[32:35], v[16:19], v[160:163]
    v_mfma_f32_16x16x32_bf16 v[164:167], v[32:35], v[20:23], v[164:167]
    v_mfma_f32_16x16x32_bf16 v[168:171], v[32:35], v[24:27], v[168:171]
    v_mfma_f32_16x16x32_bf16 v[172:175], v[32:35], v[28:31], v[172:175]
    v_mfma_f32_16x16x32_bf16 v[176:179], v[36:39], v[16:19], v[176:179]
    v_mfma_f32_16x16x32_bf16 v[180:183], v[36:39], v[20:23], v[180:183]
    v_mfma_f32_16x16x32_bf16 v[184:187], v[36:39], v[24:27], v[184:187]
    v_mfma_f32_16x16x32_bf16 v[188:191], v[36:39], v[28:31], v[188:191]
    v_mfma_f32_16x16x32_bf16 v[192:195], v[40:43], v[16:19], v[192:195]
    v_mfma_f32_16x16x32_bf16 v[196:199], v[40:43], v[20:23], v[196:199]
    v_mfma_f32_16x16x32_bf16 v[200:203], v[40:43], v[24:27], v[200:203]
    v_mfma_f32_16x16x32_bf16 v[204:207], v[40:43], v[28:31], v[204:207]
    v_mfma_f32_16x16x32_bf16 v[208:211], v[44:47], v[16:19], v[208:211]
    v_mfma_f32_16x16x32_bf16 v[212:215], v[44:47], v[20:23], v[212:215]
    v_mfma_f32_16x16x32_bf16 v[216:219], v[44:47], v[24:27], v[216:219]
    v_mfma_f32_16x16x32_bf16 v[220:223], v[44:47], v[28:31], v[220:223]
    v_mfma_f32_16x16x32_bf16 v[224:227], v[48:51], v[16:19], v[224:227]
    v_mfma_f32_16x16x32_bf16 v[228:231], v[48:51], v[20:23], v[228:231]
    v_mfma_f32_16x16x32_bf16 v[232:235], v[48:51], v[24:27], v[232:235]
    v_mfma_f32_16x16x32_bf16 v[236:239], v[48:51], v[28:31], v[236:239]
    buffer_load_dwordx4 v[16:19], v2, s[8:11], s37 offen
    buffer_load_dwordx4 v[20:23], v3, s[8:11], s37 offen
    buffer_load_dwordx4 v[24:27], v4, s[8:11], s37 offen
    buffer_load_dwordx4 v[28:31], v5, s[8:11], s37 offen
    buffer_load_dwordx4 v[32:35], v6, s[12:15], s38 offen offset:0
    buffer_load_dwordx4 v[36:39], v6, s[12:15], s38 offen offset:1024
    buffer_load_dwordx4 v[40:43], v6, s[12:15], s38 offen offset:2048
    buffer_load_dwordx4 v[44:47], v6, s[12:15], s38 offen offset:3072
    buffer_load_dwordx4 v[48:51], v7, s[12:15], s38 offen
    s_add_u32 s37, s37, 4096
    s_add_u32 s38, s38, 18432
    s_waitcnt vmcnt(27)
    v_mfma_f32_16x16x32_bf16 v[160:163], v[68:71], v[52:55], v[160:163]
    v_mfma_f32_16x16x32_bf16 v[164:167], v[68:71], v[56:59], v[164:167]
    v_mfma_f32_16x16x32_bf16 v[168:171], v[68:71], v[60:63], v[168:171]
    v_mfma_f32_16x16x32_bf16 v[172:175], v[68:71], v[64:67], v[172:175]
    v_mfma_f32_16x16x32_bf16 v[176:179], v[72:75], v[52:55], v[176:179]
    v_mfma_f32_16x16x32_bf16 v[180:183], v[72:75], v[56:59], v[180:183]
    v_mfma_f32_16x16x32_bf16 v[184:187], v[72:75], v[60:63], v[184:187]
    v_mfma_f32_16x16x32_bf16 v[188:191], v[72:75], v[64:67], v[188:191]
    v_mfma_f32_16x16x32_bf16 v[192:195], v[76:79], v[52:55], v[192:195]
    v_mfma_f32_16x16x32_bf16 v[196:199], v[76:79], v[56:59], v[196:199]
    v_mfma_f32_16x16x32_bf16 v[200:203], v[76:79], v[60:63], v[200:203]
    v_mfma_f32_16x16x32_bf16 v[204:207], v[76:79], v[64:67], v[204:207]
    v_mfma_f32_16x16x32_bf16 v[208:211], v[80:83], v[52:55], v[208:211]
    v_mfma_f32_16x16x32_bf16 v[212:215], v[80:83], v[56:59], v[212:215]
    v_mfma_f32_16x16x32_bf16 v[216:219], v[80:83], v[60:63], v[216:219]
    v_mfma_f32_16x16x32_bf16 v[220:223], v[80:83], v[64:67], v[220:223]
    v_mfma_f32_16x16x32_bf16 v[224:227], v[84:87], v[52:55], v[224:227]
    v_mfma_f32_16x16x32_bf16 v[228:231], v[84:87], v[56:59], v[228:231]
    v_mfma_f32_16x16x32_bf16 v[232:235], v[84:87], v[60:63], v[232:235]
    v_mfma_f32_16x16x32_bf16 v[236:239], v[84:87], v[64:67], v[236:239]
    buffer_load_dwordx4 v[52:55], v2, s[8:11], s37 offen
    buffer_load_dwordx4 v[56:59], v3, s[8:11], s37 offen
    buffer_load_dwordx4 v[60:63], v4, s[8:11], s37 offen
    buffer_load_dwordx4 v[64:67], v5, s[8:11], s37 offen
    buffer_load_dwordx4 v[68:71], v6, s[12:15], s38 offen offset:0
    buffer_load_dwordx4 v[72:75], v6, s[12:15], s38 offen offset:1024
    buffer_load_dwordx4 v[76:79], v6, s[12:15], s38 offen offset:2048
    buffer_load_dwordx4 v[80:83], v6, s[12:15], s38 offen offset:3072
    buffer_load_dwordx4 v[84:87], v7, s[12:15], s38 offen
    s_add_u32 s37, s37, 4096
    s_add_u32 s38, s38, 18432
    s_waitcnt vmcnt(27)
    v_mfma_f32_16x16x32_bf16 v[160:163], v[104:107], v[88:91], v[160:163]
    v_mfma_f32_16x16x32_bf16 v[164:167], v[104:107], v[92:95], v[164:167]
    v_mfma_f32_16x16x32_bf16 v[168:171], v[104:107], v[96:99], v[168:171]
    v_mfma_f32_16x16x32_bf16 v[172:175], v[104:107], v[100:103], v[172:175]
    v_mfma_f32_16x16x32_bf16 v[176:179], v[108:111], v[88:91], v[176:179]
    v_mfma_f32_16x16x32_bf16 v[180:183], v[108:111], v[92:95], v[180:183]
    v_mfma_f32_16x16x32_bf16 v[184:187], v[108:111], v[96:99], v[184:187]
    v_mfma_f32_16x16x32_bf16 v[188:191], v[108:111], v[100:103], v[188:191]
    v_mfma_f32_16x16x32_bf16 v[192:195], v[112:115], v[88:91], v[192:195]
    v_mfma_f32_16x16x32_bf16 v[196:199], v[112:115], v[92:95], v[196:199]
    v_mfma_f32_16x16x32_bf16 v[200:203], v[112:115], v[96:99], v[200:203]
    v_mfma_f32_16x16x32_bf16 v[204:207], v[112:115], v[100:103], v[204:207]
    v_mfma_f32_16x16x32_bf16 v[208:211], v[116:119], v[88:91], v[208:211]
    v_mfma_f32_16x16x32_bf16 v[212:215], v[116:119], v[92:95], v[212:215]
    v_mfma_f32_16x16x32_bf16 v[216:219], v[116:119], v[96:99], v[216:219]
    v_mfma_f32_16x16x32_bf16 v[220:223], v[116:119], v[100:103], v[220:223]
    v_mfma_f32_16x16x32_bf16 v[224:227], v[120:123], v[88:91], v[224:227]
    v_mfma_f32_16x16x32_bf16 v[228:231], v[120:123], v[92:95], v[228:231]
    v_mfma_f32_16x16x32_bf16 v[232:235], v[120:123], v[96:99], v[232:235]
    v_mfma_f32_16x16x32_bf16 v[236:239], v[120:123], v[100:103], v[236:239]
    buffer_load_dwordx4 v[88:91], v2, s[8:11], s37 offen
    buffer_load_dwordx4 v[92:95], v3, s[8:11], s37 offen
    buffer_load_dwordx4 v[96:99], v4, s[8:11], s37 offen
    buffer_load_dwordx4 v[100:103], v5, s[8:11], s37 offen
    buffer_load_dwordx4 v[104:107], v6, s[12:15], s38 offen offset:0
    buffer_load_dwordx4 v[108:111], v6, s[12:15], s38 offen offset:1024
    buffer_load_dwordx4 v[112:115], v6, s[12:15], s38 offen offset:2048
    buffer_load_dwordx4 v[116:119], v6, s[12:15], s38 offen offset:3072
    buffer_load_dwordx4 v[120:123], v7, s[12:15], s38 offen
    s_add_u32 s37, s37, 4096
    s_add_u32 s38, s38, 18432
    s_waitcnt vmcnt(27)
    v_mfma_f32_16x16x32_bf16 v[160:163], v[140:143], v[124:127], v[160:163]
    v_mfma_f32_16x16x32_bf16 v[164:167], v[140:143], v[128:131], v[164:167]
    v_mfma_f32_16x16x32_bf16 v[168:171], v[140:143], v[132:135], v[168:171]
    v_mfma_f32_16x16x32_bf16 v[172:175], v[140:143], v[136:139], v[172:175]
    v_mfma_f32_16x16x32_bf16 v[176:179], v[144:147], v[124:127], v[176:179]
    v_mfma_f32_16x16x32_bf16 v[180:183], v[144:147], v[128:131], v[180:183]
    v_mfma_f32_16x16x32_bf16 v[184:187], v[144:147], v[132:135], v[184:187]
    v_mfma_f32_16x16x32_bf16 v[188:191], v[144:147], v[136:139], v[188:191]
    v_mfma_f32_16x16x32_bf16 v[192:195], v[148:151], v[124:127], v[192:195]
    v_mfma_f32_16x16x32_bf16 v[196:199], v[148:151], v[128:131], v[196:199]
    v_mfma_f32_16x16x32_bf16 v[200:203], v[148:151], v[132:135], v[200:203]
    v_mfma_f32_16x16x32_bf16 v[204:207], v[148:151], v[136:139], v[204:207]
    v_mfma_f32_16x16x32_bf16 v[208:211], v[152:155], v[124:127], v[208:211]
    v_mfma_f32_16x16x32_bf16 v[212:215], v[152:155], v[128:131], v[212:215]
    v_mfma_f32_16x16x32_bf16 v[216:219], v[152:155], v[132:135], v[216:219]
    v_mfma_f32_16x16x32_bf16 v[220:223], v[152:155], v[136:139], v[220:223]
    v_mfma_f32_16x16x32_bf16 v[224:227], v[156:159], v[124:127], v[224:227]
    v_mfma_f32_16x16x32_bf16 v[228:231], v[156:159], v[128:131], v[228:231]
    v_mfma_f32_16x16x32_bf16 v[232:235], v[156:159], v[132:135], v[232:235]
    v_mfma_f32_16x16x32_bf16 v[236:239], v[156:159], v[136:139], v[236:239]
    s_sub_u32 s40, s40, 1
    s_cmp_lg_u32 s40, 0
    s_cbranch_scc1 L_k5_down_kernel_loop_2
    buffer_load_dwordx4 v[124:127], v2, s[8:11], s37 offen
    buffer_load_dwordx4 v[128:131], v3, s[8:11], s37 offen
    buffer_load_dwordx4 v[132:135], v4, s[8:11], s37 offen
    buffer_load_dwordx4 v[136:139], v5, s[8:11], s37 offen
    buffer_load_dwordx4 v[140:143], v6, s[12:15], s38 offen offset:0
    buffer_load_dwordx4 v[144:147], v6, s[12:15], s38 offen offset:1024
    buffer_load_dwordx4 v[148:151], v6, s[12:15], s38 offen offset:2048
    buffer_load_dwordx4 v[152:155], v6, s[12:15], s38 offen offset:3072
    buffer_load_dwordx4 v[156:159], v7, s[12:15], s38 offen
    s_add_u32 s37, s37, 4096
    s_add_u32 s38, s38, 18432
    s_waitcnt vmcnt(27)
    v_mfma_f32_16x16x32_bf16 v[160:163], v[32:35], v[16:19], v[160:163]
    v_mfma_f32_16x16x32_bf16 v[164:167], v[32:35], v[20:23], v[164:167]
    v_mfma_f32_16x16x32_bf16 v[168:171], v[32:35], v[24:27], v[168:171]
    v_mfma_f32_16x16x32_bf16 v[172:175], v[32:35], v[28:31], v[172:175]
    v_mfma_f32_16x16x32_bf16 v[176:179], v[36:39], v[16:19], v[176:179]
    v_mfma_f32_16x16x32_bf16 v[180:183], v[36:39], v[20:23], v[180:183]
    v_mfma_f32_16x16x32_bf16 v[184:187], v[36:39], v[24:27], v[184:187]
    v_mfma_f32_16x16x32_bf16 v[188:191], v[36:39], v[28:31], v[188:191]
    v_mfma_f32_16x16x32_bf16 v[192:195], v[40:43], v[16:19], v[192:195]
    v_mfma_f32_16x16x32_bf16 v[196:199], v[40:43], v[20:23], v[196:199]
    v_mfma_f32_16x16x32_bf16 v[200:203], v[40:43], v[24:27], v[200:203]
    v_mfma_f32_16x16x32_bf16 v[204:207], v[40:43], v[28:31], v[204:207]
    v_mfma_f32_16x16x32_bf16 v[208:211], v[44:47], v[16:19], v[208:211]
    v_mfma_f32_16x16x32_bf16 v[212:215], v[44:47], v[20:23], v[212:215]
    v_mfma_f32_16x16x32_bf16 v[216:219], v[44:47], v[24:27], v[216:219]
    v_mfma_f32_16x16x32_bf16 v[220:223], v[44:47], v[28:31], v[220:223]
    v_mfma_f32_16x16x32_bf16 v[224:227], v[48:51], v[16:19], v[224:227]
    v_mfma_f32_16x16x32_bf16 v[228:231], v[48:51], v[20:23], v[228:231]
    v_mfma_f32_16x16x32_bf16 v[232:235], v[48:51], v[24:27], v[232:235]
    v_mfma_f32_16x16x32_bf16 v[236:239], v[48:51], v[28:31], v[236:239]
    s_waitcnt vmcnt(18)
    v_mfma_f32_16x16x32_bf16 v[160:163], v[68:71], v[52:55], v[160:163]
    v_mfma_f32_16x16x32_bf16 v[164:167], v[68:71], v[56:59], v[164:167]
    v_mfma_f32_16x16x32_bf16 v[168:171], v[68:71], v[60:63], v[168:171]
    v_mfma_f32_16x16x32_bf16 v[172:175], v[68:71], v[64:67], v[172:175]
    v_mfma_f32_16x16x32_bf16 v[176:179], v[72:75], v[52:55], v[176:179]
    v_mfma_f32_16x16x32_bf16 v[180:183], v[72:75], v[56:59], v[180:183]
    v_mfma_f32_16x16x32_bf16 v[184:187], v[72:75], v[60:63], v[184:187]
    v_mfma_f32_16x16x32_bf16 v[188:191], v[72:75], v[64:67], v[188:191]
    v_mfma_f32_16x16x32_bf16 v[192:195], v[76:79], v[52:55], v[192:195]
    v_mfma_f32_16x16x32_bf16 v[196:199], v[76:79], v[56:59], v[196:199]
    v_mfma_f32_16x16x32_bf16 v[200:203], v[76:79], v[60:63], v[200:203]
    v_mfma_f32_16x16x32_bf16 v[204:207], v[76:79], v[64:67], v[204:207]
    v_mfma_f32_16x16x32_bf16 v[208:211], v[80:83], v[52:55], v[208:211]
    v_mfma_f32_16x16x32_bf16 v[212:215], v[80:83], v[56:59], v[212:215]
    v_mfma_f32_16x16x32_bf16 v[216:219], v[80:83], v[60:63], v[216:219]
    v_mfma_f32_16x16x32_bf16 v[220:223], v[80:83], v[64:67], v[220:223]
    v_mfma_f32_16x16x32_bf16 v[224:227], v[84:87], v[52:55], v[224:227]
    v_mfma_f32_16x16x32_bf16 v[228:231], v[84:87], v[56:59], v[228:231]
    v_mfma_f32_16x16x32_bf16 v[232:235], v[84:87], v[60:63], v[232:235]
    v_mfma_f32_16x16x32_bf16 v[236:239], v[84:87], v[64:67], v[236:239]
    s_waitcnt vmcnt(9)
    v_mfma_f32_16x16x32_bf16 v[160:163], v[104:107], v[88:91], v[160:163]
    v_mfma_f32_16x16x32_bf16 v[164:167], v[104:107], v[92:95], v[164:167]
    v_mfma_f32_16x16x32_bf16 v[168:171], v[104:107], v[96:99], v[168:171]
    v_mfma_f32_16x16x32_bf16 v[172:175], v[104:107], v[100:103], v[172:175]
    v_mfma_f32_16x16x32_bf16 v[176:179], v[108:111], v[88:91], v[176:179]
    v_mfma_f32_16x16x32_bf16 v[180:183], v[108:111], v[92:95], v[180:183]
    v_mfma_f32_16x16x32_bf16 v[184:187], v[108:111], v[96:99], v[184:187]
    v_mfma_f32_16x16x32_bf16 v[188:191], v[108:111], v[100:103], v[188:191]
    v_mfma_f32_16x16x32_bf16 v[192:195], v[112:115], v[88:91], v[192:195]
    v_mfma_f32_16x16x32_bf16 v[196:199], v[112:115], v[92:95], v[196:199]
    v_mfma_f32_16x16x32_bf16 v[200:203], v[112:115], v[96:99], v[200:203]
    v_mfma_f32_16x16x32_bf16 v[204:207], v[112:115], v[100:103], v[204:207]
    v_mfma_f32_16x16x32_bf16 v[208:211], v[116:119], v[88:91], v[208:211]
    v_mfma_f32_16x16x32_bf16 v[212:215], v[116:119], v[92:95], v[212:215]
    v_mfma_f32_16x16x32_bf16 v[216:219], v[116:119], v[96:99], v[216:219]
    v_mfma_f32_16x16x32_bf16 v[220:223], v[116:119], v[100:103], v[220:223]
    v_mfma_f32_16x16x32_bf16 v[224:227], v[120:123], v[88:91], v[224:227]
    v_mfma_f32_16x16x32_bf16 v[228:231], v[120:123], v[92:95], v[228:231]
    v_mfma_f32_16x16x32_bf16 v[232:235], v[120:123], v[96:99], v[232:235]
    v_mfma_f32_16x16x32_bf16 v[236:239], v[120:123], v[100:103], v[236:239]
    s_waitcnt vmcnt(0)
    v_mfma_f32_16x16x32_bf16 v[160:163], v[140:143], v[124:127], v[160:163]
    v_mfma_f32_16x16x32_bf16 v[164:167], v[140:143], v[128:131], v[164:167]
    v_mfma_f32_16x16x32_bf16 v[168:171], v[140:143], v[132:135], v[168:171]
    v_mfma_f32_16x16x32_bf16 v[172:175], v[140:143], v[136:139], v[172:175]
    v_mfma_f32_16x16x32_bf16 v[176:179], v[144:147], v[124:127], v[176:179]
    v_mfma_f32_16x16x32_bf16 v[180:183], v[144:147], v[128:131], v[180:183]
    v_mfma_f32_16x16x32_bf16 v[184:187], v[144:147], v[132:135], v[184:187]
    v_mfma_f32_16x16x32_bf16 v[188:191], v[144:147], v[136:139], v[188:191]
    v_mfma_f32_16x16x32_bf16 v[192:195], v[148:151], v[124:127], v[192:195]
    v_mfma_f32_16x16x32_bf16 v[196:199], v[148:151], v[128:131], v[196:199]
    v_mfma_f32_16x16x32_bf16 v[200:203], v[148:151], v[132:135], v[200:203]
    v_mfma_f32_16x16x32_bf16 v[204:207], v[148:151], v[136:139], v[204:207]
    v_mfma_f32_16x16x32_bf16 v[208:211], v[152:155], v[124:127], v[208:211]
    v_mfma_f32_16x16x32_bf16 v[212:215], v[152:155], v[128:131], v[212:215]
    v_mfma_f32_16x16x32_bf16 v[216:219], v[152:155], v[132:135], v[216:219]
    v_mfma_f32_16x16x32_bf16 v[220:223], v[152:155], v[136:139], v[220:223]
    v_mfma_f32_16x16x32_bf16 v[224:227], v[156:159], v[124:127], v[224:227]
    v_mfma_f32_16x16x32_bf16 v[228:231], v[156:159], v[128:131], v[228:231]
    v_mfma_f32_16x16x32_bf16 v[232:235], v[156:159], v[132:135], v[232:235]
    v_mfma_f32_16x16x32_bf16 v[236:239], v[156:159], v[136:139], v[236:239]
    ds_write_b128 v248, v[160:163] offset:0
    ds_write_b128 v248, v[164:167] offset:5376
    ds_write_b128 v248, v[168:171] offset:10752
    ds_write_b128 v248, v[172:175] offset:16128
    ds_write_b128 v248, v[176:179] offset:64
    ds_write_b128 v248, v[180:183] offset:5440
    ds_write_b128 v248, v[184:187] offset:10816
    ds_write_b128 v248, v[188:191] offset:16192
    ds_write_b128 v248, v[192:195] offset:128
    ds_write_b128 v248, v[196:199] offset:5504
    ds_write_b128 v248, v[200:203] offset:10880
    ds_write_b128 v248, v[204:207] offset:16256
    ds_write_b128 v248, v[208:211] offset:192
    ds_write_b128 v248, v[212:215] offset:5568
    ds_write_b128 v248, v[216:219] offset:10944
    ds_write_b128 v248, v[220:223] offset:16320
    ds_write_b128 v248, v[224:227] offset:256
    ds_write_b128 v248, v[228:231] offset:5632
    ds_write_b128 v248, v[232:235] offset:11008
    ds_write_b128 v248, v[236:239] offset:16384
    s_waitcnt lgkmcnt(0)
    s_barrier
    ds_read_b128 v[36:39], v240 offset:0
    ds_read_b128 v[40:43], v240 offset:16
    ds_read_b128 v[44:47], v240 offset:21504
    ds_read_b128 v[48:51], v240 offset:21520
    ds_read_b128 v[52:55], v240 offset:43008
    ds_read_b128 v[56:59], v240 offset:43024
    ds_read_b128 v[60:63], v240 offset:64512
    ds_read_b128 v[64:67], v240 offset:64528
    ds_read_b128 v[76:79], v241 offset:0
    ds_read_b128 v[80:83], v241 offset:16
    ds_read_b128 v[84:87], v241 offset:21504
    ds_read_b128 v[88:91], v241 offset:21520
    ds_read_b128 v[92:95], v241 offset:43008
    ds_read_b128 v[96:99], v241 offset:43024
    ds_read_b128 v[100:103], v241 offset:64512
    ds_read_b128 v[104:107], v241 offset:64528
    ds_read_b128 v[116:119], v242 offset:0
    ds_read_b128 v[120:123], v242 offset:16
    ds_read_b128 v[124:127], v242 offset:21504
    ds_read_b128 v[128:131], v242 offset:21520
    ds_read_b128 v[132:135], v242 offset:43008
    ds_read_b128 v[136:139], v242 offset:43024
    ds_read_b128 v[140:143], v242 offset:64512
    ds_read_b128 v[144:147], v242 offset:64528
    v_accvgpr_read_b32 v68, a0
    v_accvgpr_read_b32 v69, a1
    v_accvgpr_read_b32 v70, a2
    v_accvgpr_read_b32 v71, a3
    s_waitcnt lgkmcnt(15)
    v_add_f32 v36, v36, v44
    v_add_f32 v52, v52, v60
    v_add_f32 v37, v37, v45
    v_add_f32 v53, v53, v61
    v_add_f32 v38, v38, v46
    v_add_f32 v54, v54, v62
    v_add_f32 v39, v39, v47
    v_add_f32 v55, v55, v63
    v_add_f32 v40, v40, v48
    v_add_f32 v56, v56, v64
    v_add_f32 v41, v41, v49
    v_add_f32 v57, v57, v65
    v_add_f32 v42, v42, v50
    v_add_f32 v58, v58, v66
    v_add_f32 v43, v43, v51
    v_add_f32 v59, v59, v67
    v_add_f32 v36, v36, v52
    v_add_f32 v37, v37, v53
    v_add_f32 v38, v38, v54
    v_add_f32 v39, v39, v55
    v_add_f32 v40, v40, v56
    v_add_f32 v41, v41, v57
    v_add_f32 v42, v42, v58
    v_add_f32 v43, v43, v59
    v_cvt_pk_bf16_f32 v44, v36, v37
    v_cvt_pk_bf16_f32 v45, v38, v39
    v_cvt_pk_bf16_f32 v46, v40, v41
    v_cvt_pk_bf16_f32 v47, v42, v43
    v_lshlrev_b32 v36, 16, v44
    v_and_b32 v37, 0xffff0000, v44
    v_lshlrev_b32 v52, 16, v68
    v_and_b32 v53, 0xffff0000, v68
    v_lshlrev_b32 v38, 16, v45
    v_and_b32 v39, 0xffff0000, v45
    v_lshlrev_b32 v54, 16, v69
    v_and_b32 v55, 0xffff0000, v69
    v_lshlrev_b32 v40, 16, v46
    v_and_b32 v41, 0xffff0000, v46
    v_lshlrev_b32 v56, 16, v70
    v_and_b32 v57, 0xffff0000, v70
    v_lshlrev_b32 v42, 16, v47
    v_and_b32 v43, 0xffff0000, v47
    v_lshlrev_b32 v58, 16, v71
    v_and_b32 v59, 0xffff0000, v71
    v_add_f32 v36, v36, v52
    v_add_f32 v37, v37, v53
    v_add_f32 v38, v38, v54
    v_add_f32 v39, v39, v55
    v_add_f32 v40, v40, v56
    v_add_f32 v41, v41, v57
    v_add_f32 v42, v42, v58
    v_add_f32 v43, v43, v59
    v_cvt_pk_bf16_f32 v44, v36, v37
    v_cvt_pk_bf16_f32 v45, v38, v39
    v_cvt_pk_bf16_f32 v46, v40, v41
    v_cvt_pk_bf16_f32 v47, v42, v43
    buffer_store_dwordx4 v[44:47], v243, s[20:23], s49 offen
    v_accvgpr_read_b32 v108, a4
    v_accvgpr_read_b32 v109, a5
    v_accvgpr_read_b32 v110, a6
    v_accvgpr_read_b32 v111, a7
    s_waitcnt lgkmcnt(8)
    v_add_f32 v76, v76, v84
    v_add_f32 v92, v92, v100
    v_add_f32 v77, v77, v85
    v_add_f32 v93, v93, v101
    v_add_f32 v78, v78, v86
    v_add_f32 v94, v94, v102
    v_add_f32 v79, v79, v87
    v_add_f32 v95, v95, v103
    v_add_f32 v80, v80, v88
    v_add_f32 v96, v96, v104
    v_add_f32 v81, v81, v89
    v_add_f32 v97, v97, v105
    v_add_f32 v82, v82, v90
    v_add_f32 v98, v98, v106
    v_add_f32 v83, v83, v91
    v_add_f32 v99, v99, v107
    v_add_f32 v76, v76, v92
    v_add_f32 v77, v77, v93
    v_add_f32 v78, v78, v94
    v_add_f32 v79, v79, v95
    v_add_f32 v80, v80, v96
    v_add_f32 v81, v81, v97
    v_add_f32 v82, v82, v98
    v_add_f32 v83, v83, v99
    v_cvt_pk_bf16_f32 v84, v76, v77
    v_cvt_pk_bf16_f32 v85, v78, v79
    v_cvt_pk_bf16_f32 v86, v80, v81
    v_cvt_pk_bf16_f32 v87, v82, v83
    v_lshlrev_b32 v76, 16, v84
    v_and_b32 v77, 0xffff0000, v84
    v_lshlrev_b32 v92, 16, v108
    v_and_b32 v93, 0xffff0000, v108
    v_lshlrev_b32 v78, 16, v85
    v_and_b32 v79, 0xffff0000, v85
    v_lshlrev_b32 v94, 16, v109
    v_and_b32 v95, 0xffff0000, v109
    v_lshlrev_b32 v80, 16, v86
    v_and_b32 v81, 0xffff0000, v86
    v_lshlrev_b32 v96, 16, v110
    v_and_b32 v97, 0xffff0000, v110
    v_lshlrev_b32 v82, 16, v87
    v_and_b32 v83, 0xffff0000, v87
    v_lshlrev_b32 v98, 16, v111
    v_and_b32 v99, 0xffff0000, v111
    v_add_f32 v76, v76, v92
    v_add_f32 v77, v77, v93
    v_add_f32 v78, v78, v94
    v_add_f32 v79, v79, v95
    v_add_f32 v80, v80, v96
    v_add_f32 v81, v81, v97
    v_add_f32 v82, v82, v98
    v_add_f32 v83, v83, v99
    v_cvt_pk_bf16_f32 v84, v76, v77
    v_cvt_pk_bf16_f32 v85, v78, v79
    v_cvt_pk_bf16_f32 v86, v80, v81
    v_cvt_pk_bf16_f32 v87, v82, v83
    buffer_store_dwordx4 v[84:87], v244, s[20:23], s49 offen
    v_accvgpr_read_b32 v148, a8
    v_accvgpr_read_b32 v149, a9
    v_accvgpr_read_b32 v150, a10
    v_accvgpr_read_b32 v151, a11
    s_waitcnt lgkmcnt(0)
    v_add_f32 v116, v116, v124
    v_add_f32 v132, v132, v140
    v_add_f32 v117, v117, v125
    v_add_f32 v133, v133, v141
    v_add_f32 v118, v118, v126
    v_add_f32 v134, v134, v142
    v_add_f32 v119, v119, v127
    v_add_f32 v135, v135, v143
    v_add_f32 v120, v120, v128
    v_add_f32 v136, v136, v144
    v_add_f32 v121, v121, v129
    v_add_f32 v137, v137, v145
    v_add_f32 v122, v122, v130
    v_add_f32 v138, v138, v146
    v_add_f32 v123, v123, v131
    v_add_f32 v139, v139, v147
    v_add_f32 v116, v116, v132
    v_add_f32 v117, v117, v133
    v_add_f32 v118, v118, v134
    v_add_f32 v119, v119, v135
    v_add_f32 v120, v120, v136
    v_add_f32 v121, v121, v137
    v_add_f32 v122, v122, v138
    v_add_f32 v123, v123, v139
    v_cvt_pk_bf16_f32 v124, v116, v117
    v_cvt_pk_bf16_f32 v125, v118, v119
    v_cvt_pk_bf16_f32 v126, v120, v121
    v_cvt_pk_bf16_f32 v127, v122, v123
    v_lshlrev_b32 v116, 16, v124
    v_and_b32 v117, 0xffff0000, v124
    v_lshlrev_b32 v132, 16, v148
    v_and_b32 v133, 0xffff0000, v148
    v_lshlrev_b32 v118, 16, v125
    v_and_b32 v119, 0xffff0000, v125
    v_lshlrev_b32 v134, 16, v149
    v_and_b32 v135, 0xffff0000, v149
    v_lshlrev_b32 v120, 16, v126
    v_and_b32 v121, 0xffff0000, v126
    v_lshlrev_b32 v136, 16, v150
    v_and_b32 v137, 0xffff0000, v150
    v_lshlrev_b32 v122, 16, v127
    v_and_b32 v123, 0xffff0000, v127
    v_lshlrev_b32 v138, 16, v151
    v_and_b32 v139, 0xffff0000, v151
    v_add_f32 v116, v116, v132
    v_add_f32 v117, v117, v133
    v_add_f32 v118, v118, v134
    v_add_f32 v119, v119, v135
    v_add_f32 v120, v120, v136
    v_add_f32 v121, v121, v137
    v_add_f32 v122, v122, v138
    v_add_f32 v123, v123, v139
    v_cvt_pk_bf16_f32 v124, v116, v117
    v_cvt_pk_bf16_f32 v125, v118, v119
    v_cvt_pk_bf16_f32 v126, v120, v121
    v_cvt_pk_bf16_f32 v127, v122, v123
    buffer_store_dwordx4 v[124:127], v245, s[20:23], s49 offen
L_k5_down_kernel_done_1:
    s_endpgm

.section .rodata,"a"
.p2align 6
.amdhsa_kernel k5_down_kernel
  .amdhsa_next_free_vgpr 284
  .amdhsa_next_free_sgpr 102
  .amdhsa_accum_offset 252
  .amdhsa_group_segment_fixed_size 0
  .amdhsa_kernarg_size 104
  .amdhsa_user_sgpr_count 2
  .amdhsa_user_sgpr_kernarg_segment_ptr 1
  .amdhsa_system_sgpr_workgroup_id_x 1
.end_amdhsa_kernel
```
